```python
import torch

def _softmax(x, axis=-1):
    return torch.softmax(x, dim=axis)

def _gelu(x):
    return torch.nn.functional.gelu(x, approximate='tanh')

def _silu(x):
    return torch.nn.functional.silu(x)

def _sigmoid(x):
    return torch.sigmoid(x)

def _layernorm(x, axis=-1, eps=1e-05):
    m = x.mean(dim=axis, keepdim=True)
    v = x.var(dim=axis, keepdim=True, unbiased=False)
    return (x - m) / torch.sqrt(v + eps)

def _scatter_add(tgt, idx, src, axis=0):
    return tgt.clone().index_add_(axis, idx, src)

def _segment_sum(src, seg, n):
    out = torch.zeros((n,) + src.shape[1:], dtype=src.dtype)
    return out.index_add_(0, seg, src)

def _pad(x, pw):
    flat = tuple((v for pair in reversed(pw) for v in pair))
    return torch.nn.functional.pad(x, flat)
kernel_name = 'recurrent_scan__mha_block__mixer_gmlp__prompt'

def setup_inputs():

    _w = lambda a: (lambda t: t.to(torch.bfloat16) if t.is_floating_point() else t)(torch.as_tensor(a))

    def _A_setup():
        B, S, D, H = (1, 2048, 1024, 32)
        return {'x': _w((lambda *s: torch.randn(*s, dtype=torch.bfloat16) * 0.05)(B, S, D)), 'wqkv': _w((lambda *s: torch.randn(*s, dtype=torch.bfloat16) * 0.05)(D, 3 * D)), 'wo': _w((lambda *s: torch.randn(*s, dtype=torch.bfloat16) * 0.05)(D, D))}
    _A_in = _A_setup()

    def _B_setup():
        B, S, D, F = (1, 2048, 1024, 3584)
        Fh = F // 2
        return {'x': _w((lambda *s: torch.randn(*s, dtype=torch.bfloat16) * 0.05)(B, S, D)), 'w_in': _w((lambda *s: torch.randn(*s, dtype=torch.bfloat16) * 0.8)(D, 2 * Fh)), 'w_sp': _w(0.01 * (lambda *s: torch.randn(*s, dtype=torch.bfloat16) * 0.8)(S, S)), 'b_sp': _w(1.0 + 0.01 * (lambda *s: torch.randn(*s, dtype=torch.bfloat16) * 0.05)(S)), 'w_out': _w((lambda *s: torch.randn(*s, dtype=torch.bfloat16) * 0.05)(Fh, D))}
    _B_in = _B_setup()
    return {'A_x': _A_in['x'], 'A_wqkv': _A_in['wqkv'], 'A_wo': _A_in['wo'], 'B_x': _B_in['x'], 'B_w_in': _B_in['w_in'], 'B_w_sp': _B_in['w_sp'], 'B_b_sp': _B_in['b_sp'], 'B_w_out': _B_in['w_out']}

def reference(A_x, A_wqkv, A_wo, B_x, B_w_in, B_w_sp, B_b_sp, B_w_out):

    def _A_ref(x, wqkv, wo):
        B, S, D = x.shape
        H = 32
        Dh = D // H
        qkv = (lambda x, *d: x.permute(*d))((x @ wqkv).reshape(B, S, 3, H, Dh), 2, 0, 3, 1, 4)
        q, k, v = (qkv[0], qkv[1], qkv[2])
        scores = torch.einsum('bhqd,bhkd->bhqk', q, k) * Dh ** (-0.5)
        p = _softmax(scores, axis=-1)
        o = torch.einsum('bhqk,bhkd->bhqd', p, v)
        return (lambda x, *d: x.permute(*d))(o, 0, 2, 1, 3).reshape(B, S, D) @ wo

    def _B_ref(x, w_in, w_sp, b_sp, w_out):
        B, S, D = x.shape
        F = w_in.shape[-1]
        Fh = F // 2
        z = _gelu(torch.einsum('bsd,df->bsf', x, w_in))
        z1 = z[..., :Fh].clone()
        z2 = _layernorm(z[..., Fh:], axis=-1)
        g = torch.einsum('ts,bsf->btf', w_sp, z2) + b_sp[None, :, None]
        return torch.einsum('bsf,fd->bsd', z1 * g, w_out)
    x = A_x
    xn = _layernorm(x, axis=-1)
    s = _A_ref(xn, A_wqkv, A_wo)
    g = _silu(_B_ref(xn, B_w_in, B_w_sp, B_b_sp, B_w_out))
    return x + s * g
```

```asm
; @launch grid=(256,1,1) block=(512,1,1) lds=161856
.amdgcn_target "amdgcn-amd-amdhsa--gfx950"
.text
.globl recurrent_scan__mha_block__mixer_gmlp__prompt_kernel
.p2align 8
.type recurrent_scan__mha_block__mixer_gmlp__prompt_kernel,@function
recurrent_scan__mha_block__mixer_gmlp__prompt_kernel:
    s_cmp_ge_u32 s2, 256
    s_cbranch_scc1 L_end
    s_load_dwordx16 s[48:63], s[0:1], 0
    s_load_dwordx4 s[44:47], s[0:1], 64
    s_load_dwordx2 s[4:5], s[0:1], 80
    v_lshrrev_b32 v1, 6, v0
    v_and_b32 v250, 63, v0
    v_readfirstlane_b32 s20, v1
    s_and_b32 s23, s2, 7
    s_lshr_b32 s36, s2, 3
    s_and_b32 s22, s36, 7
    s_lshr_b32 s24, s36, 3
    s_lshl_b32 s25, s23, 2
    s_add_u32 s25, s25, s24
    s_and_b32 s21, s20, 3
    s_and_b32 s37, s21, 1
    s_lshr_b32 s38, s21, 1
    s_lshr_b32 s100, s23, 1
    s_lshl_b32 s100, s100, 2
    s_and_b32 s3, s36, 3
    s_add_u32 s100, s100, s3
    s_and_b32 s101, s23, 1
    s_lshl_b32 s101, s101, 3
    s_lshr_b32 s3, s36, 2
    s_add_u32 s101, s101, s3
    v_lshlrev_b32 v245, 4, v250
    s_lshl_b32 s3, s20, 8
    s_add_u32 s3, s3, 159744
    v_lshlrev_b32 v246, 2, v250
    v_and_b32 v247, 3, v250
    v_lshlrev_b32 v247, 8, v247
    v_add_u32 v247, v247, v246
    v_add_u32 v246, s3, v246
    s_and_b32 s3, s20, 4
    s_lshl_b32 s3, s3, 8
    s_add_u32 s3, s3, 159744
    v_add_u32 v247, s3, v247
    v_mov_b32 v248, 0
    ds_write_b32 v246, v248
    v_mov_b32 v1, 161796
    ds_write_b32 v1, v248
    v_mov_b32 v248, 1
    s_mov_b32 s88, 0
    s_mov_b32 s89, 0xffff0000
    s_waitcnt lgkmcnt(0)
    s_barrier
    s_add_u32 s32, s4, 0x3800000
    s_addc_u32 s33, s5, 0
    s_mov_b32 s34, 0x28000
    s_mov_b32 s35, 0x00020000
    s_lshl_b32 s3, s2, 3
    s_add_u32 s3, s3, s20
    s_cmp_lg_u32 s3, 4
    s_cbranch_scc1 non_1
    s_mov_b32 s16, s46
    s_mov_b32 s17, s47
    s_mov_b32 s18, 0x100
    s_mov_b32 s19, 0x00020000
    s_memrealtime s[6:7]
    s_waitcnt lgkmcnt(0)
    s_or_b32 s3, s6, 1
    v_mov_b32 v1, s3
    v_mov_b32 v2, 0
    s_mov_b64 exec, 1
    buffer_store_dword v1, v2, s[16:19], 0 offen sc1
    s_mov_b64 exec, -1
non_1:
    s_cmp_ge_u32 s20, 4
    s_cbranch_scc1 L_roleB
    s_mov_b32 s8, s48
    s_mov_b32 s9, s49
    s_mov_b32 s10, 0x400000
    s_mov_b32 s11, 0x00020000
    s_mov_b32 s26, 0
    s_mov_b32 s27, 65536
    s_lshl_b32 s28, s21, 13
    s_add_u32 s30, s28, 4096
    s_mov_b32 s94, 0
    v_lshrrev_b32 v1, 3, v250
    s_lshl_b32 s3, s22, 8
    s_lshl_b32 s6, s21, 6
    s_add_u32 s3, s3, s6
    v_add_u32 v1, s3, v1
    v_lshlrev_b32 v1, 11, v1
    v_lshrrev_b32 v2, 4, v250
    v_and_b32 v3, 7, v250
    v_xor_b32 v4, v2, v3
    v_xor_b32 v5, 4, v4
    v_lshl_add_u32 v4, v4, 4, v1
    v_lshl_add_u32 v5, v5, 4, v1
    v_mov_b32 v186, v4
    v_add_u32 v187, 15360, v5
    v_add_u32 v188, 30720, v4
    v_add_u32 v189, 46080, v5
    v_and_b32 v1, 15, v250
    v_lshrrev_b32 v3, 1, v1
    v_xor_b32 v4, v3, v2
    v_add_u32 v1, s6, v1
    v_lshlrev_b32 v1, 7, v1
    v_lshl_add_u32 v176, v4, 4, v1
    v_xor_b32 v177, 64, v176
    v_bfe_u32 v1, v250, 2, 2
    v_bfe_u32 v3, v250, 4, 1
    v_lshl_add_u32 v1, v3, 2, v1
    v_lshrrev_b32 v4, 5, v250
    v_lshl_add_u32 v1, v4, 4, v1
    v_mul_u32_u24 v1, 192, v1
    v_and_b32 v4, 3, v250
    v_lshl_add_u32 v1, v4, 3, v1
    v_lshlrev_b32 v3, 5, v3
    v_add_u32 v180, v1, v3
    v_sub_u32 v181, v1, v3
    s_add_u32 m0, s94, s28
    s_nop 0
    buffer_load_dwordx4 v186, s[8:11], s26 offen offset:0 lds
    buffer_load_dwordx4 v187, s[8:11], s26 offen offset:1024 lds
    buffer_load_dwordx4 v188, s[8:11], s26 offen offset:2048 lds
    buffer_load_dwordx4 v189, s[8:11], s26 offen offset:3072 lds
    s_add_u32 s26, s26, 128
    s_add_u32 m0, s94, s30
    s_nop 0
    buffer_load_dwordx4 v186, s[8:11], s27 offen offset:0 lds
    buffer_load_dwordx4 v187, s[8:11], s27 offen offset:1024 lds
    buffer_load_dwordx4 v188, s[8:11], s27 offen offset:2048 lds
    buffer_load_dwordx4 v189, s[8:11], s27 offen offset:3072 lds
    s_add_u32 s27, s27, 128
    s_add_u32 s94, s94, 32768
    s_cmp_eq_u32 s94, 98304
    s_cmov_b32 s94, 0
    s_mov_b32 s8, s48
    s_mov_b32 s9, s49
    s_mov_b32 s10, 0x400000
    s_mov_b32 s11, 0x00020000
    s_mov_b32 s16, s46
    s_mov_b32 s17, s47
    s_mov_b32 s18, 0x100
    s_mov_b32 s19, 0x00020000
    s_lshl_b32 s3, s22, 8
    s_lshl_b32 s6, s25, 3
    s_add_u32 s3, s3, s6
    s_lshl_b32 s6, s21, 1
    s_add_u32 s39, s3, s6
    s_lshl_b32 s3, s39, 11
    v_mov_b32 v242, 0
    buffer_load_dwordx4 v[8:11], v245, s[8:11], s3 offen offset:0
    buffer_load_dwordx4 v[12:15], v245, s[8:11], s3 offen offset:1024
    buffer_load_dwordx4 v[48:51], v245, s[8:11], s3 offen offset:2048
    buffer_load_dwordx4 v[52:55], v245, s[8:11], s3 offen offset:3072
    buffer_load_dword v243, v242, s[16:19], 0 offen sc1
    s_add_u32 m0, s94, s28
    s_nop 0
    buffer_load_dwordx4 v186, s[8:11], s26 offen offset:0 lds
    buffer_load_dwordx4 v187, s[8:11], s26 offen offset:1024 lds
    buffer_load_dwordx4 v188, s[8:11], s26 offen offset:2048 lds
    buffer_load_dwordx4 v189, s[8:11], s26 offen offset:3072 lds
    s_add_u32 s26, s26, 128
    s_add_u32 m0, s94, s30
    s_nop 0
    buffer_load_dwordx4 v186, s[8:11], s27 offen offset:0 lds
    buffer_load_dwordx4 v187, s[8:11], s27 offen offset:1024 lds
    buffer_load_dwordx4 v188, s[8:11], s27 offen offset:2048 lds
    buffer_load_dwordx4 v189, s[8:11], s27 offen offset:3072 lds
    s_add_u32 s27, s27, 128
    s_add_u32 s94, s94, 32768
    s_cmp_eq_u32 s94, 98304
    s_cmov_b32 s94, 0
    s_add_u32 m0, s94, s28
    s_nop 0
    buffer_load_dwordx4 v186, s[8:11], s26 offen offset:0 lds
    buffer_load_dwordx4 v187, s[8:11], s26 offen offset:1024 lds
    buffer_load_dwordx4 v188, s[8:11], s26 offen offset:2048 lds
    buffer_load_dwordx4 v189, s[8:11], s26 offen offset:3072 lds
    s_add_u32 s26, s26, 128
    s_waitcnt vmcnt(12)
    v_lshlrev_b32 v16, 16, v8
    v_lshlrev_b32 v56, 16, v48
    v_and_b32 v17, s89, v8
    v_and_b32 v57, s89, v48
    v_lshlrev_b32 v18, 16, v9
    v_lshlrev_b32 v58, 16, v49
    v_and_b32 v19, s89, v9
    v_and_b32 v59, s89, v49
    v_lshlrev_b32 v20, 16, v10
    v_lshlrev_b32 v60, 16, v50
    v_and_b32 v21, s89, v10
    v_and_b32 v61, s89, v50
    v_lshlrev_b32 v22, 16, v11
    v_lshlrev_b32 v62, 16, v51
    v_and_b32 v23, s89, v11
    v_and_b32 v63, s89, v51
    v_lshlrev_b32 v24, 16, v12
    v_lshlrev_b32 v64, 16, v52
    v_and_b32 v25, s89, v12
    v_and_b32 v65, s89, v52
    v_lshlrev_b32 v26, 16, v13
    v_lshlrev_b32 v66, 16, v53
    v_and_b32 v27, s89, v13
    v_and_b32 v67, s89, v53
    v_lshlrev_b32 v28, 16, v14
    v_lshlrev_b32 v68, 16, v54
    v_and_b32 v29, s89, v14
    v_and_b32 v69, s89, v54
    v_lshlrev_b32 v30, 16, v15
    v_lshlrev_b32 v70, 16, v55
    v_and_b32 v31, s89, v15
    v_and_b32 v71, s89, v55
    v_add_f32 v32, v16, v17
    v_add_f32 v72, v56, v57
    v_add_f32 v33, v18, v19
    v_add_f32 v73, v58, v59
    v_add_f32 v34, v20, v21
    v_add_f32 v74, v60, v61
    v_add_f32 v35, v22, v23
    v_add_f32 v75, v62, v63
    v_add_f32 v36, v24, v25
    v_add_f32 v76, v64, v65
    v_add_f32 v37, v26, v27
    v_add_f32 v77, v66, v67
    v_add_f32 v38, v28, v29
    v_add_f32 v78, v68, v69
    v_add_f32 v39, v30, v31
    v_add_f32 v79, v70, v71
    v_add_f32 v32, v32, v36
    v_add_f32 v72, v72, v76
    v_add_f32 v33, v33, v37
    v_add_f32 v73, v73, v77
    v_add_f32 v34, v34, v38
    v_add_f32 v74, v74, v78
    v_add_f32 v35, v35, v39
    v_add_f32 v75, v75, v79
    v_add_f32 v32, v32, v34
    v_add_f32 v72, v72, v74
    v_add_f32 v33, v33, v35
    v_add_f32 v73, v73, v75
    v_add_f32 v32, v32, v33
    v_add_f32 v72, v72, v73
    s_nop 0
    v_add_f32_dpp v32, v32, v32 quad_perm:[1,0,3,2] row_mask:0xf bank_mask:0xf
    v_add_f32_dpp v72, v72, v72 quad_perm:[1,0,3,2] row_mask:0xf bank_mask:0xf
    s_nop 0
    v_add_f32_dpp v32, v32, v32 quad_perm:[2,3,0,1] row_mask:0xf bank_mask:0xf
    v_add_f32_dpp v72, v72, v72 quad_perm:[2,3,0,1] row_mask:0xf bank_mask:0xf
    s_nop 0
    v_add_f32_dpp v32, v32, v32 row_half_mirror row_mask:0xf bank_mask:0xf
    v_add_f32_dpp v72, v72, v72 row_half_mirror row_mask:0xf bank_mask:0xf
    s_nop 0
    v_add_f32_dpp v32, v32, v32 row_mirror row_mask:0xf bank_mask:0xf
    v_add_f32_dpp v72, v72, v72 row_mirror row_mask:0xf bank_mask:0xf
    v_mov_b32 v33, v32
    v_mov_b32 v73, v72
    s_nop 0
    v_permlane16_swap_b32 v32, v33
    v_permlane16_swap_b32 v72, v73
    v_add_f32 v32, v32, v33
    v_add_f32 v72, v72, v73
    v_mov_b32 v33, v32
    v_mov_b32 v73, v72
    s_nop 0
    v_permlane32_swap_b32 v32, v33
    v_permlane32_swap_b32 v72, v73
    v_add_f32 v32, v32, v33
    v_add_f32 v72, v72, v73
    v_mul_f32 v32, 0x3a800000, v32
    v_mul_f32 v72, 0x3a800000, v72
    v_sub_f32 v16, v16, v32
    v_sub_f32 v56, v56, v72
    v_sub_f32 v17, v17, v32
    v_sub_f32 v57, v57, v72
    v_sub_f32 v18, v18, v32
    v_sub_f32 v58, v58, v72
    v_sub_f32 v19, v19, v32
    v_sub_f32 v59, v59, v72
    v_sub_f32 v20, v20, v32
    v_sub_f32 v60, v60, v72
    v_sub_f32 v21, v21, v32
    v_sub_f32 v61, v61, v72
    v_sub_f32 v22, v22, v32
    v_sub_f32 v62, v62, v72
    v_sub_f32 v23, v23, v32
    v_sub_f32 v63, v63, v72
    v_sub_f32 v24, v24, v32
    v_sub_f32 v64, v64, v72
    v_sub_f32 v25, v25, v32
    v_sub_f32 v65, v65, v72
    v_sub_f32 v26, v26, v32
    v_sub_f32 v66, v66, v72
    v_sub_f32 v27, v27, v32
    v_sub_f32 v67, v67, v72
    v_sub_f32 v28, v28, v32
    v_sub_f32 v68, v68, v72
    v_sub_f32 v29, v29, v32
    v_sub_f32 v69, v69, v72
    v_sub_f32 v30, v30, v32
    v_sub_f32 v70, v70, v72
    v_sub_f32 v31, v31, v32
    v_sub_f32 v71, v71, v72
    v_mul_f32 v34, v16, v16
    v_mul_f32 v74, v56, v56
    v_mul_f32 v35, v17, v17
    v_mul_f32 v75, v57, v57
    v_fmac_f32 v34, v18, v18
    v_fmac_f32 v74, v58, v58
    v_fmac_f32 v35, v19, v19
    v_fmac_f32 v75, v59, v59
    v_fmac_f32 v34, v20, v20
    v_fmac_f32 v74, v60, v60
    v_fmac_f32 v35, v21, v21
    v_fmac_f32 v75, v61, v61
    v_fmac_f32 v34, v22, v22
    v_fmac_f32 v74, v62, v62
    v_fmac_f32 v35, v23, v23
    v_fmac_f32 v75, v63, v63
    v_fmac_f32 v34, v24, v24
    v_fmac_f32 v74, v64, v64
    v_fmac_f32 v35, v25, v25
    v_fmac_f32 v75, v65, v65
    v_fmac_f32 v34, v26, v26
    v_fmac_f32 v74, v66, v66
    v_fmac_f32 v35, v27, v27
    v_fmac_f32 v75, v67, v67
    v_fmac_f32 v34, v28, v28
    v_fmac_f32 v74, v68, v68
    v_fmac_f32 v35, v29, v29
    v_fmac_f32 v75, v69, v69
    v_fmac_f32 v34, v30, v30
    v_fmac_f32 v74, v70, v70
    v_fmac_f32 v35, v31, v31
    v_fmac_f32 v75, v71, v71
    v_add_f32 v34, v34, v35
    v_add_f32 v74, v74, v75
    s_nop 0
    v_add_f32_dpp v34, v34, v34 quad_perm:[1,0,3,2] row_mask:0xf bank_mask:0xf
    v_add_f32_dpp v74, v74, v74 quad_perm:[1,0,3,2] row_mask:0xf bank_mask:0xf
    s_nop 0
    v_add_f32_dpp v34, v34, v34 quad_perm:[2,3,0,1] row_mask:0xf bank_mask:0xf
    v_add_f32_dpp v74, v74, v74 quad_perm:[2,3,0,1] row_mask:0xf bank_mask:0xf
    s_nop 0
    v_add_f32_dpp v34, v34, v34 row_half_mirror row_mask:0xf bank_mask:0xf
    v_add_f32_dpp v74, v74, v74 row_half_mirror row_mask:0xf bank_mask:0xf
    s_nop 0
    v_add_f32_dpp v34, v34, v34 row_mirror row_mask:0xf bank_mask:0xf
    v_add_f32_dpp v74, v74, v74 row_mirror row_mask:0xf bank_mask:0xf
    v_mov_b32 v33, v34
    v_mov_b32 v73, v74
    s_nop 0
    v_permlane16_swap_b32 v34, v33
    v_permlane16_swap_b32 v74, v73
    v_add_f32 v34, v34, v33
    v_add_f32 v74, v74, v73
    v_mov_b32 v33, v34
    v_mov_b32 v73, v74
    s_nop 0
    v_permlane32_swap_b32 v34, v33
    v_permlane32_swap_b32 v74, v73
    v_add_f32 v34, v34, v33
    v_add_f32 v74, v74, v73
    v_mul_f32 v34, 0x3a800000, v34
    v_mul_f32 v74, 0x3a800000, v74
    v_cvt_pk_bf16_f32 v32, v32, v32
    v_cvt_pk_bf16_f32 v72, v72, v72
    v_and_b32 v32, 0xffff0000, v32
    v_and_b32 v72, 0xffff0000, v72
    v_cvt_pk_bf16_f32 v34, v34, v34
    v_cvt_pk_bf16_f32 v74, v74, v74
    v_and_b32 v34, 0xffff0000, v34
    v_and_b32 v74, 0xffff0000, v74
    v_add_f32 v34, 0x3727c5ac, v34
    v_add_f32 v74, 0x3727c5ac, v74
    v_cvt_pk_bf16_f32 v34, v34, v34
    v_cvt_pk_bf16_f32 v74, v74, v74
    v_and_b32 v34, 0xffff0000, v34
    v_and_b32 v74, 0xffff0000, v74
    v_sqrt_f32 v34, v34
    v_sqrt_f32 v74, v74
    s_nop 0
    v_cvt_pk_bf16_f32 v34, v34, v34
    v_cvt_pk_bf16_f32 v74, v74, v74
    v_and_b32 v34, 0xffff0000, v34
    v_and_b32 v74, 0xffff0000, v74
    v_rcp_f32 v34, v34
    v_rcp_f32 v74, v74
    s_nop 0
    v_mul_f32 v32, v32, v34
    v_mul_f32 v72, v72, v74
    s_memrealtime s[6:7]
    v_readfirstlane_b32 s31, v243
    s_waitcnt lgkmcnt(0)
    s_sub_u32 s3, s6, s31
    s_add_u32 s3, s3, 16
    s_cmp_lt_u32 s3, 4000
    v_cmp_eq_u32 vcc, 0, v250
    s_cbranch_scc0 nn_2
nnd_3:
    s_nop 0
    v_mov_b32 v242, 161792
    ds_write_b32 v242, v243
    v_cndmask_b32 v4, v74, v34, vcc
    v_cndmask_b32 v6, v72, v32, vcc
    v_mov_b32 v5, s31
    v_sub_f32 v6, 0, v6
    v_mov_b32 v7, s31
    s_lshl_b32 s3, s39, 4
    s_add_u32 s12, s4, 0x2880000
    s_addc_u32 s13, s5, 0
    s_mov_b32 s14, 0x8000
    s_mov_b32 s15, 0x00020000
    s_mov_b64 exec, 3
    buffer_store_dwordx4 v[4:7], v245, s[12:15], s3 offen sc1
    s_mov_b64 exec, -1
    s_nop 0
    s_mov_b32 s95, 138240
    s_mov_b32 s96, 65536
    v_and_b32 v1, 15, v250
    v_mov_b32 v2, 0x3f803f80
    v_lshrrev_b32 v3, 5, v250
    v_lshrrev_b32 v4, 1, v1
    v_xor_b32 v3, v3, v4
    v_cmp_eq_u32 vcc, 0, v3
    v_and_b32 v5, 1, v1
    v_mul_u32_u24 v5, 0xaaaa, v5
    v_cndmask_b32 v204, 0, v2, vcc
    v_cndmask_b32 v205, 0, v2, vcc
    v_cndmask_b32 v206, 0, v2, vcc
    v_cndmask_b32 v207, 0, v2, vcc
    v_add_u32 v208, 0x4444, v5
    v_mov_b32 v192, 0
    v_mov_b32 v193, 0
    v_mov_b32 v194, 0
    v_mov_b32 v195, 0
    v_mov_b32 v196, 0
    v_mov_b32 v197, 0
    v_mov_b32 v198, 0
    v_mov_b32 v199, 0
    v_mov_b32 v200, 0
    v_mov_b32 v201, 0
    v_mov_b32 v202, 0
    v_mov_b32 v203, 0
    s_cmp_eq_u32 s21, 0
    s_cselect_b32 s42, s22, 99
    s_mov_b32 s41, 0
    s_mov_b32 s40, 0
    v_mov_b32 v240, 0
    v_mov_b32 v241, 0
    s_mov_b32 s12, s4
    s_mov_b32 s13, s5
    s_mov_b32 s14, 0x80000
    s_mov_b32 s15, 0x00020000
    v_mov_b32 v0, 0
    v_mov_b32 v1, 0
    v_mov_b32 v2, 0
    v_mov_b32 v3, 0
    v_mov_b32 v4, 0
    v_mov_b32 v5, 0
    v_mov_b32 v6, 0
    v_mov_b32 v7, 0
    v_mov_b32 v8, 0
    v_mov_b32 v9, 0
    v_mov_b32 v10, 0
    v_mov_b32 v11, 0
    v_mov_b32 v12, 0
    v_mov_b32 v13, 0
    v_mov_b32 v14, 0
    v_mov_b32 v15, 0
    v_mov_b32 v16, 0
    v_mov_b32 v17, 0
    v_mov_b32 v18, 0
    v_mov_b32 v19, 0
    v_mov_b32 v20, 0
    v_mov_b32 v21, 0
    v_mov_b32 v22, 0
    v_mov_b32 v23, 0
    v_mov_b32 v24, 0
    v_mov_b32 v25, 0
    v_mov_b32 v26, 0
    v_mov_b32 v27, 0
    v_mov_b32 v28, 0
    v_mov_b32 v29, 0
    v_mov_b32 v30, 0
    v_mov_b32 v31, 0
    v_mov_b32 v32, 0
    v_mov_b32 v33, 0
    v_mov_b32 v34, 0
    v_mov_b32 v35, 0
    v_mov_b32 v36, 0
    v_mov_b32 v37, 0
    v_mov_b32 v38, 0
    v_mov_b32 v39, 0
    v_mov_b32 v40, 0
    v_mov_b32 v41, 0
    v_mov_b32 v42, 0
    v_mov_b32 v43, 0
    v_mov_b32 v44, 0
    v_mov_b32 v45, 0
    v_mov_b32 v46, 0
    v_mov_b32 v47, 0
    v_mov_b32 v48, 0
    v_mov_b32 v49, 0
    v_mov_b32 v50, 0
    v_mov_b32 v51, 0
    v_mov_b32 v52, 0
    v_mov_b32 v53, 0
    v_mov_b32 v54, 0
    v_mov_b32 v55, 0
    v_mov_b32 v56, 0
    v_mov_b32 v57, 0
    v_mov_b32 v58, 0
    v_mov_b32 v59, 0
    v_mov_b32 v60, 0
    v_mov_b32 v61, 0
    v_mov_b32 v62, 0
    v_mov_b32 v63, 0
    v_mov_b32 v64, 0
    v_mov_b32 v65, 0
    v_mov_b32 v66, 0
    v_mov_b32 v67, 0
    v_mov_b32 v68, 0
    v_mov_b32 v69, 0
    v_mov_b32 v70, 0
    v_mov_b32 v71, 0
    v_mov_b32 v72, 0
    v_mov_b32 v73, 0
    v_mov_b32 v74, 0
    v_mov_b32 v75, 0
    v_mov_b32 v76, 0
    v_mov_b32 v77, 0
    v_mov_b32 v78, 0
    v_mov_b32 v79, 0
    v_mov_b32 v80, 0
    v_mov_b32 v81, 0
    v_mov_b32 v82, 0
    v_mov_b32 v83, 0
    v_mov_b32 v84, 0
    v_mov_b32 v85, 0
    v_mov_b32 v86, 0
    v_mov_b32 v87, 0
    v_mov_b32 v88, 0
    v_mov_b32 v89, 0
    v_mov_b32 v90, 0
    v_mov_b32 v91, 0
    v_mov_b32 v92, 0
    v_mov_b32 v93, 0
    v_mov_b32 v94, 0
    v_mov_b32 v95, 0
    s_waitcnt vmcnt(13) lgkmcnt(0)
    s_barrier
    s_add_u32 s96, s96, 32768
    s_cmp_eq_u32 s96, 98304
    s_cmov_b32 s96, 0
    v_add_u32 v178, s96, v176
    v_add_u32 v179, s96, v177
    s_add_u32 s95, s95, 13312
    s_cmp_eq_u32 s95, 151552
    s_cmov_b32 s95, 98304
    v_add_u32 v182, s95, v180
    v_add_u32 v183, s95, v181
    ds_read_b128 v[96:99], v178 offset:0
    ds_read_b128 v[100:103], v178 offset:2048
    ds_read_b128 v[104:107], v178 offset:4096
    ds_read_b128 v[108:111], v178 offset:6144
    ds_read_b64_tr_b16 v[112:113], v182 offset:0
    ds_read_b64_tr_b16 v[114:115], v182 offset:1536
    ds_read_b64_tr_b16 v[116:117], v183 offset:32
    ds_read_b64_tr_b16 v[118:119], v183 offset:1568
    ds_read_b64_tr_b16 v[120:121], v182 offset:64
    ds_read_b64_tr_b16 v[122:123], v182 offset:1600
    ds_read_b64_tr_b16 v[124:125], v183 offset:96
    ds_read_b64_tr_b16 v[126:127], v183 offset:1632
    ds_read_b64_tr_b16 v[128:129], v182 offset:128
    ds_read_b64_tr_b16 v[130:131], v182 offset:1664
    ds_read_b64_tr_b16 v[132:133], v183 offset:160
    ds_read_b64_tr_b16 v[134:135], v183 offset:1696
    s_waitcnt lgkmcnt(0)
    s_lshr_b32 s3, s41, 1
    s_cmp_eq_u32 s3, s42
    s_cselect_b64 vcc, -1, 0
    s_branch g1A_4m
.p2align 3
g1A_4:
    v_mfma_f32_16x16x32_bf16 v[68:71], v[144:147], v[172:175], v[68:71]
    v_mfma_f32_16x16x32_bf16 v[92:95], v[148:151], v[172:175], v[92:95]
    s_waitcnt lgkmcnt(0)
g1A_4m:
    s_barrier
    v_mfma_f32_16x16x32_bf16 v[0:3], v[112:115], v[96:99], v[0:3]
    s_cbranch_vccnz cs_5
cs_5r:
    s_setprio 3
    s_add_u32 m0, m0, 4096
    ds_read_b128 v[136:139], v179 offset:0
    v_mfma_f32_16x16x32_bf16 v[24:27], v[112:115], v[100:103], v[24:27]
    s_add_u32 s95, s95, 13312
    v_mfma_f32_16x16x32_bf16 v[48:51], v[112:115], v[104:107], v[48:51]
    ds_read_b128 v[140:143], v179 offset:2048
    v_mfma_f32_16x16x32_bf16 v[72:75], v[112:115], v[108:111], v[72:75]
    s_cmp_eq_u32 s95, 151552
    ds_read_b128 v[144:147], v179 offset:4096
    v_mfma_f32_16x16x32_bf16 v[4:7], v[116:119], v[96:99], v[4:7]
    s_cmov_b32 s95, 98304
    v_mfma_f32_16x16x32_bf16 v[28:31], v[116:119], v[100:103], v[28:31]
    ds_read_b128 v[148:151], v179 offset:6144
    v_mfma_f32_16x16x32_bf16 v[52:55], v[116:119], v[104:107], v[52:55]
    s_setprio 2
    v_add_u32 v182, s95, v180
    v_add_u32 v183, s95, v181
    v_mfma_f32_16x16x32_bf16 v[76:79], v[116:119], v[108:111], v[76:79]
    ds_read_b64_tr_b16 v[152:153], v182 offset:0
    v_mfma_f32_16x16x32_bf16 v[8:11], v[120:123], v[96:99], v[8:11]
    ds_read_b64_tr_b16 v[154:155], v182 offset:1536
    v_mfma_f32_16x16x32_bf16 v[32:35], v[120:123], v[100:103], v[32:35]
    ds_read_b64_tr_b16 v[156:157], v183 offset:32
    v_mfma_f32_16x16x32_bf16 v[56:59], v[120:123], v[104:107], v[56:59]
    ds_read_b64_tr_b16 v[158:159], v183 offset:1568
    buffer_load_dwordx4 v186, s[8:11], s27 offen offset:0 lds
    v_mfma_f32_16x16x32_bf16 v[80:83], v[120:123], v[108:111], v[80:83]
    ds_read_b64_tr_b16 v[160:161], v182 offset:64
    v_mfma_f32_16x16x32_bf16 v[12:15], v[124:127], v[96:99], v[12:15]
    s_setprio 1
    ds_read_b64_tr_b16 v[162:163], v182 offset:1600
    v_mfma_f32_16x16x32_bf16 v[36:39], v[124:127], v[100:103], v[36:39]
    ds_read_b64_tr_b16 v[164:165], v183 offset:96
    ds_read_b64_tr_b16 v[166:167], v183 offset:1632
    v_mfma_f32_16x16x32_bf16 v[60:63], v[124:127], v[104:107], v[60:63]
    buffer_load_dwordx4 v187, s[8:11], s27 offen offset:1024 lds
    v_mfma_f32_16x16x32_bf16 v[84:87], v[124:127], v[108:111], v[84:87]
    ds_read_b64_tr_b16 v[168:169], v182 offset:128
    v_mfma_f32_16x16x32_bf16 v[16:19], v[96:99], v[128:131], v[16:19]
    ds_read_b64_tr_b16 v[170:171], v182 offset:1664
    ds_read_b64_tr_b16 v[172:173], v183 offset:160
    v_mfma_f32_16x16x32_bf16 v[40:43], v[100:103], v[128:131], v[40:43]
    ds_read_b64_tr_b16 v[174:175], v183 offset:1696
    v_mfma_f32_16x16x32_bf16 v[64:67], v[104:107], v[128:131], v[64:67]
    s_setprio 0
    buffer_load_dwordx4 v188, s[8:11], s27 offen offset:2048 lds
    v_mfma_f32_16x16x32_bf16 v[88:91], v[108:111], v[128:131], v[88:91]
    buffer_load_dwordx4 v189, s[8:11], s27 offen offset:3072 lds
    s_add_u32 s27, s27, 128
    v_mfma_f32_16x16x32_bf16 v[20:23], v[96:99], v[132:135], v[20:23]
    v_mfma_f32_16x16x32_bf16 v[44:47], v[100:103], v[132:135], v[44:47]
    v_mfma_f32_16x16x32_bf16 v[68:71], v[104:107], v[132:135], v[68:71]
    v_mfma_f32_16x16x32_bf16 v[92:95], v[108:111], v[132:135], v[92:95]
    s_waitcnt vmcnt(8) lgkmcnt(0)
    s_barrier
    v_mfma_f32_16x16x32_bf16 v[0:3], v[152:155], v[136:139], v[0:3]
    s_cbranch_vccnz cs_6
cs_6r:
    s_setprio 3
    s_add_u32 m0, s96, s28
    s_add_u32 s96, s96, 32768
    v_mfma_f32_16x16x32_bf16 v[24:27], v[152:155], v[140:143], v[24:27]
    s_cmp_eq_u32 s96, 98304
    v_mfma_f32_16x16x32_bf16 v[48:51], v[152:155], v[144:147], v[48:51]
    s_cmov_b32 s96, 0
    v_add_u32 v178, s96, v176
    v_add_u32 v179, s96, v177
    v_mfma_f32_16x16x32_bf16 v[72:75], v[152:155], v[148:151], v[72:75]
    ds_read_b128 v[96:99], v178 offset:0
    v_mfma_f32_16x16x32_bf16 v[4:7], v[156:159], v[136:139], v[4:7]
    s_add_u32 s95, s95, 13312
    ds_read_b128 v[100:103], v178 offset:2048
    v_mfma_f32_16x16x32_bf16 v[28:31], v[156:159], v[140:143], v[28:31]
    s_cmp_eq_u32 s95, 151552
    v_mfma_f32_16x16x32_bf16 v[52:55], v[156:159], v[144:147], v[52:55]
    s_setprio 2
    ds_read_b128 v[104:107], v178 offset:4096
    s_cmov_b32 s95, 98304
    v_mfma_f32_16x16x32_bf16 v[76:79], v[156:159], v[148:151], v[76:79]
    ds_read_b128 v[108:111], v178 offset:6144
    v_mfma_f32_16x16x32_bf16 v[8:11], v[160:163], v[136:139], v[8:11]
    v_add_u32 v182, s95, v180
    v_add_u32 v183, s95, v181
    v_mfma_f32_16x16x32_bf16 v[32:35], v[160:163], v[140:143], v[32:35]
    ds_read_b64_tr_b16 v[112:113], v182 offset:0
    v_mfma_f32_16x16x32_bf16 v[56:59], v[160:163], v[144:147], v[56:59]
    ds_read_b64_tr_b16 v[114:115], v182 offset:1536
    ds_read_b64_tr_b16 v[116:117], v183 offset:32
    v_mfma_f32_16x16x32_bf16 v[80:83], v[160:163], v[148:151], v[80:83]
    ds_read_b64_tr_b16 v[118:119], v183 offset:1568
    v_mfma_f32_16x16x32_bf16 v[12:15], v[164:167], v[136:139], v[12:15]
    s_setprio 1
    buffer_load_dwordx4 v186, s[8:11], s26 offen offset:0 lds
    ds_read_b64_tr_b16 v[120:121], v182 offset:64
    v_mfma_f32_16x16x32_bf16 v[36:39], v[164:167], v[140:143], v[36:39]
    ds_read_b64_tr_b16 v[122:123], v182 offset:1600
    v_mfma_f32_16x16x32_bf16 v[60:63], v[164:167], v[144:147], v[60:63]
    ds_read_b64_tr_b16 v[124:125], v183 offset:96
    ds_read_b64_tr_b16 v[126:127], v183 offset:1632
    v_mfma_f32_16x16x32_bf16 v[84:87], v[164:167], v[148:151], v[84:87]
    buffer_load_dwordx4 v187, s[8:11], s26 offen offset:1024 lds
    v_mfma_f32_16x16x32_bf16 v[16:19], v[136:139], v[168:171], v[16:19]
    ds_read_b64_tr_b16 v[128:129], v182 offset:128
    ds_read_b64_tr_b16 v[130:131], v182 offset:1664
    v_mfma_f32_16x16x32_bf16 v[40:43], v[140:143], v[168:171], v[40:43]
    ds_read_b64_tr_b16 v[132:133], v183 offset:160
    v_mfma_f32_16x16x32_bf16 v[64:67], v[144:147], v[168:171], v[64:67]
    s_setprio 0
    ds_read_b64_tr_b16 v[134:135], v183 offset:1696
    buffer_load_dwordx4 v188, s[8:11], s26 offen offset:2048 lds
    v_mfma_f32_16x16x32_bf16 v[88:91], v[148:151], v[168:171], v[88:91]
    buffer_load_dwordx4 v189, s[8:11], s26 offen offset:3072 lds
    s_add_u32 s26, s26, 128
    v_mfma_f32_16x16x32_bf16 v[20:23], v[136:139], v[172:175], v[20:23]
    v_mfma_f32_16x16x32_bf16 v[44:47], v[140:143], v[172:175], v[44:47]
    s_add_u32 s41, s41, 1
    s_lshr_b32 s3, s41, 1
    s_cmp_eq_u32 s3, s42
    s_cselect_b64 vcc, -1, 0
    s_cmp_lt_u32 s41, 12
    s_cbranch_scc1 g1A_4
    s_cmp_eq_u32 s21, 0
    s_cselect_b64 vcc, -1, 0
    v_mfma_f32_16x16x32_bf16 v[68:71], v[144:147], v[172:175], v[68:71]
    v_mfma_f32_16x16x32_bf16 v[92:95], v[148:151], v[172:175], v[92:95]
    s_waitcnt lgkmcnt(0)
    s_barrier
    v_mfma_f32_16x16x32_bf16 v[0:3], v[112:115], v[96:99], v[0:3]
    s_cbranch_vccz cs_7r
    v_smfmac_f32_16x16x64_bf16 v[192:195], v[204:207], v[112:119], v208
    v_smfmac_f32_16x16x64_bf16 v[196:199], v[204:207], v[120:127], v208
    v_smfmac_f32_16x16x64_bf16 v[200:203], v[204:207], v[128:135], v208
cs_7r:
    s_setprio 3
    s_add_u32 m0, m0, 4096
    ds_read_b128 v[136:139], v179 offset:0
    v_mfma_f32_16x16x32_bf16 v[24:27], v[112:115], v[100:103], v[24:27]
    s_add_u32 s95, s95, 13312
    v_mfma_f32_16x16x32_bf16 v[48:51], v[112:115], v[104:107], v[48:51]
    ds_read_b128 v[140:143], v179 offset:2048
    v_mfma_f32_16x16x32_bf16 v[72:75], v[112:115], v[108:111], v[72:75]
    s_cmp_eq_u32 s95, 151552
    ds_read_b128 v[144:147], v179 offset:4096
    v_mfma_f32_16x16x32_bf16 v[4:7], v[116:119], v[96:99], v[4:7]
    s_cmov_b32 s95, 98304
    v_mfma_f32_16x16x32_bf16 v[28:31], v[116:119], v[100:103], v[28:31]
    ds_read_b128 v[148:151], v179 offset:6144
    v_mfma_f32_16x16x32_bf16 v[52:55], v[116:119], v[104:107], v[52:55]
    s_setprio 2
    v_add_u32 v182, s95, v180
    v_add_u32 v183, s95, v181
    v_mfma_f32_16x16x32_bf16 v[76:79], v[116:119], v[108:111], v[76:79]
    ds_read_b64_tr_b16 v[152:153], v182 offset:0
    v_mfma_f32_16x16x32_bf16 v[8:11], v[120:123], v[96:99], v[8:11]
    ds_read_b64_tr_b16 v[154:155], v182 offset:1536
    v_mfma_f32_16x16x32_bf16 v[32:35], v[120:123], v[100:103], v[32:35]
    ds_read_b64_tr_b16 v[156:157], v183 offset:32
    v_mfma_f32_16x16x32_bf16 v[56:59], v[120:123], v[104:107], v[56:59]
    ds_read_b64_tr_b16 v[158:159], v183 offset:1568
    buffer_load_dwordx4 v186, s[8:11], s27 offen offset:0 lds
    v_mfma_f32_16x16x32_bf16 v[80:83], v[120:123], v[108:111], v[80:83]
    ds_read_b64_tr_b16 v[160:161], v182 offset:64
    v_mfma_f32_16x16x32_bf16 v[12:15], v[124:127], v[96:99], v[12:15]
    s_setprio 1
    ds_read_b64_tr_b16 v[162:163], v182 offset:1600
    v_mfma_f32_16x16x32_bf16 v[36:39], v[124:127], v[100:103], v[36:39]
    ds_read_b64_tr_b16 v[164:165], v183 offset:96
    ds_read_b64_tr_b16 v[166:167], v183 offset:1632
    v_mfma_f32_16x16x32_bf16 v[60:63], v[124:127], v[104:107], v[60:63]
    buffer_load_dwordx4 v187, s[8:11], s27 offen offset:1024 lds
    v_mfma_f32_16x16x32_bf16 v[84:87], v[124:127], v[108:111], v[84:87]
    ds_read_b64_tr_b16 v[168:169], v182 offset:128
    v_mfma_f32_16x16x32_bf16 v[16:19], v[96:99], v[128:131], v[16:19]
    ds_read_b64_tr_b16 v[170:171], v182 offset:1664
    ds_read_b64_tr_b16 v[172:173], v183 offset:160
    v_mfma_f32_16x16x32_bf16 v[40:43], v[100:103], v[128:131], v[40:43]
    ds_read_b64_tr_b16 v[174:175], v183 offset:1696
    v_mfma_f32_16x16x32_bf16 v[64:67], v[104:107], v[128:131], v[64:67]
    s_setprio 0
    buffer_load_dwordx4 v188, s[8:11], s27 offen offset:2048 lds
    v_mfma_f32_16x16x32_bf16 v[88:91], v[108:111], v[128:131], v[88:91]
    buffer_load_dwordx4 v189, s[8:11], s27 offen offset:3072 lds
    s_add_u32 s27, s27, 128
    v_mfma_f32_16x16x32_bf16 v[20:23], v[96:99], v[132:135], v[20:23]
    v_mfma_f32_16x16x32_bf16 v[44:47], v[100:103], v[132:135], v[44:47]
    v_mfma_f32_16x16x32_bf16 v[68:71], v[104:107], v[132:135], v[68:71]
    v_mfma_f32_16x16x32_bf16 v[92:95], v[108:111], v[132:135], v[92:95]
    s_waitcnt vmcnt(8) lgkmcnt(0)
    s_barrier
    v_mfma_f32_16x16x32_bf16 v[0:3], v[152:155], v[136:139], v[0:3]
    s_cbranch_vccz cs_8r
    v_smfmac_f32_16x16x64_bf16 v[192:195], v[204:207], v[152:159], v208
    v_smfmac_f32_16x16x64_bf16 v[196:199], v[204:207], v[160:167], v208
    v_smfmac_f32_16x16x64_bf16 v[200:203], v[204:207], v[168:175], v208
cs_8r:
    s_setprio 3
    s_add_u32 m0, s96, s28
    s_add_u32 s96, s96, 32768
    v_mfma_f32_16x16x32_bf16 v[24:27], v[152:155], v[140:143], v[24:27]
    s_cmp_eq_u32 s96, 98304
    v_mfma_f32_16x16x32_bf16 v[48:51], v[152:155], v[144:147], v[48:51]
    s_cmov_b32 s96, 0
    v_add_u32 v178, s96, v176
    v_add_u32 v179, s96, v177
    v_mfma_f32_16x16x32_bf16 v[72:75], v[152:155], v[148:151], v[72:75]
    ds_read_b128 v[96:99], v178 offset:0
    v_mfma_f32_16x16x32_bf16 v[4:7], v[156:159], v[136:139], v[4:7]
    s_add_u32 s95, s95, 13312
    ds_read_b128 v[100:103], v178 offset:2048
    v_mfma_f32_16x16x32_bf16 v[28:31], v[156:159], v[140:143], v[28:31]
    s_cmp_eq_u32 s95, 151552
    v_mfma_f32_16x16x32_bf16 v[52:55], v[156:159], v[144:147], v[52:55]
    s_setprio 2
    ds_read_b128 v[104:107], v178 offset:4096
    s_cmov_b32 s95, 98304
    v_mfma_f32_16x16x32_bf16 v[76:79], v[156:159], v[148:151], v[76:79]
    ds_read_b128 v[108:111], v178 offset:6144
    v_mfma_f32_16x16x32_bf16 v[8:11], v[160:163], v[136:139], v[8:11]
    v_add_u32 v182, s95, v180
    v_add_u32 v183, s95, v181
    v_mfma_f32_16x16x32_bf16 v[32:35], v[160:163], v[140:143], v[32:35]
    ds_read_b64_tr_b16 v[112:113], v182 offset:0
    v_mfma_f32_16x16x32_bf16 v[56:59], v[160:163], v[144:147], v[56:59]
    ds_read_b64_tr_b16 v[114:115], v182 offset:1536
    ds_read_b64_tr_b16 v[116:117], v183 offset:32
    v_mfma_f32_16x16x32_bf16 v[80:83], v[160:163], v[148:151], v[80:83]
    ds_read_b64_tr_b16 v[118:119], v183 offset:1568
    v_mfma_f32_16x16x32_bf16 v[12:15], v[164:167], v[136:139], v[12:15]
    s_setprio 1
    buffer_load_dwordx4 v186, s[8:11], s26 offen offset:0 lds
    ds_read_b64_tr_b16 v[120:121], v182 offset:64
    v_mfma_f32_16x16x32_bf16 v[36:39], v[164:167], v[140:143], v[36:39]
    ds_read_b64_tr_b16 v[122:123], v182 offset:1600
    v_mfma_f32_16x16x32_bf16 v[60:63], v[164:167], v[144:147], v[60:63]
    ds_read_b64_tr_b16 v[124:125], v183 offset:96
    ds_read_b64_tr_b16 v[126:127], v183 offset:1632
    v_mfma_f32_16x16x32_bf16 v[84:87], v[164:167], v[148:151], v[84:87]
    buffer_load_dwordx4 v187, s[8:11], s26 offen offset:1024 lds
    v_mfma_f32_16x16x32_bf16 v[16:19], v[136:139], v[168:171], v[16:19]
    ds_read_b64_tr_b16 v[128:129], v182 offset:128
    ds_read_b64_tr_b16 v[130:131], v182 offset:1664
    v_mfma_f32_16x16x32_bf16 v[40:43], v[140:143], v[168:171], v[40:43]
    ds_read_b64_tr_b16 v[132:133], v183 offset:160
    v_mfma_f32_16x16x32_bf16 v[64:67], v[144:147], v[168:171], v[64:67]
    s_setprio 0
    ds_read_b64_tr_b16 v[134:135], v183 offset:1696
    buffer_load_dwordx4 v188, s[8:11], s26 offen offset:2048 lds
    v_mfma_f32_16x16x32_bf16 v[88:91], v[148:151], v[168:171], v[88:91]
    buffer_load_dwordx4 v189, s[8:11], s26 offen offset:3072 lds
    s_add_u32 s26, s26, 128
    v_mfma_f32_16x16x32_bf16 v[20:23], v[136:139], v[172:175], v[20:23]
    v_mfma_f32_16x16x32_bf16 v[44:47], v[140:143], v[172:175], v[44:47]
    v_mfma_f32_16x16x32_bf16 v[68:71], v[144:147], v[172:175], v[68:71]
    v_mfma_f32_16x16x32_bf16 v[92:95], v[148:151], v[172:175], v[92:95]
    s_waitcnt lgkmcnt(0)
    s_barrier
    v_mfma_f32_16x16x32_bf16 v[0:3], v[112:115], v[96:99], v[0:3]
    s_cbranch_vccz cs_9r
    v_smfmac_f32_16x16x64_bf16 v[192:195], v[204:207], v[112:119], v208
    v_smfmac_f32_16x16x64_bf16 v[196:199], v[204:207], v[120:127], v208
    v_smfmac_f32_16x16x64_bf16 v[200:203], v[204:207], v[128:135], v208
cs_9r:
    s_setprio 3
    s_add_u32 m0, m0, 4096
    ds_read_b128 v[136:139], v179 offset:0
    v_mfma_f32_16x16x32_bf16 v[24:27], v[112:115], v[100:103], v[24:27]
    s_add_u32 s95, s95, 13312
    v_mfma_f32_16x16x32_bf16 v[48:51], v[112:115], v[104:107], v[48:51]
    ds_read_b128 v[140:143], v179 offset:2048
    v_mfma_f32_16x16x32_bf16 v[72:75], v[112:115], v[108:111], v[72:75]
    s_cmp_eq_u32 s95, 151552
    ds_read_b128 v[144:147], v179 offset:4096
    v_mfma_f32_16x16x32_bf16 v[4:7], v[116:119], v[96:99], v[4:7]
    s_cmov_b32 s95, 98304
    v_mfma_f32_16x16x32_bf16 v[28:31], v[116:119], v[100:103], v[28:31]
    ds_read_b128 v[148:151], v179 offset:6144
    v_mfma_f32_16x16x32_bf16 v[52:55], v[116:119], v[104:107], v[52:55]
    s_setprio 2
    v_add_u32 v182, s95, v180
    v_add_u32 v183, s95, v181
    v_mfma_f32_16x16x32_bf16 v[76:79], v[116:119], v[108:111], v[76:79]
    ds_read_b64_tr_b16 v[152:153], v182 offset:0
    v_mfma_f32_16x16x32_bf16 v[8:11], v[120:123], v[96:99], v[8:11]
    ds_read_b64_tr_b16 v[154:155], v182 offset:1536
    v_mfma_f32_16x16x32_bf16 v[32:35], v[120:123], v[100:103], v[32:35]
    ds_read_b64_tr_b16 v[156:157], v183 offset:32
    v_mfma_f32_16x16x32_bf16 v[56:59], v[120:123], v[104:107], v[56:59]
    ds_read_b64_tr_b16 v[158:159], v183 offset:1568
    buffer_load_dwordx4 v186, s[8:11], s27 offen offset:0 lds
    v_mfma_f32_16x16x32_bf16 v[80:83], v[120:123], v[108:111], v[80:83]
    ds_read_b64_tr_b16 v[160:161], v182 offset:64
    v_mfma_f32_16x16x32_bf16 v[12:15], v[124:127], v[96:99], v[12:15]
    s_setprio 1
    ds_read_b64_tr_b16 v[162:163], v182 offset:1600
    v_mfma_f32_16x16x32_bf16 v[36:39], v[124:127], v[100:103], v[36:39]
    ds_read_b64_tr_b16 v[164:165], v183 offset:96
    ds_read_b64_tr_b16 v[166:167], v183 offset:1632
    v_mfma_f32_16x16x32_bf16 v[60:63], v[124:127], v[104:107], v[60:63]
    buffer_load_dwordx4 v187, s[8:11], s27 offen offset:1024 lds
    v_mfma_f32_16x16x32_bf16 v[84:87], v[124:127], v[108:111], v[84:87]
    ds_read_b64_tr_b16 v[168:169], v182 offset:128
    v_mfma_f32_16x16x32_bf16 v[16:19], v[96:99], v[128:131], v[16:19]
    ds_read_b64_tr_b16 v[170:171], v182 offset:1664
    ds_read_b64_tr_b16 v[172:173], v183 offset:160
    v_mfma_f32_16x16x32_bf16 v[40:43], v[100:103], v[128:131], v[40:43]
    ds_read_b64_tr_b16 v[174:175], v183 offset:1696
    v_mfma_f32_16x16x32_bf16 v[64:67], v[104:107], v[128:131], v[64:67]
    s_setprio 0
    buffer_load_dwordx4 v188, s[8:11], s27 offen offset:2048 lds
    v_mfma_f32_16x16x32_bf16 v[88:91], v[108:111], v[128:131], v[88:91]
    buffer_load_dwordx4 v189, s[8:11], s27 offen offset:3072 lds
    s_add_u32 s27, s27, 128
    v_mfma_f32_16x16x32_bf16 v[20:23], v[96:99], v[132:135], v[20:23]
    v_mfma_f32_16x16x32_bf16 v[44:47], v[100:103], v[132:135], v[44:47]
    v_mfma_f32_16x16x32_bf16 v[68:71], v[104:107], v[132:135], v[68:71]
    v_mfma_f32_16x16x32_bf16 v[92:95], v[108:111], v[132:135], v[92:95]
    s_waitcnt vmcnt(8) lgkmcnt(0)
    s_barrier
    v_mfma_f32_16x16x32_bf16 v[0:3], v[152:155], v[136:139], v[0:3]
    s_cbranch_vccz cs_11r
    v_smfmac_f32_16x16x64_bf16 v[192:195], v[204:207], v[152:159], v208
    v_smfmac_f32_16x16x64_bf16 v[196:199], v[204:207], v[160:167], v208
    v_smfmac_f32_16x16x64_bf16 v[200:203], v[204:207], v[168:175], v208
cs_11r:
    s_cmp_ge_u32 s21, 2
    s_cbranch_scc0 ga_10r
ga_10:
    s_lshl_b32 s40, s25, 14
    s_lshl_b32 s3, s37, 10
    s_add_u32 s40, s40, s3
    v_lshrrev_b32 v241, 4, v250
    v_and_b32 v240, 15, v250
    v_lshlrev_b32 v240, 4, v240
    v_lshl_add_u32 v240, v241, 11, v240
    v_cmp_lt_u32 vcc, 1, v241
    v_add_u32 v241, 8192, v240
    v_mov_b32 v239, 1.0
    v_cndmask_b32 v241, v241, v240, vcc
    v_cndmask_b32_e64 v239, v239, 0, vcc
    buffer_load_dwordx4 v[210:213], v240, s[12:15], s40 offen offset:0 sc1
    buffer_load_dwordx4 v[214:217], v240, s[12:15], s40 offen offset:256 sc1
    buffer_load_dwordx4 v[218:221], v240, s[12:15], s40 offen offset:512 sc1
    buffer_load_dwordx4 v[222:225], v240, s[12:15], s40 offen offset:768 sc1
    buffer_load_dwordx4 v[226:229], v241, s[12:15], s40 offen offset:0 sc1
    buffer_load_dwordx4 v[230:233], v241, s[12:15], s40 offen offset:256 sc1
    buffer_load_dwordx4 v[234:237], v241, s[12:15], s40 offen offset:512 sc1
    buffer_load_dwordx4 v[186:189], v241, s[12:15], s40 offen offset:768 sc1
    s_mov_b64 vcc, 0
ga_10r:
    s_cmp_eq_u32 s21, 0
    s_cselect_b64 vcc, -1, 0
    s_setprio 3
    s_add_u32 s96, s96, 32768
    s_cmp_eq_u32 s96, 98304
    v_mfma_f32_16x16x32_bf16 v[24:27], v[152:155], v[140:143], v[24:27]
    s_cmov_b32 s96, 0
    v_mfma_f32_16x16x32_bf16 v[48:51], v[152:155], v[144:147], v[48:51]
    v_add_u32 v178, s96, v176
    v_add_u32 v179, s96, v177
    v_mfma_f32_16x16x32_bf16 v[72:75], v[152:155], v[148:151], v[72:75]
    ds_read_b128 v[96:99], v178 offset:0
    v_mfma_f32_16x16x32_bf16 v[4:7], v[156:159], v[136:139], v[4:7]
    s_add_u32 s95, s95, 13312
    ds_read_b128 v[100:103], v178 offset:2048
    v_mfma_f32_16x16x32_bf16 v[28:31], v[156:159], v[140:143], v[28:31]
    s_cmp_eq_u32 s95, 151552
    v_mfma_f32_16x16x32_bf16 v[52:55], v[156:159], v[144:147], v[52:55]
    s_setprio 2
    ds_read_b128 v[104:107], v178 offset:4096
    v_mfma_f32_16x16x32_bf16 v[76:79], v[156:159], v[148:151], v[76:79]
    s_cmov_b32 s95, 98304
    v_mfma_f32_16x16x32_bf16 v[8:11], v[160:163], v[136:139], v[8:11]
    ds_read_b128 v[108:111], v178 offset:6144
    v_add_u32 v182, s95, v180
    v_mfma_f32_16x16x32_bf16 v[32:35], v[160:163], v[140:143], v[32:35]
    v_add_u32 v183, s95, v181
    v_mfma_f32_16x16x32_bf16 v[56:59], v[160:163], v[144:147], v[56:59]
    ds_read_b64_tr_b16 v[112:113], v182 offset:0
    v_mfma_f32_16x16x32_bf16 v[80:83], v[160:163], v[148:151], v[80:83]
    ds_read_b64_tr_b16 v[114:115], v182 offset:1536
    v_mfma_f32_16x16x32_bf16 v[12:15], v[164:167], v[136:139], v[12:15]
    s_setprio 1
    ds_read_b64_tr_b16 v[116:117], v183 offset:32
    ds_read_b64_tr_b16 v[118:119], v183 offset:1568
    v_mfma_f32_16x16x32_bf16 v[36:39], v[164:167], v[140:143], v[36:39]
    ds_read_b64_tr_b16 v[120:121], v182 offset:64
    v_mfma_f32_16x16x32_bf16 v[60:63], v[164:167], v[144:147], v[60:63]
    ds_read_b64_tr_b16 v[122:123], v182 offset:1600
    v_mfma_f32_16x16x32_bf16 v[84:87], v[164:167], v[148:151], v[84:87]
    ds_read_b64_tr_b16 v[124:125], v183 offset:96
    v_mfma_f32_16x16x32_bf16 v[16:19], v[136:139], v[168:171], v[16:19]
    ds_read_b64_tr_b16 v[126:127], v183 offset:1632
    ds_read_b64_tr_b16 v[128:129], v182 offset:128
    v_mfma_f32_16x16x32_bf16 v[40:43], v[140:143], v[168:171], v[40:43]
    ds_read_b64_tr_b16 v[130:131], v182 offset:1664
    v_mfma_f32_16x16x32_bf16 v[64:67], v[144:147], v[168:171], v[64:67]
    s_setprio 0
    ds_read_b64_tr_b16 v[132:133], v183 offset:160
    v_mfma_f32_16x16x32_bf16 v[88:91], v[148:151], v[168:171], v[88:91]
    ds_read_b64_tr_b16 v[134:135], v183 offset:1696
    v_mfma_f32_16x16x32_bf16 v[20:23], v[136:139], v[172:175], v[20:23]
    v_mfma_f32_16x16x32_bf16 v[44:47], v[140:143], v[172:175], v[44:47]
    v_mfma_f32_16x16x32_bf16 v[68:71], v[144:147], v[172:175], v[68:71]
    v_mfma_f32_16x16x32_bf16 v[92:95], v[148:151], v[172:175], v[92:95]
    s_waitcnt lgkmcnt(0)
    s_barrier
    v_mfma_f32_16x16x32_bf16 v[0:3], v[112:115], v[96:99], v[0:3]
    s_cbranch_vccz cs_12r
    v_smfmac_f32_16x16x64_bf16 v[192:195], v[204:207], v[112:119], v208
    v_smfmac_f32_16x16x64_bf16 v[196:199], v[204:207], v[120:127], v208
    v_smfmac_f32_16x16x64_bf16 v[200:203], v[204:207], v[128:135], v208
cs_12r:
    s_setprio 3
    ds_read_b128 v[136:139], v179 offset:0
    s_add_u32 s95, s95, 13312
    v_mfma_f32_16x16x32_bf16 v[24:27], v[112:115], v[100:103], v[24:27]
    ds_read_b128 v[140:143], v179 offset:2048
    v_mfma_f32_16x16x32_bf16 v[48:51], v[112:115], v[104:107], v[48:51]
    s_cmp_eq_u32 s95, 151552
    v_mfma_f32_16x16x32_bf16 v[72:75], v[112:115], v[108:111], v[72:75]
    ds_read_b128 v[144:147], v179 offset:4096
    v_mfma_f32_16x16x32_bf16 v[4:7], v[116:119], v[96:99], v[4:7]
    s_cmov_b32 s95, 98304
    v_mfma_f32_16x16x32_bf16 v[28:31], v[116:119], v[100:103], v[28:31]
    ds_read_b128 v[148:151], v179 offset:6144
    v_mfma_f32_16x16x32_bf16 v[52:55], v[116:119], v[104:107], v[52:55]
    s_setprio 2
    v_add_u32 v182, s95, v180
    v_mfma_f32_16x16x32_bf16 v[76:79], v[116:119], v[108:111], v[76:79]
    v_add_u32 v183, s95, v181
    v_mfma_f32_16x16x32_bf16 v[8:11], v[120:123], v[96:99], v[8:11]
    ds_read_b64_tr_b16 v[152:153], v182 offset:0
    v_mfma_f32_16x16x32_bf16 v[32:35], v[120:123], v[100:103], v[32:35]
    ds_read_b64_tr_b16 v[154:155], v182 offset:1536
    v_mfma_f32_16x16x32_bf16 v[56:59], v[120:123], v[104:107], v[56:59]
    ds_read_b64_tr_b16 v[156:157], v183 offset:32
    v_mfma_f32_16x16x32_bf16 v[80:83], v[120:123], v[108:111], v[80:83]
    ds_read_b64_tr_b16 v[158:159], v183 offset:1568
    v_mfma_f32_16x16x32_bf16 v[12:15], v[124:127], v[96:99], v[12:15]
    s_setprio 1
    ds_read_b64_tr_b16 v[160:161], v182 offset:64
    v_mfma_f32_16x16x32_bf16 v[36:39], v[124:127], v[100:103], v[36:39]
    ds_read_b64_tr_b16 v[162:163], v182 offset:1600
    v_mfma_f32_16x16x32_bf16 v[60:63], v[124:127], v[104:107], v[60:63]
    ds_read_b64_tr_b16 v[164:165], v183 offset:96
    v_mfma_f32_16x16x32_bf16 v[84:87], v[124:127], v[108:111], v[84:87]
    ds_read_b64_tr_b16 v[166:167], v183 offset:1632
    v_mfma_f32_16x16x32_bf16 v[16:19], v[96:99], v[128:131], v[16:19]
    ds_read_b64_tr_b16 v[168:169], v182 offset:128
    v_mfma_f32_16x16x32_bf16 v[40:43], v[100:103], v[128:131], v[40:43]
    ds_read_b64_tr_b16 v[170:171], v182 offset:1664
    v_mfma_f32_16x16x32_bf16 v[64:67], v[104:107], v[128:131], v[64:67]
    s_setprio 0
    ds_read_b64_tr_b16 v[172:173], v183 offset:160
    v_mfma_f32_16x16x32_bf16 v[88:91], v[108:111], v[128:131], v[88:91]
    ds_read_b64_tr_b16 v[174:175], v183 offset:1696
    v_mfma_f32_16x16x32_bf16 v[20:23], v[96:99], v[132:135], v[20:23]
    v_mfma_f32_16x16x32_bf16 v[44:47], v[100:103], v[132:135], v[44:47]
    v_mfma_f32_16x16x32_bf16 v[68:71], v[104:107], v[132:135], v[68:71]
    v_mfma_f32_16x16x32_bf16 v[92:95], v[108:111], v[132:135], v[92:95]
    s_waitcnt vmcnt(0) lgkmcnt(0)
    s_barrier
    v_mfma_f32_16x16x32_bf16 v[0:3], v[152:155], v[136:139], v[0:3]
    s_cbranch_vccz cs_14r
    v_smfmac_f32_16x16x64_bf16 v[192:195], v[204:207], v[152:159], v208
    v_smfmac_f32_16x16x64_bf16 v[196:199], v[204:207], v[160:167], v208
    v_smfmac_f32_16x16x64_bf16 v[200:203], v[204:207], v[168:175], v208
cs_14r:
    s_cmp_ge_u32 s21, 2
    s_cbranch_scc0 gf_13r
gf_13:
    s_mov_b32 s97, 0x20000
gf_13p:
    s_waitcnt vmcnt(0)
    v_xor_b32 v238, s31, v211
    v_xor_b32 v209, s31, v213
    v_or_b32 v238, v238, v209
    v_xor_b32 v209, s31, v215
    v_or_b32 v238, v238, v209
    v_xor_b32 v209, s31, v217
    v_or_b32 v238, v238, v209
    v_xor_b32 v209, s31, v219
    v_or_b32 v238, v238, v209
    v_xor_b32 v209, s31, v221
    v_or_b32 v238, v238, v209
    v_xor_b32 v209, s31, v227
    v_or_b32 v238, v238, v209
    v_xor_b32 v209, s31, v229
    v_or_b32 v238, v238, v209
    v_xor_b32 v209, s31, v231
    v_or_b32 v238, v238, v209
    v_xor_b32 v209, s31, v233
    v_or_b32 v238, v238, v209
    v_xor_b32 v209, s31, v235
    v_or_b32 v238, v238, v209
    v_xor_b32 v209, s31, v237
    v_or_b32 v238, v238, v209
    v_xor_b32 v209, s31, v223
    v_xor_b32 v225, s31, v187
    v_or_b32 v209, v209, v225
    v_mul_lo_u32 v209, v209, s37
    v_or_b32 v238, v238, v209
    v_cmp_ne_u32 vcc, 0, v238
    s_sub_u32 s97, s97, 1
    s_cbranch_vccz gf_13q
    s_cmp_eq_u32 s97, 0
    s_cbranch_scc1 gf_13q
    s_sleep 2
    buffer_load_dwordx4 v[210:213], v240, s[12:15], s40 offen offset:0 sc1
    buffer_load_dwordx4 v[214:217], v240, s[12:15], s40 offen offset:256 sc1
    buffer_load_dwordx4 v[218:221], v240, s[12:15], s40 offen offset:512 sc1
    buffer_load_dwordx4 v[222:225], v240, s[12:15], s40 offen offset:768 sc1
    buffer_load_dwordx4 v[226:229], v241, s[12:15], s40 offen offset:0 sc1
    buffer_load_dwordx4 v[230:233], v241, s[12:15], s40 offen offset:256 sc1
    buffer_load_dwordx4 v[234:237], v241, s[12:15], s40 offen offset:512 sc1
    buffer_load_dwordx4 v[186:189], v241, s[12:15], s40 offen offset:768 sc1
    s_branch gf_13p
gf_13q:
    v_fmac_f32 v210, v239, v226
    v_fmac_f32 v212, v239, v228
    v_fmac_f32 v214, v239, v230
    v_fmac_f32 v216, v239, v232
    v_fmac_f32 v218, v239, v234
    v_fmac_f32 v220, v239, v236
    v_fmac_f32 v222, v239, v186
    v_mov_b32 v211, v210
    v_mov_b32 v213, v212
    v_mov_b32 v215, v214
    v_mov_b32 v217, v216
    v_mov_b32 v219, v218
    v_mov_b32 v221, v220
    v_mov_b32 v223, v222
    s_nop 0
    v_permlane16_swap_b32 v210, v211
    v_permlane16_swap_b32 v212, v213
    v_permlane16_swap_b32 v214, v215
    v_permlane16_swap_b32 v216, v217
    v_permlane16_swap_b32 v218, v219
    v_permlane16_swap_b32 v220, v221
    v_permlane16_swap_b32 v222, v223
    v_add_f32 v210, v210, v211
    v_add_f32 v212, v212, v213
    v_add_f32 v214, v214, v215
    v_add_f32 v216, v216, v217
    v_add_f32 v218, v218, v219
    v_add_f32 v220, v220, v221
    v_add_f32 v222, v222, v223
    v_mov_b32 v211, v210
    v_mov_b32 v213, v212
    v_mov_b32 v215, v214
    v_mov_b32 v217, v216
    v_mov_b32 v219, v218
    v_mov_b32 v221, v220
    v_mov_b32 v223, v222
    s_nop 0
    v_permlane32_swap_b32 v210, v211
    v_permlane32_swap_b32 v212, v213
    v_permlane32_swap_b32 v214, v215
    v_permlane32_swap_b32 v216, v217
    v_permlane32_swap_b32 v218, v219
    v_permlane32_swap_b32 v220, v221
    v_permlane32_swap_b32 v222, v223
    v_add_f32 v210, v210, v211
    v_add_f32 v212, v212, v213
    v_add_f32 v214, v214, v215
    v_add_f32 v216, v216, v217
    v_add_f32 v218, v218, v219
    v_add_f32 v220, v220, v221
    v_add_f32 v222, v222, v223
    s_lshl_b32 s3, s37, 9
    s_add_u32 s3, s3, 40960
    v_lshlrev_b32 v238, 2, v250
    v_add_u32 v238, s3, v238
    s_mov_b64 exec, 0xffff
    ds_write_b32 v238, v210 offset:0
    ds_write_b32 v238, v212 offset:64
    ds_write_b32 v238, v214 offset:128
    ds_write_b32 v238, v216 offset:192
    ds_write_b32 v238, v218 offset:256
    ds_write_b32 v238, v220 offset:320
    ds_write_b32 v238, v222 offset:384
    s_mov_b64 exec, -1
    s_mov_b64 vcc, 0
gf_13r:
    s_cmp_eq_u32 s21, 0
    s_cselect_b64 vcc, -1, 0
    s_setprio 3
    s_add_u32 s96, s96, 32768
    s_cmp_eq_u32 s96, 98304
    v_mfma_f32_16x16x32_bf16 v[24:27], v[152:155], v[140:143], v[24:27]
    s_cmov_b32 s96, 0
    v_mfma_f32_16x16x32_bf16 v[48:51], v[152:155], v[144:147], v[48:51]
    v_add_u32 v178, s96, v176
    v_add_u32 v179, s96, v177
    v_mfma_f32_16x16x32_bf16 v[72:75], v[152:155], v[148:151], v[72:75]
    ds_read_b128 v[96:99], v178 offset:0
    v_mfma_f32_16x16x32_bf16 v[4:7], v[156:159], v[136:139], v[4:7]
    s_add_u32 s95, s95, 13312
    ds_read_b128 v[100:103], v178 offset:2048
    v_mfma_f32_16x16x32_bf16 v[28:31], v[156:159], v[140:143], v[28:31]
    s_cmp_eq_u32 s95, 151552
    v_mfma_f32_16x16x32_bf16 v[52:55], v[156:159], v[144:147], v[52:55]
    s_setprio 2
    ds_read_b128 v[104:107], v178 offset:4096
    v_mfma_f32_16x16x32_bf16 v[76:79], v[156:159], v[148:151], v[76:79]
    s_cmov_b32 s95, 98304
    v_mfma_f32_16x16x32_bf16 v[8:11], v[160:163], v[136:139], v[8:11]
    ds_read_b128 v[108:111], v178 offset:6144
    v_add_u32 v182, s95, v180
    v_mfma_f32_16x16x32_bf16 v[32:35], v[160:163], v[140:143], v[32:35]
    v_add_u32 v183, s95, v181
    v_mfma_f32_16x16x32_bf16 v[56:59], v[160:163], v[144:147], v[56:59]
    ds_read_b64_tr_b16 v[112:113], v182 offset:0
    v_mfma_f32_16x16x32_bf16 v[80:83], v[160:163], v[148:151], v[80:83]
    ds_read_b64_tr_b16 v[114:115], v182 offset:1536
    v_mfma_f32_16x16x32_bf16 v[12:15], v[164:167], v[136:139], v[12:15]
    s_setprio 1
    ds_read_b64_tr_b16 v[116:117], v183 offset:32
    ds_read_b64_tr_b16 v[118:119], v183 offset:1568
    v_mfma_f32_16x16x32_bf16 v[36:39], v[164:167], v[140:143], v[36:39]
    ds_read_b64_tr_b16 v[120:121], v182 offset:64
    v_mfma_f32_16x16x32_bf16 v[60:63], v[164:167], v[144:147], v[60:63]
    ds_read_b64_tr_b16 v[122:123], v182 offset:1600
    v_mfma_f32_16x16x32_bf16 v[84:87], v[164:167], v[148:151], v[84:87]
    ds_read_b64_tr_b16 v[124:125], v183 offset:96
    v_mfma_f32_16x16x32_bf16 v[16:19], v[136:139], v[168:171], v[16:19]
    ds_read_b64_tr_b16 v[126:127], v183 offset:1632
    ds_read_b64_tr_b16 v[128:129], v182 offset:128
    v_mfma_f32_16x16x32_bf16 v[40:43], v[140:143], v[168:171], v[40:43]
    ds_read_b64_tr_b16 v[130:131], v182 offset:1664
    v_mfma_f32_16x16x32_bf16 v[64:67], v[144:147], v[168:171], v[64:67]
    s_setprio 0
    ds_read_b64_tr_b16 v[132:133], v183 offset:160
    v_mfma_f32_16x16x32_bf16 v[88:91], v[148:151], v[168:171], v[88:91]
    ds_read_b64_tr_b16 v[134:135], v183 offset:1696
    v_mfma_f32_16x16x32_bf16 v[20:23], v[136:139], v[172:175], v[20:23]
    v_mfma_f32_16x16x32_bf16 v[44:47], v[140:143], v[172:175], v[44:47]
    v_mfma_f32_16x16x32_bf16 v[68:71], v[144:147], v[172:175], v[68:71]
    v_mfma_f32_16x16x32_bf16 v[92:95], v[148:151], v[172:175], v[92:95]
    s_waitcnt lgkmcnt(0)
    s_barrier
    v_mfma_f32_16x16x32_bf16 v[0:3], v[112:115], v[96:99], v[0:3]
    s_cbranch_vccz cs_15r
    v_smfmac_f32_16x16x64_bf16 v[192:195], v[204:207], v[112:119], v208
    v_smfmac_f32_16x16x64_bf16 v[196:199], v[204:207], v[120:127], v208
    v_smfmac_f32_16x16x64_bf16 v[200:203], v[204:207], v[128:135], v208
cs_15r:
    s_add_u32 s16, s4, 0x2880000
    s_addc_u32 s17, s5, 0
    s_mov_b32 s18, 0x8000
    s_mov_b32 s19, 0x00020000
    s_lshl_b32 s39, s22, 2
    s_add_u32 s39, s39, s21
    s_lshl_b32 s39, s39, 10
    buffer_load_dwordx4 v[186:189], v245, s[16:19], s39 offen sc1
    s_setprio 3
    ds_read_b128 v[136:139], v179 offset:0
    s_add_u32 s95, s95, 13312
    v_mfma_f32_16x16x32_bf16 v[24:27], v[112:115], v[100:103], v[24:27]
    ds_read_b128 v[140:143], v179 offset:2048
    v_mfma_f32_16x16x32_bf16 v[48:51], v[112:115], v[104:107], v[48:51]
    s_cmp_eq_u32 s95, 151552
    v_mfma_f32_16x16x32_bf16 v[72:75], v[112:115], v[108:111], v[72:75]
    ds_read_b128 v[144:147], v179 offset:4096
    v_mfma_f32_16x16x32_bf16 v[4:7], v[116:119], v[96:99], v[4:7]
    s_cmov_b32 s95, 98304
    v_mfma_f32_16x16x32_bf16 v[28:31], v[116:119], v[100:103], v[28:31]
    ds_read_b128 v[148:151], v179 offset:6144
    v_mfma_f32_16x16x32_bf16 v[52:55], v[116:119], v[104:107], v[52:55]
    s_setprio 2
    v_add_u32 v182, s95, v180
    v_mfma_f32_16x16x32_bf16 v[76:79], v[116:119], v[108:111], v[76:79]
    v_add_u32 v183, s95, v181
    v_mfma_f32_16x16x32_bf16 v[8:11], v[120:123], v[96:99], v[8:11]
    ds_read_b64_tr_b16 v[152:153], v182 offset:0
    v_mfma_f32_16x16x32_bf16 v[32:35], v[120:123], v[100:103], v[32:35]
    ds_read_b64_tr_b16 v[154:155], v182 offset:1536
    v_mfma_f32_16x16x32_bf16 v[56:59], v[120:123], v[104:107], v[56:59]
    ds_read_b64_tr_b16 v[156:157], v183 offset:32
    v_mfma_f32_16x16x32_bf16 v[80:83], v[120:123], v[108:111], v[80:83]
    ds_read_b64_tr_b16 v[158:159], v183 offset:1568
    v_mfma_f32_16x16x32_bf16 v[12:15], v[124:127], v[96:99], v[12:15]
    s_setprio 1
    ds_read_b64_tr_b16 v[160:161], v182 offset:64
    v_mfma_f32_16x16x32_bf16 v[36:39], v[124:127], v[100:103], v[36:39]
    ds_read_b64_tr_b16 v[162:163], v182 offset:1600
    v_mfma_f32_16x16x32_bf16 v[60:63], v[124:127], v[104:107], v[60:63]
    ds_read_b64_tr_b16 v[164:165], v183 offset:96
    v_mfma_f32_16x16x32_bf16 v[84:87], v[124:127], v[108:111], v[84:87]
    ds_read_b64_tr_b16 v[166:167], v183 offset:1632
    v_mfma_f32_16x16x32_bf16 v[16:19], v[96:99], v[128:131], v[16:19]
    ds_read_b64_tr_b16 v[168:169], v182 offset:128
    v_mfma_f32_16x16x32_bf16 v[40:43], v[100:103], v[128:131], v[40:43]
    ds_read_b64_tr_b16 v[170:171], v182 offset:1664
    v_mfma_f32_16x16x32_bf16 v[64:67], v[104:107], v[128:131], v[64:67]
    s_setprio 0
    ds_read_b64_tr_b16 v[172:173], v183 offset:160
    v_mfma_f32_16x16x32_bf16 v[88:91], v[108:111], v[128:131], v[88:91]
    ds_read_b64_tr_b16 v[174:175], v183 offset:1696
    v_mfma_f32_16x16x32_bf16 v[20:23], v[96:99], v[132:135], v[20:23]
    v_mfma_f32_16x16x32_bf16 v[44:47], v[100:103], v[132:135], v[44:47]
    v_mfma_f32_16x16x32_bf16 v[68:71], v[104:107], v[132:135], v[68:71]
    v_mfma_f32_16x16x32_bf16 v[92:95], v[108:111], v[132:135], v[92:95]
    s_waitcnt lgkmcnt(0)
    s_barrier
    v_mfma_f32_16x16x32_bf16 v[0:3], v[152:155], v[136:139], v[0:3]
    s_cbranch_vccz cs_16r
    v_smfmac_f32_16x16x64_bf16 v[192:195], v[204:207], v[152:159], v208
    v_smfmac_f32_16x16x64_bf16 v[196:199], v[204:207], v[160:167], v208
    v_smfmac_f32_16x16x64_bf16 v[200:203], v[204:207], v[168:175], v208
    v_lshlrev_b32 v238, 2, v250
    v_and_b32 v238, 63, v238
    v_add_u32 v237, 40960, v238
    v_add_u32 v238, 36864, v238
    ds_read_b32 v96, v237 offset:0
    ds_read_b32 v97, v237 offset:64
    ds_read_b32 v98, v237 offset:128
    ds_read_b32 v99, v237 offset:192
    ds_read_b32 v100, v237 offset:256
    ds_read_b32 v101, v237 offset:320
    v_add_f32 v192, v192, v193
    v_add_f32 v194, v194, v195
    v_add_f32 v196, v196, v197
    v_add_f32 v198, v198, v199
    v_add_f32 v200, v200, v201
    v_add_f32 v202, v202, v203
    s_waitcnt lgkmcnt(0)
    v_add_f32 v96, v96, v192
    v_add_f32 v97, v97, v194
    v_add_f32 v98, v98, v196
    v_add_f32 v99, v99, v198
    v_add_f32 v100, v100, v200
    v_add_f32 v101, v101, v202
    s_mov_b64 exec, 0xffff
    ds_write_b32 v238, v96 offset:0
    ds_write_b32 v238, v97 offset:64
    ds_write_b32 v238, v98 offset:128
    ds_write_b32 v238, v99 offset:192
    ds_write_b32 v238, v100 offset:256
    ds_write_b32 v238, v101 offset:320
    s_mov_b64 exec, -1
    s_waitcnt lgkmcnt(0)
cs_16r:
    v_mfma_f32_16x16x32_bf16 v[24:27], v[152:155], v[140:143], v[24:27]
    v_mfma_f32_16x16x32_bf16 v[48:51], v[152:155], v[144:147], v[48:51]
    v_mfma_f32_16x16x32_bf16 v[72:75], v[152:155], v[148:151], v[72:75]
    v_mfma_f32_16x16x32_bf16 v[4:7], v[156:159], v[136:139], v[4:7]
    v_mfma_f32_16x16x32_bf16 v[28:31], v[156:159], v[140:143], v[28:31]
    v_mfma_f32_16x16x32_bf16 v[52:55], v[156:159], v[144:147], v[52:55]
    v_mfma_f32_16x16x32_bf16 v[76:79], v[156:159], v[148:151], v[76:79]
    v_mfma_f32_16x16x32_bf16 v[8:11], v[160:163], v[136:139], v[8:11]
    v_mfma_f32_16x16x32_bf16 v[32:35], v[160:163], v[140:143], v[32:35]
    v_mfma_f32_16x16x32_bf16 v[56:59], v[160:163], v[144:147], v[56:59]
    v_mfma_f32_16x16x32_bf16 v[80:83], v[160:163], v[148:151], v[80:83]
    v_mfma_f32_16x16x32_bf16 v[12:15], v[164:167], v[136:139], v[12:15]
    v_mfma_f32_16x16x32_bf16 v[36:39], v[164:167], v[140:143], v[36:39]
    v_mfma_f32_16x16x32_bf16 v[60:63], v[164:167], v[144:147], v[60:63]
    v_mfma_f32_16x16x32_bf16 v[84:87], v[164:167], v[148:151], v[84:87]
    v_mfma_f32_16x16x32_bf16 v[16:19], v[136:139], v[168:171], v[16:19]
    v_mfma_f32_16x16x32_bf16 v[40:43], v[140:143], v[168:171], v[40:43]
    v_mfma_f32_16x16x32_bf16 v[64:67], v[144:147], v[168:171], v[64:67]
    v_mfma_f32_16x16x32_bf16 v[88:91], v[148:151], v[168:171], v[88:91]
    v_mfma_f32_16x16x32_bf16 v[20:23], v[136:139], v[172:175], v[20:23]
    v_mfma_f32_16x16x32_bf16 v[44:47], v[140:143], v[172:175], v[44:47]
    v_mfma_f32_16x16x32_bf16 v[68:71], v[144:147], v[172:175], v[68:71]
    v_mfma_f32_16x16x32_bf16 v[92:95], v[148:151], v[172:175], v[92:95]
    s_waitcnt vmcnt(0)
    v_cmp_ne_u32 vcc, s31, v187
    v_cmp_ne_u32 s[40:41], s31, v189
    s_nop 0
    s_or_b64 vcc, vcc, s[40:41]
    s_cbranch_vccnz rs_17
rs_17r:
    s_barrier
    s_setprio 3
    s_add_u32 s8, s4, 0x800000
    s_addc_u32 s9, s5, 0
    s_mov_b32 s10, 0x800000
    s_mov_b32 s11, 0x00020000
    s_lshl_b32 s3, s21, 9
    s_add_u32 s3, s3, 37888
    v_lshlrev_b32 v180, 2, v250
    v_add_u32 v181, s3, v180
    ds_write_b32 v181, v186
    ds_write_b32 v181, v188 offset:256
    v_lshrrev_b32 v182, 4, v250
    v_lshlrev_b32 v182, 4, v182
    v_add_u32 v183, s3, v182
    v_add_u32 v182, 36864, v182
    v_and_b32 v180, 63, v180
    v_add_u32 v180, 37120, v180
    ds_read_b128 v[144:147], v182 offset:0
    ds_read_b128 v[148:151], v182 offset:64
    ds_read_b128 v[152:155], v182 offset:128
    ds_read_b128 v[156:159], v182 offset:192
    ds_read_b32 v176, v180
    ds_read_b32 v178, v180 offset:64
    ds_read_b128 v[160:163], v183 offset:0
    ds_read_b128 v[164:167], v183 offset:64
    ds_read_b128 v[168:171], v183 offset:128
    ds_read_b128 v[172:175], v183 offset:192
    ds_read_b128 v[224:227], v183 offset:256
    ds_read_b128 v[228:231], v183 offset:320
    ds_read_b128 v[232:235], v183 offset:384
    ds_read_b128 v[236:239], v183 offset:448
    v_mov_b32 v192, v186
    v_mov_b32 v196, v186
    s_nop 1
    v_permlane32_swap_b32 v192, v196
    v_mov_b32 v194, v192
    v_mov_b32 v198, v196
    s_nop 1
    v_permlane16_swap_b32 v192, v194
    v_permlane16_swap_b32 v196, v198
    v_mov_b32 v193, v192
    v_mov_b32 v195, v194
    v_mov_b32 v197, v196
    v_mov_b32 v199, v198
    v_mov_b32 v200, v188
    v_mov_b32 v204, v188
    s_nop 1
    v_permlane32_swap_b32 v200, v204
    v_mov_b32 v202, v200
    v_mov_b32 v206, v204
    s_nop 1
    v_permlane16_swap_b32 v200, v202
    v_permlane16_swap_b32 v204, v206
    v_mov_b32 v201, v200
    v_mov_b32 v203, v202
    v_mov_b32 v205, v204
    v_mov_b32 v207, v206
    s_lshl_b32 s3, s25, 6
    s_lshl_b32 s6, s22, 3
    s_add_u32 s3, s3, s6
    s_lshl_b32 s6, s21, 1
    s_add_u32 s3, s3, s6
    s_lshl_b32 s6, s3, 11
    s_add_u32 s7, s6, 4194304
    s_waitcnt lgkmcnt(10)
.p2align 3
    v_pk_mul_f32 v[208:209], v[152:153], v[200:201]
    v_pk_mul_f32 v[210:211], v[154:155], v[200:201]
    v_pk_mul_f32 v[212:213], v[156:157], v[200:201]
    v_pk_mul_f32 v[214:215], v[158:159], v[200:201]
    v_pk_fma_f32 v[8:9], v[8:9], v[192:193], v[208:209]
    v_pk_fma_f32 v[10:11], v[10:11], v[192:193], v[210:211]
    v_pk_fma_f32 v[12:13], v[12:13], v[192:193], v[212:213]
    v_pk_fma_f32 v[14:15], v[14:15], v[192:193], v[214:215]
    v_pk_mul_f32 v[216:217], v[152:153], v[202:203]
    v_pk_mul_f32 v[218:219], v[154:155], v[202:203]
    v_pk_mul_f32 v[220:221], v[156:157], v[202:203]
    v_pk_mul_f32 v[222:223], v[158:159], v[202:203]
    v_pk_fma_f32 v[32:33], v[32:33], v[194:195], v[216:217]
    v_pk_fma_f32 v[34:35], v[34:35], v[194:195], v[218:219]
    v_pk_fma_f32 v[36:37], v[36:37], v[194:195], v[220:221]
    v_pk_fma_f32 v[38:39], v[38:39], v[194:195], v[222:223]
    v_pk_mul_f32 v[208:209], v[152:153], v[204:205]
    v_pk_mul_f32 v[210:211], v[154:155], v[204:205]
    v_pk_mul_f32 v[212:213], v[156:157], v[204:205]
    v_pk_mul_f32 v[214:215], v[158:159], v[204:205]
    v_pk_fma_f32 v[56:57], v[56:57], v[196:197], v[208:209]
    v_pk_fma_f32 v[58:59], v[58:59], v[196:197], v[210:211]
    v_pk_fma_f32 v[60:61], v[60:61], v[196:197], v[212:213]
    v_pk_fma_f32 v[62:63], v[62:63], v[196:197], v[214:215]
    v_pk_mul_f32 v[216:217], v[152:153], v[206:207]
    v_pk_mul_f32 v[218:219], v[154:155], v[206:207]
    v_pk_mul_f32 v[220:221], v[156:157], v[206:207]
    v_pk_mul_f32 v[222:223], v[158:159], v[206:207]
    v_pk_fma_f32 v[80:81], v[80:81], v[198:199], v[216:217]
    v_pk_fma_f32 v[82:83], v[82:83], v[198:199], v[218:219]
    v_pk_fma_f32 v[84:85], v[84:85], v[198:199], v[220:221]
    v_pk_fma_f32 v[86:87], v[86:87], v[198:199], v[222:223]
    v_cvt_pk_bf16_f32 v112, v8, v9
    v_cvt_pk_bf16_f32 v113, v10, v11
    v_cvt_pk_bf16_f32 v114, v12, v13
    v_cvt_pk_bf16_f32 v115, v14, v15
    buffer_store_dwordx4 v[112:115], v245, s[8:11], s6 offen offset:0 sc1
    v_cvt_pk_bf16_f32 v116, v32, v33
    v_cvt_pk_bf16_f32 v117, v34, v35
    v_cvt_pk_bf16_f32 v118, v36, v37
    v_cvt_pk_bf16_f32 v119, v38, v39
    buffer_store_dwordx4 v[116:119], v245, s[8:11], s6 offen offset:1024 sc1
    v_cvt_pk_bf16_f32 v120, v56, v57
    v_cvt_pk_bf16_f32 v121, v58, v59
    v_cvt_pk_bf16_f32 v122, v60, v61
    v_cvt_pk_bf16_f32 v123, v62, v63
    buffer_store_dwordx4 v[120:123], v245, s[8:11], s6 offen offset:2048 sc1
    v_cvt_pk_bf16_f32 v124, v80, v81
    v_cvt_pk_bf16_f32 v125, v82, v83
    v_cvt_pk_bf16_f32 v126, v84, v85
    v_cvt_pk_bf16_f32 v127, v86, v87
    buffer_store_dwordx4 v[124:127], v245, s[8:11], s6 offen offset:3072 sc1
    s_waitcnt lgkmcnt(0)
    v_mov_b32 v177, v176
    v_mov_b32 v179, v178
.p2align 3
    v_pk_mul_f32 v[208:209], v[224:225], v[176:177]
    v_pk_mul_f32 v[210:211], v[226:227], v[176:177]
    v_pk_mul_f32 v[212:213], v[224:225], v[178:179]
    v_pk_mul_f32 v[214:215], v[226:227], v[178:179]
    v_pk_fma_f32 v[16:17], v[16:17], v[160:161], v[208:209]
    v_pk_fma_f32 v[18:19], v[18:19], v[162:163], v[210:211]
    v_pk_fma_f32 v[20:21], v[20:21], v[160:161], v[212:213]
    v_pk_fma_f32 v[22:23], v[22:23], v[162:163], v[214:215]
    v_pk_mul_f32 v[216:217], v[228:229], v[176:177]
    v_pk_mul_f32 v[218:219], v[230:231], v[176:177]
    v_pk_mul_f32 v[220:221], v[228:229], v[178:179]
    v_pk_mul_f32 v[222:223], v[230:231], v[178:179]
    v_pk_fma_f32 v[40:41], v[40:41], v[164:165], v[216:217]
    v_pk_fma_f32 v[42:43], v[42:43], v[166:167], v[218:219]
    v_pk_fma_f32 v[44:45], v[44:45], v[164:165], v[220:221]
    v_pk_fma_f32 v[46:47], v[46:47], v[166:167], v[222:223]
    v_cvt_pk_bf16_f32 v128, v16, v17
    v_cvt_pk_bf16_f32 v129, v18, v19
    v_cvt_pk_bf16_f32 v130, v40, v41
    v_cvt_pk_bf16_f32 v131, v42, v43
    buffer_store_dwordx4 v[128:131], v245, s[8:11], s7 offen offset:0 sc1
    v_cvt_pk_bf16_f32 v132, v20, v21
    v_cvt_pk_bf16_f32 v133, v22, v23
    v_cvt_pk_bf16_f32 v134, v44, v45
    v_cvt_pk_bf16_f32 v135, v46, v47
    buffer_store_dwordx4 v[132:135], v245, s[8:11], s7 offen offset:1024 sc1
    v_pk_mul_f32 v[208:209], v[232:233], v[176:177]
    v_pk_mul_f32 v[210:211], v[234:235], v[176:177]
    v_pk_mul_f32 v[212:213], v[232:233], v[178:179]
    v_pk_mul_f32 v[214:215], v[234:235], v[178:179]
    v_pk_fma_f32 v[64:65], v[64:65], v[168:169], v[208:209]
    v_pk_fma_f32 v[66:67], v[66:67], v[170:171], v[210:211]
    v_pk_fma_f32 v[68:69], v[68:69], v[168:169], v[212:213]
    v_pk_fma_f32 v[70:71], v[70:71], v[170:171], v[214:215]
    v_pk_mul_f32 v[216:217], v[236:237], v[176:177]
    v_pk_mul_f32 v[218:219], v[238:239], v[176:177]
    v_pk_mul_f32 v[220:221], v[236:237], v[178:179]
    v_pk_mul_f32 v[222:223], v[238:239], v[178:179]
    v_pk_fma_f32 v[88:89], v[88:89], v[172:173], v[216:217]
    v_pk_fma_f32 v[90:91], v[90:91], v[174:175], v[218:219]
    v_pk_fma_f32 v[92:93], v[92:93], v[172:173], v[220:221]
    v_pk_fma_f32 v[94:95], v[94:95], v[174:175], v[222:223]
    v_cvt_pk_bf16_f32 v136, v64, v65
    v_cvt_pk_bf16_f32 v137, v66, v67
    v_cvt_pk_bf16_f32 v138, v88, v89
    v_cvt_pk_bf16_f32 v139, v90, v91
    buffer_store_dwordx4 v[136:139], v245, s[8:11], s7 offen offset:2048 sc1
    v_cvt_pk_bf16_f32 v140, v68, v69
    v_cvt_pk_bf16_f32 v141, v70, v71
    v_cvt_pk_bf16_f32 v142, v92, v93
    v_cvt_pk_bf16_f32 v143, v94, v95
    buffer_store_dwordx4 v[140:143], v245, s[8:11], s7 offen offset:3072 sc1
    v_mul_f32 v192, 0x3e8293ee, v192
    v_mul_f32 v193, 0x3e8293ee, v193
    v_mul_f32 v194, 0x3e8293ee, v194
    v_mul_f32 v195, 0x3e8293ee, v195
    v_mul_f32 v196, 0x3e8293ee, v196
    v_mul_f32 v197, 0x3e8293ee, v197
    v_mul_f32 v198, 0x3e8293ee, v198
    v_mul_f32 v199, 0x3e8293ee, v199
    v_mul_f32 v200, 0x3e8293ee, v200
    v_mul_f32 v201, 0x3e8293ee, v201
    v_mul_f32 v202, 0x3e8293ee, v202
    v_mul_f32 v203, 0x3e8293ee, v203
    v_mul_f32 v204, 0x3e8293ee, v204
    v_mul_f32 v205, 0x3e8293ee, v205
    v_mul_f32 v206, 0x3e8293ee, v206
    v_mul_f32 v207, 0x3e8293ee, v207
.p2align 3
    v_pk_mul_f32 v[208:209], v[144:145], v[200:201]
    v_pk_mul_f32 v[210:211], v[146:147], v[200:201]
    v_pk_mul_f32 v[212:213], v[148:149], v[200:201]
    v_pk_mul_f32 v[214:215], v[150:151], v[200:201]
    v_pk_fma_f32 v[0:1], v[0:1], v[192:193], v[208:209]
    v_pk_fma_f32 v[2:3], v[2:3], v[192:193], v[210:211]
    v_pk_fma_f32 v[4:5], v[4:5], v[192:193], v[212:213]
    v_pk_fma_f32 v[6:7], v[6:7], v[192:193], v[214:215]
    v_pk_mul_f32 v[216:217], v[144:145], v[202:203]
    v_pk_mul_f32 v[218:219], v[146:147], v[202:203]
    v_pk_mul_f32 v[220:221], v[148:149], v[202:203]
    v_pk_mul_f32 v[222:223], v[150:151], v[202:203]
    v_pk_fma_f32 v[24:25], v[24:25], v[194:195], v[216:217]
    v_pk_fma_f32 v[26:27], v[26:27], v[194:195], v[218:219]
    v_pk_fma_f32 v[28:29], v[28:29], v[194:195], v[220:221]
    v_pk_fma_f32 v[30:31], v[30:31], v[194:195], v[222:223]
    v_pk_mul_f32 v[208:209], v[144:145], v[204:205]
    v_pk_mul_f32 v[210:211], v[146:147], v[204:205]
    v_pk_mul_f32 v[212:213], v[148:149], v[204:205]
    v_pk_mul_f32 v[214:215], v[150:151], v[204:205]
    v_pk_fma_f32 v[48:49], v[48:49], v[196:197], v[208:209]
    v_pk_fma_f32 v[50:51], v[50:51], v[196:197], v[210:211]
    v_pk_fma_f32 v[52:53], v[52:53], v[196:197], v[212:213]
    v_pk_fma_f32 v[54:55], v[54:55], v[196:197], v[214:215]
    v_pk_mul_f32 v[216:217], v[144:145], v[206:207]
    v_pk_mul_f32 v[218:219], v[146:147], v[206:207]
    v_pk_mul_f32 v[220:221], v[148:149], v[206:207]
    v_pk_mul_f32 v[222:223], v[150:151], v[206:207]
    v_pk_fma_f32 v[72:73], v[72:73], v[198:199], v[216:217]
    v_pk_fma_f32 v[74:75], v[74:75], v[198:199], v[218:219]
    v_pk_fma_f32 v[76:77], v[76:77], v[198:199], v[220:221]
    v_pk_fma_f32 v[78:79], v[78:79], v[198:199], v[222:223]
    v_cvt_pk_bf16_f32 v96, v0, v1
    v_cvt_pk_bf16_f32 v97, v2, v3
    v_cvt_pk_bf16_f32 v98, v4, v5
    v_cvt_pk_bf16_f32 v99, v6, v7
    v_cvt_pk_bf16_f32 v100, v24, v25
    v_cvt_pk_bf16_f32 v101, v26, v27
    v_cvt_pk_bf16_f32 v102, v28, v29
    v_cvt_pk_bf16_f32 v103, v30, v31
    v_cvt_pk_bf16_f32 v104, v48, v49
    v_cvt_pk_bf16_f32 v105, v50, v51
    v_cvt_pk_bf16_f32 v106, v52, v53
    v_cvt_pk_bf16_f32 v107, v54, v55
    v_cvt_pk_bf16_f32 v108, v72, v73
    v_cvt_pk_bf16_f32 v109, v74, v75
    v_cvt_pk_bf16_f32 v110, v76, v77
    v_cvt_pk_bf16_f32 v111, v78, v79
    s_lshl_b32 s43, s25, 10
    s_add_u32 s43, s43, 32768
    s_lshl_b32 s42, s22, 7
    s_add_u32 s42, s42, s43
    s_lshl_b32 s3, s21, 13
    v_add_u32 v144, s3, v245
    ds_write_b128 v144, v[112:115] offset:0
    ds_write_b128 v144, v[116:119] offset:1024
    ds_write_b128 v144, v[128:131] offset:2048
    ds_write_b128 v144, v[132:135] offset:3072
    ds_write_b128 v144, v[120:123] offset:4096
    ds_write_b128 v144, v[124:127] offset:5120
    ds_write_b128 v144, v[136:139] offset:6144
    ds_write_b128 v144, v[140:143] offset:7168
    s_waitcnt lgkmcnt(0)
    v_mov_b32 v0, 0
    v_mov_b32 v1, 0
    v_mov_b32 v2, 0
    v_mov_b32 v3, 0
    v_mov_b32 v4, 0
    v_mov_b32 v5, 0
    v_mov_b32 v6, 0
    v_mov_b32 v7, 0
    v_mov_b32 v8, 0
    v_mov_b32 v9, 0
    v_mov_b32 v10, 0
    v_mov_b32 v11, 0
    v_mov_b32 v12, 0
    v_mov_b32 v13, 0
    v_mov_b32 v14, 0
    v_mov_b32 v15, 0
    v_mov_b32 v16, 0
    v_mov_b32 v17, 0
    v_mov_b32 v18, 0
    v_mov_b32 v19, 0
    v_mov_b32 v20, 0
    v_mov_b32 v21, 0
    v_mov_b32 v22, 0
    v_mov_b32 v23, 0
    v_mov_b32 v24, 0
    v_mov_b32 v25, 0
    v_mov_b32 v26, 0
    v_mov_b32 v27, 0
    v_mov_b32 v28, 0
    v_mov_b32 v29, 0
    v_mov_b32 v30, 0
    v_mov_b32 v31, 0
    v_mov_b32 v64, 0
    v_mov_b32 v48, 0
    v_mov_b32 v65, 0
    v_mov_b32 v49, 0
    v_mov_b32 v66, 0
    v_mov_b32 v50, 0
    v_mov_b32 v67, 0
    v_mov_b32 v51, 0
    v_mov_b32 v68, 0
    v_mov_b32 v52, 0
    v_mov_b32 v69, 0
    v_mov_b32 v53, 0
    v_mov_b32 v70, 0
    v_mov_b32 v54, 0
    v_mov_b32 v71, 0
    v_mov_b32 v55, 0
    v_mov_b32 v72, 0
    v_mov_b32 v56, 0
    v_mov_b32 v73, 0
    v_mov_b32 v57, 0
    v_mov_b32 v74, 0
    v_mov_b32 v58, 0
    v_mov_b32 v75, 0
    v_mov_b32 v59, 0
    v_mov_b32 v76, 0
    v_mov_b32 v60, 0
    v_mov_b32 v77, 0
    v_mov_b32 v61, 0
    v_mov_b32 v78, 0
    v_mov_b32 v62, 0
    v_mov_b32 v79, 0
    v_mov_b32 v63, 0
    v_mov_b32 v120, 0
    v_mov_b32 v128, 0
    v_mov_b32 v121, 0
    v_mov_b32 v129, 0
    v_mov_b32 v122, 0
    v_mov_b32 v130, 0
    v_mov_b32 v123, 0
    v_mov_b32 v131, 0
    v_mov_b32 v124, 0
    v_mov_b32 v132, 0
    v_mov_b32 v125, 0
    v_mov_b32 v133, 0
    v_mov_b32 v126, 0
    v_mov_b32 v134, 0
    v_mov_b32 v127, 0
    v_mov_b32 v135, 0
    v_and_b32 v148, 15, v250
    v_mov_b32 v149, 0x3f803f80
    v_lshrrev_b32 v150, 1, v148
    v_lshrrev_b32 v151, 5, v250
    v_cmp_eq_u32 vcc, v150, v151
    v_and_b32 v148, 1, v148
    v_mul_u32_u24 v148, 0xaaaa, v148
    v_cndmask_b32 v136, 0, v149, vcc
    v_cndmask_b32 v137, 0, v149, vcc
    v_cndmask_b32 v138, 0, v149, vcc
    v_cndmask_b32 v139, 0, v149, vcc
    v_add_u32 v140, 0x4444, v148
    s_lshl_b32 s3, s25, 17
    s_lshl_b32 s6, s21, 11
    s_add_u32 s6, s6, s3
    v_add_u32 v143, s6, v245
    v_add_u32 v144, 4192256, v143
    s_add_u32 s26, s22, 1
    s_lshl_b32 s26, s26, 14
    s_and_b32 s26, s26, 131071
    s_lshl_b32 s28, s21, 12
    s_waitcnt vmcnt(0)
    s_add_u32 s88, s88, 1
    ds_add_u32 v246, v248
    ds_read_b32 v249, v247
    s_waitcnt lgkmcnt(0)
    v_cmp_gt_u32 vcc, s88, v249
    s_cbranch_vccnz spin_19
ok_20:
    s_cmp_lg_u32 s21, 0
    s_cbranch_scc1 kq_18
    v_mov_b32 v242, 0
    v_mov_b32 v243, s31
    s_mov_b64 exec, 1
    buffer_store_dword v243, v242, s[32:35], s42 offen sc1
    s_mov_b64 exec, -1
kq_18:
    s_setprio 1
    ds_read_b128 v[112:115], v245 offset:0
    ds_read_b128 v[116:119], v245 offset:1024
    s_waitcnt lgkmcnt(0)
    v_mfma_f32_16x16x32_bf16 v[32:35], v[112:115], v[96:99], 0
    v_mfma_f32_16x16x32_bf16 v[36:39], v[116:119], v[96:99], 0
    v_mfma_f32_16x16x32_bf16 v[40:43], v[112:115], v[100:103], 0
    v_mfma_f32_16x16x32_bf16 v[44:47], v[116:119], v[100:103], 0
    s_mov_b32 s29, 0
    s_nop 3
.p2align 3
    s_nop 0
att_21:
    v_cvt_pk_bf16_f32 v79, v62, v63
    v_mfma_f32_16x16x32_bf16 v[48:51], v[112:115], v[104:107], 0
    v_exp_f32 v32, v32
    v_exp_f32 v33, v33
    v_exp_f32 v34, v34
    v_mfma_f32_16x16x32_bf16 v[52:55], v[116:119], v[104:107], 0
    v_exp_f32 v35, v35
    v_cvt_pk_bf16_f32 v64, v32, v33
    v_mfma_f32_16x16x32_bf16 v[56:59], v[112:115], v[108:111], 0
    v_exp_f32 v36, v36
    v_exp_f32 v37, v37
    v_cvt_pk_bf16_f32 v65, v34, v35
    v_mfma_f32_16x16x32_bf16 v[60:63], v[116:119], v[108:111], 0
    ds_read_b128 v[112:115], v245 offset:4096
    ds_read_b128 v[116:119], v245 offset:5120
    v_exp_f32 v38, v38
    v_exp_f32 v39, v39
    v_mfma_f32_16x16x32_bf16 v[16:19], v[120:123], v[72:75], v[16:19]
    v_cvt_pk_bf16_f32 v66, v36, v37
    v_exp_f32 v40, v40
    v_exp_f32 v41, v41
    v_mfma_f32_16x16x32_bf16 v[20:23], v[124:127], v[72:75], v[20:23]
    v_cvt_pk_bf16_f32 v67, v38, v39
    v_exp_f32 v42, v42
    v_mfma_f32_16x16x32_bf16 v[24:27], v[120:123], v[76:79], v[24:27]
    v_exp_f32 v43, v43
    v_cvt_pk_bf16_f32 v68, v40, v41
    v_exp_f32 v44, v44
    v_mfma_f32_16x16x32_bf16 v[28:31], v[124:127], v[76:79], v[28:31]
    ds_read_b128 v[120:123], v245 offset:2048
    ds_read_b128 v[124:127], v245 offset:3072
    v_exp_f32 v45, v45
    v_cvt_pk_bf16_f32 v69, v42, v43
    v_smfmac_f32_16x16x64_bf16 v[132:135], v[136:139], v[72:79], v140
    v_exp_f32 v46, v46
    v_exp_f32 v47, v47
    v_cvt_pk_bf16_f32 v70, v44, v45
    v_cvt_pk_bf16_f32 v71, v46, v47
    s_waitcnt lgkmcnt(2)
    v_mfma_f32_16x16x32_bf16 v[32:35], v[112:115], v[96:99], 0
    v_exp_f32 v48, v48
    v_exp_f32 v49, v49
    v_exp_f32 v50, v50
    v_mfma_f32_16x16x32_bf16 v[36:39], v[116:119], v[96:99], 0
    v_exp_f32 v51, v51
    v_cvt_pk_bf16_f32 v72, v48, v49
    v_mfma_f32_16x16x32_bf16 v[40:43], v[112:115], v[100:103], 0
    v_exp_f32 v52, v52
    v_exp_f32 v53, v53
    v_cvt_pk_bf16_f32 v73, v50, v51
    v_mfma_f32_16x16x32_bf16 v[44:47], v[116:119], v[100:103], 0
    v_exp_f32 v54, v54
    v_exp_f32 v55, v55
    s_waitcnt lgkmcnt(0)
    v_mfma_f32_16x16x32_bf16 v[0:3], v[120:123], v[64:67], v[0:3]
    v_cvt_pk_bf16_f32 v74, v52, v53
    v_exp_f32 v56, v56
    v_exp_f32 v57, v57
    v_mfma_f32_16x16x32_bf16 v[4:7], v[124:127], v[64:67], v[4:7]
    v_cvt_pk_bf16_f32 v75, v54, v55
    v_exp_f32 v58, v58
    v_mfma_f32_16x16x32_bf16 v[8:11], v[120:123], v[68:71], v[8:11]
    v_exp_f32 v59, v59
    v_cvt_pk_bf16_f32 v76, v56, v57
    v_exp_f32 v60, v60
    v_mfma_f32_16x16x32_bf16 v[12:15], v[124:127], v[68:71], v[12:15]
    v_exp_f32 v61, v61
    v_cvt_pk_bf16_f32 v77, v58, v59
    v_smfmac_f32_16x16x64_bf16 v[128:131], v[136:139], v[64:71], v140
    v_exp_f32 v62, v62
    v_exp_f32 v63, v63
    v_cvt_pk_bf16_f32 v78, v60, v61
    v_cvt_pk_bf16_f32 v79, v62, v63
    v_mfma_f32_16x16x32_bf16 v[48:51], v[112:115], v[104:107], 0
    v_exp_f32 v32, v32
    v_exp_f32 v33, v33
    v_exp_f32 v34, v34
    v_mfma_f32_16x16x32_bf16 v[52:55], v[116:119], v[104:107], 0
    v_exp_f32 v35, v35
    v_cvt_pk_bf16_f32 v64, v32, v33
    v_mfma_f32_16x16x32_bf16 v[56:59], v[112:115], v[108:111], 0
    v_exp_f32 v36, v36
    v_exp_f32 v37, v37
    v_cvt_pk_bf16_f32 v65, v34, v35
    v_mfma_f32_16x16x32_bf16 v[60:63], v[116:119], v[108:111], 0
    ds_read_b128 v[112:115], v245 offset:8192
    ds_read_b128 v[116:119], v245 offset:9216
    v_exp_f32 v38, v38
    v_exp_f32 v39, v39
    v_mfma_f32_16x16x32_bf16 v[16:19], v[120:123], v[72:75], v[16:19]
    v_cvt_pk_bf16_f32 v66, v36, v37
    v_exp_f32 v40, v40
    v_exp_f32 v41, v41
    v_mfma_f32_16x16x32_bf16 v[20:23], v[124:127], v[72:75], v[20:23]
    v_cvt_pk_bf16_f32 v67, v38, v39
    v_exp_f32 v42, v42
    v_mfma_f32_16x16x32_bf16 v[24:27], v[120:123], v[76:79], v[24:27]
    v_exp_f32 v43, v43
    v_cvt_pk_bf16_f32 v68, v40, v41
    v_exp_f32 v44, v44
    v_mfma_f32_16x16x32_bf16 v[28:31], v[124:127], v[76:79], v[28:31]
    ds_read_b128 v[120:123], v245 offset:6144
    ds_read_b128 v[124:127], v245 offset:7168
    v_exp_f32 v45, v45
    v_cvt_pk_bf16_f32 v69, v42, v43
    v_smfmac_f32_16x16x64_bf16 v[132:135], v[136:139], v[72:79], v140
    v_exp_f32 v46, v46
    v_exp_f32 v47, v47
    v_cvt_pk_bf16_f32 v70, v44, v45
    v_cvt_pk_bf16_f32 v71, v46, v47
    s_waitcnt lgkmcnt(2)
    v_mfma_f32_16x16x32_bf16 v[32:35], v[112:115], v[96:99], 0
    v_exp_f32 v48, v48
    v_exp_f32 v49, v49
    v_exp_f32 v50, v50
    v_mfma_f32_16x16x32_bf16 v[36:39], v[116:119], v[96:99], 0
    v_exp_f32 v51, v51
    v_cvt_pk_bf16_f32 v72, v48, v49
    v_mfma_f32_16x16x32_bf16 v[40:43], v[112:115], v[100:103], 0
    v_exp_f32 v52, v52
    v_exp_f32 v53, v53
    v_cvt_pk_bf16_f32 v73, v50, v51
    v_mfma_f32_16x16x32_bf16 v[44:47], v[116:119], v[100:103], 0
    v_exp_f32 v54, v54
    v_exp_f32 v55, v55
    s_waitcnt lgkmcnt(0)
    v_mfma_f32_16x16x32_bf16 v[0:3], v[120:123], v[64:67], v[0:3]
    v_cvt_pk_bf16_f32 v74, v52, v53
    v_exp_f32 v56, v56
    v_exp_f32 v57, v57
    v_mfma_f32_16x16x32_bf16 v[4:7], v[124:127], v[64:67], v[4:7]
    v_cvt_pk_bf16_f32 v75, v54, v55
    v_exp_f32 v58, v58
    v_mfma_f32_16x16x32_bf16 v[8:11], v[120:123], v[68:71], v[8:11]
    v_exp_f32 v59, v59
    v_cvt_pk_bf16_f32 v76, v56, v57
    v_exp_f32 v60, v60
    v_mfma_f32_16x16x32_bf16 v[12:15], v[124:127], v[68:71], v[12:15]
    v_exp_f32 v61, v61
    v_cvt_pk_bf16_f32 v77, v58, v59
    v_smfmac_f32_16x16x64_bf16 v[128:131], v[136:139], v[64:71], v140
    v_exp_f32 v62, v62
    v_exp_f32 v63, v63
    v_cvt_pk_bf16_f32 v78, v60, v61
    s_cmp_eq_u32 s29, 0
    s_cbranch_scc1 kp_22
kp_22r:
    v_cvt_pk_bf16_f32 v79, v62, v63
    v_mfma_f32_16x16x32_bf16 v[48:51], v[112:115], v[104:107], 0
    v_exp_f32 v32, v32
    v_exp_f32 v33, v33
    v_exp_f32 v34, v34
    v_mfma_f32_16x16x32_bf16 v[52:55], v[116:119], v[104:107], 0
    v_exp_f32 v35, v35
    v_cvt_pk_bf16_f32 v64, v32, v33
    v_mfma_f32_16x16x32_bf16 v[56:59], v[112:115], v[108:111], 0
    v_exp_f32 v36, v36
    v_exp_f32 v37, v37
    v_cvt_pk_bf16_f32 v65, v34, v35
    v_mfma_f32_16x16x32_bf16 v[60:63], v[116:119], v[108:111], 0
    ds_read_b128 v[112:115], v245 offset:12288
    ds_read_b128 v[116:119], v245 offset:13312
    v_exp_f32 v38, v38
    v_exp_f32 v39, v39
    v_mfma_f32_16x16x32_bf16 v[16:19], v[120:123], v[72:75], v[16:19]
    v_cvt_pk_bf16_f32 v66, v36, v37
    v_exp_f32 v40, v40
    v_exp_f32 v41, v41
    v_mfma_f32_16x16x32_bf16 v[20:23], v[124:127], v[72:75], v[20:23]
    v_cvt_pk_bf16_f32 v67, v38, v39
    v_exp_f32 v42, v42
    v_mfma_f32_16x16x32_bf16 v[24:27], v[120:123], v[76:79], v[24:27]
    v_exp_f32 v43, v43
    v_cvt_pk_bf16_f32 v68, v40, v41
    v_exp_f32 v44, v44
    v_mfma_f32_16x16x32_bf16 v[28:31], v[124:127], v[76:79], v[28:31]
    ds_read_b128 v[120:123], v245 offset:10240
    ds_read_b128 v[124:127], v245 offset:11264
    v_exp_f32 v45, v45
    v_cvt_pk_bf16_f32 v69, v42, v43
    v_smfmac_f32_16x16x64_bf16 v[132:135], v[136:139], v[72:79], v140
    s_waitcnt vmcnt(0)
    s_add_u32 s88, s88, 1
    ds_add_u32 v246, v248
    v_exp_f32 v46, v46
    v_exp_f32 v47, v47
    v_cvt_pk_bf16_f32 v70, v44, v45
    v_cvt_pk_bf16_f32 v71, v46, v47
    s_waitcnt lgkmcnt(2)
    v_mfma_f32_16x16x32_bf16 v[32:35], v[112:115], v[96:99], 0
    v_exp_f32 v48, v48
    v_exp_f32 v49, v49
    v_exp_f32 v50, v50
    v_mfma_f32_16x16x32_bf16 v[36:39], v[116:119], v[96:99], 0
    v_exp_f32 v51, v51
    v_cvt_pk_bf16_f32 v72, v48, v49
    v_mfma_f32_16x16x32_bf16 v[40:43], v[112:115], v[100:103], 0
    ds_read_b32 v249, v247
    v_exp_f32 v52, v52
    v_exp_f32 v53, v53
    v_cvt_pk_bf16_f32 v73, v50, v51
    v_mfma_f32_16x16x32_bf16 v[44:47], v[116:119], v[100:103], 0
    v_exp_f32 v54, v54
    v_exp_f32 v55, v55
    s_waitcnt lgkmcnt(0)
    v_mfma_f32_16x16x32_bf16 v[0:3], v[120:123], v[64:67], v[0:3]
    v_cvt_pk_bf16_f32 v74, v52, v53
    v_exp_f32 v56, v56
    v_exp_f32 v57, v57
    v_mfma_f32_16x16x32_bf16 v[4:7], v[124:127], v[64:67], v[4:7]
    v_cvt_pk_bf16_f32 v75, v54, v55
    v_exp_f32 v58, v58
    v_mfma_f32_16x16x32_bf16 v[8:11], v[120:123], v[68:71], v[8:11]
    s_add_u32 m0, s28, 32768
    v_exp_f32 v59, v59
    v_cvt_pk_bf16_f32 v76, v56, v57
    v_exp_f32 v60, v60
    v_mfma_f32_16x16x32_bf16 v[12:15], v[124:127], v[68:71], v[12:15]
    v_exp_f32 v61, v61
    v_cvt_pk_bf16_f32 v77, v58, v59
    v_smfmac_f32_16x16x64_bf16 v[128:131], v[136:139], v[64:71], v140
    s_waitcnt lgkmcnt(0)
    v_cmp_gt_u32 vcc, s88, v249
    v_exp_f32 v62, v62
    v_exp_f32 v63, v63
    v_cvt_pk_bf16_f32 v78, v60, v61
    s_cbranch_vccnz spin_23
ok_24:
    v_cvt_pk_bf16_f32 v79, v62, v63
    v_mfma_f32_16x16x32_bf16 v[48:51], v[112:115], v[104:107], 0
    buffer_load_dwordx4 v143, s[8:11], s26 offen sc1 lds
    v_exp_f32 v32, v32
    v_exp_f32 v33, v33
    v_exp_f32 v34, v34
    v_mfma_f32_16x16x32_bf16 v[52:55], v[116:119], v[104:107], 0
    v_exp_f32 v35, v35
    v_cvt_pk_bf16_f32 v64, v32, v33
    v_mfma_f32_16x16x32_bf16 v[56:59], v[112:115], v[108:111], 0
    v_exp_f32 v36, v36
    v_exp_f32 v37, v37
    v_cvt_pk_bf16_f32 v65, v34, v35
    v_mfma_f32_16x16x32_bf16 v[60:63], v[116:119], v[108:111], 0
    ds_read_b128 v[112:115], v245 offset:16384
    ds_read_b128 v[116:119], v245 offset:17408
    v_exp_f32 v38, v38
    v_exp_f32 v39, v39
    v_mfma_f32_16x16x32_bf16 v[16:19], v[120:123], v[72:75], v[16:19]
    buffer_load_dwordx4 v143, s[8:11], s26 offen offset:1024 sc1 lds
    v_cvt_pk_bf16_f32 v66, v36, v37
    v_exp_f32 v40, v40
    v_exp_f32 v41, v41
    v_mfma_f32_16x16x32_bf16 v[20:23], v[124:127], v[72:75], v[20:23]
    v_cvt_pk_bf16_f32 v67, v38, v39
    v_exp_f32 v42, v42
    v_mfma_f32_16x16x32_bf16 v[24:27], v[120:123], v[76:79], v[24:27]
    v_exp_f32 v43, v43
    v_cvt_pk_bf16_f32 v68, v40, v41
    v_exp_f32 v44, v44
    v_mfma_f32_16x16x32_bf16 v[28:31], v[124:127], v[76:79], v[28:31]
    ds_read_b128 v[120:123], v245 offset:14336
    ds_read_b128 v[124:127], v245 offset:15360
    v_exp_f32 v45, v45
    v_cvt_pk_bf16_f32 v69, v42, v43
    v_smfmac_f32_16x16x64_bf16 v[132:135], v[136:139], v[72:79], v140
    buffer_load_dwordx4 v144, s[8:11], s26 offen offset:2048 sc1 lds
    v_exp_f32 v46, v46
    v_exp_f32 v47, v47
    v_cvt_pk_bf16_f32 v70, v44, v45
    v_cvt_pk_bf16_f32 v71, v46, v47
    s_waitcnt lgkmcnt(2)
    v_mfma_f32_16x16x32_bf16 v[32:35], v[112:115], v[96:99], 0
    v_exp_f32 v48, v48
    v_exp_f32 v49, v49
    v_exp_f32 v50, v50
    v_mfma_f32_16x16x32_bf16 v[36:39], v[116:119], v[96:99], 0
    v_exp_f32 v51, v51
    v_cvt_pk_bf16_f32 v72, v48, v49
    v_mfma_f32_16x16x32_bf16 v[40:43], v[112:115], v[100:103], 0
    buffer_load_dwordx4 v144, s[8:11], s26 offen offset:3072 sc1 lds
    s_add_u32 s26, s26, 8192
    s_and_b32 s26, s26, 0x1ffff
    v_exp_f32 v52, v52
    v_exp_f32 v53, v53
    v_cvt_pk_bf16_f32 v73, v50, v51
    v_mfma_f32_16x16x32_bf16 v[44:47], v[116:119], v[100:103], 0
    v_exp_f32 v54, v54
    v_exp_f32 v55, v55
    s_waitcnt lgkmcnt(0)
    v_mfma_f32_16x16x32_bf16 v[0:3], v[120:123], v[64:67], v[0:3]
    v_cvt_pk_bf16_f32 v74, v52, v53
    v_exp_f32 v56, v56
    v_exp_f32 v57, v57
    v_mfma_f32_16x16x32_bf16 v[4:7], v[124:127], v[64:67], v[4:7]
    v_cvt_pk_bf16_f32 v75, v54, v55
    v_exp_f32 v58, v58
    v_mfma_f32_16x16x32_bf16 v[8:11], v[120:123], v[68:71], v[8:11]
    v_exp_f32 v59, v59
    v_cvt_pk_bf16_f32 v76, v56, v57
    v_exp_f32 v60, v60
    v_mfma_f32_16x16x32_bf16 v[12:15], v[124:127], v[68:71], v[12:15]
    v_exp_f32 v61, v61
    v_cvt_pk_bf16_f32 v77, v58, v59
    v_smfmac_f32_16x16x64_bf16 v[128:131], v[136:139], v[64:71], v140
    v_exp_f32 v62, v62
    v_exp_f32 v63, v63
    v_cvt_pk_bf16_f32 v78, v60, v61
    v_cvt_pk_bf16_f32 v79, v62, v63
    v_mfma_f32_16x16x32_bf16 v[48:51], v[112:115], v[104:107], 0
    v_exp_f32 v32, v32
    v_exp_f32 v33, v33
    v_exp_f32 v34, v34
    v_mfma_f32_16x16x32_bf16 v[52:55], v[116:119], v[104:107], 0
    v_exp_f32 v35, v35
    v_cvt_pk_bf16_f32 v64, v32, v33
    v_mfma_f32_16x16x32_bf16 v[56:59], v[112:115], v[108:111], 0
    v_exp_f32 v36, v36
    v_exp_f32 v37, v37
    v_cvt_pk_bf16_f32 v65, v34, v35
    v_mfma_f32_16x16x32_bf16 v[60:63], v[116:119], v[108:111], 0
    ds_read_b128 v[112:115], v245 offset:20480
    ds_read_b128 v[116:119], v245 offset:21504
    v_exp_f32 v38, v38
    v_exp_f32 v39, v39
    v_mfma_f32_16x16x32_bf16 v[16:19], v[120:123], v[72:75], v[16:19]
    v_cvt_pk_bf16_f32 v66, v36, v37
    v_exp_f32 v40, v40
    v_exp_f32 v41, v41
    v_mfma_f32_16x16x32_bf16 v[20:23], v[124:127], v[72:75], v[20:23]
    v_cvt_pk_bf16_f32 v67, v38, v39
    v_exp_f32 v42, v42
    v_mfma_f32_16x16x32_bf16 v[24:27], v[120:123], v[76:79], v[24:27]
    v_exp_f32 v43, v43
    v_cvt_pk_bf16_f32 v68, v40, v41
    v_exp_f32 v44, v44
    v_mfma_f32_16x16x32_bf16 v[28:31], v[124:127], v[76:79], v[28:31]
    ds_read_b128 v[120:123], v245 offset:18432
    ds_read_b128 v[124:127], v245 offset:19456
    v_exp_f32 v45, v45
    v_cvt_pk_bf16_f32 v69, v42, v43
    v_smfmac_f32_16x16x64_bf16 v[132:135], v[136:139], v[72:79], v140
    v_exp_f32 v46, v46
    v_exp_f32 v47, v47
    v_cvt_pk_bf16_f32 v70, v44, v45
    v_cvt_pk_bf16_f32 v71, v46, v47
    s_waitcnt lgkmcnt(2)
    v_mfma_f32_16x16x32_bf16 v[32:35], v[112:115], v[96:99], 0
    v_exp_f32 v48, v48
    v_exp_f32 v49, v49
    v_exp_f32 v50, v50
    v_mfma_f32_16x16x32_bf16 v[36:39], v[116:119], v[96:99], 0
    v_exp_f32 v51, v51
    v_cvt_pk_bf16_f32 v72, v48, v49
    v_mfma_f32_16x16x32_bf16 v[40:43], v[112:115], v[100:103], 0
    v_exp_f32 v52, v52
    v_exp_f32 v53, v53
    v_cvt_pk_bf16_f32 v73, v50, v51
    v_mfma_f32_16x16x32_bf16 v[44:47], v[116:119], v[100:103], 0
    v_exp_f32 v54, v54
    v_exp_f32 v55, v55
    s_waitcnt lgkmcnt(0)
    v_mfma_f32_16x16x32_bf16 v[0:3], v[120:123], v[64:67], v[0:3]
    v_cvt_pk_bf16_f32 v74, v52, v53
    v_exp_f32 v56, v56
    v_exp_f32 v57, v57
    v_mfma_f32_16x16x32_bf16 v[4:7], v[124:127], v[64:67], v[4:7]
    v_cvt_pk_bf16_f32 v75, v54, v55
    v_exp_f32 v58, v58
    v_mfma_f32_16x16x32_bf16 v[8:11], v[120:123], v[68:71], v[8:11]
    v_exp_f32 v59, v59
    v_cvt_pk_bf16_f32 v76, v56, v57
    v_exp_f32 v60, v60
    v_mfma_f32_16x16x32_bf16 v[12:15], v[124:127], v[68:71], v[12:15]
    v_exp_f32 v61, v61
    v_cvt_pk_bf16_f32 v77, v58, v59
    v_smfmac_f32_16x16x64_bf16 v[128:131], v[136:139], v[64:71], v140
    v_exp_f32 v62, v62
    v_exp_f32 v63, v63
    v_cvt_pk_bf16_f32 v78, v60, v61
    v_cvt_pk_bf16_f32 v79, v62, v63
    v_mfma_f32_16x16x32_bf16 v[48:51], v[112:115], v[104:107], 0
    v_exp_f32 v32, v32
    v_exp_f32 v33, v33
    v_exp_f32 v34, v34
    v_mfma_f32_16x16x32_bf16 v[52:55], v[116:119], v[104:107], 0
    v_exp_f32 v35, v35
    v_cvt_pk_bf16_f32 v64, v32, v33
    v_mfma_f32_16x16x32_bf16 v[56:59], v[112:115], v[108:111], 0
    v_exp_f32 v36, v36
    v_exp_f32 v37, v37
    v_cvt_pk_bf16_f32 v65, v34, v35
    v_mfma_f32_16x16x32_bf16 v[60:63], v[116:119], v[108:111], 0
    ds_read_b128 v[112:115], v245 offset:24576
    ds_read_b128 v[116:119], v245 offset:25600
    v_exp_f32 v38, v38
    v_exp_f32 v39, v39
    v_mfma_f32_16x16x32_bf16 v[16:19], v[120:123], v[72:75], v[16:19]
    v_cvt_pk_bf16_f32 v66, v36, v37
    v_exp_f32 v40, v40
    v_exp_f32 v41, v41
    v_mfma_f32_16x16x32_bf16 v[20:23], v[124:127], v[72:75], v[20:23]
    v_cvt_pk_bf16_f32 v67, v38, v39
    v_exp_f32 v42, v42
    v_mfma_f32_16x16x32_bf16 v[24:27], v[120:123], v[76:79], v[24:27]
    v_exp_f32 v43, v43
    v_cvt_pk_bf16_f32 v68, v40, v41
    v_exp_f32 v44, v44
    v_mfma_f32_16x16x32_bf16 v[28:31], v[124:127], v[76:79], v[28:31]
    ds_read_b128 v[120:123], v245 offset:22528
    ds_read_b128 v[124:127], v245 offset:23552
    v_exp_f32 v45, v45
    v_cvt_pk_bf16_f32 v69, v42, v43
    v_smfmac_f32_16x16x64_bf16 v[132:135], v[136:139], v[72:79], v140
    v_exp_f32 v46, v46
    v_exp_f32 v47, v47
    v_cvt_pk_bf16_f32 v70, v44, v45
    v_cvt_pk_bf16_f32 v71, v46, v47
    s_waitcnt lgkmcnt(2)
    v_mfma_f32_16x16x32_bf16 v[32:35], v[112:115], v[96:99], 0
    v_exp_f32 v48, v48
    v_exp_f32 v49, v49
    v_exp_f32 v50, v50
    v_mfma_f32_16x16x32_bf16 v[36:39], v[116:119], v[96:99], 0
    v_exp_f32 v51, v51
    v_cvt_pk_bf16_f32 v72, v48, v49
    v_mfma_f32_16x16x32_bf16 v[40:43], v[112:115], v[100:103], 0
    v_exp_f32 v52, v52
    v_exp_f32 v53, v53
    v_cvt_pk_bf16_f32 v73, v50, v51
    v_mfma_f32_16x16x32_bf16 v[44:47], v[116:119], v[100:103], 0
    v_exp_f32 v54, v54
    v_exp_f32 v55, v55
    s_waitcnt lgkmcnt(0)
    v_mfma_f32_16x16x32_bf16 v[0:3], v[120:123], v[64:67], v[0:3]
    v_cvt_pk_bf16_f32 v74, v52, v53
    v_exp_f32 v56, v56
    v_exp_f32 v57, v57
    v_mfma_f32_16x16x32_bf16 v[4:7], v[124:127], v[64:67], v[4:7]
    v_cvt_pk_bf16_f32 v75, v54, v55
    v_exp_f32 v58, v58
    v_mfma_f32_16x16x32_bf16 v[8:11], v[120:123], v[68:71], v[8:11]
    v_exp_f32 v59, v59
    v_cvt_pk_bf16_f32 v76, v56, v57
    v_exp_f32 v60, v60
    v_mfma_f32_16x16x32_bf16 v[12:15], v[124:127], v[68:71], v[12:15]
    v_exp_f32 v61, v61
    v_cvt_pk_bf16_f32 v77, v58, v59
    v_smfmac_f32_16x16x64_bf16 v[128:131], v[136:139], v[64:71], v140
    v_exp_f32 v62, v62
    v_exp_f32 v63, v63
    v_cvt_pk_bf16_f32 v78, v60, v61
    v_cvt_pk_bf16_f32 v79, v62, v63
    v_mfma_f32_16x16x32_bf16 v[48:51], v[112:115], v[104:107], 0
    v_exp_f32 v32, v32
    v_exp_f32 v33, v33
    v_exp_f32 v34, v34
    v_mfma_f32_16x16x32_bf16 v[52:55], v[116:119], v[104:107], 0
    v_exp_f32 v35, v35
    v_cvt_pk_bf16_f32 v64, v32, v33
    v_mfma_f32_16x16x32_bf16 v[56:59], v[112:115], v[108:111], 0
    v_exp_f32 v36, v36
    v_exp_f32 v37, v37
    v_cvt_pk_bf16_f32 v65, v34, v35
    v_mfma_f32_16x16x32_bf16 v[60:63], v[116:119], v[108:111], 0
    ds_read_b128 v[112:115], v245 offset:28672
    ds_read_b128 v[116:119], v245 offset:29696
    v_exp_f32 v38, v38
    v_exp_f32 v39, v39
    v_mfma_f32_16x16x32_bf16 v[16:19], v[120:123], v[72:75], v[16:19]
    v_cvt_pk_bf16_f32 v66, v36, v37
    v_exp_f32 v40, v40
    v_exp_f32 v41, v41
    v_mfma_f32_16x16x32_bf16 v[20:23], v[124:127], v[72:75], v[20:23]
    v_cvt_pk_bf16_f32 v67, v38, v39
    v_exp_f32 v42, v42
    v_mfma_f32_16x16x32_bf16 v[24:27], v[120:123], v[76:79], v[24:27]
    v_exp_f32 v43, v43
    v_cvt_pk_bf16_f32 v68, v40, v41
    v_exp_f32 v44, v44
    v_mfma_f32_16x16x32_bf16 v[28:31], v[124:127], v[76:79], v[28:31]
    ds_read_b128 v[120:123], v245 offset:26624
    ds_read_b128 v[124:127], v245 offset:27648
    v_exp_f32 v45, v45
    v_cvt_pk_bf16_f32 v69, v42, v43
    v_smfmac_f32_16x16x64_bf16 v[132:135], v[136:139], v[72:79], v140
    s_waitcnt vmcnt(0)
    s_add_u32 s88, s88, 1
    ds_add_u32 v246, v248
    v_exp_f32 v46, v46
    v_exp_f32 v47, v47
    v_cvt_pk_bf16_f32 v70, v44, v45
    v_cvt_pk_bf16_f32 v71, v46, v47
    s_waitcnt lgkmcnt(2)
    v_mfma_f32_16x16x32_bf16 v[32:35], v[112:115], v[96:99], 0
    v_exp_f32 v48, v48
    v_exp_f32 v49, v49
    v_exp_f32 v50, v50
    v_mfma_f32_16x16x32_bf16 v[36:39], v[116:119], v[96:99], 0
    v_exp_f32 v51, v51
    v_cvt_pk_bf16_f32 v72, v48, v49
    v_mfma_f32_16x16x32_bf16 v[40:43], v[112:115], v[100:103], 0
    ds_read_b32 v249, v247
    v_exp_f32 v52, v52
    v_exp_f32 v53, v53
    v_cvt_pk_bf16_f32 v73, v50, v51
    v_mfma_f32_16x16x32_bf16 v[44:47], v[116:119], v[100:103], 0
    v_exp_f32 v54, v54
    v_exp_f32 v55, v55
    s_waitcnt lgkmcnt(0)
    v_mfma_f32_16x16x32_bf16 v[0:3], v[120:123], v[64:67], v[0:3]
    v_cvt_pk_bf16_f32 v74, v52, v53
    v_exp_f32 v56, v56
    v_exp_f32 v57, v57
    v_mfma_f32_16x16x32_bf16 v[4:7], v[124:127], v[64:67], v[4:7]
    v_cvt_pk_bf16_f32 v75, v54, v55
    v_exp_f32 v58, v58
    v_mfma_f32_16x16x32_bf16 v[8:11], v[120:123], v[68:71], v[8:11]
    s_add_u32 m0, s28, 0
    v_exp_f32 v59, v59
    v_cvt_pk_bf16_f32 v76, v56, v57
    v_exp_f32 v60, v60
    v_mfma_f32_16x16x32_bf16 v[12:15], v[124:127], v[68:71], v[12:15]
    v_exp_f32 v61, v61
    v_cvt_pk_bf16_f32 v77, v58, v59
    v_smfmac_f32_16x16x64_bf16 v[128:131], v[136:139], v[64:71], v140
    s_waitcnt lgkmcnt(0)
    v_cmp_gt_u32 vcc, s88, v249
    v_exp_f32 v62, v62
    v_exp_f32 v63, v63
    v_cvt_pk_bf16_f32 v78, v60, v61
    s_cbranch_vccnz spin_25
ok_26:
    v_cvt_pk_bf16_f32 v79, v62, v63
    v_mfma_f32_16x16x32_bf16 v[48:51], v[112:115], v[104:107], 0
    buffer_load_dwordx4 v143, s[8:11], s26 offen sc1 lds
    v_exp_f32 v32, v32
    v_exp_f32 v33, v33
    v_exp_f32 v34, v34
    v_mfma_f32_16x16x32_bf16 v[52:55], v[116:119], v[104:107], 0
    v_exp_f32 v35, v35
    v_cvt_pk_bf16_f32 v64, v32, v33
    v_mfma_f32_16x16x32_bf16 v[56:59], v[112:115], v[108:111], 0
    v_exp_f32 v36, v36
    v_exp_f32 v37, v37
    v_cvt_pk_bf16_f32 v65, v34, v35
    v_mfma_f32_16x16x32_bf16 v[60:63], v[116:119], v[108:111], 0
    ds_read_b128 v[112:115], v245 offset:32768
    ds_read_b128 v[116:119], v245 offset:33792
    v_exp_f32 v38, v38
    v_exp_f32 v39, v39
    v_mfma_f32_16x16x32_bf16 v[16:19], v[120:123], v[72:75], v[16:19]
    buffer_load_dwordx4 v143, s[8:11], s26 offen offset:1024 sc1 lds
    v_cvt_pk_bf16_f32 v66, v36, v37
    v_exp_f32 v40, v40
    v_exp_f32 v41, v41
    v_mfma_f32_16x16x32_bf16 v[20:23], v[124:127], v[72:75], v[20:23]
    v_cvt_pk_bf16_f32 v67, v38, v39
    v_exp_f32 v42, v42
    v_mfma_f32_16x16x32_bf16 v[24:27], v[120:123], v[76:79], v[24:27]
    v_exp_f32 v43, v43
    v_cvt_pk_bf16_f32 v68, v40, v41
    v_exp_f32 v44, v44
    v_mfma_f32_16x16x32_bf16 v[28:31], v[124:127], v[76:79], v[28:31]
    ds_read_b128 v[120:123], v245 offset:30720
    ds_read_b128 v[124:127], v245 offset:31744
    v_exp_f32 v45, v45
    v_cvt_pk_bf16_f32 v69, v42, v43
    v_smfmac_f32_16x16x64_bf16 v[132:135], v[136:139], v[72:79], v140
    buffer_load_dwordx4 v144, s[8:11], s26 offen offset:2048 sc1 lds
    v_exp_f32 v46, v46
    v_exp_f32 v47, v47
    v_cvt_pk_bf16_f32 v70, v44, v45
    v_cvt_pk_bf16_f32 v71, v46, v47
    s_waitcnt lgkmcnt(2)
    v_mfma_f32_16x16x32_bf16 v[32:35], v[112:115], v[96:99], 0
    v_exp_f32 v48, v48
    v_exp_f32 v49, v49
    v_exp_f32 v50, v50
    v_mfma_f32_16x16x32_bf16 v[36:39], v[116:119], v[96:99], 0
    v_exp_f32 v51, v51
    v_cvt_pk_bf16_f32 v72, v48, v49
    v_mfma_f32_16x16x32_bf16 v[40:43], v[112:115], v[100:103], 0
    buffer_load_dwordx4 v144, s[8:11], s26 offen offset:3072 sc1 lds
    s_add_u32 s26, s26, 8192
    s_and_b32 s26, s26, 0x1ffff
    v_exp_f32 v52, v52
    v_exp_f32 v53, v53
    v_cvt_pk_bf16_f32 v73, v50, v51
    v_mfma_f32_16x16x32_bf16 v[44:47], v[116:119], v[100:103], 0
    v_exp_f32 v54, v54
    v_exp_f32 v55, v55
    s_waitcnt lgkmcnt(0)
    v_mfma_f32_16x16x32_bf16 v[0:3], v[120:123], v[64:67], v[0:3]
    v_cvt_pk_bf16_f32 v74, v52, v53
    v_exp_f32 v56, v56
    v_exp_f32 v57, v57
    v_mfma_f32_16x16x32_bf16 v[4:7], v[124:127], v[64:67], v[4:7]
    v_cvt_pk_bf16_f32 v75, v54, v55
    v_exp_f32 v58, v58
    v_mfma_f32_16x16x32_bf16 v[8:11], v[120:123], v[68:71], v[8:11]
    v_exp_f32 v59, v59
    v_cvt_pk_bf16_f32 v76, v56, v57
    v_exp_f32 v60, v60
    v_mfma_f32_16x16x32_bf16 v[12:15], v[124:127], v[68:71], v[12:15]
    v_exp_f32 v61, v61
    v_cvt_pk_bf16_f32 v77, v58, v59
    v_smfmac_f32_16x16x64_bf16 v[128:131], v[136:139], v[64:71], v140
    v_exp_f32 v62, v62
    v_exp_f32 v63, v63
    v_cvt_pk_bf16_f32 v78, v60, v61
    v_cvt_pk_bf16_f32 v79, v62, v63
    v_mfma_f32_16x16x32_bf16 v[48:51], v[112:115], v[104:107], 0
    v_exp_f32 v32, v32
    v_exp_f32 v33, v33
    v_exp_f32 v34, v34
    v_mfma_f32_16x16x32_bf16 v[52:55], v[116:119], v[104:107], 0
    v_exp_f32 v35, v35
    v_cvt_pk_bf16_f32 v64, v32, v33
    v_mfma_f32_16x16x32_bf16 v[56:59], v[112:115], v[108:111], 0
    v_exp_f32 v36, v36
    v_exp_f32 v37, v37
    v_cvt_pk_bf16_f32 v65, v34, v35
    v_mfma_f32_16x16x32_bf16 v[60:63], v[116:119], v[108:111], 0
    ds_read_b128 v[112:115], v245 offset:36864
    ds_read_b128 v[116:119], v245 offset:37888
    v_exp_f32 v38, v38
    v_exp_f32 v39, v39
    v_mfma_f32_16x16x32_bf16 v[16:19], v[120:123], v[72:75], v[16:19]
    v_cvt_pk_bf16_f32 v66, v36, v37
    v_exp_f32 v40, v40
    v_exp_f32 v41, v41
    v_mfma_f32_16x16x32_bf16 v[20:23], v[124:127], v[72:75], v[20:23]
    v_cvt_pk_bf16_f32 v67, v38, v39
    v_exp_f32 v42, v42
    v_mfma_f32_16x16x32_bf16 v[24:27], v[120:123], v[76:79], v[24:27]
    v_exp_f32 v43, v43
    v_cvt_pk_bf16_f32 v68, v40, v41
    v_exp_f32 v44, v44
    v_mfma_f32_16x16x32_bf16 v[28:31], v[124:127], v[76:79], v[28:31]
    ds_read_b128 v[120:123], v245 offset:34816
    ds_read_b128 v[124:127], v245 offset:35840
    v_exp_f32 v45, v45
    v_cvt_pk_bf16_f32 v69, v42, v43
    v_smfmac_f32_16x16x64_bf16 v[132:135], v[136:139], v[72:79], v140
    v_exp_f32 v46, v46
    v_exp_f32 v47, v47
    v_cvt_pk_bf16_f32 v70, v44, v45
    v_cvt_pk_bf16_f32 v71, v46, v47
    s_waitcnt lgkmcnt(2)
    v_mfma_f32_16x16x32_bf16 v[32:35], v[112:115], v[96:99], 0
    v_exp_f32 v48, v48
    v_exp_f32 v49, v49
    v_exp_f32 v50, v50
    v_mfma_f32_16x16x32_bf16 v[36:39], v[116:119], v[96:99], 0
    v_exp_f32 v51, v51
    v_cvt_pk_bf16_f32 v72, v48, v49
    v_mfma_f32_16x16x32_bf16 v[40:43], v[112:115], v[100:103], 0
    v_exp_f32 v52, v52
    v_exp_f32 v53, v53
    v_cvt_pk_bf16_f32 v73, v50, v51
    v_mfma_f32_16x16x32_bf16 v[44:47], v[116:119], v[100:103], 0
    v_exp_f32 v54, v54
    v_exp_f32 v55, v55
    s_waitcnt lgkmcnt(0)
    v_mfma_f32_16x16x32_bf16 v[0:3], v[120:123], v[64:67], v[0:3]
    v_cvt_pk_bf16_f32 v74, v52, v53
    v_exp_f32 v56, v56
    v_exp_f32 v57, v57
    v_mfma_f32_16x16x32_bf16 v[4:7], v[124:127], v[64:67], v[4:7]
    v_cvt_pk_bf16_f32 v75, v54, v55
    v_exp_f32 v58, v58
    v_mfma_f32_16x16x32_bf16 v[8:11], v[120:123], v[68:71], v[8:11]
    v_exp_f32 v59, v59
    v_cvt_pk_bf16_f32 v76, v56, v57
    v_exp_f32 v60, v60
    v_mfma_f32_16x16x32_bf16 v[12:15], v[124:127], v[68:71], v[12:15]
    v_exp_f32 v61, v61
    v_cvt_pk_bf16_f32 v77, v58, v59
    v_smfmac_f32_16x16x64_bf16 v[128:131], v[136:139], v[64:71], v140
    v_exp_f32 v62, v62
    v_exp_f32 v63, v63
    v_cvt_pk_bf16_f32 v78, v60, v61
    v_cvt_pk_bf16_f32 v79, v62, v63
    v_mfma_f32_16x16x32_bf16 v[48:51], v[112:115], v[104:107], 0
    v_exp_f32 v32, v32
    v_exp_f32 v33, v33
    v_exp_f32 v34, v34
    v_mfma_f32_16x16x32_bf16 v[52:55], v[116:119], v[104:107], 0
    v_exp_f32 v35, v35
    v_cvt_pk_bf16_f32 v64, v32, v33
    v_mfma_f32_16x16x32_bf16 v[56:59], v[112:115], v[108:111], 0
    v_exp_f32 v36, v36
    v_exp_f32 v37, v37
    v_cvt_pk_bf16_f32 v65, v34, v35
    v_mfma_f32_16x16x32_bf16 v[60:63], v[116:119], v[108:111], 0
    ds_read_b128 v[112:115], v245 offset:40960
    ds_read_b128 v[116:119], v245 offset:41984
    v_exp_f32 v38, v38
    v_exp_f32 v39, v39
    v_mfma_f32_16x16x32_bf16 v[16:19], v[120:123], v[72:75], v[16:19]
    v_cvt_pk_bf16_f32 v66, v36, v37
    v_exp_f32 v40, v40
    v_exp_f32 v41, v41
    v_mfma_f32_16x16x32_bf16 v[20:23], v[124:127], v[72:75], v[20:23]
    v_cvt_pk_bf16_f32 v67, v38, v39
    v_exp_f32 v42, v42
    v_mfma_f32_16x16x32_bf16 v[24:27], v[120:123], v[76:79], v[24:27]
    v_exp_f32 v43, v43
    v_cvt_pk_bf16_f32 v68, v40, v41
    v_exp_f32 v44, v44
    v_mfma_f32_16x16x32_bf16 v[28:31], v[124:127], v[76:79], v[28:31]
    ds_read_b128 v[120:123], v245 offset:38912
    ds_read_b128 v[124:127], v245 offset:39936
    v_exp_f32 v45, v45
    v_cvt_pk_bf16_f32 v69, v42, v43
    v_smfmac_f32_16x16x64_bf16 v[132:135], v[136:139], v[72:79], v140
    v_exp_f32 v46, v46
    v_exp_f32 v47, v47
    v_cvt_pk_bf16_f32 v70, v44, v45
    v_cvt_pk_bf16_f32 v71, v46, v47
    s_waitcnt lgkmcnt(2)
    v_mfma_f32_16x16x32_bf16 v[32:35], v[112:115], v[96:99], 0
    v_exp_f32 v48, v48
    v_exp_f32 v49, v49
    v_exp_f32 v50, v50
    v_mfma_f32_16x16x32_bf16 v[36:39], v[116:119], v[96:99], 0
    v_exp_f32 v51, v51
    v_cvt_pk_bf16_f32 v72, v48, v49
    v_mfma_f32_16x16x32_bf16 v[40:43], v[112:115], v[100:103], 0
    v_exp_f32 v52, v52
    v_exp_f32 v53, v53
    v_cvt_pk_bf16_f32 v73, v50, v51
    v_mfma_f32_16x16x32_bf16 v[44:47], v[116:119], v[100:103], 0
    v_exp_f32 v54, v54
    v_exp_f32 v55, v55
    s_waitcnt lgkmcnt(0)
    v_mfma_f32_16x16x32_bf16 v[0:3], v[120:123], v[64:67], v[0:3]
    v_cvt_pk_bf16_f32 v74, v52, v53
    v_exp_f32 v56, v56
    v_exp_f32 v57, v57
    v_mfma_f32_16x16x32_bf16 v[4:7], v[124:127], v[64:67], v[4:7]
    v_cvt_pk_bf16_f32 v75, v54, v55
    v_exp_f32 v58, v58
    v_mfma_f32_16x16x32_bf16 v[8:11], v[120:123], v[68:71], v[8:11]
    v_exp_f32 v59, v59
    v_cvt_pk_bf16_f32 v76, v56, v57
    v_exp_f32 v60, v60
    v_mfma_f32_16x16x32_bf16 v[12:15], v[124:127], v[68:71], v[12:15]
    v_exp_f32 v61, v61
    v_cvt_pk_bf16_f32 v77, v58, v59
    v_smfmac_f32_16x16x64_bf16 v[128:131], v[136:139], v[64:71], v140
    v_exp_f32 v62, v62
    v_exp_f32 v63, v63
    v_cvt_pk_bf16_f32 v78, v60, v61
    v_cvt_pk_bf16_f32 v79, v62, v63
    v_mfma_f32_16x16x32_bf16 v[48:51], v[112:115], v[104:107], 0
    v_exp_f32 v32, v32
    v_exp_f32 v33, v33
    v_exp_f32 v34, v34
    v_mfma_f32_16x16x32_bf16 v[52:55], v[116:119], v[104:107], 0
    v_exp_f32 v35, v35
    v_cvt_pk_bf16_f32 v64, v32, v33
    v_mfma_f32_16x16x32_bf16 v[56:59], v[112:115], v[108:111], 0
    v_exp_f32 v36, v36
    v_exp_f32 v37, v37
    v_cvt_pk_bf16_f32 v65, v34, v35
    v_mfma_f32_16x16x32_bf16 v[60:63], v[116:119], v[108:111], 0
    ds_read_b128 v[112:115], v245 offset:45056
    ds_read_b128 v[116:119], v245 offset:46080
    v_exp_f32 v38, v38
    v_exp_f32 v39, v39
    v_mfma_f32_16x16x32_bf16 v[16:19], v[120:123], v[72:75], v[16:19]
    v_cvt_pk_bf16_f32 v66, v36, v37
    v_exp_f32 v40, v40
    v_exp_f32 v41, v41
    v_mfma_f32_16x16x32_bf16 v[20:23], v[124:127], v[72:75], v[20:23]
    v_cvt_pk_bf16_f32 v67, v38, v39
    v_exp_f32 v42, v42
    v_mfma_f32_16x16x32_bf16 v[24:27], v[120:123], v[76:79], v[24:27]
    v_exp_f32 v43, v43
    v_cvt_pk_bf16_f32 v68, v40, v41
    v_exp_f32 v44, v44
    v_mfma_f32_16x16x32_bf16 v[28:31], v[124:127], v[76:79], v[28:31]
    ds_read_b128 v[120:123], v245 offset:43008
    ds_read_b128 v[124:127], v245 offset:44032
    v_exp_f32 v45, v45
    v_cvt_pk_bf16_f32 v69, v42, v43
    v_smfmac_f32_16x16x64_bf16 v[132:135], v[136:139], v[72:79], v140
    s_waitcnt vmcnt(0)
    s_add_u32 s88, s88, 1
    ds_add_u32 v246, v248
    v_exp_f32 v46, v46
    v_exp_f32 v47, v47
    v_cvt_pk_bf16_f32 v70, v44, v45
    v_cvt_pk_bf16_f32 v71, v46, v47
    s_waitcnt lgkmcnt(2)
    v_mfma_f32_16x16x32_bf16 v[32:35], v[112:115], v[96:99], 0
    v_exp_f32 v48, v48
    v_exp_f32 v49, v49
    v_exp_f32 v50, v50
    v_mfma_f32_16x16x32_bf16 v[36:39], v[116:119], v[96:99], 0
    v_exp_f32 v51, v51
    v_cvt_pk_bf16_f32 v72, v48, v49
    v_mfma_f32_16x16x32_bf16 v[40:43], v[112:115], v[100:103], 0
    ds_read_b32 v249, v247
    v_exp_f32 v52, v52
    v_exp_f32 v53, v53
    v_cvt_pk_bf16_f32 v73, v50, v51
    v_mfma_f32_16x16x32_bf16 v[44:47], v[116:119], v[100:103], 0
    v_exp_f32 v54, v54
    v_exp_f32 v55, v55
    s_waitcnt lgkmcnt(0)
    v_mfma_f32_16x16x32_bf16 v[0:3], v[120:123], v[64:67], v[0:3]
    v_cvt_pk_bf16_f32 v74, v52, v53
    v_exp_f32 v56, v56
    v_exp_f32 v57, v57
    v_mfma_f32_16x16x32_bf16 v[4:7], v[124:127], v[64:67], v[4:7]
    v_cvt_pk_bf16_f32 v75, v54, v55
    v_exp_f32 v58, v58
    v_mfma_f32_16x16x32_bf16 v[8:11], v[120:123], v[68:71], v[8:11]
    s_add_u32 m0, s28, 16384
    v_exp_f32 v59, v59
    v_cvt_pk_bf16_f32 v76, v56, v57
    v_exp_f32 v60, v60
    v_mfma_f32_16x16x32_bf16 v[12:15], v[124:127], v[68:71], v[12:15]
    v_exp_f32 v61, v61
    v_cvt_pk_bf16_f32 v77, v58, v59
    v_smfmac_f32_16x16x64_bf16 v[128:131], v[136:139], v[64:71], v140
    s_waitcnt lgkmcnt(0)
    v_cmp_gt_u32 vcc, s88, v249
    v_exp_f32 v62, v62
    v_exp_f32 v63, v63
    v_cvt_pk_bf16_f32 v78, v60, v61
    s_cbranch_vccnz spin_27
ok_28:
    v_cvt_pk_bf16_f32 v79, v62, v63
    v_mfma_f32_16x16x32_bf16 v[48:51], v[112:115], v[104:107], 0
    s_cmp_eq_u32 s29, 4
    s_cbranch_scc1 kd_29
    buffer_load_dwordx4 v143, s[8:11], s26 offen sc1 lds
    buffer_load_dwordx4 v143, s[8:11], s26 offen offset:1024 sc1 lds
    buffer_load_dwordx4 v144, s[8:11], s26 offen offset:2048 sc1 lds
    buffer_load_dwordx4 v144, s[8:11], s26 offen offset:3072 sc1 lds
    s_add_u32 s26, s26, 8192
    s_and_b32 s26, s26, 0x1ffff
kd_29:
    v_exp_f32 v32, v32
    v_exp_f32 v33, v33
    v_exp_f32 v34, v34
    v_mfma_f32_16x16x32_bf16 v[52:55], v[116:119], v[104:107], 0
    v_exp_f32 v35, v35
    v_cvt_pk_bf16_f32 v64, v32, v33
    v_mfma_f32_16x16x32_bf16 v[56:59], v[112:115], v[108:111], 0
    v_exp_f32 v36, v36
    v_exp_f32 v37, v37
    v_cvt_pk_bf16_f32 v65, v34, v35
    v_mfma_f32_16x16x32_bf16 v[60:63], v[116:119], v[108:111], 0
    ds_read_b128 v[112:115], v245 offset:0
    ds_read_b128 v[116:119], v245 offset:1024
    v_exp_f32 v38, v38
    v_exp_f32 v39, v39
    v_mfma_f32_16x16x32_bf16 v[16:19], v[120:123], v[72:75], v[16:19]
    v_cvt_pk_bf16_f32 v66, v36, v37
    v_exp_f32 v40, v40
    v_exp_f32 v41, v41
    v_mfma_f32_16x16x32_bf16 v[20:23], v[124:127], v[72:75], v[20:23]
    v_cvt_pk_bf16_f32 v67, v38, v39
    v_exp_f32 v42, v42
    v_mfma_f32_16x16x32_bf16 v[24:27], v[120:123], v[76:79], v[24:27]
    v_exp_f32 v43, v43
    v_cvt_pk_bf16_f32 v68, v40, v41
    v_exp_f32 v44, v44
    v_mfma_f32_16x16x32_bf16 v[28:31], v[124:127], v[76:79], v[28:31]
    ds_read_b128 v[120:123], v245 offset:47104
    ds_read_b128 v[124:127], v245 offset:48128
    v_exp_f32 v45, v45
    v_cvt_pk_bf16_f32 v69, v42, v43
    v_smfmac_f32_16x16x64_bf16 v[132:135], v[136:139], v[72:79], v140
    v_exp_f32 v46, v46
    v_exp_f32 v47, v47
    v_cvt_pk_bf16_f32 v70, v44, v45
    v_cvt_pk_bf16_f32 v71, v46, v47
    s_waitcnt lgkmcnt(2)
    v_mfma_f32_16x16x32_bf16 v[32:35], v[112:115], v[96:99], 0
    v_exp_f32 v48, v48
    v_exp_f32 v49, v49
    v_exp_f32 v50, v50
    v_mfma_f32_16x16x32_bf16 v[36:39], v[116:119], v[96:99], 0
    v_exp_f32 v51, v51
    v_cvt_pk_bf16_f32 v72, v48, v49
    v_mfma_f32_16x16x32_bf16 v[40:43], v[112:115], v[100:103], 0
    v_exp_f32 v52, v52
    v_exp_f32 v53, v53
    v_cvt_pk_bf16_f32 v73, v50, v51
    v_mfma_f32_16x16x32_bf16 v[44:47], v[116:119], v[100:103], 0
    v_exp_f32 v54, v54
    v_exp_f32 v55, v55
    s_waitcnt lgkmcnt(0)
    v_mfma_f32_16x16x32_bf16 v[0:3], v[120:123], v[64:67], v[0:3]
    v_cvt_pk_bf16_f32 v74, v52, v53
    v_exp_f32 v56, v56
    v_exp_f32 v57, v57
    v_mfma_f32_16x16x32_bf16 v[4:7], v[124:127], v[64:67], v[4:7]
    v_cvt_pk_bf16_f32 v75, v54, v55
    v_exp_f32 v58, v58
    v_mfma_f32_16x16x32_bf16 v[8:11], v[120:123], v[68:71], v[8:11]
    v_exp_f32 v59, v59
    v_cvt_pk_bf16_f32 v76, v56, v57
    v_exp_f32 v60, v60
    v_mfma_f32_16x16x32_bf16 v[12:15], v[124:127], v[68:71], v[12:15]
    v_exp_f32 v61, v61
    v_cvt_pk_bf16_f32 v77, v58, v59
    v_smfmac_f32_16x16x64_bf16 v[128:131], v[136:139], v[64:71], v140
    v_exp_f32 v62, v62
    v_exp_f32 v63, v63
    v_cvt_pk_bf16_f32 v78, v60, v61
    s_add_u32 s29, s29, 1
    s_cmp_lt_u32 s29, 5
    s_cbranch_scc1 att_21
    v_cvt_pk_bf16_f32 v79, v62, v63
    v_mfma_f32_16x16x32_bf16 v[48:51], v[112:115], v[104:107], 0
    v_exp_f32 v32, v32
    v_exp_f32 v33, v33
    v_exp_f32 v34, v34
    v_mfma_f32_16x16x32_bf16 v[52:55], v[116:119], v[104:107], 0
    v_exp_f32 v35, v35
    v_cvt_pk_bf16_f32 v64, v32, v33
    v_mfma_f32_16x16x32_bf16 v[56:59], v[112:115], v[108:111], 0
    v_exp_f32 v36, v36
    v_exp_f32 v37, v37
    v_cvt_pk_bf16_f32 v65, v34, v35
    v_mfma_f32_16x16x32_bf16 v[60:63], v[116:119], v[108:111], 0
    ds_read_b128 v[112:115], v245 offset:4096
    ds_read_b128 v[116:119], v245 offset:5120
    v_exp_f32 v38, v38
    v_exp_f32 v39, v39
    v_mfma_f32_16x16x32_bf16 v[16:19], v[120:123], v[72:75], v[16:19]
    v_cvt_pk_bf16_f32 v66, v36, v37
    v_exp_f32 v40, v40
    v_exp_f32 v41, v41
    v_mfma_f32_16x16x32_bf16 v[20:23], v[124:127], v[72:75], v[20:23]
    v_cvt_pk_bf16_f32 v67, v38, v39
    v_exp_f32 v42, v42
    v_mfma_f32_16x16x32_bf16 v[24:27], v[120:123], v[76:79], v[24:27]
    v_exp_f32 v43, v43
    v_cvt_pk_bf16_f32 v68, v40, v41
    v_exp_f32 v44, v44
    v_mfma_f32_16x16x32_bf16 v[28:31], v[124:127], v[76:79], v[28:31]
    ds_read_b128 v[120:123], v245 offset:2048
    ds_read_b128 v[124:127], v245 offset:3072
    v_exp_f32 v45, v45
    v_cvt_pk_bf16_f32 v69, v42, v43
    v_smfmac_f32_16x16x64_bf16 v[132:135], v[136:139], v[72:79], v140
    v_exp_f32 v46, v46
    v_exp_f32 v47, v47
    v_cvt_pk_bf16_f32 v70, v44, v45
    v_cvt_pk_bf16_f32 v71, v46, v47
    s_waitcnt lgkmcnt(2)
    v_mfma_f32_16x16x32_bf16 v[32:35], v[112:115], v[96:99], 0
    v_exp_f32 v48, v48
    v_exp_f32 v49, v49
    v_exp_f32 v50, v50
    v_mfma_f32_16x16x32_bf16 v[36:39], v[116:119], v[96:99], 0
    v_exp_f32 v51, v51
    v_cvt_pk_bf16_f32 v72, v48, v49
    v_mfma_f32_16x16x32_bf16 v[40:43], v[112:115], v[100:103], 0
    v_exp_f32 v52, v52
    v_exp_f32 v53, v53
    v_cvt_pk_bf16_f32 v73, v50, v51
    v_mfma_f32_16x16x32_bf16 v[44:47], v[116:119], v[100:103], 0
    v_exp_f32 v54, v54
    v_exp_f32 v55, v55
    s_waitcnt lgkmcnt(0)
    v_mfma_f32_16x16x32_bf16 v[0:3], v[120:123], v[64:67], v[0:3]
    v_cvt_pk_bf16_f32 v74, v52, v53
    v_exp_f32 v56, v56
    v_exp_f32 v57, v57
    v_mfma_f32_16x16x32_bf16 v[4:7], v[124:127], v[64:67], v[4:7]
    v_cvt_pk_bf16_f32 v75, v54, v55
    v_exp_f32 v58, v58
    v_mfma_f32_16x16x32_bf16 v[8:11], v[120:123], v[68:71], v[8:11]
    v_exp_f32 v59, v59
    v_cvt_pk_bf16_f32 v76, v56, v57
    v_exp_f32 v60, v60
    v_mfma_f32_16x16x32_bf16 v[12:15], v[124:127], v[68:71], v[12:15]
    v_exp_f32 v61, v61
    v_cvt_pk_bf16_f32 v77, v58, v59
    v_smfmac_f32_16x16x64_bf16 v[128:131], v[136:139], v[64:71], v140
    v_exp_f32 v62, v62
    v_exp_f32 v63, v63
    v_cvt_pk_bf16_f32 v78, v60, v61
    v_cvt_pk_bf16_f32 v79, v62, v63
    v_mfma_f32_16x16x32_bf16 v[48:51], v[112:115], v[104:107], 0
    v_exp_f32 v32, v32
    v_exp_f32 v33, v33
    v_exp_f32 v34, v34
    v_mfma_f32_16x16x32_bf16 v[52:55], v[116:119], v[104:107], 0
    v_exp_f32 v35, v35
    v_cvt_pk_bf16_f32 v64, v32, v33
    v_mfma_f32_16x16x32_bf16 v[56:59], v[112:115], v[108:111], 0
    v_exp_f32 v36, v36
    v_exp_f32 v37, v37
    v_cvt_pk_bf16_f32 v65, v34, v35
    v_mfma_f32_16x16x32_bf16 v[60:63], v[116:119], v[108:111], 0
    ds_read_b128 v[112:115], v245 offset:8192
    ds_read_b128 v[116:119], v245 offset:9216
    v_exp_f32 v38, v38
    v_exp_f32 v39, v39
    v_mfma_f32_16x16x32_bf16 v[16:19], v[120:123], v[72:75], v[16:19]
    v_cvt_pk_bf16_f32 v66, v36, v37
    v_exp_f32 v40, v40
    v_exp_f32 v41, v41
    v_mfma_f32_16x16x32_bf16 v[20:23], v[124:127], v[72:75], v[20:23]
    v_cvt_pk_bf16_f32 v67, v38, v39
    v_exp_f32 v42, v42
    v_mfma_f32_16x16x32_bf16 v[24:27], v[120:123], v[76:79], v[24:27]
    v_exp_f32 v43, v43
    v_cvt_pk_bf16_f32 v68, v40, v41
    v_exp_f32 v44, v44
    v_mfma_f32_16x16x32_bf16 v[28:31], v[124:127], v[76:79], v[28:31]
    ds_read_b128 v[120:123], v245 offset:6144
    ds_read_b128 v[124:127], v245 offset:7168
    v_exp_f32 v45, v45
    v_cvt_pk_bf16_f32 v69, v42, v43
    v_smfmac_f32_16x16x64_bf16 v[132:135], v[136:139], v[72:79], v140
    v_exp_f32 v46, v46
    v_exp_f32 v47, v47
    v_cvt_pk_bf16_f32 v70, v44, v45
    v_cvt_pk_bf16_f32 v71, v46, v47
    s_waitcnt lgkmcnt(2)
    v_mfma_f32_16x16x32_bf16 v[32:35], v[112:115], v[96:99], 0
    v_exp_f32 v48, v48
    v_exp_f32 v49, v49
    v_exp_f32 v50, v50
    v_mfma_f32_16x16x32_bf16 v[36:39], v[116:119], v[96:99], 0
    v_exp_f32 v51, v51
    v_cvt_pk_bf16_f32 v72, v48, v49
    v_mfma_f32_16x16x32_bf16 v[40:43], v[112:115], v[100:103], 0
    v_exp_f32 v52, v52
    v_exp_f32 v53, v53
    v_cvt_pk_bf16_f32 v73, v50, v51
    v_mfma_f32_16x16x32_bf16 v[44:47], v[116:119], v[100:103], 0
    v_exp_f32 v54, v54
    v_exp_f32 v55, v55
    s_waitcnt lgkmcnt(0)
    v_mfma_f32_16x16x32_bf16 v[0:3], v[120:123], v[64:67], v[0:3]
    v_cvt_pk_bf16_f32 v74, v52, v53
    v_exp_f32 v56, v56
    v_exp_f32 v57, v57
    v_mfma_f32_16x16x32_bf16 v[4:7], v[124:127], v[64:67], v[4:7]
    v_cvt_pk_bf16_f32 v75, v54, v55
    v_exp_f32 v58, v58
    v_mfma_f32_16x16x32_bf16 v[8:11], v[120:123], v[68:71], v[8:11]
    v_exp_f32 v59, v59
    v_cvt_pk_bf16_f32 v76, v56, v57
    v_exp_f32 v60, v60
    v_mfma_f32_16x16x32_bf16 v[12:15], v[124:127], v[68:71], v[12:15]
    v_exp_f32 v61, v61
    v_cvt_pk_bf16_f32 v77, v58, v59
    v_smfmac_f32_16x16x64_bf16 v[128:131], v[136:139], v[64:71], v140
    v_exp_f32 v62, v62
    v_exp_f32 v63, v63
    v_cvt_pk_bf16_f32 v78, v60, v61
    v_cvt_pk_bf16_f32 v79, v62, v63
    v_mfma_f32_16x16x32_bf16 v[48:51], v[112:115], v[104:107], 0
    v_exp_f32 v32, v32
    v_exp_f32 v33, v33
    v_exp_f32 v34, v34
    v_mfma_f32_16x16x32_bf16 v[52:55], v[116:119], v[104:107], 0
    v_exp_f32 v35, v35
    v_cvt_pk_bf16_f32 v64, v32, v33
    v_mfma_f32_16x16x32_bf16 v[56:59], v[112:115], v[108:111], 0
    v_exp_f32 v36, v36
    v_exp_f32 v37, v37
    v_cvt_pk_bf16_f32 v65, v34, v35
    v_mfma_f32_16x16x32_bf16 v[60:63], v[116:119], v[108:111], 0
    ds_read_b128 v[112:115], v245 offset:12288
    ds_read_b128 v[116:119], v245 offset:13312
    v_exp_f32 v38, v38
    v_exp_f32 v39, v39
    v_mfma_f32_16x16x32_bf16 v[16:19], v[120:123], v[72:75], v[16:19]
    v_cvt_pk_bf16_f32 v66, v36, v37
    v_exp_f32 v40, v40
    v_exp_f32 v41, v41
    v_mfma_f32_16x16x32_bf16 v[20:23], v[124:127], v[72:75], v[20:23]
    v_cvt_pk_bf16_f32 v67, v38, v39
    v_exp_f32 v42, v42
    v_mfma_f32_16x16x32_bf16 v[24:27], v[120:123], v[76:79], v[24:27]
    v_exp_f32 v43, v43
    v_cvt_pk_bf16_f32 v68, v40, v41
    v_exp_f32 v44, v44
    v_mfma_f32_16x16x32_bf16 v[28:31], v[124:127], v[76:79], v[28:31]
    ds_read_b128 v[120:123], v245 offset:10240
    ds_read_b128 v[124:127], v245 offset:11264
    v_exp_f32 v45, v45
    v_cvt_pk_bf16_f32 v69, v42, v43
    v_smfmac_f32_16x16x64_bf16 v[132:135], v[136:139], v[72:79], v140
    v_exp_f32 v46, v46
    v_exp_f32 v47, v47
    v_cvt_pk_bf16_f32 v70, v44, v45
    v_cvt_pk_bf16_f32 v71, v46, v47
    s_waitcnt lgkmcnt(2)
    v_mfma_f32_16x16x32_bf16 v[32:35], v[112:115], v[96:99], 0
    v_exp_f32 v48, v48
    v_exp_f32 v49, v49
    v_exp_f32 v50, v50
    v_mfma_f32_16x16x32_bf16 v[36:39], v[116:119], v[96:99], 0
    v_exp_f32 v51, v51
    v_cvt_pk_bf16_f32 v72, v48, v49
    v_mfma_f32_16x16x32_bf16 v[40:43], v[112:115], v[100:103], 0
    v_exp_f32 v52, v52
    v_exp_f32 v53, v53
    v_cvt_pk_bf16_f32 v73, v50, v51
    v_mfma_f32_16x16x32_bf16 v[44:47], v[116:119], v[100:103], 0
    v_exp_f32 v54, v54
    v_exp_f32 v55, v55
    s_waitcnt lgkmcnt(0)
    v_mfma_f32_16x16x32_bf16 v[0:3], v[120:123], v[64:67], v[0:3]
    v_cvt_pk_bf16_f32 v74, v52, v53
    v_exp_f32 v56, v56
    v_exp_f32 v57, v57
    v_mfma_f32_16x16x32_bf16 v[4:7], v[124:127], v[64:67], v[4:7]
    v_cvt_pk_bf16_f32 v75, v54, v55
    v_exp_f32 v58, v58
    v_mfma_f32_16x16x32_bf16 v[8:11], v[120:123], v[68:71], v[8:11]
    v_exp_f32 v59, v59
    v_cvt_pk_bf16_f32 v76, v56, v57
    v_exp_f32 v60, v60
    v_mfma_f32_16x16x32_bf16 v[12:15], v[124:127], v[68:71], v[12:15]
    v_exp_f32 v61, v61
    v_cvt_pk_bf16_f32 v77, v58, v59
    v_smfmac_f32_16x16x64_bf16 v[128:131], v[136:139], v[64:71], v140
    v_exp_f32 v62, v62
    v_exp_f32 v63, v63
    v_cvt_pk_bf16_f32 v78, v60, v61
    v_cvt_pk_bf16_f32 v79, v62, v63
    v_mfma_f32_16x16x32_bf16 v[48:51], v[112:115], v[104:107], 0
    v_exp_f32 v32, v32
    v_exp_f32 v33, v33
    v_exp_f32 v34, v34
    v_mfma_f32_16x16x32_bf16 v[52:55], v[116:119], v[104:107], 0
    v_exp_f32 v35, v35
    v_cvt_pk_bf16_f32 v64, v32, v33
    v_mfma_f32_16x16x32_bf16 v[56:59], v[112:115], v[108:111], 0
    v_exp_f32 v36, v36
    v_exp_f32 v37, v37
    v_cvt_pk_bf16_f32 v65, v34, v35
    v_mfma_f32_16x16x32_bf16 v[60:63], v[116:119], v[108:111], 0
    ds_read_b128 v[112:115], v245 offset:16384
    ds_read_b128 v[116:119], v245 offset:17408
    v_exp_f32 v38, v38
    v_exp_f32 v39, v39
    v_mfma_f32_16x16x32_bf16 v[16:19], v[120:123], v[72:75], v[16:19]
    v_cvt_pk_bf16_f32 v66, v36, v37
    v_exp_f32 v40, v40
    v_exp_f32 v41, v41
    v_mfma_f32_16x16x32_bf16 v[20:23], v[124:127], v[72:75], v[20:23]
    v_cvt_pk_bf16_f32 v67, v38, v39
    v_exp_f32 v42, v42
    v_mfma_f32_16x16x32_bf16 v[24:27], v[120:123], v[76:79], v[24:27]
    v_exp_f32 v43, v43
    v_cvt_pk_bf16_f32 v68, v40, v41
    v_exp_f32 v44, v44
    v_mfma_f32_16x16x32_bf16 v[28:31], v[124:127], v[76:79], v[28:31]
    ds_read_b128 v[120:123], v245 offset:14336
    ds_read_b128 v[124:127], v245 offset:15360
    v_exp_f32 v45, v45
    v_cvt_pk_bf16_f32 v69, v42, v43
    v_smfmac_f32_16x16x64_bf16 v[132:135], v[136:139], v[72:79], v140
    v_exp_f32 v46, v46
    v_exp_f32 v47, v47
    v_cvt_pk_bf16_f32 v70, v44, v45
    v_cvt_pk_bf16_f32 v71, v46, v47
    s_waitcnt lgkmcnt(2)
    v_mfma_f32_16x16x32_bf16 v[32:35], v[112:115], v[96:99], 0
    v_exp_f32 v48, v48
    v_exp_f32 v49, v49
    v_exp_f32 v50, v50
    v_mfma_f32_16x16x32_bf16 v[36:39], v[116:119], v[96:99], 0
    v_exp_f32 v51, v51
    v_cvt_pk_bf16_f32 v72, v48, v49
    v_mfma_f32_16x16x32_bf16 v[40:43], v[112:115], v[100:103], 0
    v_exp_f32 v52, v52
    v_exp_f32 v53, v53
    v_cvt_pk_bf16_f32 v73, v50, v51
    v_mfma_f32_16x16x32_bf16 v[44:47], v[116:119], v[100:103], 0
    v_exp_f32 v54, v54
    v_exp_f32 v55, v55
    s_waitcnt lgkmcnt(0)
    v_mfma_f32_16x16x32_bf16 v[0:3], v[120:123], v[64:67], v[0:3]
    v_cvt_pk_bf16_f32 v74, v52, v53
    v_exp_f32 v56, v56
    v_exp_f32 v57, v57
    v_mfma_f32_16x16x32_bf16 v[4:7], v[124:127], v[64:67], v[4:7]
    v_cvt_pk_bf16_f32 v75, v54, v55
    v_exp_f32 v58, v58
    v_mfma_f32_16x16x32_bf16 v[8:11], v[120:123], v[68:71], v[8:11]
    v_exp_f32 v59, v59
    v_cvt_pk_bf16_f32 v76, v56, v57
    v_exp_f32 v60, v60
    v_mfma_f32_16x16x32_bf16 v[12:15], v[124:127], v[68:71], v[12:15]
    v_exp_f32 v61, v61
    v_cvt_pk_bf16_f32 v77, v58, v59
    v_smfmac_f32_16x16x64_bf16 v[128:131], v[136:139], v[64:71], v140
    v_exp_f32 v62, v62
    v_exp_f32 v63, v63
    v_cvt_pk_bf16_f32 v78, v60, v61
    v_cvt_pk_bf16_f32 v79, v62, v63
    s_nop 1
    v_mfma_f32_16x16x32_bf16 v[16:19], v[120:123], v[72:75], v[16:19]
    v_mfma_f32_16x16x32_bf16 v[20:23], v[124:127], v[72:75], v[20:23]
    v_mfma_f32_16x16x32_bf16 v[24:27], v[120:123], v[76:79], v[24:27]
    v_mfma_f32_16x16x32_bf16 v[28:31], v[124:127], v[76:79], v[28:31]
    v_smfmac_f32_16x16x64_bf16 v[132:135], v[136:139], v[72:79], v140
    s_nop 7
    s_setprio 3
    v_add_f32 v148, v128, v129
    v_add_f32 v149, v130, v131
    v_add_f32 v150, v132, v133
    v_add_f32 v151, v134, v135
    v_mov_b32 v152, v148
    v_mov_b32 v153, v149
    v_mov_b32 v154, v150
    v_mov_b32 v155, v151
    s_nop 1
    v_permlane16_swap_b32 v148, v152
    v_permlane16_swap_b32 v149, v153
    v_permlane16_swap_b32 v150, v154
    v_permlane16_swap_b32 v151, v155
    v_add_f32 v148, v148, v152
    v_add_f32 v149, v149, v153
    v_add_f32 v150, v150, v154
    v_add_f32 v151, v151, v155
    v_mov_b32 v152, v148
    v_mov_b32 v153, v149
    v_mov_b32 v154, v150
    v_mov_b32 v155, v151
    s_nop 1
    v_permlane32_swap_b32 v148, v152
    v_permlane32_swap_b32 v149, v153
    v_permlane32_swap_b32 v150, v154
    v_permlane32_swap_b32 v151, v155
    v_add_f32 v148, v148, v152
    v_add_f32 v149, v149, v153
    v_add_f32 v150, v150, v154
    v_add_f32 v151, v151, v155
.p2align 3
    v_mov_b32 v156, 0
    v_mov_b32 v157, 0
    v_pk_mul_f32 v[152:153], v[0:1], v[156:157]
    v_pk_fma_f32 v[152:153], v[2:3], v[156:157], v[152:153]
    v_pk_fma_f32 v[152:153], v[4:5], v[156:157], v[152:153]
    v_pk_fma_f32 v[152:153], v[6:7], v[156:157], v[152:153]
    v_pk_fma_f32 v[152:153], v[8:9], v[156:157], v[152:153]
    v_pk_fma_f32 v[152:153], v[10:11], v[156:157], v[152:153]
    v_pk_fma_f32 v[152:153], v[12:13], v[156:157], v[152:153]
    v_pk_fma_f32 v[152:153], v[14:15], v[156:157], v[152:153]
    v_pk_fma_f32 v[152:153], v[16:17], v[156:157], v[152:153]
    v_pk_fma_f32 v[152:153], v[18:19], v[156:157], v[152:153]
    v_pk_fma_f32 v[152:153], v[20:21], v[156:157], v[152:153]
    v_pk_fma_f32 v[152:153], v[22:23], v[156:157], v[152:153]
    v_pk_fma_f32 v[152:153], v[24:25], v[156:157], v[152:153]
    v_pk_fma_f32 v[152:153], v[26:27], v[156:157], v[152:153]
    v_pk_fma_f32 v[152:153], v[28:29], v[156:157], v[152:153]
    v_pk_fma_f32 v[152:153], v[30:31], v[156:157], v[152:153]
    v_pk_fma_f32 v[152:153], v[148:149], v[156:157], v[152:153]
    v_pk_fma_f32 v[152:153], v[150:151], v[156:157], v[152:153]
    v_add_f32 v152, v152, v153
    v_min3_f32 v153, v148, v149, v150
    v_max3_f32 v154, v148, v149, v150
    v_min_f32 v153, v153, v151
    v_max_f32 v154, v154, v151
    v_add_f32 v153, v153, v152
    v_add_f32 v154, v154, v152
    v_cmp_nle_f32 vcc, 0x21800000, v153
    s_mov_b32 s42, 0x5d800000
    v_cmp_nge_f32 s[40:41], s42, v154
    s_nop 1
    s_or_b64 vcc, vcc, s[40:41]
    s_cbranch_vccnz slow_30
fin_31:
    s_add_u32 s12, s4, 0x2900000
    s_addc_u32 s13, s5, 0
    s_mov_b32 s14, 0x400000
    s_mov_b32 s15, 0x00020000
    v_rcp_f32 v152, v148
    v_rcp_f32 v153, v148
    v_rcp_f32 v154, v149
    v_rcp_f32 v155, v149
    v_rcp_f32 v156, v150
    v_rcp_f32 v157, v150
    v_rcp_f32 v158, v151
    v_rcp_f32 v159, v151
    s_lshl_b32 s6, s22, 3
    s_lshl_b32 s7, s21, 1
    s_add_u32 s6, s6, s7
    s_lshl_b32 s6, s6, 5
    s_add_u32 s6, s6, s25
    s_lshl_b32 s6, s6, 11
    s_add_u32 s7, s6, 65536
.p2align 3
    v_pk_mul_f32 v[0:1], v[0:1], v[152:153]
    v_pk_mul_f32 v[2:3], v[2:3], v[152:153]
    v_pk_mul_f32 v[4:5], v[4:5], v[152:153]
    v_pk_mul_f32 v[6:7], v[6:7], v[152:153]
    v_cvt_pk_bf16_f32 v64, v0, v1
    v_cvt_pk_bf16_f32 v65, v2, v3
    v_cvt_pk_bf16_f32 v66, v4, v5
    v_cvt_pk_bf16_f32 v67, v6, v7
    buffer_store_dwordx4 v[64:67], v245, s[12:15], s6 offen offset:0 sc1
    v_pk_mul_f32 v[8:9], v[8:9], v[154:155]
    v_pk_mul_f32 v[10:11], v[10:11], v[154:155]
    v_pk_mul_f32 v[12:13], v[12:13], v[154:155]
    v_pk_mul_f32 v[14:15], v[14:15], v[154:155]
    v_cvt_pk_bf16_f32 v68, v8, v9
    v_cvt_pk_bf16_f32 v69, v10, v11
    v_cvt_pk_bf16_f32 v70, v12, v13
    v_cvt_pk_bf16_f32 v71, v14, v15
    buffer_store_dwordx4 v[68:71], v245, s[12:15], s6 offen offset:1024 sc1
    v_pk_mul_f32 v[16:17], v[16:17], v[156:157]
    v_pk_mul_f32 v[18:19], v[18:19], v[156:157]
    v_pk_mul_f32 v[20:21], v[20:21], v[156:157]
    v_pk_mul_f32 v[22:23], v[22:23], v[156:157]
    v_cvt_pk_bf16_f32 v72, v16, v17
    v_cvt_pk_bf16_f32 v73, v18, v19
    v_cvt_pk_bf16_f32 v74, v20, v21
    v_cvt_pk_bf16_f32 v75, v22, v23
    buffer_store_dwordx4 v[72:75], v245, s[12:15], s7 offen offset:0 sc1
    v_pk_mul_f32 v[24:25], v[24:25], v[158:159]
    v_pk_mul_f32 v[26:27], v[26:27], v[158:159]
    v_pk_mul_f32 v[28:29], v[28:29], v[158:159]
    v_pk_mul_f32 v[30:31], v[30:31], v[158:159]
    v_cvt_pk_bf16_f32 v76, v24, v25
    v_cvt_pk_bf16_f32 v77, v26, v27
    v_cvt_pk_bf16_f32 v78, v28, v29
    v_cvt_pk_bf16_f32 v79, v30, v31
    buffer_store_dwordx4 v[76:79], v245, s[12:15], s7 offen offset:1024 sc1
    s_lshl_b32 s42, s22, 5
    s_add_u32 s42, s42, s25
    s_lshl_b32 s42, s42, 7
    s_add_u32 s42, s42, 131072
    s_lshr_b32 s43, s100, 1
    s_lshl_b32 s43, s43, 12
    s_add_u32 s43, s43, 131072
    s_nop 1
    s_add_u32 s8, s4, 0x2900000
    s_addc_u32 s9, s5, 0
    s_mov_b32 s10, 0x400000
    s_mov_b32 s11, 0x00020000
    s_mov_b32 s12, s52
    s_mov_b32 s13, s53
    s_mov_b32 s14, 0x200000
    s_mov_b32 s15, 0x00020000
    s_lshl_b32 s3, s100, 2
    s_add_u32 s3, s3, s21
    s_mul_i32 s3, s3, 65536
    v_add_u32 v228, s3, v245
    v_lshrrev_b32 v97, 3, v250
    s_lshl_b32 s3, s21, 4
    v_add_u32 v97, s3, v97
    v_lshlrev_b32 v97, 11, v97
    v_lshrrev_b32 v98, 4, v250
    v_lshlrev_b32 v98, 1, v98
    v_and_b32 v99, 7, v250
    v_xor_b32 v98, v98, v99
    v_lshl_add_u32 v97, v98, 4, v97
    s_lshl_b32 s3, s101, 7
    v_add_u32 v229, s3, v97
    v_add_u32 v230, 15360, v229
    s_lshl_b32 s30, s21, 11
    s_mov_b32 s26, 0
    s_mov_b32 s27, 0
    v_bfe_u32 v97, v250, 4, 1
    v_lshrrev_b32 v98, 5, v250
    v_bfe_u32 v99, v250, 2, 2
    v_lshlrev_b32 v100, 2, v97
    v_lshl_add_u32 v100, v98, 3, v100
    v_add_u32 v100, v100, v99
    v_lshlrev_b32 v100, 7, v100
    v_lshrrev_b32 v99, 1, v99
    v_lshl_add_u32 v99, v97, 1, v99
    v_lshl_add_u32 v100, v99, 5, v100
    v_and_b32 v98, 3, v250
    v_lshl_add_u32 v100, v98, 3, v100
    v_add_u32 v224, 0, v100
    v_xor_b32 v225, 32, v224
    v_xor_b32 v226, 64, v224
    v_xor_b32 v227, 96, v224
    v_mov_b32 v0, 0
    v_mov_b32 v1, 0
    v_mov_b32 v2, 0
    v_mov_b32 v3, 0
    v_mov_b32 v4, 0
    v_mov_b32 v5, 0
    v_mov_b32 v6, 0
    v_mov_b32 v7, 0
    v_mov_b32 v8, 0
    v_mov_b32 v9, 0
    v_mov_b32 v10, 0
    v_mov_b32 v11, 0
    v_mov_b32 v12, 0
    v_mov_b32 v13, 0
    v_mov_b32 v14, 0
    v_mov_b32 v15, 0
    v_mov_b32 v16, 0
    v_mov_b32 v17, 0
    v_mov_b32 v18, 0
    v_mov_b32 v19, 0
    v_mov_b32 v20, 0
    v_mov_b32 v21, 0
    v_mov_b32 v22, 0
    v_mov_b32 v23, 0
    v_mov_b32 v24, 0
    v_mov_b32 v25, 0
    v_mov_b32 v26, 0
    v_mov_b32 v27, 0
    v_mov_b32 v28, 0
    v_mov_b32 v29, 0
    v_mov_b32 v30, 0
    v_mov_b32 v31, 0
    s_waitcnt vmcnt(0)
    s_add_u32 s88, s88, 1
    ds_add_u32 v246, v248
    ds_read_b32 v249, v247
    s_waitcnt lgkmcnt(0)
    v_cmp_gt_u32 vcc, s88, v249
    s_cbranch_vccnz spin_33
ok_34:
    s_cmp_lg_u32 s21, 0
    s_cbranch_scc1 fw_32
    v_mov_b32 v242, 0
    v_mov_b32 v243, s31
    s_mov_b64 exec, 1
    buffer_store_dword v243, v242, s[32:35], s42 offen sc1
    s_mov_b64 exec, -1
fw_32:
    v_add_u32 v244, 1024, v247
    ds_read_b32 v249, v244
    s_waitcnt lgkmcnt(0)
    v_cmp_gt_u32 vcc, 35, v249
    s_cbranch_vccnz spin_36
ok_37:
    s_mov_b32 s16, s48
    s_mov_b32 s17, s49
    s_mov_b32 s18, 0x400000
    s_mov_b32 s19, 0x00020000
    s_lshl_b32 s3, s100, 2
    s_add_u32 s3, s3, s21
    s_lshl_b32 s3, s3, 5
    v_and_b32 v231, 15, v250
    v_add_u32 v231, s3, v231
    v_lshlrev_b32 v231, 11, v231
    v_lshrrev_b32 v232, 5, v250
    v_lshl_add_u32 v231, v232, 4, v231
    v_bfe_u32 v232, v250, 4, 1
    v_lshl_add_u32 v231, v232, 5, v231
    s_lshl_b32 s3, s101, 7
    s_add_u32 s3, s3, 0
    v_add_u32 v231, s3, v231
    s_mov_b32 s41, 32768
    buffer_load_dwordx4 v[232:235], v231, s[16:19], 0 offen
    buffer_load_dwordx4 v[236:239], v231, s[16:19], s41 offen
    s_add_u32 m0, s30, 0
    s_nop 0
    buffer_load_dwordx4 v229, s[12:15], s27 offen lds
    buffer_load_dwordx4 v230, s[12:15], s27 offen offset:1024 lds
    s_add_u32 s27, s27, 131072
    s_add_u32 m0, s30, 8192
    s_nop 0
    buffer_load_dwordx4 v229, s[12:15], s27 offen lds
    buffer_load_dwordx4 v230, s[12:15], s27 offen offset:1024 lds
    s_add_u32 s27, s27, 131072
    s_add_u32 m0, s30, 16384
    s_nop 0
    buffer_load_dwordx4 v229, s[12:15], s27 offen lds
    buffer_load_dwordx4 v230, s[12:15], s27 offen offset:1024 lds
    s_add_u32 s27, s27, 131072
    s_add_u32 m0, s30, 24576
    s_nop 0
    buffer_load_dwordx4 v229, s[12:15], s27 offen lds
    buffer_load_dwordx4 v230, s[12:15], s27 offen offset:1024 lds
    s_add_u32 s27, s27, 131072
    s_add_u32 m0, s30, 32768
    s_nop 0
    buffer_load_dwordx4 v229, s[12:15], s27 offen lds
    buffer_load_dwordx4 v230, s[12:15], s27 offen offset:1024 lds
    s_add_u32 s27, s27, 131072
    s_add_u32 m0, s30, 40960
    s_nop 0
    buffer_load_dwordx4 v229, s[12:15], s27 offen lds
    buffer_load_dwordx4 v230, s[12:15], s27 offen offset:1024 lds
    s_add_u32 s27, s27, 131072
    s_add_u32 m0, s30, 49152
    s_nop 0
    buffer_load_dwordx4 v229, s[12:15], s27 offen lds
    buffer_load_dwordx4 v230, s[12:15], s27 offen offset:1024 lds
    s_add_u32 s27, s27, 131072
    s_cmp_lg_u32 s21, 0
    s_cbranch_scc1 fw_35
    v_and_b32 v244, 31, v250
    v_lshlrev_b32 v244, 7, v244
    s_mov_b32 s97, 0x20000
    v_mov_b32 v240, 161796
gp_38:
    buffer_load_dword v242, v244, s[32:35], s43 offen sc1
    ds_read_b32 v243, v240
    s_waitcnt vmcnt(0) lgkmcnt(0)
    v_cmp_ne_u32 vcc, s31, v242
    s_cbranch_vccz gpd_39
    s_sleep 4
    v_readfirstlane_b32 s3, v243
    s_nop 0
    s_cmp_eq_u32 s3, s31
    s_cbranch_scc1 gp_38s
    s_sleep 8
gp_38s:
    s_sub_u32 s97, s97, 1
    s_cmp_lg_u32 s97, 0
    s_cbranch_scc1 gp_38
gpd_39:
fw_35:
    s_add_u32 s88, s88, 1
    ds_add_u32 v246, v248
    ds_read_b32 v249, v247
    s_waitcnt lgkmcnt(0)
    v_cmp_gt_u32 vcc, s88, v249
    s_cbranch_vccnz spin_40
ok_41:
    buffer_load_dwordx4 v[96:99], v228, s[8:11], s26 offen offset:0 sc1
    buffer_load_dwordx4 v[100:103], v228, s[8:11], s26 offen offset:1024 sc1
    buffer_load_dwordx4 v[104:107], v228, s[8:11], s26 offen offset:2048 sc1
    buffer_load_dwordx4 v[108:111], v228, s[8:11], s26 offen offset:3072 sc1
    s_add_u32 s26, s26, 4096
    buffer_load_dwordx4 v[112:115], v228, s[8:11], s26 offen offset:0 sc1
    buffer_load_dwordx4 v[116:119], v228, s[8:11], s26 offen offset:1024 sc1
    buffer_load_dwordx4 v[120:123], v228, s[8:11], s26 offen offset:2048 sc1
    buffer_load_dwordx4 v[124:127], v228, s[8:11], s26 offen offset:3072 sc1
    s_add_u32 s26, s26, 4096
    buffer_load_dwordx4 v[128:131], v228, s[8:11], s26 offen offset:0 sc1
    buffer_load_dwordx4 v[132:135], v228, s[8:11], s26 offen offset:1024 sc1
    buffer_load_dwordx4 v[136:139], v228, s[8:11], s26 offen offset:2048 sc1
    buffer_load_dwordx4 v[140:143], v228, s[8:11], s26 offen offset:3072 sc1
    s_add_u32 s26, s26, 4096
    s_waitcnt vmcnt(12)
    s_add_u32 s88, s88, 1
    ds_add_u32 v246, v248
    ds_read_b32 v249, v247
    s_waitcnt lgkmcnt(0)
    v_cmp_gt_u32 vcc, s88, v249
    s_cbranch_vccnz spin_42
ok_43:
    ds_read_b64_tr_b16 v[32:33], v224 offset:0
    ds_read_b64_tr_b16 v[34:35], v224 offset:2048
    ds_read_b64_tr_b16 v[36:37], v225 offset:0
    ds_read_b64_tr_b16 v[38:39], v225 offset:2048
    ds_read_b64_tr_b16 v[40:41], v226 offset:0
    ds_read_b64_tr_b16 v[42:43], v226 offset:2048
    ds_read_b64_tr_b16 v[44:45], v227 offset:0
    ds_read_b64_tr_b16 v[46:47], v227 offset:2048
    ds_read_b64_tr_b16 v[48:49], v224 offset:4096
    ds_read_b64_tr_b16 v[50:51], v224 offset:6144
    ds_read_b64_tr_b16 v[52:53], v225 offset:4096
    ds_read_b64_tr_b16 v[54:55], v225 offset:6144
    ds_read_b64_tr_b16 v[56:57], v226 offset:4096
    ds_read_b64_tr_b16 v[58:59], v226 offset:6144
    ds_read_b64_tr_b16 v[60:61], v227 offset:4096
    ds_read_b64_tr_b16 v[62:63], v227 offset:6144
    s_add_u32 s88, s88, 1
    ds_add_u32 v246, v248
    ds_read_b32 v249, v247
    s_waitcnt vmcnt(8)
    s_waitcnt lgkmcnt(0)
    v_cmp_gt_u32 vcc, s88, v249
    s_cbranch_vccnz spin_44
ok_45:
    s_add_u32 s88, s88, 1
    ds_add_u32 v246, v248
    v_mfma_f32_16x16x32_bf16 v[0:3], v[32:35], v[96:99], v[0:3]
    ds_read_b64_tr_b16 v[64:65], v224 offset:8192
    ds_read_b64_tr_b16 v[66:67], v224 offset:10240
    v_mfma_f32_16x16x32_bf16 v[4:7], v[32:35], v[100:103], v[4:7]
    ds_read_b64_tr_b16 v[68:69], v225 offset:8192
    s_add_u32 m0, s30, 57344
    s_nop 0
    buffer_load_dwordx4 v229, s[12:15], s27 offen lds
    v_mfma_f32_16x16x32_bf16 v[8:11], v[36:39], v[96:99], v[8:11]
    ds_read_b64_tr_b16 v[70:71], v225 offset:10240
    ds_read_b64_tr_b16 v[72:73], v226 offset:8192
    v_mfma_f32_16x16x32_bf16 v[12:15], v[36:39], v[100:103], v[12:15]
    ds_read_b64_tr_b16 v[74:75], v226 offset:10240
    buffer_load_dwordx4 v230, s[12:15], s27 offen offset:1024 lds
    s_add_u32 s27, s27, 131072
    v_mfma_f32_16x16x32_bf16 v[16:19], v[40:43], v[96:99], v[16:19]
    ds_read_b64_tr_b16 v[76:77], v227 offset:8192
    ds_read_b64_tr_b16 v[78:79], v227 offset:10240
    v_mfma_f32_16x16x32_bf16 v[20:23], v[40:43], v[100:103], v[20:23]
    ds_read_b64_tr_b16 v[80:81], v224 offset:12288
    v_mfma_f32_16x16x32_bf16 v[24:27], v[44:47], v[96:99], v[24:27]
    buffer_load_dwordx4 v[144:147], v228, s[8:11], s26 offen offset:0 sc1
    ds_read_b64_tr_b16 v[82:83], v224 offset:14336
    v_mfma_f32_16x16x32_bf16 v[28:31], v[44:47], v[100:103], v[28:31]
    ds_read_b64_tr_b16 v[84:85], v225 offset:12288
    ds_read_b64_tr_b16 v[86:87], v225 offset:14336
    v_mfma_f32_16x16x32_bf16 v[0:3], v[48:51], v[104:107], v[0:3]
    buffer_load_dwordx4 v[148:151], v228, s[8:11], s26 offen offset:1024 sc1
    ds_read_b64_tr_b16 v[88:89], v226 offset:12288
    v_mfma_f32_16x16x32_bf16 v[4:7], v[48:51], v[108:111], v[4:7]
    ds_read_b64_tr_b16 v[90:91], v226 offset:14336
    ds_read_b64_tr_b16 v[92:93], v227 offset:12288
    v_mfma_f32_16x16x32_bf16 v[8:11], v[52:55], v[104:107], v[8:11]
    buffer_load_dwordx4 v[152:155], v228, s[8:11], s26 offen offset:2048 sc1
    ds_read_b64_tr_b16 v[94:95], v227 offset:14336
    v_mfma_f32_16x16x32_bf16 v[12:15], v[52:55], v[108:111], v[12:15]
    buffer_load_dwordx4 v[156:159], v228, s[8:11], s26 offen offset:3072 sc1
    s_add_u32 s26, s26, 4096
    v_mfma_f32_16x16x32_bf16 v[16:19], v[56:59], v[104:107], v[16:19]
    v_mfma_f32_16x16x32_bf16 v[20:23], v[56:59], v[108:111], v[20:23]
    ds_read_b32 v249, v247
    v_mfma_f32_16x16x32_bf16 v[24:27], v[60:63], v[104:107], v[24:27]
    v_mfma_f32_16x16x32_bf16 v[28:31], v[60:63], v[108:111], v[28:31]
    s_waitcnt vmcnt(10)
    s_waitcnt lgkmcnt(0)
    v_cmp_gt_u32 vcc, s88, v249
    s_cbranch_vccnz spin_46
ok_47:
    s_add_u32 s88, s88, 1
    ds_add_u32 v246, v248
    v_mfma_f32_16x16x32_bf16 v[0:3], v[64:67], v[112:115], v[0:3]
    ds_read_b64_tr_b16 v[32:33], v224 offset:16384
    ds_read_b64_tr_b16 v[34:35], v224 offset:18432
    v_mfma_f32_16x16x32_bf16 v[4:7], v[64:67], v[116:119], v[4:7]
    ds_read_b64_tr_b16 v[36:37], v225 offset:16384
    s_add_u32 m0, s30, 0
    s_nop 0
    buffer_load_dwordx4 v229, s[12:15], s27 offen lds
    v_mfma_f32_16x16x32_bf16 v[8:11], v[68:71], v[112:115], v[8:11]
    ds_read_b64_tr_b16 v[38:39], v225 offset:18432
    ds_read_b64_tr_b16 v[40:41], v226 offset:16384
    v_mfma_f32_16x16x32_bf16 v[12:15], v[68:71], v[116:119], v[12:15]
    ds_read_b64_tr_b16 v[42:43], v226 offset:18432
    buffer_load_dwordx4 v230, s[12:15], s27 offen offset:1024 lds
    s_add_u32 s27, s27, 131072
    v_mfma_f32_16x16x32_bf16 v[16:19], v[72:75], v[112:115], v[16:19]
    ds_read_b64_tr_b16 v[44:45], v227 offset:16384
    ds_read_b64_tr_b16 v[46:47], v227 offset:18432
    v_mfma_f32_16x16x32_bf16 v[20:23], v[72:75], v[116:119], v[20:23]
    ds_read_b64_tr_b16 v[48:49], v224 offset:20480
    v_mfma_f32_16x16x32_bf16 v[24:27], v[76:79], v[112:115], v[24:27]
    buffer_load_dwordx4 v[160:163], v228, s[8:11], s26 offen offset:0 sc1
    ds_read_b64_tr_b16 v[50:51], v224 offset:22528
    v_mfma_f32_16x16x32_bf16 v[28:31], v[76:79], v[116:119], v[28:31]
    ds_read_b64_tr_b16 v[52:53], v225 offset:20480
    ds_read_b64_tr_b16 v[54:55], v225 offset:22528
    v_mfma_f32_16x16x32_bf16 v[0:3], v[80:83], v[120:123], v[0:3]
    buffer_load_dwordx4 v[164:167], v228, s[8:11], s26 offen offset:1024 sc1
    ds_read_b64_tr_b16 v[56:57], v226 offset:20480
    v_mfma_f32_16x16x32_bf16 v[4:7], v[80:83], v[124:127], v[4:7]
    ds_read_b64_tr_b16 v[58:59], v226 offset:22528
    ds_read_b64_tr_b16 v[60:61], v227 offset:20480
    v_mfma_f32_16x16x32_bf16 v[8:11], v[84:87], v[120:123], v[8:11]
    buffer_load_dwordx4 v[168:171], v228, s[8:11], s26 offen offset:2048 sc1
    ds_read_b64_tr_b16 v[62:63], v227 offset:22528
    v_mfma_f32_16x16x32_bf16 v[12:15], v[84:87], v[124:127], v[12:15]
    buffer_load_dwordx4 v[172:175], v228, s[8:11], s26 offen offset:3072 sc1
    s_add_u32 s26, s26, 4096
    v_mfma_f32_16x16x32_bf16 v[16:19], v[88:91], v[120:123], v[16:19]
    v_mfma_f32_16x16x32_bf16 v[20:23], v[88:91], v[124:127], v[20:23]
    ds_read_b32 v249, v247
    v_mfma_f32_16x16x32_bf16 v[24:27], v[92:95], v[120:123], v[24:27]
    v_mfma_f32_16x16x32_bf16 v[28:31], v[92:95], v[124:127], v[28:31]
    s_waitcnt vmcnt(12)
    s_waitcnt lgkmcnt(0)
    v_cmp_gt_u32 vcc, s88, v249
    s_cbranch_vccnz spin_48
ok_49:
    s_add_u32 s88, s88, 1
    ds_add_u32 v246, v248
    v_mfma_f32_16x16x32_bf16 v[0:3], v[32:35], v[128:131], v[0:3]
    ds_read_b64_tr_b16 v[64:65], v224 offset:24576
    ds_read_b64_tr_b16 v[66:67], v224 offset:26624
    v_mfma_f32_16x16x32_bf16 v[4:7], v[32:35], v[132:135], v[4:7]
    ds_read_b64_tr_b16 v[68:69], v225 offset:24576
    s_add_u32 m0, s30, 8192
    s_nop 0
    buffer_load_dwordx4 v229, s[12:15], s27 offen lds
    v_mfma_f32_16x16x32_bf16 v[8:11], v[36:39], v[128:131], v[8:11]
    ds_read_b64_tr_b16 v[70:71], v225 offset:26624
    ds_read_b64_tr_b16 v[72:73], v226 offset:24576
    v_mfma_f32_16x16x32_bf16 v[12:15], v[36:39], v[132:135], v[12:15]
    ds_read_b64_tr_b16 v[74:75], v226 offset:26624
    buffer_load_dwordx4 v230, s[12:15], s27 offen offset:1024 lds
    s_add_u32 s27, s27, 131072
    v_mfma_f32_16x16x32_bf16 v[16:19], v[40:43], v[128:131], v[16:19]
    ds_read_b64_tr_b16 v[76:77], v227 offset:24576
    ds_read_b64_tr_b16 v[78:79], v227 offset:26624
    v_mfma_f32_16x16x32_bf16 v[20:23], v[40:43], v[132:135], v[20:23]
    ds_read_b64_tr_b16 v[80:81], v224 offset:28672
    v_mfma_f32_16x16x32_bf16 v[24:27], v[44:47], v[128:131], v[24:27]
    buffer_load_dwordx4 v[176:179], v228, s[8:11], s26 offen offset:0 sc1
    ds_read_b64_tr_b16 v[82:83], v224 offset:30720
    v_mfma_f32_16x16x32_bf16 v[28:31], v[44:47], v[132:135], v[28:31]
    ds_read_b64_tr_b16 v[84:85], v225 offset:28672
    ds_read_b64_tr_b16 v[86:87], v225 offset:30720
    v_mfma_f32_16x16x32_bf16 v[0:3], v[48:51], v[136:139], v[0:3]
    buffer_load_dwordx4 v[180:183], v228, s[8:11], s26 offen offset:1024 sc1
    ds_read_b64_tr_b16 v[88:89], v226 offset:28672
    v_mfma_f32_16x16x32_bf16 v[4:7], v[48:51], v[140:143], v[4:7]
    ds_read_b64_tr_b16 v[90:91], v226 offset:30720
    ds_read_b64_tr_b16 v[92:93], v227 offset:28672
    v_mfma_f32_16x16x32_bf16 v[8:11], v[52:55], v[136:139], v[8:11]
    buffer_load_dwordx4 v[184:187], v228, s[8:11], s26 offen offset:2048 sc1
    ds_read_b64_tr_b16 v[94:95], v227 offset:30720
    v_mfma_f32_16x16x32_bf16 v[12:15], v[52:55], v[140:143], v[12:15]
    buffer_load_dwordx4 v[188:191], v228, s[8:11], s26 offen offset:3072 sc1
    s_add_u32 s26, s26, 4096
    v_mfma_f32_16x16x32_bf16 v[16:19], v[56:59], v[136:139], v[16:19]
    v_mfma_f32_16x16x32_bf16 v[20:23], v[56:59], v[140:143], v[20:23]
    ds_read_b32 v249, v247
    v_mfma_f32_16x16x32_bf16 v[24:27], v[60:63], v[136:139], v[24:27]
    v_mfma_f32_16x16x32_bf16 v[28:31], v[60:63], v[140:143], v[28:31]
    s_waitcnt vmcnt(12)
    s_waitcnt lgkmcnt(0)
    v_cmp_gt_u32 vcc, s88, v249
    s_cbranch_vccnz spin_50
ok_51:
    s_add_u32 s88, s88, 1
    ds_add_u32 v246, v248
    v_mfma_f32_16x16x32_bf16 v[0:3], v[64:67], v[144:147], v[0:3]
    ds_read_b64_tr_b16 v[32:33], v224 offset:32768
    ds_read_b64_tr_b16 v[34:35], v224 offset:34816
    v_mfma_f32_16x16x32_bf16 v[4:7], v[64:67], v[148:151], v[4:7]
    ds_read_b64_tr_b16 v[36:37], v225 offset:32768
    s_add_u32 m0, s30, 16384
    s_nop 0
    buffer_load_dwordx4 v229, s[12:15], s27 offen lds
    v_mfma_f32_16x16x32_bf16 v[8:11], v[68:71], v[144:147], v[8:11]
    ds_read_b64_tr_b16 v[38:39], v225 offset:34816
    ds_read_b64_tr_b16 v[40:41], v226 offset:32768
    v_mfma_f32_16x16x32_bf16 v[12:15], v[68:71], v[148:151], v[12:15]
    ds_read_b64_tr_b16 v[42:43], v226 offset:34816
    buffer_load_dwordx4 v230, s[12:15], s27 offen offset:1024 lds
    s_add_u32 s27, s27, 131072
    v_mfma_f32_16x16x32_bf16 v[16:19], v[72:75], v[144:147], v[16:19]
    ds_read_b64_tr_b16 v[44:45], v227 offset:32768
    ds_read_b64_tr_b16 v[46:47], v227 offset:34816
    v_mfma_f32_16x16x32_bf16 v[20:23], v[72:75], v[148:151], v[20:23]
    ds_read_b64_tr_b16 v[48:49], v224 offset:36864
    v_mfma_f32_16x16x32_bf16 v[24:27], v[76:79], v[144:147], v[24:27]
    buffer_load_dwordx4 v[192:195], v228, s[8:11], s26 offen offset:0 sc1
    ds_read_b64_tr_b16 v[50:51], v224 offset:38912
    v_mfma_f32_16x16x32_bf16 v[28:31], v[76:79], v[148:151], v[28:31]
    ds_read_b64_tr_b16 v[52:53], v225 offset:36864
    ds_read_b64_tr_b16 v[54:55], v225 offset:38912
    v_mfma_f32_16x16x32_bf16 v[0:3], v[80:83], v[152:155], v[0:3]
    buffer_load_dwordx4 v[196:199], v228, s[8:11], s26 offen offset:1024 sc1
    ds_read_b64_tr_b16 v[56:57], v226 offset:36864
    v_mfma_f32_16x16x32_bf16 v[4:7], v[80:83], v[156:159], v[4:7]
    ds_read_b64_tr_b16 v[58:59], v226 offset:38912
    ds_read_b64_tr_b16 v[60:61], v227 offset:36864
    v_mfma_f32_16x16x32_bf16 v[8:11], v[84:87], v[152:155], v[8:11]
    buffer_load_dwordx4 v[200:203], v228, s[8:11], s26 offen offset:2048 sc1
    ds_read_b64_tr_b16 v[62:63], v227 offset:38912
    v_mfma_f32_16x16x32_bf16 v[12:15], v[84:87], v[156:159], v[12:15]
    buffer_load_dwordx4 v[204:207], v228, s[8:11], s26 offen offset:3072 sc1
    s_add_u32 s26, s26, 4096
    v_mfma_f32_16x16x32_bf16 v[16:19], v[88:91], v[152:155], v[16:19]
    v_mfma_f32_16x16x32_bf16 v[20:23], v[88:91], v[156:159], v[20:23]
    ds_read_b32 v249, v247
    v_mfma_f32_16x16x32_bf16 v[24:27], v[92:95], v[152:155], v[24:27]
    v_mfma_f32_16x16x32_bf16 v[28:31], v[92:95], v[156:159], v[28:31]
    s_waitcnt vmcnt(12)
    s_waitcnt lgkmcnt(0)
    v_cmp_gt_u32 vcc, s88, v249
    s_cbranch_vccnz spin_52
ok_53:
    s_add_u32 s88, s88, 1
    ds_add_u32 v246, v248
    v_mfma_f32_16x16x32_bf16 v[0:3], v[32:35], v[160:163], v[0:3]
    ds_read_b64_tr_b16 v[64:65], v224 offset:40960
    ds_read_b64_tr_b16 v[66:67], v224 offset:43008
    v_mfma_f32_16x16x32_bf16 v[4:7], v[32:35], v[164:167], v[4:7]
    ds_read_b64_tr_b16 v[68:69], v225 offset:40960
    s_add_u32 m0, s30, 24576
    s_nop 0
    buffer_load_dwordx4 v229, s[12:15], s27 offen lds
    v_mfma_f32_16x16x32_bf16 v[8:11], v[36:39], v[160:163], v[8:11]
    ds_read_b64_tr_b16 v[70:71], v225 offset:43008
    ds_read_b64_tr_b16 v[72:73], v226 offset:40960
    v_mfma_f32_16x16x32_bf16 v[12:15], v[36:39], v[164:167], v[12:15]
    ds_read_b64_tr_b16 v[74:75], v226 offset:43008
    buffer_load_dwordx4 v230, s[12:15], s27 offen offset:1024 lds
    s_add_u32 s27, s27, 131072
    v_mfma_f32_16x16x32_bf16 v[16:19], v[40:43], v[160:163], v[16:19]
    ds_read_b64_tr_b16 v[76:77], v227 offset:40960
    ds_read_b64_tr_b16 v[78:79], v227 offset:43008
    v_mfma_f32_16x16x32_bf16 v[20:23], v[40:43], v[164:167], v[20:23]
    ds_read_b64_tr_b16 v[80:81], v224 offset:45056
    v_mfma_f32_16x16x32_bf16 v[24:27], v[44:47], v[160:163], v[24:27]
    buffer_load_dwordx4 v[208:211], v228, s[8:11], s26 offen offset:0 sc1
    ds_read_b64_tr_b16 v[82:83], v224 offset:47104
    v_mfma_f32_16x16x32_bf16 v[28:31], v[44:47], v[164:167], v[28:31]
    ds_read_b64_tr_b16 v[84:85], v225 offset:45056
    ds_read_b64_tr_b16 v[86:87], v225 offset:47104
    v_mfma_f32_16x16x32_bf16 v[0:3], v[48:51], v[168:171], v[0:3]
    buffer_load_dwordx4 v[212:215], v228, s[8:11], s26 offen offset:1024 sc1
    ds_read_b64_tr_b16 v[88:89], v226 offset:45056
    v_mfma_f32_16x16x32_bf16 v[4:7], v[48:51], v[172:175], v[4:7]
    ds_read_b64_tr_b16 v[90:91], v226 offset:47104
    ds_read_b64_tr_b16 v[92:93], v227 offset:45056
    v_mfma_f32_16x16x32_bf16 v[8:11], v[52:55], v[168:171], v[8:11]
    buffer_load_dwordx4 v[216:219], v228, s[8:11], s26 offen offset:2048 sc1
    ds_read_b64_tr_b16 v[94:95], v227 offset:47104
    v_mfma_f32_16x16x32_bf16 v[12:15], v[52:55], v[172:175], v[12:15]
    buffer_load_dwordx4 v[220:223], v228, s[8:11], s26 offen offset:3072 sc1
    s_add_u32 s26, s26, 4096
    v_mfma_f32_16x16x32_bf16 v[16:19], v[56:59], v[168:171], v[16:19]
    v_mfma_f32_16x16x32_bf16 v[20:23], v[56:59], v[172:175], v[20:23]
    ds_read_b32 v249, v247
    v_mfma_f32_16x16x32_bf16 v[24:27], v[60:63], v[168:171], v[24:27]
    v_mfma_f32_16x16x32_bf16 v[28:31], v[60:63], v[172:175], v[28:31]
    s_waitcnt vmcnt(12)
    s_waitcnt lgkmcnt(0)
    v_cmp_gt_u32 vcc, s88, v249
    s_cbranch_vccnz spin_54
ok_55:
    s_add_u32 s88, s88, 1
    ds_add_u32 v246, v248
    v_mfma_f32_16x16x32_bf16 v[0:3], v[64:67], v[176:179], v[0:3]
    ds_read_b64_tr_b16 v[32:33], v224 offset:49152
    ds_read_b64_tr_b16 v[34:35], v224 offset:51200
    v_mfma_f32_16x16x32_bf16 v[4:7], v[64:67], v[180:183], v[4:7]
    ds_read_b64_tr_b16 v[36:37], v225 offset:49152
    s_add_u32 m0, s30, 32768
    s_nop 0
    buffer_load_dwordx4 v229, s[12:15], s27 offen lds
    v_mfma_f32_16x16x32_bf16 v[8:11], v[68:71], v[176:179], v[8:11]
    ds_read_b64_tr_b16 v[38:39], v225 offset:51200
    ds_read_b64_tr_b16 v[40:41], v226 offset:49152
    v_mfma_f32_16x16x32_bf16 v[12:15], v[68:71], v[180:183], v[12:15]
    ds_read_b64_tr_b16 v[42:43], v226 offset:51200
    buffer_load_dwordx4 v230, s[12:15], s27 offen offset:1024 lds
    s_add_u32 s27, s27, 131072
    v_mfma_f32_16x16x32_bf16 v[16:19], v[72:75], v[176:179], v[16:19]
    ds_read_b64_tr_b16 v[44:45], v227 offset:49152
    ds_read_b64_tr_b16 v[46:47], v227 offset:51200
    v_mfma_f32_16x16x32_bf16 v[20:23], v[72:75], v[180:183], v[20:23]
    ds_read_b64_tr_b16 v[48:49], v224 offset:53248
    v_mfma_f32_16x16x32_bf16 v[24:27], v[76:79], v[176:179], v[24:27]
    buffer_load_dwordx4 v[96:99], v228, s[8:11], s26 offen offset:0 sc1
    ds_read_b64_tr_b16 v[50:51], v224 offset:55296
    v_mfma_f32_16x16x32_bf16 v[28:31], v[76:79], v[180:183], v[28:31]
    ds_read_b64_tr_b16 v[52:53], v225 offset:53248
    ds_read_b64_tr_b16 v[54:55], v225 offset:55296
    v_mfma_f32_16x16x32_bf16 v[0:3], v[80:83], v[184:187], v[0:3]
    buffer_load_dwordx4 v[100:103], v228, s[8:11], s26 offen offset:1024 sc1
    ds_read_b64_tr_b16 v[56:57], v226 offset:53248
    v_mfma_f32_16x16x32_bf16 v[4:7], v[80:83], v[188:191], v[4:7]
    ds_read_b64_tr_b16 v[58:59], v226 offset:55296
    ds_read_b64_tr_b16 v[60:61], v227 offset:53248
    v_mfma_f32_16x16x32_bf16 v[8:11], v[84:87], v[184:187], v[8:11]
    buffer_load_dwordx4 v[104:107], v228, s[8:11], s26 offen offset:2048 sc1
    ds_read_b64_tr_b16 v[62:63], v227 offset:55296
    v_mfma_f32_16x16x32_bf16 v[12:15], v[84:87], v[188:191], v[12:15]
    buffer_load_dwordx4 v[108:111], v228, s[8:11], s26 offen offset:3072 sc1
    s_add_u32 s26, s26, 4096
    v_mfma_f32_16x16x32_bf16 v[16:19], v[88:91], v[184:187], v[16:19]
    v_mfma_f32_16x16x32_bf16 v[20:23], v[88:91], v[188:191], v[20:23]
    ds_read_b32 v249, v247
    v_mfma_f32_16x16x32_bf16 v[24:27], v[92:95], v[184:187], v[24:27]
    v_mfma_f32_16x16x32_bf16 v[28:31], v[92:95], v[188:191], v[28:31]
    s_waitcnt vmcnt(12)
    s_waitcnt lgkmcnt(0)
    v_cmp_gt_u32 vcc, s88, v249
    s_cbranch_vccnz spin_56
ok_57:
    s_add_u32 s88, s88, 1
    ds_add_u32 v246, v248
    v_mfma_f32_16x16x32_bf16 v[0:3], v[32:35], v[192:195], v[0:3]
    ds_read_b64_tr_b16 v[64:65], v224 offset:57344
    ds_read_b64_tr_b16 v[66:67], v224 offset:59392
    v_mfma_f32_16x16x32_bf16 v[4:7], v[32:35], v[196:199], v[4:7]
    ds_read_b64_tr_b16 v[68:69], v225 offset:57344
    s_add_u32 m0, s30, 40960
    s_nop 0
    buffer_load_dwordx4 v229, s[12:15], s27 offen lds
    v_mfma_f32_16x16x32_bf16 v[8:11], v[36:39], v[192:195], v[8:11]
    ds_read_b64_tr_b16 v[70:71], v225 offset:59392
    ds_read_b64_tr_b16 v[72:73], v226 offset:57344
    v_mfma_f32_16x16x32_bf16 v[12:15], v[36:39], v[196:199], v[12:15]
    ds_read_b64_tr_b16 v[74:75], v226 offset:59392
    buffer_load_dwordx4 v230, s[12:15], s27 offen offset:1024 lds
    s_add_u32 s27, s27, 131072
    v_mfma_f32_16x16x32_bf16 v[16:19], v[40:43], v[192:195], v[16:19]
    ds_read_b64_tr_b16 v[76:77], v227 offset:57344
    ds_read_b64_tr_b16 v[78:79], v227 offset:59392
    v_mfma_f32_16x16x32_bf16 v[20:23], v[40:43], v[196:199], v[20:23]
    ds_read_b64_tr_b16 v[80:81], v224 offset:61440
    v_mfma_f32_16x16x32_bf16 v[24:27], v[44:47], v[192:195], v[24:27]
    buffer_load_dwordx4 v[112:115], v228, s[8:11], s26 offen offset:0 sc1
    ds_read_b64_tr_b16 v[82:83], v224 offset:63488
    v_mfma_f32_16x16x32_bf16 v[28:31], v[44:47], v[196:199], v[28:31]
    ds_read_b64_tr_b16 v[84:85], v225 offset:61440
    ds_read_b64_tr_b16 v[86:87], v225 offset:63488
    v_mfma_f32_16x16x32_bf16 v[0:3], v[48:51], v[200:203], v[0:3]
    buffer_load_dwordx4 v[116:119], v228, s[8:11], s26 offen offset:1024 sc1
    ds_read_b64_tr_b16 v[88:89], v226 offset:61440
    v_mfma_f32_16x16x32_bf16 v[4:7], v[48:51], v[204:207], v[4:7]
    ds_read_b64_tr_b16 v[90:91], v226 offset:63488
    ds_read_b64_tr_b16 v[92:93], v227 offset:61440
    v_mfma_f32_16x16x32_bf16 v[8:11], v[52:55], v[200:203], v[8:11]
    buffer_load_dwordx4 v[120:123], v228, s[8:11], s26 offen offset:2048 sc1
    ds_read_b64_tr_b16 v[94:95], v227 offset:63488
    v_mfma_f32_16x16x32_bf16 v[12:15], v[52:55], v[204:207], v[12:15]
    buffer_load_dwordx4 v[124:127], v228, s[8:11], s26 offen offset:3072 sc1
    s_add_u32 s26, s26, 4096
    v_mfma_f32_16x16x32_bf16 v[16:19], v[56:59], v[200:203], v[16:19]
    v_mfma_f32_16x16x32_bf16 v[20:23], v[56:59], v[204:207], v[20:23]
    ds_read_b32 v249, v247
    v_mfma_f32_16x16x32_bf16 v[24:27], v[60:63], v[200:203], v[24:27]
    v_mfma_f32_16x16x32_bf16 v[28:31], v[60:63], v[204:207], v[28:31]
    s_waitcnt vmcnt(12)
    s_waitcnt lgkmcnt(0)
    v_cmp_gt_u32 vcc, s88, v249
    s_cbranch_vccnz spin_58
ok_59:
    s_add_u32 s88, s88, 1
    ds_add_u32 v246, v248
    v_mfma_f32_16x16x32_bf16 v[0:3], v[64:67], v[208:211], v[0:3]
    ds_read_b64_tr_b16 v[32:33], v224 offset:0
    ds_read_b64_tr_b16 v[34:35], v224 offset:2048
    v_mfma_f32_16x16x32_bf16 v[4:7], v[64:67], v[212:215], v[4:7]
    ds_read_b64_tr_b16 v[36:37], v225 offset:0
    s_add_u32 m0, s30, 49152
    s_nop 0
    buffer_load_dwordx4 v229, s[12:15], s27 offen lds
    v_mfma_f32_16x16x32_bf16 v[8:11], v[68:71], v[208:211], v[8:11]
    ds_read_b64_tr_b16 v[38:39], v225 offset:2048
    ds_read_b64_tr_b16 v[40:41], v226 offset:0
    v_mfma_f32_16x16x32_bf16 v[12:15], v[68:71], v[212:215], v[12:15]
    ds_read_b64_tr_b16 v[42:43], v226 offset:2048
    buffer_load_dwordx4 v230, s[12:15], s27 offen offset:1024 lds
    s_add_u32 s27, s27, 131072
    v_mfma_f32_16x16x32_bf16 v[16:19], v[72:75], v[208:211], v[16:19]
    ds_read_b64_tr_b16 v[44:45], v227 offset:0
    ds_read_b64_tr_b16 v[46:47], v227 offset:2048
    v_mfma_f32_16x16x32_bf16 v[20:23], v[72:75], v[212:215], v[20:23]
    ds_read_b64_tr_b16 v[48:49], v224 offset:4096
    v_mfma_f32_16x16x32_bf16 v[24:27], v[76:79], v[208:211], v[24:27]
    buffer_load_dwordx4 v[128:131], v228, s[8:11], s26 offen offset:0 sc1
    ds_read_b64_tr_b16 v[50:51], v224 offset:6144
    v_mfma_f32_16x16x32_bf16 v[28:31], v[76:79], v[212:215], v[28:31]
    ds_read_b64_tr_b16 v[52:53], v225 offset:4096
    ds_read_b64_tr_b16 v[54:55], v225 offset:6144
    v_mfma_f32_16x16x32_bf16 v[0:3], v[80:83], v[216:219], v[0:3]
    buffer_load_dwordx4 v[132:135], v228, s[8:11], s26 offen offset:1024 sc1
    ds_read_b64_tr_b16 v[56:57], v226 offset:4096
    v_mfma_f32_16x16x32_bf16 v[4:7], v[80:83], v[220:223], v[4:7]
    ds_read_b64_tr_b16 v[58:59], v226 offset:6144
    ds_read_b64_tr_b16 v[60:61], v227 offset:4096
    v_mfma_f32_16x16x32_bf16 v[8:11], v[84:87], v[216:219], v[8:11]
    buffer_load_dwordx4 v[136:139], v228, s[8:11], s26 offen offset:2048 sc1
    ds_read_b64_tr_b16 v[62:63], v227 offset:6144
    v_mfma_f32_16x16x32_bf16 v[12:15], v[84:87], v[220:223], v[12:15]
    buffer_load_dwordx4 v[140:143], v228, s[8:11], s26 offen offset:3072 sc1
    s_add_u32 s26, s26, 4096
    v_mfma_f32_16x16x32_bf16 v[16:19], v[88:91], v[216:219], v[16:19]
    v_mfma_f32_16x16x32_bf16 v[20:23], v[88:91], v[220:223], v[20:23]
    ds_read_b32 v249, v247
    v_mfma_f32_16x16x32_bf16 v[24:27], v[92:95], v[216:219], v[24:27]
    v_mfma_f32_16x16x32_bf16 v[28:31], v[92:95], v[220:223], v[28:31]
    s_waitcnt vmcnt(12)
    s_waitcnt lgkmcnt(0)
    v_cmp_gt_u32 vcc, s88, v249
    s_cbranch_vccnz spin_60
ok_61:
    s_add_u32 s88, s88, 1
    ds_add_u32 v246, v248
    v_mfma_f32_16x16x32_bf16 v[0:3], v[32:35], v[96:99], v[0:3]
    ds_read_b64_tr_b16 v[64:65], v224 offset:8192
    ds_read_b64_tr_b16 v[66:67], v224 offset:10240
    v_mfma_f32_16x16x32_bf16 v[4:7], v[32:35], v[100:103], v[4:7]
    ds_read_b64_tr_b16 v[68:69], v225 offset:8192
    s_add_u32 m0, s30, 57344
    s_nop 0
    buffer_load_dwordx4 v229, s[12:15], s27 offen lds
    v_mfma_f32_16x16x32_bf16 v[8:11], v[36:39], v[96:99], v[8:11]
    ds_read_b64_tr_b16 v[70:71], v225 offset:10240
    ds_read_b64_tr_b16 v[72:73], v226 offset:8192
    v_mfma_f32_16x16x32_bf16 v[12:15], v[36:39], v[100:103], v[12:15]
    ds_read_b64_tr_b16 v[74:75], v226 offset:10240
    buffer_load_dwordx4 v230, s[12:15], s27 offen offset:1024 lds
    s_add_u32 s27, s27, 131072
    v_mfma_f32_16x16x32_bf16 v[16:19], v[40:43], v[96:99], v[16:19]
    ds_read_b64_tr_b16 v[76:77], v227 offset:8192
    ds_read_b64_tr_b16 v[78:79], v227 offset:10240
    v_mfma_f32_16x16x32_bf16 v[20:23], v[40:43], v[100:103], v[20:23]
    ds_read_b64_tr_b16 v[80:81], v224 offset:12288
    v_mfma_f32_16x16x32_bf16 v[24:27], v[44:47], v[96:99], v[24:27]
    buffer_load_dwordx4 v[144:147], v228, s[8:11], s26 offen offset:0 sc1
    ds_read_b64_tr_b16 v[82:83], v224 offset:14336
    v_mfma_f32_16x16x32_bf16 v[28:31], v[44:47], v[100:103], v[28:31]
    ds_read_b64_tr_b16 v[84:85], v225 offset:12288
    ds_read_b64_tr_b16 v[86:87], v225 offset:14336
    v_mfma_f32_16x16x32_bf16 v[0:3], v[48:51], v[104:107], v[0:3]
    buffer_load_dwordx4 v[148:151], v228, s[8:11], s26 offen offset:1024 sc1
    ds_read_b64_tr_b16 v[88:89], v226 offset:12288
    v_mfma_f32_16x16x32_bf16 v[4:7], v[48:51], v[108:111], v[4:7]
    ds_read_b64_tr_b16 v[90:91], v226 offset:14336
    ds_read_b64_tr_b16 v[92:93], v227 offset:12288
    v_mfma_f32_16x16x32_bf16 v[8:11], v[52:55], v[104:107], v[8:11]
    buffer_load_dwordx4 v[152:155], v228, s[8:11], s26 offen offset:2048 sc1
    ds_read_b64_tr_b16 v[94:95], v227 offset:14336
    v_mfma_f32_16x16x32_bf16 v[12:15], v[52:55], v[108:111], v[12:15]
    buffer_load_dwordx4 v[156:159], v228, s[8:11], s26 offen offset:3072 sc1
    s_add_u32 s26, s26, 4096
    v_mfma_f32_16x16x32_bf16 v[16:19], v[56:59], v[104:107], v[16:19]
    v_mfma_f32_16x16x32_bf16 v[20:23], v[56:59], v[108:111], v[20:23]
    ds_read_b32 v249, v247
    v_mfma_f32_16x16x32_bf16 v[24:27], v[60:63], v[104:107], v[24:27]
    v_mfma_f32_16x16x32_bf16 v[28:31], v[60:63], v[108:111], v[28:31]
    s_waitcnt vmcnt(12)
    s_waitcnt lgkmcnt(0)
    v_cmp_gt_u32 vcc, s88, v249
    s_cbranch_vccnz spin_62
ok_63:
    s_add_u32 s88, s88, 1
    ds_add_u32 v246, v248
    v_mfma_f32_16x16x32_bf16 v[0:3], v[64:67], v[112:115], v[0:3]
    ds_read_b64_tr_b16 v[32:33], v224 offset:16384
    ds_read_b64_tr_b16 v[34:35], v224 offset:18432
    v_mfma_f32_16x16x32_bf16 v[4:7], v[64:67], v[116:119], v[4:7]
    ds_read_b64_tr_b16 v[36:37], v225 offset:16384
    buffer_load_dwordx4 v[160:163], v228, s[8:11], s26 offen offset:0 sc1
    v_mfma_f32_16x16x32_bf16 v[8:11], v[68:71], v[112:115], v[8:11]
    ds_read_b64_tr_b16 v[38:39], v225 offset:18432
    v_mfma_f32_16x16x32_bf16 v[12:15], v[68:71], v[116:119], v[12:15]
    ds_read_b64_tr_b16 v[40:41], v226 offset:16384
    ds_read_b64_tr_b16 v[42:43], v226 offset:18432
    v_mfma_f32_16x16x32_bf16 v[16:19], v[72:75], v[112:115], v[16:19]
    buffer_load_dwordx4 v[164:167], v228, s[8:11], s26 offen offset:1024 sc1
    ds_read_b64_tr_b16 v[44:45], v227 offset:16384
    v_mfma_f32_16x16x32_bf16 v[20:23], v[72:75], v[116:119], v[20:23]
    ds_read_b64_tr_b16 v[46:47], v227 offset:18432
    v_mfma_f32_16x16x32_bf16 v[24:27], v[76:79], v[112:115], v[24:27]
    ds_read_b64_tr_b16 v[48:49], v224 offset:20480
    buffer_load_dwordx4 v[168:171], v228, s[8:11], s26 offen offset:2048 sc1
    v_mfma_f32_16x16x32_bf16 v[28:31], v[76:79], v[116:119], v[28:31]
    ds_read_b64_tr_b16 v[50:51], v224 offset:22528
    ds_read_b64_tr_b16 v[52:53], v225 offset:20480
    v_mfma_f32_16x16x32_bf16 v[0:3], v[80:83], v[120:123], v[0:3]
    ds_read_b64_tr_b16 v[54:55], v225 offset:22528
    v_mfma_f32_16x16x32_bf16 v[4:7], v[80:83], v[124:127], v[4:7]
    buffer_load_dwordx4 v[172:175], v228, s[8:11], s26 offen offset:3072 sc1
    s_add_u32 s26, s26, 4096
    ds_read_b64_tr_b16 v[56:57], v226 offset:20480
    v_mfma_f32_16x16x32_bf16 v[8:11], v[84:87], v[120:123], v[8:11]
    ds_read_b64_tr_b16 v[58:59], v226 offset:22528
    ds_read_b64_tr_b16 v[60:61], v227 offset:20480
    v_mfma_f32_16x16x32_bf16 v[12:15], v[84:87], v[124:127], v[12:15]
    ds_read_b64_tr_b16 v[62:63], v227 offset:22528
    v_mfma_f32_16x16x32_bf16 v[16:19], v[88:91], v[120:123], v[16:19]
    v_mfma_f32_16x16x32_bf16 v[20:23], v[88:91], v[124:127], v[20:23]
    ds_read_b32 v249, v247
    v_mfma_f32_16x16x32_bf16 v[24:27], v[92:95], v[120:123], v[24:27]
    v_mfma_f32_16x16x32_bf16 v[28:31], v[92:95], v[124:127], v[28:31]
    s_waitcnt vmcnt(10)
    s_waitcnt lgkmcnt(0)
    v_cmp_gt_u32 vcc, s88, v249
    s_cbranch_vccnz spin_64
ok_65:
    s_add_u32 s88, s88, 1
    ds_add_u32 v246, v248
    v_mfma_f32_16x16x32_bf16 v[0:3], v[32:35], v[128:131], v[0:3]
    ds_read_b64_tr_b16 v[64:65], v224 offset:24576
    ds_read_b64_tr_b16 v[66:67], v224 offset:26624
    v_mfma_f32_16x16x32_bf16 v[4:7], v[32:35], v[132:135], v[4:7]
    ds_read_b64_tr_b16 v[68:69], v225 offset:24576
    buffer_load_dwordx4 v[176:179], v228, s[8:11], s26 offen offset:0 sc1
    v_mfma_f32_16x16x32_bf16 v[8:11], v[36:39], v[128:131], v[8:11]
    ds_read_b64_tr_b16 v[70:71], v225 offset:26624
    v_mfma_f32_16x16x32_bf16 v[12:15], v[36:39], v[132:135], v[12:15]
    ds_read_b64_tr_b16 v[72:73], v226 offset:24576
    ds_read_b64_tr_b16 v[74:75], v226 offset:26624
    v_mfma_f32_16x16x32_bf16 v[16:19], v[40:43], v[128:131], v[16:19]
    buffer_load_dwordx4 v[180:183], v228, s[8:11], s26 offen offset:1024 sc1
    ds_read_b64_tr_b16 v[76:77], v227 offset:24576
    v_mfma_f32_16x16x32_bf16 v[20:23], v[40:43], v[132:135], v[20:23]
    ds_read_b64_tr_b16 v[78:79], v227 offset:26624
    v_mfma_f32_16x16x32_bf16 v[24:27], v[44:47], v[128:131], v[24:27]
    ds_read_b64_tr_b16 v[80:81], v224 offset:28672
    buffer_load_dwordx4 v[184:187], v228, s[8:11], s26 offen offset:2048 sc1
    v_mfma_f32_16x16x32_bf16 v[28:31], v[44:47], v[132:135], v[28:31]
    ds_read_b64_tr_b16 v[82:83], v224 offset:30720
    ds_read_b64_tr_b16 v[84:85], v225 offset:28672
    v_mfma_f32_16x16x32_bf16 v[0:3], v[48:51], v[136:139], v[0:3]
    ds_read_b64_tr_b16 v[86:87], v225 offset:30720
    v_mfma_f32_16x16x32_bf16 v[4:7], v[48:51], v[140:143], v[4:7]
    buffer_load_dwordx4 v[188:191], v228, s[8:11], s26 offen offset:3072 sc1
    s_add_u32 s26, s26, 4096
    ds_read_b64_tr_b16 v[88:89], v226 offset:28672
    v_mfma_f32_16x16x32_bf16 v[8:11], v[52:55], v[136:139], v[8:11]
    ds_read_b64_tr_b16 v[90:91], v226 offset:30720
    ds_read_b64_tr_b16 v[92:93], v227 offset:28672
    v_mfma_f32_16x16x32_bf16 v[12:15], v[52:55], v[140:143], v[12:15]
    ds_read_b64_tr_b16 v[94:95], v227 offset:30720
    v_mfma_f32_16x16x32_bf16 v[16:19], v[56:59], v[136:139], v[16:19]
    v_mfma_f32_16x16x32_bf16 v[20:23], v[56:59], v[140:143], v[20:23]
    ds_read_b32 v249, v247
    v_mfma_f32_16x16x32_bf16 v[24:27], v[60:63], v[136:139], v[24:27]
    v_mfma_f32_16x16x32_bf16 v[28:31], v[60:63], v[140:143], v[28:31]
    s_waitcnt vmcnt(8)
    s_waitcnt lgkmcnt(0)
    v_cmp_gt_u32 vcc, s88, v249
    s_cbranch_vccnz spin_66
ok_67:
    s_add_u32 s88, s88, 1
    ds_add_u32 v246, v248
    v_mfma_f32_16x16x32_bf16 v[0:3], v[64:67], v[144:147], v[0:3]
    ds_read_b64_tr_b16 v[32:33], v224 offset:32768
    ds_read_b64_tr_b16 v[34:35], v224 offset:34816
    v_mfma_f32_16x16x32_bf16 v[4:7], v[64:67], v[148:151], v[4:7]
    ds_read_b64_tr_b16 v[36:37], v225 offset:32768
    buffer_load_dwordx4 v[192:195], v228, s[8:11], s26 offen offset:0 sc1
    v_mfma_f32_16x16x32_bf16 v[8:11], v[68:71], v[144:147], v[8:11]
    ds_read_b64_tr_b16 v[38:39], v225 offset:34816
    v_mfma_f32_16x16x32_bf16 v[12:15], v[68:71], v[148:151], v[12:15]
    ds_read_b64_tr_b16 v[40:41], v226 offset:32768
    ds_read_b64_tr_b16 v[42:43], v226 offset:34816
    v_mfma_f32_16x16x32_bf16 v[16:19], v[72:75], v[144:147], v[16:19]
    buffer_load_dwordx4 v[196:199], v228, s[8:11], s26 offen offset:1024 sc1
    ds_read_b64_tr_b16 v[44:45], v227 offset:32768
    v_mfma_f32_16x16x32_bf16 v[20:23], v[72:75], v[148:151], v[20:23]
    ds_read_b64_tr_b16 v[46:47], v227 offset:34816
    v_mfma_f32_16x16x32_bf16 v[24:27], v[76:79], v[144:147], v[24:27]
    ds_read_b64_tr_b16 v[48:49], v224 offset:36864
    buffer_load_dwordx4 v[200:203], v228, s[8:11], s26 offen offset:2048 sc1
    v_mfma_f32_16x16x32_bf16 v[28:31], v[76:79], v[148:151], v[28:31]
    ds_read_b64_tr_b16 v[50:51], v224 offset:38912
    ds_read_b64_tr_b16 v[52:53], v225 offset:36864
    v_mfma_f32_16x16x32_bf16 v[0:3], v[80:83], v[152:155], v[0:3]
    ds_read_b64_tr_b16 v[54:55], v225 offset:38912
    v_mfma_f32_16x16x32_bf16 v[4:7], v[80:83], v[156:159], v[4:7]
    buffer_load_dwordx4 v[204:207], v228, s[8:11], s26 offen offset:3072 sc1
    s_add_u32 s26, s26, 4096
    ds_read_b64_tr_b16 v[56:57], v226 offset:36864
    v_mfma_f32_16x16x32_bf16 v[8:11], v[84:87], v[152:155], v[8:11]
    ds_read_b64_tr_b16 v[58:59], v226 offset:38912
    ds_read_b64_tr_b16 v[60:61], v227 offset:36864
    v_mfma_f32_16x16x32_bf16 v[12:15], v[84:87], v[156:159], v[12:15]
    ds_read_b64_tr_b16 v[62:63], v227 offset:38912
    v_mfma_f32_16x16x32_bf16 v[16:19], v[88:91], v[152:155], v[16:19]
    v_mfma_f32_16x16x32_bf16 v[20:23], v[88:91], v[156:159], v[20:23]
    ds_read_b32 v249, v247
    v_mfma_f32_16x16x32_bf16 v[24:27], v[92:95], v[152:155], v[24:27]
    v_mfma_f32_16x16x32_bf16 v[28:31], v[92:95], v[156:159], v[28:31]
    s_waitcnt vmcnt(8)
    s_waitcnt lgkmcnt(0)
    v_cmp_gt_u32 vcc, s88, v249
    s_cbranch_vccnz spin_68
ok_69:
    s_add_u32 s88, s88, 1
    ds_add_u32 v246, v248
    v_mfma_f32_16x16x32_bf16 v[0:3], v[32:35], v[160:163], v[0:3]
    ds_read_b64_tr_b16 v[64:65], v224 offset:40960
    ds_read_b64_tr_b16 v[66:67], v224 offset:43008
    v_mfma_f32_16x16x32_bf16 v[4:7], v[32:35], v[164:167], v[4:7]
    ds_read_b64_tr_b16 v[68:69], v225 offset:40960
    buffer_load_dwordx4 v[208:211], v228, s[8:11], s26 offen offset:0 sc1
    v_mfma_f32_16x16x32_bf16 v[8:11], v[36:39], v[160:163], v[8:11]
    ds_read_b64_tr_b16 v[70:71], v225 offset:43008
    v_mfma_f32_16x16x32_bf16 v[12:15], v[36:39], v[164:167], v[12:15]
    ds_read_b64_tr_b16 v[72:73], v226 offset:40960
    ds_read_b64_tr_b16 v[74:75], v226 offset:43008
    v_mfma_f32_16x16x32_bf16 v[16:19], v[40:43], v[160:163], v[16:19]
    buffer_load_dwordx4 v[212:215], v228, s[8:11], s26 offen offset:1024 sc1
    ds_read_b64_tr_b16 v[76:77], v227 offset:40960
    v_mfma_f32_16x16x32_bf16 v[20:23], v[40:43], v[164:167], v[20:23]
    ds_read_b64_tr_b16 v[78:79], v227 offset:43008
    v_mfma_f32_16x16x32_bf16 v[24:27], v[44:47], v[160:163], v[24:27]
    ds_read_b64_tr_b16 v[80:81], v224 offset:45056
    buffer_load_dwordx4 v[216:219], v228, s[8:11], s26 offen offset:2048 sc1
    v_mfma_f32_16x16x32_bf16 v[28:31], v[44:47], v[164:167], v[28:31]
    ds_read_b64_tr_b16 v[82:83], v224 offset:47104
    ds_read_b64_tr_b16 v[84:85], v225 offset:45056
    v_mfma_f32_16x16x32_bf16 v[0:3], v[48:51], v[168:171], v[0:3]
    ds_read_b64_tr_b16 v[86:87], v225 offset:47104
    v_mfma_f32_16x16x32_bf16 v[4:7], v[48:51], v[172:175], v[4:7]
    buffer_load_dwordx4 v[220:223], v228, s[8:11], s26 offen offset:3072 sc1
    s_add_u32 s26, s26, 4096
    ds_read_b64_tr_b16 v[88:89], v226 offset:45056
    v_mfma_f32_16x16x32_bf16 v[8:11], v[52:55], v[168:171], v[8:11]
    ds_read_b64_tr_b16 v[90:91], v226 offset:47104
    ds_read_b64_tr_b16 v[92:93], v227 offset:45056
    v_mfma_f32_16x16x32_bf16 v[12:15], v[52:55], v[172:175], v[12:15]
    ds_read_b64_tr_b16 v[94:95], v227 offset:47104
    v_mfma_f32_16x16x32_bf16 v[16:19], v[56:59], v[168:171], v[16:19]
    v_mfma_f32_16x16x32_bf16 v[20:23], v[56:59], v[172:175], v[20:23]
    ds_read_b32 v249, v247
    v_mfma_f32_16x16x32_bf16 v[24:27], v[60:63], v[168:171], v[24:27]
    v_mfma_f32_16x16x32_bf16 v[28:31], v[60:63], v[172:175], v[28:31]
    s_waitcnt vmcnt(8)
    s_waitcnt lgkmcnt(0)
    v_cmp_gt_u32 vcc, s88, v249
    s_cbranch_vccnz spin_70
ok_71:
    s_add_u32 s88, s88, 1
    ds_add_u32 v246, v248
    v_mfma_f32_16x16x32_bf16 v[0:3], v[64:67], v[176:179], v[0:3]
    ds_read_b64_tr_b16 v[32:33], v224 offset:49152
    ds_read_b64_tr_b16 v[34:35], v224 offset:51200
    v_mfma_f32_16x16x32_bf16 v[4:7], v[64:67], v[180:183], v[4:7]
    ds_read_b64_tr_b16 v[36:37], v225 offset:49152
    v_mfma_f32_16x16x32_bf16 v[8:11], v[68:71], v[176:179], v[8:11]
    ds_read_b64_tr_b16 v[38:39], v225 offset:51200
    v_mfma_f32_16x16x32_bf16 v[12:15], v[68:71], v[180:183], v[12:15]
    ds_read_b64_tr_b16 v[40:41], v226 offset:49152
    ds_read_b64_tr_b16 v[42:43], v226 offset:51200
    v_mfma_f32_16x16x32_bf16 v[16:19], v[72:75], v[176:179], v[16:19]
    ds_read_b64_tr_b16 v[44:45], v227 offset:49152
    v_mfma_f32_16x16x32_bf16 v[20:23], v[72:75], v[180:183], v[20:23]
    ds_read_b64_tr_b16 v[46:47], v227 offset:51200
    v_mfma_f32_16x16x32_bf16 v[24:27], v[76:79], v[176:179], v[24:27]
    ds_read_b64_tr_b16 v[48:49], v224 offset:53248
    ds_read_b64_tr_b16 v[50:51], v224 offset:55296
    v_mfma_f32_16x16x32_bf16 v[28:31], v[76:79], v[180:183], v[28:31]
    ds_read_b64_tr_b16 v[52:53], v225 offset:53248
    v_mfma_f32_16x16x32_bf16 v[0:3], v[80:83], v[184:187], v[0:3]
    ds_read_b64_tr_b16 v[54:55], v225 offset:55296
    v_mfma_f32_16x16x32_bf16 v[4:7], v[80:83], v[188:191], v[4:7]
    ds_read_b64_tr_b16 v[56:57], v226 offset:53248
    ds_read_b64_tr_b16 v[58:59], v226 offset:55296
    v_mfma_f32_16x16x32_bf16 v[8:11], v[84:87], v[184:187], v[8:11]
    ds_read_b64_tr_b16 v[60:61], v227 offset:53248
    v_mfma_f32_16x16x32_bf16 v[12:15], v[84:87], v[188:191], v[12:15]
    ds_read_b64_tr_b16 v[62:63], v227 offset:55296
    v_mfma_f32_16x16x32_bf16 v[16:19], v[88:91], v[184:187], v[16:19]
    v_mfma_f32_16x16x32_bf16 v[20:23], v[88:91], v[188:191], v[20:23]
    ds_read_b32 v249, v247
    v_mfma_f32_16x16x32_bf16 v[24:27], v[92:95], v[184:187], v[24:27]
    v_mfma_f32_16x16x32_bf16 v[28:31], v[92:95], v[188:191], v[28:31]
    s_waitcnt vmcnt(4)
    s_waitcnt lgkmcnt(0)
    v_cmp_gt_u32 vcc, s88, v249
    s_cbranch_vccnz spin_72
ok_73:
    s_add_u32 s88, s88, 1
    ds_add_u32 v246, v248
    v_mfma_f32_16x16x32_bf16 v[0:3], v[32:35], v[192:195], v[0:3]
    ds_read_b64_tr_b16 v[64:65], v224 offset:57344
    ds_read_b64_tr_b16 v[66:67], v224 offset:59392
    v_mfma_f32_16x16x32_bf16 v[4:7], v[32:35], v[196:199], v[4:7]
    ds_read_b64_tr_b16 v[68:69], v225 offset:57344
    v_mfma_f32_16x16x32_bf16 v[8:11], v[36:39], v[192:195], v[8:11]
    ds_read_b64_tr_b16 v[70:71], v225 offset:59392
    v_mfma_f32_16x16x32_bf16 v[12:15], v[36:39], v[196:199], v[12:15]
    ds_read_b64_tr_b16 v[72:73], v226 offset:57344
    ds_read_b64_tr_b16 v[74:75], v226 offset:59392
    v_mfma_f32_16x16x32_bf16 v[16:19], v[40:43], v[192:195], v[16:19]
    ds_read_b64_tr_b16 v[76:77], v227 offset:57344
    v_mfma_f32_16x16x32_bf16 v[20:23], v[40:43], v[196:199], v[20:23]
    ds_read_b64_tr_b16 v[78:79], v227 offset:59392
    v_mfma_f32_16x16x32_bf16 v[24:27], v[44:47], v[192:195], v[24:27]
    ds_read_b64_tr_b16 v[80:81], v224 offset:61440
    ds_read_b64_tr_b16 v[82:83], v224 offset:63488
    v_mfma_f32_16x16x32_bf16 v[28:31], v[44:47], v[196:199], v[28:31]
    ds_read_b64_tr_b16 v[84:85], v225 offset:61440
    v_mfma_f32_16x16x32_bf16 v[0:3], v[48:51], v[200:203], v[0:3]
    ds_read_b64_tr_b16 v[86:87], v225 offset:63488
    v_mfma_f32_16x16x32_bf16 v[4:7], v[48:51], v[204:207], v[4:7]
    ds_read_b64_tr_b16 v[88:89], v226 offset:61440
    ds_read_b64_tr_b16 v[90:91], v226 offset:63488
    v_mfma_f32_16x16x32_bf16 v[8:11], v[52:55], v[200:203], v[8:11]
    ds_read_b64_tr_b16 v[92:93], v227 offset:61440
    v_mfma_f32_16x16x32_bf16 v[12:15], v[52:55], v[204:207], v[12:15]
    ds_read_b64_tr_b16 v[94:95], v227 offset:63488
    v_mfma_f32_16x16x32_bf16 v[16:19], v[56:59], v[200:203], v[16:19]
    v_mfma_f32_16x16x32_bf16 v[20:23], v[56:59], v[204:207], v[20:23]
    ds_read_b32 v249, v247
    v_mfma_f32_16x16x32_bf16 v[24:27], v[60:63], v[200:203], v[24:27]
    v_mfma_f32_16x16x32_bf16 v[28:31], v[60:63], v[204:207], v[28:31]
    s_waitcnt vmcnt(0) lgkmcnt(0)
    v_mfma_f32_16x16x32_bf16 v[0:3], v[64:67], v[208:211], v[0:3]
    v_mfma_f32_16x16x32_bf16 v[4:7], v[64:67], v[212:215], v[4:7]
    v_mfma_f32_16x16x32_bf16 v[8:11], v[68:71], v[208:211], v[8:11]
    v_mfma_f32_16x16x32_bf16 v[12:15], v[68:71], v[212:215], v[12:15]
    v_mfma_f32_16x16x32_bf16 v[16:19], v[72:75], v[208:211], v[16:19]
    v_mfma_f32_16x16x32_bf16 v[20:23], v[72:75], v[212:215], v[20:23]
    v_mfma_f32_16x16x32_bf16 v[24:27], v[76:79], v[208:211], v[24:27]
    v_mfma_f32_16x16x32_bf16 v[28:31], v[76:79], v[212:215], v[28:31]
    v_mfma_f32_16x16x32_bf16 v[0:3], v[80:83], v[216:219], v[0:3]
    v_mfma_f32_16x16x32_bf16 v[4:7], v[80:83], v[220:223], v[4:7]
    v_mfma_f32_16x16x32_bf16 v[8:11], v[84:87], v[216:219], v[8:11]
    v_mfma_f32_16x16x32_bf16 v[12:15], v[84:87], v[220:223], v[12:15]
    v_mfma_f32_16x16x32_bf16 v[16:19], v[88:91], v[216:219], v[16:19]
    v_mfma_f32_16x16x32_bf16 v[20:23], v[88:91], v[220:223], v[20:23]
    v_mfma_f32_16x16x32_bf16 v[24:27], v[92:95], v[216:219], v[24:27]
    v_mfma_f32_16x16x32_bf16 v[28:31], v[92:95], v[220:223], v[28:31]
    s_mov_b32 s12, s44
    s_mov_b32 s13, s45
    s_mov_b32 s14, 0x400000
    s_mov_b32 s15, 0x00020000
    s_lshl_b32 s3, s21, 12
    v_add_u32 v103, s3, v245
    v_add_u32 v102, 16384, v103
    v_add_u32 v103, 131072, v103
    v_permlane16_swap_b32 v232, v234
    v_permlane16_swap_b32 v233, v235
    v_permlane16_swap_b32 v236, v238
    v_permlane16_swap_b32 v237, v239
    s_nop 0
    ds_write_b128 v102, v[16:19] offset:0
    ds_write_b128 v102, v[20:23] offset:1024
    ds_write_b128 v102, v[24:27] offset:2048
    ds_write_b128 v102, v[28:31] offset:3072
    v_lshlrev_b32 v64, 16, v232
    v_and_b32 v65, s89, v232
    v_lshlrev_b32 v66, 16, v233
    v_and_b32 v67, s89, v233
    v_lshlrev_b32 v68, 16, v236
    v_and_b32 v69, s89, v236
    v_lshlrev_b32 v70, 16, v237
    v_and_b32 v71, s89, v237
    v_lshlrev_b32 v72, 16, v234
    v_and_b32 v73, s89, v234
    v_lshlrev_b32 v74, 16, v235
    v_and_b32 v75, s89, v235
    v_lshlrev_b32 v76, 16, v238
    v_and_b32 v77, s89, v238
    v_lshlrev_b32 v78, 16, v239
    v_and_b32 v79, s89, v239
    s_waitcnt lgkmcnt(0)
    s_barrier
    ds_read_b128 v[32:35], v103 offset:0
    ds_read_b128 v[36:39], v103 offset:1024
    ds_read_b128 v[40:43], v103 offset:2048
    ds_read_b128 v[44:47], v103 offset:3072
    s_waitcnt lgkmcnt(0)
    v_pk_fma_f32 v[64:65], v[0:1], v[32:33], v[64:65]
    v_pk_fma_f32 v[66:67], v[2:3], v[34:35], v[66:67]
    v_pk_fma_f32 v[68:69], v[4:5], v[36:37], v[68:69]
    v_pk_fma_f32 v[70:71], v[6:7], v[38:39], v[70:71]
    v_pk_fma_f32 v[72:73], v[8:9], v[40:41], v[72:73]
    v_pk_fma_f32 v[74:75], v[10:11], v[42:43], v[74:75]
    v_pk_fma_f32 v[76:77], v[12:13], v[44:45], v[76:77]
    v_pk_fma_f32 v[78:79], v[14:15], v[46:47], v[78:79]
    v_cvt_pk_bf16_f32 v232, v64, v65
    v_cvt_pk_bf16_f32 v233, v66, v67
    v_cvt_pk_bf16_f32 v236, v68, v69
    v_cvt_pk_bf16_f32 v237, v70, v71
    v_cvt_pk_bf16_f32 v234, v72, v73
    v_cvt_pk_bf16_f32 v235, v74, v75
    v_cvt_pk_bf16_f32 v238, v76, v77
    v_cvt_pk_bf16_f32 v239, v78, v79
    s_nop 1
    v_permlane16_swap_b32 v232, v234
    v_permlane16_swap_b32 v233, v235
    buffer_store_dwordx4 v[232:235], v231, s[12:15], 0 offen
    v_permlane16_swap_b32 v236, v238
    v_permlane16_swap_b32 v237, v239
    buffer_store_dwordx4 v[236:239], v231, s[12:15], s41 offen
    s_endpgm
L_roleB:
    s_mov_b32 s26, 0
    s_mov_b32 s94, 98304
    s_cmp_eq_u32 s21, 2
    s_cselect_b32 s98, -1, 0
    s_mov_b32 s99, s98
    s_cmp_ge_u32 s21, 2
    s_cselect_b32 s8, s56, s50
    s_cselect_b32 s9, s57, s51
    s_mov_b32 s10, 6291456
    s_cmov_b32 s10, 7340032
    s_mov_b32 s11, 0x00020000
    s_mov_b32 s27, 196608
    s_cmov_b32 s27, 229376
    s_cbranch_scc1 sB_74
    s_mul_i32 s3, s21, 3
    s_lshl_b32 s28, s3, 10
    s_lshl_b32 s3, s3, 6
    s_lshl_b32 s39, s25, 6
    v_add_u32 v1, s3, v250
    v_add_u32 v1, 0, v1
    v_mul_u32_u24 v2, 171, v1
    v_lshrrev_b32 v2, 11, v2
    v_mul_u32_u24 v3, 12, v2
    v_sub_u32 v3, v1, v3
    v_bfe_u32 v5, v2, 2, 1
    v_lshlrev_b32 v4, 1, v5
    v_xor_b32 v3, v3, v4
    v_and_b32 v4, 0x13, v2
    v_lshl_add_u32 v4, v5, 3, v4
    v_bfe_u32 v5, v2, 3, 1
    v_lshl_add_u32 v2, v5, 2, v4
    v_mul_u32_u24 v2, 6144, v2
    v_lshrrev_b32 v4, 2, v3
    v_lshl_add_u32 v2, v4, 11, v2
    v_and_b32 v3, 3, v3
    v_lshl_add_u32 v2, v3, 4, v2
    v_add_u32 v2, s39, v2
    v_subrev_u32 v206, 0, v2
    v_add_u32 v1, s3, v250
    v_add_u32 v1, 64, v1
    v_mul_u32_u24 v2, 171, v1
    v_lshrrev_b32 v2, 11, v2
    v_mul_u32_u24 v3, 12, v2
    v_sub_u32 v3, v1, v3
    v_bfe_u32 v5, v2, 2, 1
    v_lshlrev_b32 v4, 1, v5
    v_xor_b32 v3, v3, v4
    v_and_b32 v4, 0x13, v2
    v_lshl_add_u32 v4, v5, 3, v4
    v_bfe_u32 v5, v2, 3, 1
    v_lshl_add_u32 v2, v5, 2, v4
    v_mul_u32_u24 v2, 6144, v2
    v_lshrrev_b32 v4, 2, v3
    v_lshl_add_u32 v2, v4, 11, v2
    v_and_b32 v3, 3, v3
    v_lshl_add_u32 v2, v3, 4, v2
    v_add_u32 v2, s39, v2
    v_subrev_u32 v207, 1024, v2
    v_add_u32 v1, s3, v250
    v_add_u32 v1, 128, v1
    v_mul_u32_u24 v2, 171, v1
    v_lshrrev_b32 v2, 11, v2
    v_mul_u32_u24 v3, 12, v2
    v_sub_u32 v3, v1, v3
    v_bfe_u32 v5, v2, 2, 1
    v_lshlrev_b32 v4, 1, v5
    v_xor_b32 v3, v3, v4
    v_and_b32 v4, 0x13, v2
    v_lshl_add_u32 v4, v5, 3, v4
    v_bfe_u32 v5, v2, 3, 1
    v_lshl_add_u32 v2, v5, 2, v4
    v_mul_u32_u24 v2, 6144, v2
    v_lshrrev_b32 v4, 2, v3
    v_lshl_add_u32 v2, v4, 11, v2
    v_and_b32 v3, 3, v3
    v_lshl_add_u32 v2, v3, 4, v2
    v_add_u32 v2, s39, v2
    v_subrev_u32 v208, 2048, v2
    v_add_u32 v1, s3, v250
    v_add_u32 v1, 192, v1
    v_mul_u32_u24 v2, 171, v1
    v_lshrrev_b32 v2, 11, v2
    v_mul_u32_u24 v3, 12, v2
    v_sub_u32 v3, v1, v3
    v_bfe_u32 v5, v2, 2, 1
    v_lshlrev_b32 v4, 1, v5
    v_xor_b32 v3, v3, v4
    v_and_b32 v4, 0x13, v2
    v_lshl_add_u32 v4, v5, 3, v4
    v_bfe_u32 v5, v2, 3, 1
    v_lshl_add_u32 v2, v5, 2, v4
    v_mul_u32_u24 v2, 6144, v2
    v_lshrrev_b32 v4, 2, v3
    v_lshl_add_u32 v2, v4, 11, v2
    v_and_b32 v3, 3, v3
    v_lshl_add_u32 v2, v3, 4, v2
    v_add_u32 v2, s39, v2
    v_subrev_u32 v209, 3072, v2
    s_add_u32 s40, s39, 2048
    s_add_u32 s41, s39, 4096
    s_branch sE_75
sB_74:
    s_sub_u32 s3, s21, 2
    s_lshl_b32 s3, s3, 2
    s_lshl_b32 s28, s3, 10
    s_add_u32 s28, s28, 6144
    s_lshl_b32 s3, s3, 6
    s_lshr_b32 s39, s24, 1
    s_mul_i32 s39, s39, 3584
    s_mul_i32 s7, s23, 448
    s_add_u32 s39, s39, s7
    s_and_b32 s7, s24, 1
    s_mul_i32 s7, s7, 224
    s_add_u32 s39, s39, s7
    v_add_u32 v1, s3, v250
    v_add_u32 v1, 0, v1
    v_mul_u32_u24 v2, 293, v1
    v_lshrrev_b32 v2, 12, v2
    v_mul_u32_u24 v3, 14, v2
    v_sub_u32 v3, v1, v3
    v_and_b32 v4, 0x13, v2
    v_bfe_u32 v5, v2, 2, 1
    v_lshl_add_u32 v4, v5, 3, v4
    v_bfe_u32 v5, v2, 3, 1
    v_lshl_add_u32 v4, v5, 2, v4
    v_mul_u32_u24 v4, 7168, v4
    v_lshl_add_u32 v4, v3, 4, v4
    v_add_u32 v4, s39, v4
    v_subrev_u32 v206, 0, v4
    v_add_u32 v1, s3, v250
    v_add_u32 v1, 64, v1
    v_mul_u32_u24 v2, 293, v1
    v_lshrrev_b32 v2, 12, v2
    v_mul_u32_u24 v3, 14, v2
    v_sub_u32 v3, v1, v3
    v_and_b32 v4, 0x13, v2
    v_bfe_u32 v5, v2, 2, 1
    v_lshl_add_u32 v4, v5, 3, v4
    v_bfe_u32 v5, v2, 3, 1
    v_lshl_add_u32 v4, v5, 2, v4
    v_mul_u32_u24 v4, 7168, v4
    v_lshl_add_u32 v4, v3, 4, v4
    v_add_u32 v4, s39, v4
    v_subrev_u32 v207, 1024, v4
    v_add_u32 v1, s3, v250
    v_add_u32 v1, 128, v1
    v_mul_u32_u24 v2, 293, v1
    v_lshrrev_b32 v2, 12, v2
    v_mul_u32_u24 v3, 14, v2
    v_sub_u32 v3, v1, v3
    v_and_b32 v4, 0x13, v2
    v_bfe_u32 v5, v2, 2, 1
    v_lshl_add_u32 v4, v5, 3, v4
    v_bfe_u32 v5, v2, 3, 1
    v_lshl_add_u32 v4, v5, 2, v4
    v_mul_u32_u24 v4, 7168, v4
    v_lshl_add_u32 v4, v3, 4, v4
    v_add_u32 v4, s39, v4
    v_subrev_u32 v208, 2048, v4
    v_add_u32 v1, s3, v250
    v_add_u32 v1, 192, v1
    v_mul_u32_u24 v2, 293, v1
    v_lshrrev_b32 v2, 12, v2
    v_mul_u32_u24 v3, 14, v2
    v_sub_u32 v3, v1, v3
    v_and_b32 v4, 0x13, v2
    v_bfe_u32 v5, v2, 2, 1
    v_lshl_add_u32 v4, v5, 3, v4
    v_bfe_u32 v5, v2, 3, 1
    v_lshl_add_u32 v4, v5, 2, v4
    v_mul_u32_u24 v4, 7168, v4
    v_lshl_add_u32 v4, v3, 4, v4
    v_add_u32 v4, s39, v4
    v_subrev_u32 v209, 3072, v4
    s_add_u32 s40, s39, 128
    s_add_u32 s41, s39, 220
sE_75:
    s_add_u32 m0, s94, s28
    s_nop 0
    buffer_load_dwordx4 v206, s[8:11], s26 offen offset:0 lds
    buffer_load_dwordx4 v207, s[8:11], s26 offen offset:1024 lds
    buffer_load_dwordx4 v208, s[8:11], s26 offen offset:2048 lds
    s_mov_b64 exec, s[98:99]
    buffer_load_dwordx4 v209, s[8:11], s26 offen offset:3072 lds
    s_mov_b64 exec, -1
    s_add_u32 s26, s26, s27
    s_add_u32 s94, s94, 13312
    s_cmp_eq_u32 s94, 151552
    s_cmov_b32 s94, 98304
    s_add_u32 m0, s94, s28
    s_nop 0
    buffer_load_dwordx4 v206, s[8:11], s26 offen offset:0 lds
    buffer_load_dwordx4 v207, s[8:11], s26 offen offset:1024 lds
    buffer_load_dwordx4 v208, s[8:11], s26 offen offset:2048 lds
    s_mov_b64 exec, s[98:99]
    buffer_load_dwordx4 v209, s[8:11], s26 offen offset:3072 lds
    s_mov_b64 exec, -1
    s_add_u32 s26, s26, s27
    s_add_u32 s94, s94, 13312
    s_cmp_eq_u32 s94, 151552
    s_cmov_b32 s94, 98304
    s_add_u32 m0, s94, s28
    s_nop 0
    buffer_load_dwordx4 v206, s[8:11], s26 offen offset:0 lds
    buffer_load_dwordx4 v207, s[8:11], s26 offen offset:1024 lds
    buffer_load_dwordx4 v208, s[8:11], s26 offen offset:2048 lds
    s_mov_b64 exec, s[98:99]
    buffer_load_dwordx4 v209, s[8:11], s26 offen offset:3072 lds
    s_mov_b64 exec, -1
    s_add_u32 s26, s26, s27
    s_add_u32 s94, s94, 13312
    s_cmp_eq_u32 s94, 151552
    s_cmov_b32 s94, 98304
    s_add_u32 m0, s94, s28
    s_nop 0
    buffer_load_dwordx4 v206, s[8:11], s26 offen offset:0 lds
    buffer_load_dwordx4 v207, s[8:11], s26 offen offset:1024 lds
    buffer_load_dwordx4 v208, s[8:11], s26 offen offset:2048 lds
    s_mov_b64 exec, s[98:99]
    buffer_load_dwordx4 v209, s[8:11], s26 offen offset:3072 lds
    s_mov_b64 exec, -1
    s_add_u32 s26, s26, s27
    s_add_u32 s94, s94, 13312
    s_cmp_eq_u32 s94, 151552
    s_cmov_b32 s94, 98304
    s_lshl_b32 s3, s37, 9
    s_lshl_b32 s6, s22, 6
    s_add_u32 s3, s3, s6
    v_add_u32 v214, s3, v250
    s_lshr_b32 s3, s27, 5
    v_mul_lo_u32 v214, v214, s3
    v_add_u32 v214, s39, v214
    s_sub_u32 s14, s40, s39
    s_sub_u32 s15, s41, s39
    v_add_u32 v215, s14, v214
    v_add_u32 v237, s15, v214
    s_and_b32 s39, s36, 3
    s_add_u32 s39, s39, 2
    s_cmp_eq_u32 s37, 1
    s_cbranch_scc1 wt_76
    s_mov_b32 s39, 99
    buffer_load_dword v213, v214, s[8:11], 0 offen
    buffer_load_dword v213, v215, s[8:11], 0 offen
    buffer_load_dword v213, v237, s[8:11], 0 offen
wt_76:
    s_getpc_b64 s[6:7]
L_pc:
    s_sub_u32 s12, s6, L_pc-recurrent_scan__mha_block__mixer_gmlp__prompt_kernel
    s_subb_u32 s13, s7, 0
    s_mov_b32 s14, L_codeend-recurrent_scan__mha_block__mixer_gmlp__prompt_kernel
    s_mov_b32 s15, 0x00020000
    v_and_b32 v212, 7, v250
    v_lshlrev_b32 v212, 7, v212
    s_lshl_b32 s3, s36, 2
    s_add_u32 s3, s3, s21
    s_lshl_b32 s3, s3, 10
    buffer_load_dword v213, v212, s[12:15], s3 offen
    v_and_b32 v1, 15, v250
    v_lshrrev_b32 v2, 4, v250
    v_lshrrev_b32 v3, 1, v1
    v_xor_b32 v4, v3, v2
    s_lshl_b32 s6, s21, 6
    v_add_u32 v1, s6, v1
    v_lshlrev_b32 v1, 7, v1
    v_lshl_add_u32 v200, v4, 4, v1
    v_xor_b32 v201, 64, v200
    v_bfe_u32 v1, v250, 2, 2
    v_bfe_u32 v3, v250, 4, 1
    v_lshl_add_u32 v1, v3, 2, v1
    v_lshrrev_b32 v3, 5, v250
    v_lshl_add_u32 v1, v3, 4, v1
    v_mul_u32_u24 v1, 224, v1
    v_and_b32 v3, 3, v250
    v_lshl_add_u32 v204, v3, 3, v1
    s_cmp_lt_u32 s21, 2
    s_cselect_b32 s16, s58, s62
    s_cselect_b32 s17, s59, s63
    s_mov_b32 s18, 14336
    s_cmov_b32 s18, 16384
    s_cmp_eq_u32 s21, 3
    s_cselect_b32 s16, s52, s16
    s_cselect_b32 s17, s53, s17
    s_cmov_b32 s18, 8192
    s_cmp_eq_u32 s21, 1
    s_cselect_b32 s3, 256, 0
    s_add_u32 s3, s3, s2
    s_mul_i32 s3, s3, s18
    s_add_u32 s16, s16, s3
    s_addc_u32 s17, s17, 0
    s_mov_b32 s19, 0x00020000
    v_lshlrev_b32 v210, 7, v250
    s_mov_b32 s30, 0
    s_mul_i32 s3, s36, 86
    s_lshr_b32 s3, s3, 8
    s_mul_i32 s3, s3, 3
    s_sub_u32 s43, s36, s3
    s_add_u32 s43, s43, 6
    s_mov_b32 s95, 138240
    s_mov_b32 s96, 65536
    s_setprio 0
    v_and_b32 v1, 15, v250
    v_mov_b32 v2, 0x3f803f80
    v_lshrrev_b32 v3, 5, v250
    v_lshrrev_b32 v4, 1, v1
    v_xor_b32 v3, v3, v4
    v_cmp_eq_u32 vcc, 0, v3
    v_and_b32 v5, 1, v1
    v_mul_u32_u24 v5, 0xaaaa, v5
    v_cndmask_b32 v232, 0, v2, vcc
    v_cndmask_b32 v233, 0, v2, vcc
    v_cndmask_b32 v234, 0, v2, vcc
    v_cndmask_b32 v235, 0, v2, vcc
    v_add_u32 v236, 0x4444, v5
    v_mov_b32 v216, 0
    v_mov_b32 v217, 0
    v_mov_b32 v218, 0
    v_mov_b32 v219, 0
    v_mov_b32 v220, 0
    v_mov_b32 v221, 0
    v_mov_b32 v222, 0
    v_mov_b32 v223, 0
    v_mov_b32 v224, 0
    v_mov_b32 v225, 0
    v_mov_b32 v226, 0
    v_mov_b32 v227, 0
    v_mov_b32 v228, 0
    v_mov_b32 v229, 0
    v_mov_b32 v230, 0
    v_mov_b32 v231, 0
    s_cmp_eq_u32 s21, 1
    s_cselect_b32 s42, s22, 99
    s_mov_b32 s41, 0
    s_mov_b32 s40, 0
    v_mov_b32 v240, 0
    v_mov_b32 v241, 0
    s_mov_b32 s12, s4
    s_mov_b32 s13, s5
    s_mov_b32 s14, 0x80000
    s_mov_b32 s15, 0x00020000
    v_mov_b32 v0, 0
    v_mov_b32 v1, 0
    v_mov_b32 v2, 0
    v_mov_b32 v3, 0
    v_mov_b32 v4, 0
    v_mov_b32 v5, 0
    v_mov_b32 v6, 0
    v_mov_b32 v7, 0
    v_mov_b32 v8, 0
    v_mov_b32 v9, 0
    v_mov_b32 v10, 0
    v_mov_b32 v11, 0
    v_mov_b32 v12, 0
    v_mov_b32 v13, 0
    v_mov_b32 v14, 0
    v_mov_b32 v15, 0
    v_mov_b32 v16, 0
    v_mov_b32 v17, 0
    v_mov_b32 v18, 0
    v_mov_b32 v19, 0
    v_mov_b32 v20, 0
    v_mov_b32 v21, 0
    v_mov_b32 v22, 0
    v_mov_b32 v23, 0
    v_mov_b32 v24, 0
    v_mov_b32 v25, 0
    v_mov_b32 v26, 0
    v_mov_b32 v27, 0
    v_mov_b32 v28, 0
    v_mov_b32 v29, 0
    v_mov_b32 v30, 0
    v_mov_b32 v31, 0
    v_mov_b32 v32, 0
    v_mov_b32 v33, 0
    v_mov_b32 v34, 0
    v_mov_b32 v35, 0
    v_mov_b32 v36, 0
    v_mov_b32 v37, 0
    v_mov_b32 v38, 0
    v_mov_b32 v39, 0
    v_mov_b32 v40, 0
    v_mov_b32 v41, 0
    v_mov_b32 v42, 0
    v_mov_b32 v43, 0
    v_mov_b32 v44, 0
    v_mov_b32 v45, 0
    v_mov_b32 v46, 0
    v_mov_b32 v47, 0
    v_mov_b32 v48, 0
    v_mov_b32 v49, 0
    v_mov_b32 v50, 0
    v_mov_b32 v51, 0
    v_mov_b32 v52, 0
    v_mov_b32 v53, 0
    v_mov_b32 v54, 0
    v_mov_b32 v55, 0
    v_mov_b32 v56, 0
    v_mov_b32 v57, 0
    v_mov_b32 v58, 0
    v_mov_b32 v59, 0
    v_mov_b32 v60, 0
    v_mov_b32 v61, 0
    v_mov_b32 v62, 0
    v_mov_b32 v63, 0
    v_mov_b32 v64, 0
    v_mov_b32 v65, 0
    v_mov_b32 v66, 0
    v_mov_b32 v67, 0
    v_mov_b32 v68, 0
    v_mov_b32 v69, 0
    v_mov_b32 v70, 0
    v_mov_b32 v71, 0
    v_mov_b32 v72, 0
    v_mov_b32 v73, 0
    v_mov_b32 v74, 0
    v_mov_b32 v75, 0
    v_mov_b32 v76, 0
    v_mov_b32 v77, 0
    v_mov_b32 v78, 0
    v_mov_b32 v79, 0
    v_mov_b32 v80, 0
    v_mov_b32 v81, 0
    v_mov_b32 v82, 0
    v_mov_b32 v83, 0
    v_mov_b32 v84, 0
    v_mov_b32 v85, 0
    v_mov_b32 v86, 0
    v_mov_b32 v87, 0
    v_mov_b32 v88, 0
    v_mov_b32 v89, 0
    v_mov_b32 v90, 0
    v_mov_b32 v91, 0
    v_mov_b32 v92, 0
    v_mov_b32 v93, 0
    v_mov_b32 v94, 0
    v_mov_b32 v95, 0
    v_mov_b32 v96, 0
    v_mov_b32 v97, 0
    v_mov_b32 v98, 0
    v_mov_b32 v99, 0
    v_mov_b32 v100, 0
    v_mov_b32 v101, 0
    v_mov_b32 v102, 0
    v_mov_b32 v103, 0
    v_mov_b32 v104, 0
    v_mov_b32 v105, 0
    v_mov_b32 v106, 0
    v_mov_b32 v107, 0
    v_mov_b32 v108, 0
    v_mov_b32 v109, 0
    v_mov_b32 v110, 0
    v_mov_b32 v111, 0
    s_waitcnt vmcnt(13) lgkmcnt(0)
    s_barrier
    v_mov_b32 v242, 161792
    ds_read_b32 v243, v242
    s_add_u32 s96, s96, 32768
    s_cmp_eq_u32 s96, 98304
    s_cmov_b32 s96, 0
    v_add_u32 v202, s96, v200
    v_add_u32 v203, s96, v201
    s_add_u32 s95, s95, 13312
    s_cmp_eq_u32 s95, 151552
    s_cmov_b32 s95, 98304
    v_add_u32 v205, s95, v204
    ds_read_b128 v[112:115], v202 offset:0
    ds_read_b128 v[116:119], v202 offset:2048
    ds_read_b128 v[120:123], v202 offset:4096
    ds_read_b128 v[124:127], v202 offset:6144
    ds_read_b64_tr_b16 v[128:129], v205 offset:6144
    ds_read_b64_tr_b16 v[130:131], v205 offset:7936
    ds_read_b64_tr_b16 v[132:133], v205 offset:6176
    ds_read_b64_tr_b16 v[134:135], v205 offset:7968
    ds_read_b64_tr_b16 v[136:137], v205 offset:6208
    ds_read_b64_tr_b16 v[138:139], v205 offset:8000
    ds_read_b64_tr_b16 v[140:141], v205 offset:6240
    ds_read_b64_tr_b16 v[142:143], v205 offset:8032
    ds_read_b64_tr_b16 v[144:145], v205 offset:6272
    ds_read_b64_tr_b16 v[146:147], v205 offset:8064
    ds_read_b64_tr_b16 v[148:149], v205 offset:6304
    ds_read_b64_tr_b16 v[150:151], v205 offset:8096
    ds_read_b64_tr_b16 v[152:153], v205 offset:6336
    ds_read_b64_tr_b16 v[154:155], v205 offset:8128
    s_waitcnt vmcnt(9) lgkmcnt(0)
    v_readfirstlane_b32 s31, v243
    s_lshr_b32 s3, s41, 1
    s_cmp_eq_u32 s3, s42
    s_cselect_b64 vcc, -1, 0
    s_branch g1B_79m
.p2align 3
    s_nop 0
g1B_79:
    v_mfma_f32_16x16x32_bf16 v[80:83], v[196:199], v[164:167], v[80:83]
    v_mfma_f32_16x16x32_bf16 v[108:111], v[196:199], v[168:171], v[108:111]
    s_waitcnt vmcnt(8) lgkmcnt(0)
g1B_79m:
    s_barrier
    v_mfma_f32_16x16x32_bf16 v[0:3], v[128:131], v[112:115], v[0:3]
    s_cbranch_vccnz cs_80
cs_80r:
    s_setprio 3
    s_add_u32 m0, s95, s28
    ds_read_b128 v[156:159], v203 offset:0
    v_mfma_f32_16x16x32_bf16 v[28:31], v[128:131], v[116:119], v[28:31]
    s_add_u32 s95, s95, 13312
    v_mfma_f32_16x16x32_bf16 v[56:59], v[128:131], v[120:123], v[56:59]
    ds_read_b128 v[160:163], v203 offset:2048
    v_mfma_f32_16x16x32_bf16 v[84:87], v[128:131], v[124:127], v[84:87]
    s_cmp_eq_u32 s95, 151552
    v_mfma_f32_16x16x32_bf16 v[4:7], v[132:135], v[112:115], v[4:7]
    ds_read_b128 v[164:167], v203 offset:4096
    v_mfma_f32_16x16x32_bf16 v[32:35], v[132:135], v[116:119], v[32:35]
    s_cmov_b32 s95, 98304
    ds_read_b128 v[168:171], v203 offset:6144
    v_mfma_f32_16x16x32_bf16 v[60:63], v[132:135], v[120:123], v[60:63]
    v_add_u32 v205, s95, v204
    v_mfma_f32_16x16x32_bf16 v[88:91], v[132:135], v[124:127], v[88:91]
    s_setprio 2
    ds_read_b64_tr_b16 v[172:173], v205 offset:6144
    v_mfma_f32_16x16x32_bf16 v[8:11], v[136:139], v[112:115], v[8:11]
    ds_read_b64_tr_b16 v[174:175], v205 offset:7936
    v_mfma_f32_16x16x32_bf16 v[36:39], v[136:139], v[116:119], v[36:39]
    ds_read_b64_tr_b16 v[176:177], v205 offset:6176
    v_mfma_f32_16x16x32_bf16 v[64:67], v[136:139], v[120:123], v[64:67]
    ds_read_b64_tr_b16 v[178:179], v205 offset:7968
    v_mfma_f32_16x16x32_bf16 v[92:95], v[136:139], v[124:127], v[92:95]
    buffer_load_dwordx4 v206, s[8:11], s26 offen offset:0 lds
    ds_read_b64_tr_b16 v[180:181], v205 offset:6208
    v_mfma_f32_16x16x32_bf16 v[12:15], v[140:143], v[112:115], v[12:15]
    ds_read_b64_tr_b16 v[182:183], v205 offset:8000
    v_mfma_f32_16x16x32_bf16 v[40:43], v[140:143], v[116:119], v[40:43]
    ds_read_b64_tr_b16 v[184:185], v205 offset:6240
    v_mfma_f32_16x16x32_bf16 v[68:71], v[140:143], v[120:123], v[68:71]
    s_setprio 1
    ds_read_b64_tr_b16 v[186:187], v205 offset:8032
    v_mfma_f32_16x16x32_bf16 v[96:99], v[140:143], v[124:127], v[96:99]
    buffer_load_dwordx4 v207, s[8:11], s26 offen offset:1024 lds
    v_mfma_f32_16x16x32_bf16 v[16:19], v[144:147], v[112:115], v[16:19]
    ds_read_b64_tr_b16 v[188:189], v205 offset:6272
    v_mfma_f32_16x16x32_bf16 v[44:47], v[144:147], v[116:119], v[44:47]
    ds_read_b64_tr_b16 v[190:191], v205 offset:8064
    ds_read_b64_tr_b16 v[192:193], v205 offset:6304
    v_mfma_f32_16x16x32_bf16 v[72:75], v[144:147], v[120:123], v[72:75]
    ds_read_b64_tr_b16 v[194:195], v205 offset:8096
    v_mfma_f32_16x16x32_bf16 v[100:103], v[144:147], v[124:127], v[100:103]
    buffer_load_dwordx4 v208, s[8:11], s26 offen offset:2048 lds
    v_mfma_f32_16x16x32_bf16 v[20:23], v[148:151], v[112:115], v[20:23]
    ds_read_b64_tr_b16 v[196:197], v205 offset:6336
    v_mfma_f32_16x16x32_bf16 v[48:51], v[148:151], v[116:119], v[48:51]
    s_setprio 0
    ds_read_b64_tr_b16 v[198:199], v205 offset:8128
    v_mfma_f32_16x16x32_bf16 v[76:79], v[148:151], v[120:123], v[76:79]
    s_mov_b64 exec, s[98:99]
    buffer_load_dwordx4 v209, s[8:11], s26 offen offset:3072 lds
    s_mov_b64 exec, -1
    s_add_u32 s26, s26, s27
    v_mfma_f32_16x16x32_bf16 v[104:107], v[148:151], v[124:127], v[104:107]
    v_mfma_f32_16x16x32_bf16 v[24:27], v[152:155], v[112:115], v[24:27]
    v_mfma_f32_16x16x32_bf16 v[52:55], v[152:155], v[116:119], v[52:55]
    s_cmp_eq_u32 s41, s43
    s_cbranch_scc1 mw_77
mw_77r:
    s_cmp_eq_u32 s41, s39
    s_cbranch_scc1 w2_78
w2_78r:
    v_mfma_f32_16x16x32_bf16 v[80:83], v[152:155], v[120:123], v[80:83]
    v_mfma_f32_16x16x32_bf16 v[108:111], v[152:155], v[124:127], v[108:111]
    s_waitcnt vmcnt(8) lgkmcnt(0)
    s_barrier
    v_mfma_f32_16x16x32_bf16 v[0:3], v[172:175], v[156:159], v[0:3]
    s_cbranch_vccnz cs_81
cs_81r:
    s_setprio 3
    s_add_u32 m0, s95, s28
    s_add_u32 s96, s96, 32768
    v_mfma_f32_16x16x32_bf16 v[28:31], v[172:175], v[160:163], v[28:31]
    s_cmp_eq_u32 s96, 98304
    v_mfma_f32_16x16x32_bf16 v[56:59], v[172:175], v[164:167], v[56:59]
    s_cmov_b32 s96, 0
    v_add_u32 v202, s96, v200
    v_add_u32 v203, s96, v201
    v_mfma_f32_16x16x32_bf16 v[84:87], v[172:175], v[168:171], v[84:87]
    ds_read_b128 v[112:115], v202 offset:0
    v_mfma_f32_16x16x32_bf16 v[4:7], v[176:179], v[156:159], v[4:7]
    s_add_u32 s95, s95, 13312
    v_mfma_f32_16x16x32_bf16 v[32:35], v[176:179], v[160:163], v[32:35]
    ds_read_b128 v[116:119], v202 offset:2048
    s_cmp_eq_u32 s95, 151552
    v_mfma_f32_16x16x32_bf16 v[60:63], v[176:179], v[164:167], v[60:63]
    ds_read_b128 v[120:123], v202 offset:4096
    v_mfma_f32_16x16x32_bf16 v[88:91], v[176:179], v[168:171], v[88:91]
    s_setprio 2
    s_cmov_b32 s95, 98304
    v_mfma_f32_16x16x32_bf16 v[8:11], v[180:183], v[156:159], v[8:11]
    ds_read_b128 v[124:127], v202 offset:6144
    v_add_u32 v205, s95, v204
    v_mfma_f32_16x16x32_bf16 v[36:39], v[180:183], v[160:163], v[36:39]
    ds_read_b64_tr_b16 v[128:129], v205 offset:6144
    v_mfma_f32_16x16x32_bf16 v[64:67], v[180:183], v[164:167], v[64:67]
    ds_read_b64_tr_b16 v[130:131], v205 offset:7936
    v_mfma_f32_16x16x32_bf16 v[92:95], v[180:183], v[168:171], v[92:95]
    ds_read_b64_tr_b16 v[132:133], v205 offset:6176
    ds_read_b64_tr_b16 v[134:135], v205 offset:7968
    v_mfma_f32_16x16x32_bf16 v[12:15], v[184:187], v[156:159], v[12:15]
    buffer_load_dwordx4 v206, s[8:11], s26 offen offset:0 lds
    v_mfma_f32_16x16x32_bf16 v[40:43], v[184:187], v[160:163], v[40:43]
    ds_read_b64_tr_b16 v[136:137], v205 offset:6208
    v_mfma_f32_16x16x32_bf16 v[68:71], v[184:187], v[164:167], v[68:71]
    s_setprio 1
    ds_read_b64_tr_b16 v[138:139], v205 offset:8000
    ds_read_b64_tr_b16 v[140:141], v205 offset:6240
    v_mfma_f32_16x16x32_bf16 v[96:99], v[184:187], v[168:171], v[96:99]
    ds_read_b64_tr_b16 v[142:143], v205 offset:8032
    v_mfma_f32_16x16x32_bf16 v[16:19], v[188:191], v[156:159], v[16:19]
    buffer_load_dwordx4 v207, s[8:11], s26 offen offset:1024 lds
    v_mfma_f32_16x16x32_bf16 v[44:47], v[188:191], v[160:163], v[44:47]
    ds_read_b64_tr_b16 v[144:145], v205 offset:6272
    ds_read_b64_tr_b16 v[146:147], v205 offset:8064
    v_mfma_f32_16x16x32_bf16 v[72:75], v[188:191], v[164:167], v[72:75]
    ds_read_b64_tr_b16 v[148:149], v205 offset:6304
    v_mfma_f32_16x16x32_bf16 v[100:103], v[188:191], v[168:171], v[100:103]
    ds_read_b64_tr_b16 v[150:151], v205 offset:8096
    v_mfma_f32_16x16x32_bf16 v[20:23], v[192:195], v[156:159], v[20:23]
    buffer_load_dwordx4 v208, s[8:11], s26 offen offset:2048 lds
    ds_read_b64_tr_b16 v[152:153], v205 offset:6336
    v_mfma_f32_16x16x32_bf16 v[48:51], v[192:195], v[160:163], v[48:51]
    s_setprio 0
    ds_read_b64_tr_b16 v[154:155], v205 offset:8128
    v_mfma_f32_16x16x32_bf16 v[76:79], v[192:195], v[164:167], v[76:79]
    s_mov_b64 exec, s[98:99]
    buffer_load_dwordx4 v209, s[8:11], s26 offen offset:3072 lds
    s_mov_b64 exec, -1
    s_add_u32 s26, s26, s27
    v_mfma_f32_16x16x32_bf16 v[104:107], v[192:195], v[168:171], v[104:107]
    v_mfma_f32_16x16x32_bf16 v[24:27], v[196:199], v[156:159], v[24:27]
    v_mfma_f32_16x16x32_bf16 v[52:55], v[196:199], v[160:163], v[52:55]
    s_add_u32 s41, s41, 1
    s_lshr_b32 s3, s41, 1
    s_cmp_eq_u32 s3, s42
    s_cselect_b64 vcc, -1, 0
    s_cmp_lt_u32 s41, 12
    s_cbranch_scc1 g1B_79
    s_cmp_eq_u32 s21, 1
    s_cselect_b64 vcc, -1, 0
    v_mfma_f32_16x16x32_bf16 v[80:83], v[196:199], v[164:167], v[80:83]
    v_mfma_f32_16x16x32_bf16 v[108:111], v[196:199], v[168:171], v[108:111]
    s_waitcnt vmcnt(8) lgkmcnt(0)
    s_barrier
    v_mfma_f32_16x16x32_bf16 v[0:3], v[128:131], v[112:115], v[0:3]
    s_cbranch_vccz cs_82r
    v_smfmac_f32_16x16x64_bf16 v[216:219], v[232:235], v[128:135], v236
    v_smfmac_f32_16x16x64_bf16 v[220:223], v[232:235], v[136:143], v236
    v_smfmac_f32_16x16x64_bf16 v[224:227], v[232:235], v[144:151], v236
    v_mfma_f32_16x16x32_bf16 v[228:231], v[232:235], v[152:155], v[228:231]
cs_82r:
    s_setprio 3
    s_add_u32 m0, s95, s28
    ds_read_b128 v[156:159], v203 offset:0
    v_mfma_f32_16x16x32_bf16 v[28:31], v[128:131], v[116:119], v[28:31]
    s_add_u32 s95, s95, 13312
    v_mfma_f32_16x16x32_bf16 v[56:59], v[128:131], v[120:123], v[56:59]
    ds_read_b128 v[160:163], v203 offset:2048
    v_mfma_f32_16x16x32_bf16 v[84:87], v[128:131], v[124:127], v[84:87]
    s_cmp_eq_u32 s95, 151552
    v_mfma_f32_16x16x32_bf16 v[4:7], v[132:135], v[112:115], v[4:7]
    ds_read_b128 v[164:167], v203 offset:4096
    v_mfma_f32_16x16x32_bf16 v[32:35], v[132:135], v[116:119], v[32:35]
    s_cmov_b32 s95, 98304
    ds_read_b128 v[168:171], v203 offset:6144
    v_mfma_f32_16x16x32_bf16 v[60:63], v[132:135], v[120:123], v[60:63]
    v_add_u32 v205, s95, v204
    v_mfma_f32_16x16x32_bf16 v[88:91], v[132:135], v[124:127], v[88:91]
    s_setprio 2
    ds_read_b64_tr_b16 v[172:173], v205 offset:6144
    v_mfma_f32_16x16x32_bf16 v[8:11], v[136:139], v[112:115], v[8:11]
    ds_read_b64_tr_b16 v[174:175], v205 offset:7936
    v_mfma_f32_16x16x32_bf16 v[36:39], v[136:139], v[116:119], v[36:39]
    ds_read_b64_tr_b16 v[176:177], v205 offset:6176
    v_mfma_f32_16x16x32_bf16 v[64:67], v[136:139], v[120:123], v[64:67]
    ds_read_b64_tr_b16 v[178:179], v205 offset:7968
    v_mfma_f32_16x16x32_bf16 v[92:95], v[136:139], v[124:127], v[92:95]
    buffer_load_dwordx4 v206, s[8:11], s26 offen offset:0 lds
    ds_read_b64_tr_b16 v[180:181], v205 offset:6208
    v_mfma_f32_16x16x32_bf16 v[12:15], v[140:143], v[112:115], v[12:15]
    ds_read_b64_tr_b16 v[182:183], v205 offset:8000
    v_mfma_f32_16x16x32_bf16 v[40:43], v[140:143], v[116:119], v[40:43]
    ds_read_b64_tr_b16 v[184:185], v205 offset:6240
    v_mfma_f32_16x16x32_bf16 v[68:71], v[140:143], v[120:123], v[68:71]
    s_setprio 1
    ds_read_b64_tr_b16 v[186:187], v205 offset:8032
    v_mfma_f32_16x16x32_bf16 v[96:99], v[140:143], v[124:127], v[96:99]
    buffer_load_dwordx4 v207, s[8:11], s26 offen offset:1024 lds
    v_mfma_f32_16x16x32_bf16 v[16:19], v[144:147], v[112:115], v[16:19]
    ds_read_b64_tr_b16 v[188:189], v205 offset:6272
    v_mfma_f32_16x16x32_bf16 v[44:47], v[144:147], v[116:119], v[44:47]
    ds_read_b64_tr_b16 v[190:191], v205 offset:8064
    ds_read_b64_tr_b16 v[192:193], v205 offset:6304
    v_mfma_f32_16x16x32_bf16 v[72:75], v[144:147], v[120:123], v[72:75]
    ds_read_b64_tr_b16 v[194:195], v205 offset:8096
    v_mfma_f32_16x16x32_bf16 v[100:103], v[144:147], v[124:127], v[100:103]
    buffer_load_dwordx4 v208, s[8:11], s26 offen offset:2048 lds
    v_mfma_f32_16x16x32_bf16 v[20:23], v[148:151], v[112:115], v[20:23]
    ds_read_b64_tr_b16 v[196:197], v205 offset:6336
    v_mfma_f32_16x16x32_bf16 v[48:51], v[148:151], v[116:119], v[48:51]
    s_setprio 0
    ds_read_b64_tr_b16 v[198:199], v205 offset:8128
    v_mfma_f32_16x16x32_bf16 v[76:79], v[148:151], v[120:123], v[76:79]
    s_mov_b64 exec, s[98:99]
    buffer_load_dwordx4 v209, s[8:11], s26 offen offset:3072 lds
    s_mov_b64 exec, -1
    s_add_u32 s26, s26, s27
    v_mfma_f32_16x16x32_bf16 v[104:107], v[148:151], v[124:127], v[104:107]
    v_mfma_f32_16x16x32_bf16 v[24:27], v[152:155], v[112:115], v[24:27]
    v_mfma_f32_16x16x32_bf16 v[52:55], v[152:155], v[116:119], v[52:55]
    v_mfma_f32_16x16x32_bf16 v[80:83], v[152:155], v[120:123], v[80:83]
    v_mfma_f32_16x16x32_bf16 v[108:111], v[152:155], v[124:127], v[108:111]
    s_waitcnt vmcnt(8) lgkmcnt(0)
    s_barrier
    v_mfma_f32_16x16x32_bf16 v[0:3], v[172:175], v[156:159], v[0:3]
    s_cbranch_vccz cs_83r
    v_smfmac_f32_16x16x64_bf16 v[216:219], v[232:235], v[172:179], v236
    v_smfmac_f32_16x16x64_bf16 v[220:223], v[232:235], v[180:187], v236
    v_smfmac_f32_16x16x64_bf16 v[224:227], v[232:235], v[188:195], v236
    v_mfma_f32_16x16x32_bf16 v[228:231], v[232:235], v[196:199], v[228:231]
cs_83r:
    s_setprio 3
    s_add_u32 m0, s95, s28
    s_add_u32 s96, s96, 32768
    v_mfma_f32_16x16x32_bf16 v[28:31], v[172:175], v[160:163], v[28:31]
    s_cmp_eq_u32 s96, 98304
    v_mfma_f32_16x16x32_bf16 v[56:59], v[172:175], v[164:167], v[56:59]
    s_cmov_b32 s96, 0
    v_add_u32 v202, s96, v200
    v_add_u32 v203, s96, v201
    v_mfma_f32_16x16x32_bf16 v[84:87], v[172:175], v[168:171], v[84:87]
    ds_read_b128 v[112:115], v202 offset:0
    v_mfma_f32_16x16x32_bf16 v[4:7], v[176:179], v[156:159], v[4:7]
    s_add_u32 s95, s95, 13312
    v_mfma_f32_16x16x32_bf16 v[32:35], v[176:179], v[160:163], v[32:35]
    ds_read_b128 v[116:119], v202 offset:2048
    s_cmp_eq_u32 s95, 151552
    v_mfma_f32_16x16x32_bf16 v[60:63], v[176:179], v[164:167], v[60:63]
    ds_read_b128 v[120:123], v202 offset:4096
    v_mfma_f32_16x16x32_bf16 v[88:91], v[176:179], v[168:171], v[88:91]
    s_setprio 2
    s_cmov_b32 s95, 98304
    v_mfma_f32_16x16x32_bf16 v[8:11], v[180:183], v[156:159], v[8:11]
    ds_read_b128 v[124:127], v202 offset:6144
    v_add_u32 v205, s95, v204
    v_mfma_f32_16x16x32_bf16 v[36:39], v[180:183], v[160:163], v[36:39]
    ds_read_b64_tr_b16 v[128:129], v205 offset:6144
    v_mfma_f32_16x16x32_bf16 v[64:67], v[180:183], v[164:167], v[64:67]
    ds_read_b64_tr_b16 v[130:131], v205 offset:7936
    v_mfma_f32_16x16x32_bf16 v[92:95], v[180:183], v[168:171], v[92:95]
    ds_read_b64_tr_b16 v[132:133], v205 offset:6176
    ds_read_b64_tr_b16 v[134:135], v205 offset:7968
    v_mfma_f32_16x16x32_bf16 v[12:15], v[184:187], v[156:159], v[12:15]
    buffer_load_dwordx4 v206, s[8:11], s26 offen offset:0 lds
    v_mfma_f32_16x16x32_bf16 v[40:43], v[184:187], v[160:163], v[40:43]
    ds_read_b64_tr_b16 v[136:137], v205 offset:6208
    v_mfma_f32_16x16x32_bf16 v[68:71], v[184:187], v[164:167], v[68:71]
    s_setprio 1
    ds_read_b64_tr_b16 v[138:139], v205 offset:8000
    ds_read_b64_tr_b16 v[140:141], v205 offset:6240
    v_mfma_f32_16x16x32_bf16 v[96:99], v[184:187], v[168:171], v[96:99]
    ds_read_b64_tr_b16 v[142:143], v205 offset:8032
    v_mfma_f32_16x16x32_bf16 v[16:19], v[188:191], v[156:159], v[16:19]
    buffer_load_dwordx4 v207, s[8:11], s26 offen offset:1024 lds
    v_mfma_f32_16x16x32_bf16 v[44:47], v[188:191], v[160:163], v[44:47]
    ds_read_b64_tr_b16 v[144:145], v205 offset:6272
    ds_read_b64_tr_b16 v[146:147], v205 offset:8064
    v_mfma_f32_16x16x32_bf16 v[72:75], v[188:191], v[164:167], v[72:75]
    ds_read_b64_tr_b16 v[148:149], v205 offset:6304
    v_mfma_f32_16x16x32_bf16 v[100:103], v[188:191], v[168:171], v[100:103]
    ds_read_b64_tr_b16 v[150:151], v205 offset:8096
    v_mfma_f32_16x16x32_bf16 v[20:23], v[192:195], v[156:159], v[20:23]
    buffer_load_dwordx4 v208, s[8:11], s26 offen offset:2048 lds
    ds_read_b64_tr_b16 v[152:153], v205 offset:6336
    v_mfma_f32_16x16x32_bf16 v[48:51], v[192:195], v[160:163], v[48:51]
    s_setprio 0
    ds_read_b64_tr_b16 v[154:155], v205 offset:8128
    v_mfma_f32_16x16x32_bf16 v[76:79], v[192:195], v[164:167], v[76:79]
    s_mov_b64 exec, s[98:99]
    buffer_load_dwordx4 v209, s[8:11], s26 offen offset:3072 lds
    s_mov_b64 exec, -1
    s_add_u32 s26, s26, s27
    v_mfma_f32_16x16x32_bf16 v[104:107], v[192:195], v[168:171], v[104:107]
    v_mfma_f32_16x16x32_bf16 v[24:27], v[196:199], v[156:159], v[24:27]
    v_mfma_f32_16x16x32_bf16 v[52:55], v[196:199], v[160:163], v[52:55]
    v_mfma_f32_16x16x32_bf16 v[80:83], v[196:199], v[164:167], v[80:83]
    v_mfma_f32_16x16x32_bf16 v[108:111], v[196:199], v[168:171], v[108:111]
    s_waitcnt vmcnt(8) lgkmcnt(0)
    s_barrier
    v_mfma_f32_16x16x32_bf16 v[0:3], v[128:131], v[112:115], v[0:3]
    s_cbranch_vccz cs_84r
    v_smfmac_f32_16x16x64_bf16 v[216:219], v[232:235], v[128:135], v236
    v_smfmac_f32_16x16x64_bf16 v[220:223], v[232:235], v[136:143], v236
    v_smfmac_f32_16x16x64_bf16 v[224:227], v[232:235], v[144:151], v236
    v_mfma_f32_16x16x32_bf16 v[228:231], v[232:235], v[152:155], v[228:231]
cs_84r:
    s_setprio 3
    s_add_u32 m0, s95, s28
    ds_read_b128 v[156:159], v203 offset:0
    v_mfma_f32_16x16x32_bf16 v[28:31], v[128:131], v[116:119], v[28:31]
    s_add_u32 s95, s95, 13312
    v_mfma_f32_16x16x32_bf16 v[56:59], v[128:131], v[120:123], v[56:59]
    ds_read_b128 v[160:163], v203 offset:2048
    v_mfma_f32_16x16x32_bf16 v[84:87], v[128:131], v[124:127], v[84:87]
    s_cmp_eq_u32 s95, 151552
    v_mfma_f32_16x16x32_bf16 v[4:7], v[132:135], v[112:115], v[4:7]
    ds_read_b128 v[164:167], v203 offset:4096
    v_mfma_f32_16x16x32_bf16 v[32:35], v[132:135], v[116:119], v[32:35]
    s_cmov_b32 s95, 98304
    ds_read_b128 v[168:171], v203 offset:6144
    v_mfma_f32_16x16x32_bf16 v[60:63], v[132:135], v[120:123], v[60:63]
    v_add_u32 v205, s95, v204
    v_mfma_f32_16x16x32_bf16 v[88:91], v[132:135], v[124:127], v[88:91]
    s_setprio 2
    ds_read_b64_tr_b16 v[172:173], v205 offset:6144
    v_mfma_f32_16x16x32_bf16 v[8:11], v[136:139], v[112:115], v[8:11]
    ds_read_b64_tr_b16 v[174:175], v205 offset:7936
    v_mfma_f32_16x16x32_bf16 v[36:39], v[136:139], v[116:119], v[36:39]
    ds_read_b64_tr_b16 v[176:177], v205 offset:6176
    v_mfma_f32_16x16x32_bf16 v[64:67], v[136:139], v[120:123], v[64:67]
    ds_read_b64_tr_b16 v[178:179], v205 offset:7968
    v_mfma_f32_16x16x32_bf16 v[92:95], v[136:139], v[124:127], v[92:95]
    buffer_load_dwordx4 v206, s[8:11], s26 offen offset:0 lds
    ds_read_b64_tr_b16 v[180:181], v205 offset:6208
    v_mfma_f32_16x16x32_bf16 v[12:15], v[140:143], v[112:115], v[12:15]
    ds_read_b64_tr_b16 v[182:183], v205 offset:8000
    v_mfma_f32_16x16x32_bf16 v[40:43], v[140:143], v[116:119], v[40:43]
    ds_read_b64_tr_b16 v[184:185], v205 offset:6240
    v_mfma_f32_16x16x32_bf16 v[68:71], v[140:143], v[120:123], v[68:71]
    s_setprio 1
    ds_read_b64_tr_b16 v[186:187], v205 offset:8032
    v_mfma_f32_16x16x32_bf16 v[96:99], v[140:143], v[124:127], v[96:99]
    buffer_load_dwordx4 v207, s[8:11], s26 offen offset:1024 lds
    v_mfma_f32_16x16x32_bf16 v[16:19], v[144:147], v[112:115], v[16:19]
    ds_read_b64_tr_b16 v[188:189], v205 offset:6272
    v_mfma_f32_16x16x32_bf16 v[44:47], v[144:147], v[116:119], v[44:47]
    ds_read_b64_tr_b16 v[190:191], v205 offset:8064
    ds_read_b64_tr_b16 v[192:193], v205 offset:6304
    v_mfma_f32_16x16x32_bf16 v[72:75], v[144:147], v[120:123], v[72:75]
    ds_read_b64_tr_b16 v[194:195], v205 offset:8096
    v_mfma_f32_16x16x32_bf16 v[100:103], v[144:147], v[124:127], v[100:103]
    buffer_load_dwordx4 v208, s[8:11], s26 offen offset:2048 lds
    v_mfma_f32_16x16x32_bf16 v[20:23], v[148:151], v[112:115], v[20:23]
    ds_read_b64_tr_b16 v[196:197], v205 offset:6336
    v_mfma_f32_16x16x32_bf16 v[48:51], v[148:151], v[116:119], v[48:51]
    s_setprio 0
    ds_read_b64_tr_b16 v[198:199], v205 offset:8128
    v_mfma_f32_16x16x32_bf16 v[76:79], v[148:151], v[120:123], v[76:79]
    s_mov_b64 exec, s[98:99]
    buffer_load_dwordx4 v209, s[8:11], s26 offen offset:3072 lds
    s_mov_b64 exec, -1
    s_add_u32 s26, s26, s27
    v_mfma_f32_16x16x32_bf16 v[104:107], v[148:151], v[124:127], v[104:107]
    v_mfma_f32_16x16x32_bf16 v[24:27], v[152:155], v[112:115], v[24:27]
    v_mfma_f32_16x16x32_bf16 v[52:55], v[152:155], v[116:119], v[52:55]
    v_mfma_f32_16x16x32_bf16 v[80:83], v[152:155], v[120:123], v[80:83]
    v_mfma_f32_16x16x32_bf16 v[108:111], v[152:155], v[124:127], v[108:111]
    s_waitcnt vmcnt(8) lgkmcnt(0)
    s_barrier
    v_mfma_f32_16x16x32_bf16 v[0:3], v[172:175], v[156:159], v[0:3]
    s_cbranch_vccz cs_85r
    v_smfmac_f32_16x16x64_bf16 v[216:219], v[232:235], v[172:179], v236
    v_smfmac_f32_16x16x64_bf16 v[220:223], v[232:235], v[180:187], v236
    v_smfmac_f32_16x16x64_bf16 v[224:227], v[232:235], v[188:195], v236
    v_mfma_f32_16x16x32_bf16 v[228:231], v[232:235], v[196:199], v[228:231]
cs_85r:
    s_setprio 3
    s_add_u32 m0, s95, s28
    s_add_u32 s96, s96, 32768
    v_mfma_f32_16x16x32_bf16 v[28:31], v[172:175], v[160:163], v[28:31]
    s_cmp_eq_u32 s96, 98304
    v_mfma_f32_16x16x32_bf16 v[56:59], v[172:175], v[164:167], v[56:59]
    s_cmov_b32 s96, 0
    v_add_u32 v202, s96, v200
    v_add_u32 v203, s96, v201
    v_mfma_f32_16x16x32_bf16 v[84:87], v[172:175], v[168:171], v[84:87]
    ds_read_b128 v[112:115], v202 offset:0
    v_mfma_f32_16x16x32_bf16 v[4:7], v[176:179], v[156:159], v[4:7]
    s_add_u32 s95, s95, 13312
    v_mfma_f32_16x16x32_bf16 v[32:35], v[176:179], v[160:163], v[32:35]
    ds_read_b128 v[116:119], v202 offset:2048
    s_cmp_eq_u32 s95, 151552
    v_mfma_f32_16x16x32_bf16 v[60:63], v[176:179], v[164:167], v[60:63]
    ds_read_b128 v[120:123], v202 offset:4096
    v_mfma_f32_16x16x32_bf16 v[88:91], v[176:179], v[168:171], v[88:91]
    s_setprio 2
    s_cmov_b32 s95, 98304
    v_mfma_f32_16x16x32_bf16 v[8:11], v[180:183], v[156:159], v[8:11]
    ds_read_b128 v[124:127], v202 offset:6144
    v_add_u32 v205, s95, v204
    v_mfma_f32_16x16x32_bf16 v[36:39], v[180:183], v[160:163], v[36:39]
    ds_read_b64_tr_b16 v[128:129], v205 offset:6144
    v_mfma_f32_16x16x32_bf16 v[64:67], v[180:183], v[164:167], v[64:67]
    ds_read_b64_tr_b16 v[130:131], v205 offset:7936
    v_mfma_f32_16x16x32_bf16 v[92:95], v[180:183], v[168:171], v[92:95]
    ds_read_b64_tr_b16 v[132:133], v205 offset:6176
    ds_read_b64_tr_b16 v[134:135], v205 offset:7968
    v_mfma_f32_16x16x32_bf16 v[12:15], v[184:187], v[156:159], v[12:15]
    buffer_load_dwordx4 v206, s[8:11], s26 offen offset:0 lds
    v_mfma_f32_16x16x32_bf16 v[40:43], v[184:187], v[160:163], v[40:43]
    ds_read_b64_tr_b16 v[136:137], v205 offset:6208
    v_mfma_f32_16x16x32_bf16 v[68:71], v[184:187], v[164:167], v[68:71]
    s_setprio 1
    ds_read_b64_tr_b16 v[138:139], v205 offset:8000
    ds_read_b64_tr_b16 v[140:141], v205 offset:6240
    v_mfma_f32_16x16x32_bf16 v[96:99], v[184:187], v[168:171], v[96:99]
    ds_read_b64_tr_b16 v[142:143], v205 offset:8032
    v_mfma_f32_16x16x32_bf16 v[16:19], v[188:191], v[156:159], v[16:19]
    buffer_load_dwordx4 v207, s[8:11], s26 offen offset:1024 lds
    v_mfma_f32_16x16x32_bf16 v[44:47], v[188:191], v[160:163], v[44:47]
    ds_read_b64_tr_b16 v[144:145], v205 offset:6272
    ds_read_b64_tr_b16 v[146:147], v205 offset:8064
    v_mfma_f32_16x16x32_bf16 v[72:75], v[188:191], v[164:167], v[72:75]
    ds_read_b64_tr_b16 v[148:149], v205 offset:6304
    v_mfma_f32_16x16x32_bf16 v[100:103], v[188:191], v[168:171], v[100:103]
    ds_read_b64_tr_b16 v[150:151], v205 offset:8096
    v_mfma_f32_16x16x32_bf16 v[20:23], v[192:195], v[156:159], v[20:23]
    buffer_load_dwordx4 v208, s[8:11], s26 offen offset:2048 lds
    ds_read_b64_tr_b16 v[152:153], v205 offset:6336
    v_mfma_f32_16x16x32_bf16 v[48:51], v[192:195], v[160:163], v[48:51]
    s_setprio 0
    ds_read_b64_tr_b16 v[154:155], v205 offset:8128
    v_mfma_f32_16x16x32_bf16 v[76:79], v[192:195], v[164:167], v[76:79]
    s_mov_b64 exec, s[98:99]
    buffer_load_dwordx4 v209, s[8:11], s26 offen offset:3072 lds
    s_mov_b64 exec, -1
    s_add_u32 s26, s26, s27
    v_mfma_f32_16x16x32_bf16 v[104:107], v[192:195], v[168:171], v[104:107]
    v_mfma_f32_16x16x32_bf16 v[24:27], v[196:199], v[156:159], v[24:27]
    v_mfma_f32_16x16x32_bf16 v[52:55], v[196:199], v[160:163], v[52:55]
    v_mfma_f32_16x16x32_bf16 v[80:83], v[196:199], v[164:167], v[80:83]
    v_mfma_f32_16x16x32_bf16 v[108:111], v[196:199], v[168:171], v[108:111]
    s_waitcnt vmcnt(8) lgkmcnt(0)
    s_barrier
    v_mfma_f32_16x16x32_bf16 v[0:3], v[128:131], v[112:115], v[0:3]
    s_cbranch_vccz cs_86r
    v_smfmac_f32_16x16x64_bf16 v[216:219], v[232:235], v[128:135], v236
    v_smfmac_f32_16x16x64_bf16 v[220:223], v[232:235], v[136:143], v236
    v_smfmac_f32_16x16x64_bf16 v[224:227], v[232:235], v[144:151], v236
    v_mfma_f32_16x16x32_bf16 v[228:231], v[232:235], v[152:155], v[228:231]
cs_86r:
    s_setprio 3
    ds_read_b128 v[156:159], v203 offset:0
    v_mfma_f32_16x16x32_bf16 v[28:31], v[128:131], v[116:119], v[28:31]
    s_add_u32 s95, s95, 13312
    v_mfma_f32_16x16x32_bf16 v[56:59], v[128:131], v[120:123], v[56:59]
    ds_read_b128 v[160:163], v203 offset:2048
    v_mfma_f32_16x16x32_bf16 v[84:87], v[128:131], v[124:127], v[84:87]
    s_cmp_eq_u32 s95, 151552
    v_mfma_f32_16x16x32_bf16 v[4:7], v[132:135], v[112:115], v[4:7]
    ds_read_b128 v[164:167], v203 offset:4096
    v_mfma_f32_16x16x32_bf16 v[32:35], v[132:135], v[116:119], v[32:35]
    s_cmov_b32 s95, 98304
    v_mfma_f32_16x16x32_bf16 v[60:63], v[132:135], v[120:123], v[60:63]
    ds_read_b128 v[168:171], v203 offset:6144
    v_mfma_f32_16x16x32_bf16 v[88:91], v[132:135], v[124:127], v[88:91]
    s_setprio 2
    v_add_u32 v205, s95, v204
    v_mfma_f32_16x16x32_bf16 v[8:11], v[136:139], v[112:115], v[8:11]
    ds_read_b64_tr_b16 v[172:173], v205 offset:6144
    v_mfma_f32_16x16x32_bf16 v[36:39], v[136:139], v[116:119], v[36:39]
    ds_read_b64_tr_b16 v[174:175], v205 offset:7936
    v_mfma_f32_16x16x32_bf16 v[64:67], v[136:139], v[120:123], v[64:67]
    ds_read_b64_tr_b16 v[176:177], v205 offset:6176
    v_mfma_f32_16x16x32_bf16 v[92:95], v[136:139], v[124:127], v[92:95]
    ds_read_b64_tr_b16 v[178:179], v205 offset:7968
    v_mfma_f32_16x16x32_bf16 v[12:15], v[140:143], v[112:115], v[12:15]
    ds_read_b64_tr_b16 v[180:181], v205 offset:6208
    v_mfma_f32_16x16x32_bf16 v[40:43], v[140:143], v[116:119], v[40:43]
    ds_read_b64_tr_b16 v[182:183], v205 offset:8000
    v_mfma_f32_16x16x32_bf16 v[68:71], v[140:143], v[120:123], v[68:71]
    s_setprio 1
    ds_read_b64_tr_b16 v[184:185], v205 offset:6240
    v_mfma_f32_16x16x32_bf16 v[96:99], v[140:143], v[124:127], v[96:99]
    ds_read_b64_tr_b16 v[186:187], v205 offset:8032
    v_mfma_f32_16x16x32_bf16 v[16:19], v[144:147], v[112:115], v[16:19]
    ds_read_b64_tr_b16 v[188:189], v205 offset:6272
    v_mfma_f32_16x16x32_bf16 v[44:47], v[144:147], v[116:119], v[44:47]
    ds_read_b64_tr_b16 v[190:191], v205 offset:8064
    v_mfma_f32_16x16x32_bf16 v[72:75], v[144:147], v[120:123], v[72:75]
    ds_read_b64_tr_b16 v[192:193], v205 offset:6304
    v_mfma_f32_16x16x32_bf16 v[100:103], v[144:147], v[124:127], v[100:103]
    ds_read_b64_tr_b16 v[194:195], v205 offset:8096
    v_mfma_f32_16x16x32_bf16 v[20:23], v[148:151], v[112:115], v[20:23]
    ds_read_b64_tr_b16 v[196:197], v205 offset:6336
    v_mfma_f32_16x16x32_bf16 v[48:51], v[148:151], v[116:119], v[48:51]
    s_setprio 0
    ds_read_b64_tr_b16 v[198:199], v205 offset:8128
    v_mfma_f32_16x16x32_bf16 v[76:79], v[148:151], v[120:123], v[76:79]
    v_mfma_f32_16x16x32_bf16 v[104:107], v[148:151], v[124:127], v[104:107]
    v_mfma_f32_16x16x32_bf16 v[24:27], v[152:155], v[112:115], v[24:27]
    v_mfma_f32_16x16x32_bf16 v[52:55], v[152:155], v[116:119], v[52:55]
    v_mfma_f32_16x16x32_bf16 v[80:83], v[152:155], v[120:123], v[80:83]
    v_mfma_f32_16x16x32_bf16 v[108:111], v[152:155], v[124:127], v[108:111]
    s_waitcnt vmcnt(4) lgkmcnt(0)
    s_barrier
    v_mfma_f32_16x16x32_bf16 v[0:3], v[172:175], v[156:159], v[0:3]
    s_cbranch_vccz cs_87r
    v_smfmac_f32_16x16x64_bf16 v[216:219], v[232:235], v[172:179], v236
    v_smfmac_f32_16x16x64_bf16 v[220:223], v[232:235], v[180:187], v236
    v_smfmac_f32_16x16x64_bf16 v[224:227], v[232:235], v[188:195], v236
    v_mfma_f32_16x16x32_bf16 v[228:231], v[232:235], v[196:199], v[228:231]
cs_87r:
    s_setprio 3
    s_add_u32 s96, s96, 32768
    s_cmp_eq_u32 s96, 98304
    v_mfma_f32_16x16x32_bf16 v[28:31], v[172:175], v[160:163], v[28:31]
    s_cmov_b32 s96, 0
    v_mfma_f32_16x16x32_bf16 v[56:59], v[172:175], v[164:167], v[56:59]
    v_add_u32 v202, s96, v200
    v_add_u32 v203, s96, v201
    v_mfma_f32_16x16x32_bf16 v[84:87], v[172:175], v[168:171], v[84:87]
    ds_read_b128 v[112:115], v202 offset:0
    v_mfma_f32_16x16x32_bf16 v[4:7], v[176:179], v[156:159], v[4:7]
    s_add_u32 s95, s95, 13312
    v_mfma_f32_16x16x32_bf16 v[32:35], v[176:179], v[160:163], v[32:35]
    ds_read_b128 v[116:119], v202 offset:2048
    v_mfma_f32_16x16x32_bf16 v[60:63], v[176:179], v[164:167], v[60:63]
    s_cmp_eq_u32 s95, 151552
    v_mfma_f32_16x16x32_bf16 v[88:91], v[176:179], v[168:171], v[88:91]
    s_setprio 2
    ds_read_b128 v[120:123], v202 offset:4096
    s_cmov_b32 s95, 98304
    v_mfma_f32_16x16x32_bf16 v[8:11], v[180:183], v[156:159], v[8:11]
    ds_read_b128 v[124:127], v202 offset:6144
    v_mfma_f32_16x16x32_bf16 v[36:39], v[180:183], v[160:163], v[36:39]
    v_add_u32 v205, s95, v204
    v_mfma_f32_16x16x32_bf16 v[64:67], v[180:183], v[164:167], v[64:67]
    ds_read_b64_tr_b16 v[128:129], v205 offset:6144
    v_mfma_f32_16x16x32_bf16 v[92:95], v[180:183], v[168:171], v[92:95]
    ds_read_b64_tr_b16 v[130:131], v205 offset:7936
    v_mfma_f32_16x16x32_bf16 v[12:15], v[184:187], v[156:159], v[12:15]
    ds_read_b64_tr_b16 v[132:133], v205 offset:6176
    v_mfma_f32_16x16x32_bf16 v[40:43], v[184:187], v[160:163], v[40:43]
    ds_read_b64_tr_b16 v[134:135], v205 offset:7968
    v_mfma_f32_16x16x32_bf16 v[68:71], v[184:187], v[164:167], v[68:71]
    s_setprio 1
    ds_read_b64_tr_b16 v[136:137], v205 offset:6208
    v_mfma_f32_16x16x32_bf16 v[96:99], v[184:187], v[168:171], v[96:99]
    ds_read_b64_tr_b16 v[138:139], v205 offset:8000
    ds_read_b64_tr_b16 v[140:141], v205 offset:6240
    v_mfma_f32_16x16x32_bf16 v[16:19], v[188:191], v[156:159], v[16:19]
    ds_read_b64_tr_b16 v[142:143], v205 offset:8032
    v_mfma_f32_16x16x32_bf16 v[44:47], v[188:191], v[160:163], v[44:47]
    ds_read_b64_tr_b16 v[144:145], v205 offset:6272
    v_mfma_f32_16x16x32_bf16 v[72:75], v[188:191], v[164:167], v[72:75]
    ds_read_b64_tr_b16 v[146:147], v205 offset:8064
    v_mfma_f32_16x16x32_bf16 v[100:103], v[188:191], v[168:171], v[100:103]
    ds_read_b64_tr_b16 v[148:149], v205 offset:6304
    v_mfma_f32_16x16x32_bf16 v[20:23], v[192:195], v[156:159], v[20:23]
    ds_read_b64_tr_b16 v[150:151], v205 offset:8096
    v_mfma_f32_16x16x32_bf16 v[48:51], v[192:195], v[160:163], v[48:51]
    s_setprio 0
    ds_read_b64_tr_b16 v[152:153], v205 offset:6336
    v_mfma_f32_16x16x32_bf16 v[76:79], v[192:195], v[164:167], v[76:79]
    ds_read_b64_tr_b16 v[154:155], v205 offset:8128
    v_mfma_f32_16x16x32_bf16 v[104:107], v[192:195], v[168:171], v[104:107]
    v_mfma_f32_16x16x32_bf16 v[24:27], v[196:199], v[156:159], v[24:27]
    v_mfma_f32_16x16x32_bf16 v[52:55], v[196:199], v[160:163], v[52:55]
    v_mfma_f32_16x16x32_bf16 v[80:83], v[196:199], v[164:167], v[80:83]
    v_mfma_f32_16x16x32_bf16 v[108:111], v[196:199], v[168:171], v[108:111]
    s_waitcnt vmcnt(0) lgkmcnt(0)
    s_barrier
    v_mfma_f32_16x16x32_bf16 v[0:3], v[128:131], v[112:115], v[0:3]
    s_cbranch_vccz cs_88r
    v_smfmac_f32_16x16x64_bf16 v[216:219], v[232:235], v[128:135], v236
    v_smfmac_f32_16x16x64_bf16 v[220:223], v[232:235], v[136:143], v236
    v_smfmac_f32_16x16x64_bf16 v[224:227], v[232:235], v[144:151], v236
    v_mfma_f32_16x16x32_bf16 v[228:231], v[232:235], v[152:155], v[228:231]
cs_88r:
    s_add_u32 s16, s4, 0x2880000
    s_addc_u32 s17, s5, 0
    s_mov_b32 s18, 0x8000
    s_mov_b32 s19, 0x00020000
    s_lshl_b32 s39, s22, 2
    s_add_u32 s39, s39, s21
    s_lshl_b32 s39, s39, 10
    buffer_load_dwordx4 v[212:215], v245, s[16:19], s39 offen sc1
    s_setprio 3
    ds_read_b128 v[156:159], v203 offset:0
    v_mfma_f32_16x16x32_bf16 v[28:31], v[128:131], v[116:119], v[28:31]
    s_add_u32 s95, s95, 13312
    v_mfma_f32_16x16x32_bf16 v[56:59], v[128:131], v[120:123], v[56:59]
    ds_read_b128 v[160:163], v203 offset:2048
    v_mfma_f32_16x16x32_bf16 v[84:87], v[128:131], v[124:127], v[84:87]
    s_cmp_eq_u32 s95, 151552
    v_mfma_f32_16x16x32_bf16 v[4:7], v[132:135], v[112:115], v[4:7]
    ds_read_b128 v[164:167], v203 offset:4096
    v_mfma_f32_16x16x32_bf16 v[32:35], v[132:135], v[116:119], v[32:35]
    s_cmov_b32 s95, 98304
    v_mfma_f32_16x16x32_bf16 v[60:63], v[132:135], v[120:123], v[60:63]
    ds_read_b128 v[168:171], v203 offset:6144
    v_mfma_f32_16x16x32_bf16 v[88:91], v[132:135], v[124:127], v[88:91]
    s_setprio 2
    v_add_u32 v205, s95, v204
    v_mfma_f32_16x16x32_bf16 v[8:11], v[136:139], v[112:115], v[8:11]
    ds_read_b64_tr_b16 v[172:173], v205 offset:6144
    v_mfma_f32_16x16x32_bf16 v[36:39], v[136:139], v[116:119], v[36:39]
    ds_read_b64_tr_b16 v[174:175], v205 offset:7936
    v_mfma_f32_16x16x32_bf16 v[64:67], v[136:139], v[120:123], v[64:67]
    ds_read_b64_tr_b16 v[176:177], v205 offset:6176
    v_mfma_f32_16x16x32_bf16 v[92:95], v[136:139], v[124:127], v[92:95]
    ds_read_b64_tr_b16 v[178:179], v205 offset:7968
    v_mfma_f32_16x16x32_bf16 v[12:15], v[140:143], v[112:115], v[12:15]
    ds_read_b64_tr_b16 v[180:181], v205 offset:6208
    v_mfma_f32_16x16x32_bf16 v[40:43], v[140:143], v[116:119], v[40:43]
    ds_read_b64_tr_b16 v[182:183], v205 offset:8000
    v_mfma_f32_16x16x32_bf16 v[68:71], v[140:143], v[120:123], v[68:71]
    s_setprio 1
    ds_read_b64_tr_b16 v[184:185], v205 offset:6240
    v_mfma_f32_16x16x32_bf16 v[96:99], v[140:143], v[124:127], v[96:99]
    ds_read_b64_tr_b16 v[186:187], v205 offset:8032
    v_mfma_f32_16x16x32_bf16 v[16:19], v[144:147], v[112:115], v[16:19]
    ds_read_b64_tr_b16 v[188:189], v205 offset:6272
    v_mfma_f32_16x16x32_bf16 v[44:47], v[144:147], v[116:119], v[44:47]
    ds_read_b64_tr_b16 v[190:191], v205 offset:8064
    v_mfma_f32_16x16x32_bf16 v[72:75], v[144:147], v[120:123], v[72:75]
    ds_read_b64_tr_b16 v[192:193], v205 offset:6304
    v_mfma_f32_16x16x32_bf16 v[100:103], v[144:147], v[124:127], v[100:103]
    ds_read_b64_tr_b16 v[194:195], v205 offset:8096
    v_mfma_f32_16x16x32_bf16 v[20:23], v[148:151], v[112:115], v[20:23]
    ds_read_b64_tr_b16 v[196:197], v205 offset:6336
    v_mfma_f32_16x16x32_bf16 v[48:51], v[148:151], v[116:119], v[48:51]
    s_setprio 0
    ds_read_b64_tr_b16 v[198:199], v205 offset:8128
    v_mfma_f32_16x16x32_bf16 v[76:79], v[148:151], v[120:123], v[76:79]
    v_mfma_f32_16x16x32_bf16 v[104:107], v[148:151], v[124:127], v[104:107]
    v_mfma_f32_16x16x32_bf16 v[24:27], v[152:155], v[112:115], v[24:27]
    v_mfma_f32_16x16x32_bf16 v[52:55], v[152:155], v[116:119], v[52:55]
    v_mfma_f32_16x16x32_bf16 v[80:83], v[152:155], v[120:123], v[80:83]
    v_mfma_f32_16x16x32_bf16 v[108:111], v[152:155], v[124:127], v[108:111]
    s_waitcnt lgkmcnt(0)
    s_barrier
    v_mfma_f32_16x16x32_bf16 v[0:3], v[172:175], v[156:159], v[0:3]
    s_cbranch_vccz cs_89r
    v_smfmac_f32_16x16x64_bf16 v[216:219], v[232:235], v[172:179], v236
    v_smfmac_f32_16x16x64_bf16 v[220:223], v[232:235], v[180:187], v236
    v_smfmac_f32_16x16x64_bf16 v[224:227], v[232:235], v[188:195], v236
    v_mfma_f32_16x16x32_bf16 v[228:231], v[232:235], v[196:199], v[228:231]
    v_lshlrev_b32 v238, 2, v250
    v_and_b32 v238, 63, v238
    v_add_u32 v237, 41472, v238
    v_add_u32 v238, 49152, v238
    ds_read_b32 v112, v237 offset:0
    ds_read_b32 v113, v237 offset:64
    ds_read_b32 v114, v237 offset:128
    ds_read_b32 v115, v237 offset:192
    ds_read_b32 v116, v237 offset:256
    ds_read_b32 v117, v237 offset:320
    ds_read_b32 v118, v237 offset:384
    v_add_f32 v216, v216, v217
    v_add_f32 v218, v218, v219
    v_add_f32 v220, v220, v221
    v_add_f32 v222, v222, v223
    v_add_f32 v224, v224, v225
    v_add_f32 v226, v226, v227
    v_add_f32 v228, v228, v230
    s_waitcnt lgkmcnt(0)
    v_add_f32 v112, v112, v216
    v_add_f32 v113, v113, v218
    v_add_f32 v114, v114, v220
    v_add_f32 v115, v115, v222
    v_add_f32 v116, v116, v224
    v_add_f32 v117, v117, v226
    v_add_f32 v118, v118, v228
    s_mov_b64 exec, 0xffff
    ds_write_b32 v238, v112 offset:0
    ds_write_b32 v238, v113 offset:64
    ds_write_b32 v238, v114 offset:128
    ds_write_b32 v238, v115 offset:192
    ds_write_b32 v238, v116 offset:256
    ds_write_b32 v238, v117 offset:320
    ds_write_b32 v238, v118 offset:384
    s_mov_b64 exec, -1
    s_waitcnt lgkmcnt(0)
cs_89r:
    v_mfma_f32_16x16x32_bf16 v[28:31], v[172:175], v[160:163], v[28:31]
    v_mfma_f32_16x16x32_bf16 v[56:59], v[172:175], v[164:167], v[56:59]
    v_mfma_f32_16x16x32_bf16 v[84:87], v[172:175], v[168:171], v[84:87]
    v_mfma_f32_16x16x32_bf16 v[4:7], v[176:179], v[156:159], v[4:7]
    v_mfma_f32_16x16x32_bf16 v[32:35], v[176:179], v[160:163], v[32:35]
    v_mfma_f32_16x16x32_bf16 v[60:63], v[176:179], v[164:167], v[60:63]
    v_mfma_f32_16x16x32_bf16 v[88:91], v[176:179], v[168:171], v[88:91]
    v_mfma_f32_16x16x32_bf16 v[8:11], v[180:183], v[156:159], v[8:11]
    v_mfma_f32_16x16x32_bf16 v[36:39], v[180:183], v[160:163], v[36:39]
    v_mfma_f32_16x16x32_bf16 v[64:67], v[180:183], v[164:167], v[64:67]
    v_mfma_f32_16x16x32_bf16 v[92:95], v[180:183], v[168:171], v[92:95]
    v_mfma_f32_16x16x32_bf16 v[12:15], v[184:187], v[156:159], v[12:15]
    v_mfma_f32_16x16x32_bf16 v[40:43], v[184:187], v[160:163], v[40:43]
    v_mfma_f32_16x16x32_bf16 v[68:71], v[184:187], v[164:167], v[68:71]
    v_mfma_f32_16x16x32_bf16 v[96:99], v[184:187], v[168:171], v[96:99]
    v_mfma_f32_16x16x32_bf16 v[16:19], v[188:191], v[156:159], v[16:19]
    v_mfma_f32_16x16x32_bf16 v[44:47], v[188:191], v[160:163], v[44:47]
    v_mfma_f32_16x16x32_bf16 v[72:75], v[188:191], v[164:167], v[72:75]
    v_mfma_f32_16x16x32_bf16 v[100:103], v[188:191], v[168:171], v[100:103]
    v_mfma_f32_16x16x32_bf16 v[20:23], v[192:195], v[156:159], v[20:23]
    v_mfma_f32_16x16x32_bf16 v[48:51], v[192:195], v[160:163], v[48:51]
    v_mfma_f32_16x16x32_bf16 v[76:79], v[192:195], v[164:167], v[76:79]
    v_mfma_f32_16x16x32_bf16 v[104:107], v[192:195], v[168:171], v[104:107]
    v_mfma_f32_16x16x32_bf16 v[24:27], v[196:199], v[156:159], v[24:27]
    v_mfma_f32_16x16x32_bf16 v[52:55], v[196:199], v[160:163], v[52:55]
    v_mfma_f32_16x16x32_bf16 v[80:83], v[196:199], v[164:167], v[80:83]
    v_mfma_f32_16x16x32_bf16 v[108:111], v[196:199], v[168:171], v[108:111]
    s_waitcnt vmcnt(0)
    v_cmp_ne_u32 vcc, s31, v213
    v_cmp_ne_u32 s[40:41], s31, v215
    s_nop 0
    s_or_b64 vcc, vcc, s[40:41]
    s_cbranch_vccnz rs_90
rs_90r:
    s_barrier
    s_setprio 2
    v_lshrrev_b32 v204, 4, v250
    v_lshlrev_b32 v204, 4, v204
    v_add_u32 v204, 49152, v204
    ds_read_b128 v[160:163], v204 offset:0
    ds_read_b128 v[164:167], v204 offset:64
    ds_read_b128 v[168:171], v204 offset:128
    ds_read_b128 v[172:175], v204 offset:192
    ds_read_b128 v[176:179], v204 offset:256
    ds_read_b128 v[180:183], v204 offset:320
    ds_read_b128 v[184:187], v204 offset:384
    v_rcp_f32 v213, v212
    v_mul_f32 v215, v212, v212
    v_mul_f32 v215, v215, v212
    v_mul_f32 v214, v214, v213
    v_mul_f32 v212, 0xc0135761, v212
    v_mul_f32 v215, 0xbdd2d3e8, v215
    v_mov_b32 v188, v214
    v_mov_b32 v192, v214
    s_nop 1
    v_permlane32_swap_b32 v188, v192
    v_mov_b32 v190, v188
    v_mov_b32 v194, v192
    s_nop 1
    v_permlane16_swap_b32 v188, v190
    v_permlane16_swap_b32 v192, v194
    v_mov_b32 v189, v188
    v_mov_b32 v191, v190
    v_mov_b32 v193, v192
    v_mov_b32 v195, v194
    v_mov_b32 v196, v212
    v_mov_b32 v200, v212
    s_nop 1
    v_permlane32_swap_b32 v196, v200
    v_mov_b32 v198, v196
    v_mov_b32 v202, v200
    s_nop 1
    v_permlane16_swap_b32 v196, v198
    v_permlane16_swap_b32 v200, v202
    v_mov_b32 v197, v196
    v_mov_b32 v199, v198
    v_mov_b32 v201, v200
    v_mov_b32 v203, v202
    v_mov_b32 v128, v215
    v_mov_b32 v132, v215
    s_nop 1
    v_permlane32_swap_b32 v128, v132
    v_mov_b32 v130, v128
    v_mov_b32 v134, v132
    s_nop 1
    v_permlane16_swap_b32 v128, v130
    v_permlane16_swap_b32 v132, v134
    v_mov_b32 v129, v128
    v_mov_b32 v131, v130
    v_mov_b32 v133, v132
    v_mov_b32 v135, v134
    v_mov_b32 v136, v213
    v_mov_b32 v140, v213
    s_nop 1
    v_permlane32_swap_b32 v136, v140
    v_mov_b32 v138, v136
    v_mov_b32 v142, v140
    s_nop 1
    v_permlane16_swap_b32 v136, v138
    v_permlane16_swap_b32 v140, v142
    v_mov_b32 v137, v136
    v_mov_b32 v139, v138
    v_mov_b32 v141, v140
    v_mov_b32 v143, v142
    s_waitcnt lgkmcnt(0)
.p2align 3
    v_pk_fma_f32 v[0:1], v[160:161], v[188:189], v[0:1]
    v_pk_fma_f32 v[2:3], v[162:163], v[188:189], v[2:3]
    v_pk_fma_f32 v[4:5], v[164:165], v[188:189], v[4:5]
    v_pk_fma_f32 v[6:7], v[166:167], v[188:189], v[6:7]
    v_pk_mul_f32 v[112:113], v[0:1], v[0:1]
    v_pk_mul_f32 v[114:115], v[2:3], v[2:3]
    v_pk_mul_f32 v[116:117], v[4:5], v[4:5]
    v_pk_mul_f32 v[118:119], v[6:7], v[6:7]
    v_pk_fma_f32 v[112:113], v[112:113], v[128:129], v[196:197]
    v_pk_fma_f32 v[114:115], v[114:115], v[128:129], v[196:197]
    v_pk_fma_f32 v[116:117], v[116:117], v[128:129], v[196:197]
    v_pk_fma_f32 v[118:119], v[118:119], v[128:129], v[196:197]
    v_pk_mul_f32 v[112:113], v[112:113], v[0:1]
    v_pk_mul_f32 v[114:115], v[114:115], v[2:3]
    v_pk_mul_f32 v[116:117], v[116:117], v[4:5]
    v_pk_mul_f32 v[118:119], v[118:119], v[6:7]
    v_exp_f32 v112, v112
    v_exp_f32 v113, v113
    v_exp_f32 v114, v114
    v_exp_f32 v115, v115
    v_exp_f32 v116, v116
    v_exp_f32 v117, v117
    v_exp_f32 v118, v118
    v_exp_f32 v119, v119
    v_pk_fma_f32 v[112:113], v[112:113], v[136:137], v[136:137]
    v_pk_fma_f32 v[114:115], v[114:115], v[136:137], v[136:137]
    v_pk_fma_f32 v[116:117], v[116:117], v[136:137], v[136:137]
    v_pk_fma_f32 v[118:119], v[118:119], v[136:137], v[136:137]
    v_rcp_f32 v112, v112
    v_rcp_f32 v113, v113
    v_rcp_f32 v114, v114
    v_rcp_f32 v115, v115
    v_rcp_f32 v116, v116
    v_rcp_f32 v117, v117
    v_rcp_f32 v118, v118
    v_rcp_f32 v119, v119
    v_pk_mul_f32 v[0:1], v[0:1], v[112:113]
    v_pk_mul_f32 v[2:3], v[2:3], v[114:115]
    v_pk_mul_f32 v[4:5], v[4:5], v[116:117]
    v_pk_mul_f32 v[6:7], v[6:7], v[118:119]
    v_pk_fma_f32 v[8:9], v[168:169], v[188:189], v[8:9]
    v_pk_fma_f32 v[10:11], v[170:171], v[188:189], v[10:11]
    v_pk_fma_f32 v[12:13], v[172:173], v[188:189], v[12:13]
    v_pk_fma_f32 v[14:15], v[174:175], v[188:189], v[14:15]
    v_pk_mul_f32 v[112:113], v[8:9], v[8:9]
    v_pk_mul_f32 v[114:115], v[10:11], v[10:11]
    v_pk_mul_f32 v[116:117], v[12:13], v[12:13]
    v_pk_mul_f32 v[118:119], v[14:15], v[14:15]
    v_pk_fma_f32 v[112:113], v[112:113], v[128:129], v[196:197]
    v_pk_fma_f32 v[114:115], v[114:115], v[128:129], v[196:197]
    v_pk_fma_f32 v[116:117], v[116:117], v[128:129], v[196:197]
    v_pk_fma_f32 v[118:119], v[118:119], v[128:129], v[196:197]
    v_pk_mul_f32 v[112:113], v[112:113], v[8:9]
    v_pk_mul_f32 v[114:115], v[114:115], v[10:11]
    v_pk_mul_f32 v[116:117], v[116:117], v[12:13]
    v_pk_mul_f32 v[118:119], v[118:119], v[14:15]
    v_exp_f32 v112, v112
    v_exp_f32 v113, v113
    v_exp_f32 v114, v114
    v_exp_f32 v115, v115
    v_exp_f32 v116, v116
    v_exp_f32 v117, v117
    v_exp_f32 v118, v118
    v_exp_f32 v119, v119
    v_pk_fma_f32 v[112:113], v[112:113], v[136:137], v[136:137]
    v_pk_fma_f32 v[114:115], v[114:115], v[136:137], v[136:137]
    v_pk_fma_f32 v[116:117], v[116:117], v[136:137], v[136:137]
    v_pk_fma_f32 v[118:119], v[118:119], v[136:137], v[136:137]
    v_rcp_f32 v112, v112
    v_rcp_f32 v113, v113
    v_rcp_f32 v114, v114
    v_rcp_f32 v115, v115
    v_rcp_f32 v116, v116
    v_rcp_f32 v117, v117
    v_rcp_f32 v118, v118
    v_rcp_f32 v119, v119
    v_pk_mul_f32 v[8:9], v[8:9], v[112:113]
    v_pk_mul_f32 v[10:11], v[10:11], v[114:115]
    v_pk_mul_f32 v[12:13], v[12:13], v[116:117]
    v_pk_mul_f32 v[14:15], v[14:15], v[118:119]
    v_pk_fma_f32 v[16:17], v[176:177], v[188:189], v[16:17]
    v_pk_fma_f32 v[18:19], v[178:179], v[188:189], v[18:19]
    v_pk_fma_f32 v[20:21], v[180:181], v[188:189], v[20:21]
    v_pk_fma_f32 v[22:23], v[182:183], v[188:189], v[22:23]
    v_pk_mul_f32 v[112:113], v[16:17], v[16:17]
    v_pk_mul_f32 v[114:115], v[18:19], v[18:19]
    v_pk_mul_f32 v[116:117], v[20:21], v[20:21]
    v_pk_mul_f32 v[118:119], v[22:23], v[22:23]
    v_pk_fma_f32 v[112:113], v[112:113], v[128:129], v[196:197]
    v_pk_fma_f32 v[114:115], v[114:115], v[128:129], v[196:197]
    v_pk_fma_f32 v[116:117], v[116:117], v[128:129], v[196:197]
    v_pk_fma_f32 v[118:119], v[118:119], v[128:129], v[196:197]
    v_pk_mul_f32 v[112:113], v[112:113], v[16:17]
    v_pk_mul_f32 v[114:115], v[114:115], v[18:19]
    v_pk_mul_f32 v[116:117], v[116:117], v[20:21]
    v_pk_mul_f32 v[118:119], v[118:119], v[22:23]
    v_exp_f32 v112, v112
    v_exp_f32 v113, v113
    v_exp_f32 v114, v114
    v_exp_f32 v115, v115
    v_exp_f32 v116, v116
    v_exp_f32 v117, v117
    v_exp_f32 v118, v118
    v_exp_f32 v119, v119
    v_pk_fma_f32 v[112:113], v[112:113], v[136:137], v[136:137]
    v_pk_fma_f32 v[114:115], v[114:115], v[136:137], v[136:137]
    v_pk_fma_f32 v[116:117], v[116:117], v[136:137], v[136:137]
    v_pk_fma_f32 v[118:119], v[118:119], v[136:137], v[136:137]
    v_rcp_f32 v112, v112
    v_rcp_f32 v113, v113
    v_rcp_f32 v114, v114
    v_rcp_f32 v115, v115
    v_rcp_f32 v116, v116
    v_rcp_f32 v117, v117
    v_rcp_f32 v118, v118
    v_rcp_f32 v119, v119
    v_pk_mul_f32 v[16:17], v[16:17], v[112:113]
    v_pk_mul_f32 v[18:19], v[18:19], v[114:115]
    v_pk_mul_f32 v[20:21], v[20:21], v[116:117]
    v_pk_mul_f32 v[22:23], v[22:23], v[118:119]
    v_pk_fma_f32 v[24:25], v[184:185], v[188:189], v[24:25]
    v_pk_fma_f32 v[26:27], v[186:187], v[188:189], v[26:27]
    v_pk_fma_f32 v[28:29], v[160:161], v[190:191], v[28:29]
    v_pk_fma_f32 v[30:31], v[162:163], v[190:191], v[30:31]
    v_pk_mul_f32 v[112:113], v[24:25], v[24:25]
    v_pk_mul_f32 v[114:115], v[26:27], v[26:27]
    v_pk_mul_f32 v[116:117], v[28:29], v[28:29]
    v_pk_mul_f32 v[118:119], v[30:31], v[30:31]
    v_pk_fma_f32 v[112:113], v[112:113], v[128:129], v[196:197]
    v_pk_fma_f32 v[114:115], v[114:115], v[128:129], v[196:197]
    v_pk_fma_f32 v[116:117], v[116:117], v[130:131], v[198:199]
    v_pk_fma_f32 v[118:119], v[118:119], v[130:131], v[198:199]
    v_pk_mul_f32 v[112:113], v[112:113], v[24:25]
    v_pk_mul_f32 v[114:115], v[114:115], v[26:27]
    v_pk_mul_f32 v[116:117], v[116:117], v[28:29]
    v_pk_mul_f32 v[118:119], v[118:119], v[30:31]
    v_exp_f32 v112, v112
    v_exp_f32 v113, v113
    v_exp_f32 v114, v114
    v_exp_f32 v115, v115
    v_exp_f32 v116, v116
    v_exp_f32 v117, v117
    v_exp_f32 v118, v118
    v_exp_f32 v119, v119
    v_pk_fma_f32 v[112:113], v[112:113], v[136:137], v[136:137]
    v_pk_fma_f32 v[114:115], v[114:115], v[136:137], v[136:137]
    v_pk_fma_f32 v[116:117], v[116:117], v[138:139], v[138:139]
    v_pk_fma_f32 v[118:119], v[118:119], v[138:139], v[138:139]
    v_rcp_f32 v112, v112
    v_rcp_f32 v113, v113
    v_rcp_f32 v114, v114
    v_rcp_f32 v115, v115
    v_rcp_f32 v116, v116
    v_rcp_f32 v117, v117
    v_rcp_f32 v118, v118
    v_rcp_f32 v119, v119
    v_pk_mul_f32 v[24:25], v[24:25], v[112:113]
    v_pk_mul_f32 v[26:27], v[26:27], v[114:115]
    v_pk_mul_f32 v[28:29], v[28:29], v[116:117]
    v_pk_mul_f32 v[30:31], v[30:31], v[118:119]
    v_pk_fma_f32 v[32:33], v[164:165], v[190:191], v[32:33]
    v_pk_fma_f32 v[34:35], v[166:167], v[190:191], v[34:35]
    v_pk_fma_f32 v[36:37], v[168:169], v[190:191], v[36:37]
    v_pk_fma_f32 v[38:39], v[170:171], v[190:191], v[38:39]
    v_pk_mul_f32 v[112:113], v[32:33], v[32:33]
    v_pk_mul_f32 v[114:115], v[34:35], v[34:35]
    v_pk_mul_f32 v[116:117], v[36:37], v[36:37]
    v_pk_mul_f32 v[118:119], v[38:39], v[38:39]
    v_pk_fma_f32 v[112:113], v[112:113], v[130:131], v[198:199]
    v_pk_fma_f32 v[114:115], v[114:115], v[130:131], v[198:199]
    v_pk_fma_f32 v[116:117], v[116:117], v[130:131], v[198:199]
    v_pk_fma_f32 v[118:119], v[118:119], v[130:131], v[198:199]
    v_pk_mul_f32 v[112:113], v[112:113], v[32:33]
    v_pk_mul_f32 v[114:115], v[114:115], v[34:35]
    v_pk_mul_f32 v[116:117], v[116:117], v[36:37]
    v_pk_mul_f32 v[118:119], v[118:119], v[38:39]
    v_exp_f32 v112, v112
    v_exp_f32 v113, v113
    v_exp_f32 v114, v114
    v_exp_f32 v115, v115
    v_exp_f32 v116, v116
    v_exp_f32 v117, v117
    v_exp_f32 v118, v118
    v_exp_f32 v119, v119
    v_pk_fma_f32 v[112:113], v[112:113], v[138:139], v[138:139]
    v_pk_fma_f32 v[114:115], v[114:115], v[138:139], v[138:139]
    v_pk_fma_f32 v[116:117], v[116:117], v[138:139], v[138:139]
    v_pk_fma_f32 v[118:119], v[118:119], v[138:139], v[138:139]
    v_rcp_f32 v112, v112
    v_rcp_f32 v113, v113
    v_rcp_f32 v114, v114
    v_rcp_f32 v115, v115
    v_rcp_f32 v116, v116
    v_rcp_f32 v117, v117
    v_rcp_f32 v118, v118
    v_rcp_f32 v119, v119
    v_pk_mul_f32 v[32:33], v[32:33], v[112:113]
    v_pk_mul_f32 v[34:35], v[34:35], v[114:115]
    v_pk_mul_f32 v[36:37], v[36:37], v[116:117]
    v_pk_mul_f32 v[38:39], v[38:39], v[118:119]
    v_pk_fma_f32 v[40:41], v[172:173], v[190:191], v[40:41]
    v_pk_fma_f32 v[42:43], v[174:175], v[190:191], v[42:43]
    v_pk_fma_f32 v[44:45], v[176:177], v[190:191], v[44:45]
    v_pk_fma_f32 v[46:47], v[178:179], v[190:191], v[46:47]
    v_pk_mul_f32 v[112:113], v[40:41], v[40:41]
    v_pk_mul_f32 v[114:115], v[42:43], v[42:43]
    v_pk_mul_f32 v[116:117], v[44:45], v[44:45]
    v_pk_mul_f32 v[118:119], v[46:47], v[46:47]
    v_pk_fma_f32 v[112:113], v[112:113], v[130:131], v[198:199]
    v_pk_fma_f32 v[114:115], v[114:115], v[130:131], v[198:199]
    v_pk_fma_f32 v[116:117], v[116:117], v[130:131], v[198:199]
    v_pk_fma_f32 v[118:119], v[118:119], v[130:131], v[198:199]
    v_pk_mul_f32 v[112:113], v[112:113], v[40:41]
    v_pk_mul_f32 v[114:115], v[114:115], v[42:43]
    v_pk_mul_f32 v[116:117], v[116:117], v[44:45]
    v_pk_mul_f32 v[118:119], v[118:119], v[46:47]
    v_exp_f32 v112, v112
    v_exp_f32 v113, v113
    v_exp_f32 v114, v114
    v_exp_f32 v115, v115
    v_exp_f32 v116, v116
    v_exp_f32 v117, v117
    v_exp_f32 v118, v118
    v_exp_f32 v119, v119
    v_pk_fma_f32 v[112:113], v[112:113], v[138:139], v[138:139]
    v_pk_fma_f32 v[114:115], v[114:115], v[138:139], v[138:139]
    v_pk_fma_f32 v[116:117], v[116:117], v[138:139], v[138:139]
    v_pk_fma_f32 v[118:119], v[118:119], v[138:139], v[138:139]
    v_rcp_f32 v112, v112
    v_rcp_f32 v113, v113
    v_rcp_f32 v114, v114
    v_rcp_f32 v115, v115
    v_rcp_f32 v116, v116
    v_rcp_f32 v117, v117
    v_rcp_f32 v118, v118
    v_rcp_f32 v119, v119
    v_pk_mul_f32 v[40:41], v[40:41], v[112:113]
    v_pk_mul_f32 v[42:43], v[42:43], v[114:115]
    v_pk_mul_f32 v[44:45], v[44:45], v[116:117]
    v_pk_mul_f32 v[46:47], v[46:47], v[118:119]
    v_pk_fma_f32 v[48:49], v[180:181], v[190:191], v[48:49]
    v_pk_fma_f32 v[50:51], v[182:183], v[190:191], v[50:51]
    v_pk_fma_f32 v[52:53], v[184:185], v[190:191], v[52:53]
    v_pk_fma_f32 v[54:55], v[186:187], v[190:191], v[54:55]
    v_pk_mul_f32 v[112:113], v[48:49], v[48:49]
    v_pk_mul_f32 v[114:115], v[50:51], v[50:51]
    v_pk_mul_f32 v[116:117], v[52:53], v[52:53]
    v_pk_mul_f32 v[118:119], v[54:55], v[54:55]
    v_pk_fma_f32 v[112:113], v[112:113], v[130:131], v[198:199]
    v_pk_fma_f32 v[114:115], v[114:115], v[130:131], v[198:199]
    v_pk_fma_f32 v[116:117], v[116:117], v[130:131], v[198:199]
    v_pk_fma_f32 v[118:119], v[118:119], v[130:131], v[198:199]
    v_pk_mul_f32 v[112:113], v[112:113], v[48:49]
    v_pk_mul_f32 v[114:115], v[114:115], v[50:51]
    v_pk_mul_f32 v[116:117], v[116:117], v[52:53]
    v_pk_mul_f32 v[118:119], v[118:119], v[54:55]
    v_exp_f32 v112, v112
    v_exp_f32 v113, v113
    v_exp_f32 v114, v114
    v_exp_f32 v115, v115
    v_exp_f32 v116, v116
    v_exp_f32 v117, v117
    v_exp_f32 v118, v118
    v_exp_f32 v119, v119
    v_pk_fma_f32 v[112:113], v[112:113], v[138:139], v[138:139]
    v_pk_fma_f32 v[114:115], v[114:115], v[138:139], v[138:139]
    v_pk_fma_f32 v[116:117], v[116:117], v[138:139], v[138:139]
    v_pk_fma_f32 v[118:119], v[118:119], v[138:139], v[138:139]
    v_rcp_f32 v112, v112
    v_rcp_f32 v113, v113
    v_rcp_f32 v114, v114
    v_rcp_f32 v115, v115
    v_rcp_f32 v116, v116
    v_rcp_f32 v117, v117
    v_rcp_f32 v118, v118
    v_rcp_f32 v119, v119
    v_pk_mul_f32 v[48:49], v[48:49], v[112:113]
    v_pk_mul_f32 v[50:51], v[50:51], v[114:115]
    v_pk_mul_f32 v[52:53], v[52:53], v[116:117]
    v_pk_mul_f32 v[54:55], v[54:55], v[118:119]
    v_pk_fma_f32 v[56:57], v[160:161], v[192:193], v[56:57]
    v_pk_fma_f32 v[58:59], v[162:163], v[192:193], v[58:59]
    v_pk_fma_f32 v[60:61], v[164:165], v[192:193], v[60:61]
    v_pk_fma_f32 v[62:63], v[166:167], v[192:193], v[62:63]
    v_pk_mul_f32 v[112:113], v[56:57], v[56:57]
    v_pk_mul_f32 v[114:115], v[58:59], v[58:59]
    v_pk_mul_f32 v[116:117], v[60:61], v[60:61]
    v_pk_mul_f32 v[118:119], v[62:63], v[62:63]
    v_pk_fma_f32 v[112:113], v[112:113], v[132:133], v[200:201]
    v_pk_fma_f32 v[114:115], v[114:115], v[132:133], v[200:201]
    v_pk_fma_f32 v[116:117], v[116:117], v[132:133], v[200:201]
    v_pk_fma_f32 v[118:119], v[118:119], v[132:133], v[200:201]
    v_pk_mul_f32 v[112:113], v[112:113], v[56:57]
    v_pk_mul_f32 v[114:115], v[114:115], v[58:59]
    v_pk_mul_f32 v[116:117], v[116:117], v[60:61]
    v_pk_mul_f32 v[118:119], v[118:119], v[62:63]
    v_exp_f32 v112, v112
    v_exp_f32 v113, v113
    v_exp_f32 v114, v114
    v_exp_f32 v115, v115
    v_exp_f32 v116, v116
    v_exp_f32 v117, v117
    v_exp_f32 v118, v118
    v_exp_f32 v119, v119
    v_pk_fma_f32 v[112:113], v[112:113], v[140:141], v[140:141]
    v_pk_fma_f32 v[114:115], v[114:115], v[140:141], v[140:141]
    v_pk_fma_f32 v[116:117], v[116:117], v[140:141], v[140:141]
    v_pk_fma_f32 v[118:119], v[118:119], v[140:141], v[140:141]
    v_rcp_f32 v112, v112
    v_rcp_f32 v113, v113
    v_rcp_f32 v114, v114
    v_rcp_f32 v115, v115
    v_rcp_f32 v116, v116
    v_rcp_f32 v117, v117
    v_rcp_f32 v118, v118
    v_rcp_f32 v119, v119
    v_pk_mul_f32 v[56:57], v[56:57], v[112:113]
    v_pk_mul_f32 v[58:59], v[58:59], v[114:115]
    v_pk_mul_f32 v[60:61], v[60:61], v[116:117]
    v_pk_mul_f32 v[62:63], v[62:63], v[118:119]
    v_pk_fma_f32 v[64:65], v[168:169], v[192:193], v[64:65]
    v_pk_fma_f32 v[66:67], v[170:171], v[192:193], v[66:67]
    v_pk_fma_f32 v[68:69], v[172:173], v[192:193], v[68:69]
    v_pk_fma_f32 v[70:71], v[174:175], v[192:193], v[70:71]
    v_pk_mul_f32 v[112:113], v[64:65], v[64:65]
    v_pk_mul_f32 v[114:115], v[66:67], v[66:67]
    v_pk_mul_f32 v[116:117], v[68:69], v[68:69]
    v_pk_mul_f32 v[118:119], v[70:71], v[70:71]
    v_pk_fma_f32 v[112:113], v[112:113], v[132:133], v[200:201]
    v_pk_fma_f32 v[114:115], v[114:115], v[132:133], v[200:201]
    v_pk_fma_f32 v[116:117], v[116:117], v[132:133], v[200:201]
    v_pk_fma_f32 v[118:119], v[118:119], v[132:133], v[200:201]
    v_pk_mul_f32 v[112:113], v[112:113], v[64:65]
    v_pk_mul_f32 v[114:115], v[114:115], v[66:67]
    v_pk_mul_f32 v[116:117], v[116:117], v[68:69]
    v_pk_mul_f32 v[118:119], v[118:119], v[70:71]
    v_exp_f32 v112, v112
    v_exp_f32 v113, v113
    v_exp_f32 v114, v114
    v_exp_f32 v115, v115
    v_exp_f32 v116, v116
    v_exp_f32 v117, v117
    v_exp_f32 v118, v118
    v_exp_f32 v119, v119
    v_pk_fma_f32 v[112:113], v[112:113], v[140:141], v[140:141]
    v_pk_fma_f32 v[114:115], v[114:115], v[140:141], v[140:141]
    v_pk_fma_f32 v[116:117], v[116:117], v[140:141], v[140:141]
    v_pk_fma_f32 v[118:119], v[118:119], v[140:141], v[140:141]
    v_rcp_f32 v112, v112
    v_rcp_f32 v113, v113
    v_rcp_f32 v114, v114
    v_rcp_f32 v115, v115
    v_rcp_f32 v116, v116
    v_rcp_f32 v117, v117
    v_rcp_f32 v118, v118
    v_rcp_f32 v119, v119
    v_pk_mul_f32 v[64:65], v[64:65], v[112:113]
    v_pk_mul_f32 v[66:67], v[66:67], v[114:115]
    v_pk_mul_f32 v[68:69], v[68:69], v[116:117]
    v_pk_mul_f32 v[70:71], v[70:71], v[118:119]
    v_pk_fma_f32 v[72:73], v[176:177], v[192:193], v[72:73]
    v_pk_fma_f32 v[74:75], v[178:179], v[192:193], v[74:75]
    v_pk_fma_f32 v[76:77], v[180:181], v[192:193], v[76:77]
    v_pk_fma_f32 v[78:79], v[182:183], v[192:193], v[78:79]
    v_pk_mul_f32 v[112:113], v[72:73], v[72:73]
    v_pk_mul_f32 v[114:115], v[74:75], v[74:75]
    v_pk_mul_f32 v[116:117], v[76:77], v[76:77]
    v_pk_mul_f32 v[118:119], v[78:79], v[78:79]
    v_pk_fma_f32 v[112:113], v[112:113], v[132:133], v[200:201]
    v_pk_fma_f32 v[114:115], v[114:115], v[132:133], v[200:201]
    v_pk_fma_f32 v[116:117], v[116:117], v[132:133], v[200:201]
    v_pk_fma_f32 v[118:119], v[118:119], v[132:133], v[200:201]
    v_pk_mul_f32 v[112:113], v[112:113], v[72:73]
    v_pk_mul_f32 v[114:115], v[114:115], v[74:75]
    v_pk_mul_f32 v[116:117], v[116:117], v[76:77]
    v_pk_mul_f32 v[118:119], v[118:119], v[78:79]
    v_exp_f32 v112, v112
    v_exp_f32 v113, v113
    v_exp_f32 v114, v114
    v_exp_f32 v115, v115
    v_exp_f32 v116, v116
    v_exp_f32 v117, v117
    v_exp_f32 v118, v118
    v_exp_f32 v119, v119
    v_pk_fma_f32 v[112:113], v[112:113], v[140:141], v[140:141]
    v_pk_fma_f32 v[114:115], v[114:115], v[140:141], v[140:141]
    v_pk_fma_f32 v[116:117], v[116:117], v[140:141], v[140:141]
    v_pk_fma_f32 v[118:119], v[118:119], v[140:141], v[140:141]
    v_rcp_f32 v112, v112
    v_rcp_f32 v113, v113
    v_rcp_f32 v114, v114
    v_rcp_f32 v115, v115
    v_rcp_f32 v116, v116
    v_rcp_f32 v117, v117
    v_rcp_f32 v118, v118
    v_rcp_f32 v119, v119
    v_pk_mul_f32 v[72:73], v[72:73], v[112:113]
    v_pk_mul_f32 v[74:75], v[74:75], v[114:115]
    v_pk_mul_f32 v[76:77], v[76:77], v[116:117]
    v_pk_mul_f32 v[78:79], v[78:79], v[118:119]
    v_pk_fma_f32 v[80:81], v[184:185], v[192:193], v[80:81]
    v_pk_fma_f32 v[82:83], v[186:187], v[192:193], v[82:83]
    v_pk_fma_f32 v[84:85], v[160:161], v[194:195], v[84:85]
    v_pk_fma_f32 v[86:87], v[162:163], v[194:195], v[86:87]
    v_pk_mul_f32 v[112:113], v[80:81], v[80:81]
    v_pk_mul_f32 v[114:115], v[82:83], v[82:83]
    v_pk_mul_f32 v[116:117], v[84:85], v[84:85]
    v_pk_mul_f32 v[118:119], v[86:87], v[86:87]
    v_pk_fma_f32 v[112:113], v[112:113], v[132:133], v[200:201]
    v_pk_fma_f32 v[114:115], v[114:115], v[132:133], v[200:201]
    v_pk_fma_f32 v[116:117], v[116:117], v[134:135], v[202:203]
    v_pk_fma_f32 v[118:119], v[118:119], v[134:135], v[202:203]
    v_pk_mul_f32 v[112:113], v[112:113], v[80:81]
    v_pk_mul_f32 v[114:115], v[114:115], v[82:83]
    v_pk_mul_f32 v[116:117], v[116:117], v[84:85]
    v_pk_mul_f32 v[118:119], v[118:119], v[86:87]
    v_exp_f32 v112, v112
    v_exp_f32 v113, v113
    v_exp_f32 v114, v114
    v_exp_f32 v115, v115
    v_exp_f32 v116, v116
    v_exp_f32 v117, v117
    v_exp_f32 v118, v118
    v_exp_f32 v119, v119
    v_pk_fma_f32 v[112:113], v[112:113], v[140:141], v[140:141]
    v_pk_fma_f32 v[114:115], v[114:115], v[140:141], v[140:141]
    v_pk_fma_f32 v[116:117], v[116:117], v[142:143], v[142:143]
    v_pk_fma_f32 v[118:119], v[118:119], v[142:143], v[142:143]
    v_rcp_f32 v112, v112
    v_rcp_f32 v113, v113
    v_rcp_f32 v114, v114
    v_rcp_f32 v115, v115
    v_rcp_f32 v116, v116
    v_rcp_f32 v117, v117
    v_rcp_f32 v118, v118
    v_rcp_f32 v119, v119
    v_pk_mul_f32 v[80:81], v[80:81], v[112:113]
    v_pk_mul_f32 v[82:83], v[82:83], v[114:115]
    v_pk_mul_f32 v[84:85], v[84:85], v[116:117]
    v_pk_mul_f32 v[86:87], v[86:87], v[118:119]
    v_pk_fma_f32 v[88:89], v[164:165], v[194:195], v[88:89]
    v_pk_fma_f32 v[90:91], v[166:167], v[194:195], v[90:91]
    v_pk_fma_f32 v[92:93], v[168:169], v[194:195], v[92:93]
    v_pk_fma_f32 v[94:95], v[170:171], v[194:195], v[94:95]
    v_pk_mul_f32 v[112:113], v[88:89], v[88:89]
    v_pk_mul_f32 v[114:115], v[90:91], v[90:91]
    v_pk_mul_f32 v[116:117], v[92:93], v[92:93]
    v_pk_mul_f32 v[118:119], v[94:95], v[94:95]
    v_pk_fma_f32 v[112:113], v[112:113], v[134:135], v[202:203]
    v_pk_fma_f32 v[114:115], v[114:115], v[134:135], v[202:203]
    v_pk_fma_f32 v[116:117], v[116:117], v[134:135], v[202:203]
    v_pk_fma_f32 v[118:119], v[118:119], v[134:135], v[202:203]
    v_pk_mul_f32 v[112:113], v[112:113], v[88:89]
    v_pk_mul_f32 v[114:115], v[114:115], v[90:91]
    v_pk_mul_f32 v[116:117], v[116:117], v[92:93]
    v_pk_mul_f32 v[118:119], v[118:119], v[94:95]
    v_exp_f32 v112, v112
    v_exp_f32 v113, v113
    v_exp_f32 v114, v114
    v_exp_f32 v115, v115
    v_exp_f32 v116, v116
    v_exp_f32 v117, v117
    v_exp_f32 v118, v118
    v_exp_f32 v119, v119
    v_pk_fma_f32 v[112:113], v[112:113], v[142:143], v[142:143]
    v_pk_fma_f32 v[114:115], v[114:115], v[142:143], v[142:143]
    v_pk_fma_f32 v[116:117], v[116:117], v[142:143], v[142:143]
    v_pk_fma_f32 v[118:119], v[118:119], v[142:143], v[142:143]
    v_rcp_f32 v112, v112
    v_rcp_f32 v113, v113
    v_rcp_f32 v114, v114
    v_rcp_f32 v115, v115
    v_rcp_f32 v116, v116
    v_rcp_f32 v117, v117
    v_rcp_f32 v118, v118
    v_rcp_f32 v119, v119
    v_pk_mul_f32 v[88:89], v[88:89], v[112:113]
    v_pk_mul_f32 v[90:91], v[90:91], v[114:115]
    v_pk_mul_f32 v[92:93], v[92:93], v[116:117]
    v_pk_mul_f32 v[94:95], v[94:95], v[118:119]
    v_pk_fma_f32 v[96:97], v[172:173], v[194:195], v[96:97]
    v_pk_fma_f32 v[98:99], v[174:175], v[194:195], v[98:99]
    v_pk_fma_f32 v[100:101], v[176:177], v[194:195], v[100:101]
    v_pk_fma_f32 v[102:103], v[178:179], v[194:195], v[102:103]
    v_pk_mul_f32 v[112:113], v[96:97], v[96:97]
    v_pk_mul_f32 v[114:115], v[98:99], v[98:99]
    v_pk_mul_f32 v[116:117], v[100:101], v[100:101]
    v_pk_mul_f32 v[118:119], v[102:103], v[102:103]
    v_pk_fma_f32 v[112:113], v[112:113], v[134:135], v[202:203]
    v_pk_fma_f32 v[114:115], v[114:115], v[134:135], v[202:203]
    v_pk_fma_f32 v[116:117], v[116:117], v[134:135], v[202:203]
    v_pk_fma_f32 v[118:119], v[118:119], v[134:135], v[202:203]
    v_pk_mul_f32 v[112:113], v[112:113], v[96:97]
    v_pk_mul_f32 v[114:115], v[114:115], v[98:99]
    v_pk_mul_f32 v[116:117], v[116:117], v[100:101]
    v_pk_mul_f32 v[118:119], v[118:119], v[102:103]
    v_exp_f32 v112, v112
    v_exp_f32 v113, v113
    v_exp_f32 v114, v114
    v_exp_f32 v115, v115
    v_exp_f32 v116, v116
    v_exp_f32 v117, v117
    v_exp_f32 v118, v118
    v_exp_f32 v119, v119
    v_pk_fma_f32 v[112:113], v[112:113], v[142:143], v[142:143]
    v_pk_fma_f32 v[114:115], v[114:115], v[142:143], v[142:143]
    v_pk_fma_f32 v[116:117], v[116:117], v[142:143], v[142:143]
    v_pk_fma_f32 v[118:119], v[118:119], v[142:143], v[142:143]
    v_rcp_f32 v112, v112
    v_rcp_f32 v113, v113
    v_rcp_f32 v114, v114
    v_rcp_f32 v115, v115
    v_rcp_f32 v116, v116
    v_rcp_f32 v117, v117
    v_rcp_f32 v118, v118
    v_rcp_f32 v119, v119
    v_pk_mul_f32 v[96:97], v[96:97], v[112:113]
    v_pk_mul_f32 v[98:99], v[98:99], v[114:115]
    v_pk_mul_f32 v[100:101], v[100:101], v[116:117]
    v_pk_mul_f32 v[102:103], v[102:103], v[118:119]
    v_pk_fma_f32 v[104:105], v[180:181], v[194:195], v[104:105]
    v_pk_fma_f32 v[106:107], v[182:183], v[194:195], v[106:107]
    v_pk_fma_f32 v[108:109], v[184:185], v[194:195], v[108:109]
    v_pk_fma_f32 v[110:111], v[186:187], v[194:195], v[110:111]
    v_pk_mul_f32 v[112:113], v[104:105], v[104:105]
    v_pk_mul_f32 v[114:115], v[106:107], v[106:107]
    v_pk_mul_f32 v[116:117], v[108:109], v[108:109]
    v_pk_mul_f32 v[118:119], v[110:111], v[110:111]
    v_pk_fma_f32 v[112:113], v[112:113], v[134:135], v[202:203]
    v_pk_fma_f32 v[114:115], v[114:115], v[134:135], v[202:203]
    v_pk_fma_f32 v[116:117], v[116:117], v[134:135], v[202:203]
    v_pk_fma_f32 v[118:119], v[118:119], v[134:135], v[202:203]
    v_pk_mul_f32 v[112:113], v[112:113], v[104:105]
    v_pk_mul_f32 v[114:115], v[114:115], v[106:107]
    v_pk_mul_f32 v[116:117], v[116:117], v[108:109]
    v_pk_mul_f32 v[118:119], v[118:119], v[110:111]
    v_exp_f32 v112, v112
    v_exp_f32 v113, v113
    v_exp_f32 v114, v114
    v_exp_f32 v115, v115
    v_exp_f32 v116, v116
    v_exp_f32 v117, v117
    v_exp_f32 v118, v118
    v_exp_f32 v119, v119
    v_pk_fma_f32 v[112:113], v[112:113], v[142:143], v[142:143]
    v_pk_fma_f32 v[114:115], v[114:115], v[142:143], v[142:143]
    v_pk_fma_f32 v[116:117], v[116:117], v[142:143], v[142:143]
    v_pk_fma_f32 v[118:119], v[118:119], v[142:143], v[142:143]
    v_rcp_f32 v112, v112
    v_rcp_f32 v113, v113
    v_rcp_f32 v114, v114
    v_rcp_f32 v115, v115
    v_rcp_f32 v116, v116
    v_rcp_f32 v117, v117
    v_rcp_f32 v118, v118
    v_rcp_f32 v119, v119
    v_pk_mul_f32 v[104:105], v[104:105], v[112:113]
    v_pk_mul_f32 v[106:107], v[106:107], v[114:115]
    v_pk_mul_f32 v[108:109], v[108:109], v[116:117]
    v_pk_mul_f32 v[110:111], v[110:111], v[118:119]
    s_mov_b32 s16, 4096
    s_mov_b32 s17, 8192
    s_mov_b32 s18, 12288
    s_cmp_lt_u32 s24, 2
    s_cbranch_scc1 z2_91x
.p2align 3
    v_pk_add_f32 v[128:129], v[0:1], v[2:3]
    v_pk_add_f32 v[130:131], v[28:29], v[30:31]
    v_pk_add_f32 v[132:133], v[56:57], v[58:59]
    v_pk_add_f32 v[134:135], v[84:85], v[86:87]
    v_pk_add_f32 v[128:129], v[128:129], v[4:5]
    v_pk_add_f32 v[130:131], v[130:131], v[32:33]
    v_pk_add_f32 v[132:133], v[132:133], v[60:61]
    v_pk_add_f32 v[134:135], v[134:135], v[88:89]
    v_pk_add_f32 v[128:129], v[128:129], v[6:7]
    v_pk_add_f32 v[130:131], v[130:131], v[34:35]
    v_pk_add_f32 v[132:133], v[132:133], v[62:63]
    v_pk_add_f32 v[134:135], v[134:135], v[90:91]
    v_pk_add_f32 v[128:129], v[128:129], v[8:9]
    v_pk_add_f32 v[130:131], v[130:131], v[36:37]
    v_pk_add_f32 v[132:133], v[132:133], v[64:65]
    v_pk_add_f32 v[134:135], v[134:135], v[92:93]
    v_pk_add_f32 v[128:129], v[128:129], v[10:11]
    v_pk_add_f32 v[130:131], v[130:131], v[38:39]
    v_pk_add_f32 v[132:133], v[132:133], v[66:67]
    v_pk_add_f32 v[134:135], v[134:135], v[94:95]
    v_pk_add_f32 v[128:129], v[128:129], v[12:13]
    v_pk_add_f32 v[130:131], v[130:131], v[40:41]
    v_pk_add_f32 v[132:133], v[132:133], v[68:69]
    v_pk_add_f32 v[134:135], v[134:135], v[96:97]
    v_pk_add_f32 v[128:129], v[128:129], v[14:15]
    v_pk_add_f32 v[130:131], v[130:131], v[42:43]
    v_pk_add_f32 v[132:133], v[132:133], v[70:71]
    v_pk_add_f32 v[134:135], v[134:135], v[98:99]
    v_pk_add_f32 v[128:129], v[128:129], v[16:17]
    v_pk_add_f32 v[130:131], v[130:131], v[44:45]
    v_pk_add_f32 v[132:133], v[132:133], v[72:73]
    v_pk_add_f32 v[134:135], v[134:135], v[100:101]
    v_pk_add_f32 v[128:129], v[128:129], v[18:19]
    v_pk_add_f32 v[130:131], v[130:131], v[46:47]
    v_pk_add_f32 v[132:133], v[132:133], v[74:75]
    v_pk_add_f32 v[134:135], v[134:135], v[102:103]
    v_pk_add_f32 v[128:129], v[128:129], v[20:21]
    v_pk_add_f32 v[130:131], v[130:131], v[48:49]
    v_pk_add_f32 v[132:133], v[132:133], v[76:77]
    v_pk_add_f32 v[134:135], v[134:135], v[104:105]
    v_pk_add_f32 v[128:129], v[128:129], v[22:23]
    v_pk_add_f32 v[130:131], v[130:131], v[50:51]
    v_pk_add_f32 v[132:133], v[132:133], v[78:79]
    v_pk_add_f32 v[134:135], v[134:135], v[106:107]
    v_pk_add_f32 v[128:129], v[128:129], v[24:25]
    v_pk_add_f32 v[130:131], v[130:131], v[52:53]
    v_pk_add_f32 v[132:133], v[132:133], v[80:81]
    v_pk_add_f32 v[134:135], v[134:135], v[108:109]
    v_pk_add_f32 v[128:129], v[128:129], v[26:27]
    v_pk_add_f32 v[130:131], v[130:131], v[54:55]
    v_pk_add_f32 v[132:133], v[132:133], v[82:83]
    v_pk_add_f32 v[134:135], v[134:135], v[110:111]
    v_add_f32 v136, v128, v129
    v_add_f32 v137, v130, v131
    v_add_f32 v138, v132, v133
    v_add_f32 v139, v134, v135
    s_nop 1
    v_permlane16_swap_b32 v136, v137
    v_permlane16_swap_b32 v138, v139
    v_add_f32 v136, v136, v137
    v_add_f32 v138, v138, v139
    s_nop 1
    v_permlane32_swap_b32 v136, v138
    v_add_f32 v136, v136, v138
    v_mul_f32 v137, 0xbc124925, v136
    v_mov_b32 v140, v137
    v_mov_b32 v144, v137
    s_nop 1
    v_permlane32_swap_b32 v140, v144
    v_mov_b32 v142, v140
    v_mov_b32 v146, v144
    s_nop 1
    v_permlane16_swap_b32 v140, v142
    v_permlane16_swap_b32 v144, v146
    v_mov_b32 v141, v140
    v_mov_b32 v143, v142
    v_mov_b32 v145, v144
    v_mov_b32 v147, v146
.p2align 3
    v_pk_add_f32 v[148:149], v[0:1], v[140:141]
    v_pk_add_f32 v[150:151], v[28:29], v[142:143]
    v_pk_add_f32 v[152:153], v[56:57], v[144:145]
    v_pk_add_f32 v[154:155], v[84:85], v[146:147]
    v_pk_mul_f32 v[128:129], v[148:149], v[148:149]
    v_pk_mul_f32 v[130:131], v[150:151], v[150:151]
    v_pk_mul_f32 v[132:133], v[152:153], v[152:153]
    v_pk_mul_f32 v[134:135], v[154:155], v[154:155]
    v_pk_add_f32 v[148:149], v[2:3], v[140:141]
    v_pk_add_f32 v[150:151], v[30:31], v[142:143]
    v_pk_add_f32 v[152:153], v[58:59], v[144:145]
    v_pk_add_f32 v[154:155], v[86:87], v[146:147]
    v_pk_fma_f32 v[128:129], v[148:149], v[148:149], v[128:129]
    v_pk_fma_f32 v[130:131], v[150:151], v[150:151], v[130:131]
    v_pk_fma_f32 v[132:133], v[152:153], v[152:153], v[132:133]
    v_pk_fma_f32 v[134:135], v[154:155], v[154:155], v[134:135]
    v_pk_add_f32 v[148:149], v[4:5], v[140:141]
    v_pk_add_f32 v[150:151], v[32:33], v[142:143]
    v_pk_add_f32 v[152:153], v[60:61], v[144:145]
    v_pk_add_f32 v[154:155], v[88:89], v[146:147]
    v_pk_fma_f32 v[128:129], v[148:149], v[148:149], v[128:129]
    v_pk_fma_f32 v[130:131], v[150:151], v[150:151], v[130:131]
    v_pk_fma_f32 v[132:133], v[152:153], v[152:153], v[132:133]
    v_pk_fma_f32 v[134:135], v[154:155], v[154:155], v[134:135]
    v_pk_add_f32 v[148:149], v[6:7], v[140:141]
    v_pk_add_f32 v[150:151], v[34:35], v[142:143]
    v_pk_add_f32 v[152:153], v[62:63], v[144:145]
    v_pk_add_f32 v[154:155], v[90:91], v[146:147]
    v_pk_fma_f32 v[128:129], v[148:149], v[148:149], v[128:129]
    v_pk_fma_f32 v[130:131], v[150:151], v[150:151], v[130:131]
    v_pk_fma_f32 v[132:133], v[152:153], v[152:153], v[132:133]
    v_pk_fma_f32 v[134:135], v[154:155], v[154:155], v[134:135]
    v_pk_add_f32 v[148:149], v[8:9], v[140:141]
    v_pk_add_f32 v[150:151], v[36:37], v[142:143]
    v_pk_add_f32 v[152:153], v[64:65], v[144:145]
    v_pk_add_f32 v[154:155], v[92:93], v[146:147]
    v_pk_fma_f32 v[128:129], v[148:149], v[148:149], v[128:129]
    v_pk_fma_f32 v[130:131], v[150:151], v[150:151], v[130:131]
    v_pk_fma_f32 v[132:133], v[152:153], v[152:153], v[132:133]
    v_pk_fma_f32 v[134:135], v[154:155], v[154:155], v[134:135]
    v_pk_add_f32 v[148:149], v[10:11], v[140:141]
    v_pk_add_f32 v[150:151], v[38:39], v[142:143]
    v_pk_add_f32 v[152:153], v[66:67], v[144:145]
    v_pk_add_f32 v[154:155], v[94:95], v[146:147]
    v_pk_fma_f32 v[128:129], v[148:149], v[148:149], v[128:129]
    v_pk_fma_f32 v[130:131], v[150:151], v[150:151], v[130:131]
    v_pk_fma_f32 v[132:133], v[152:153], v[152:153], v[132:133]
    v_pk_fma_f32 v[134:135], v[154:155], v[154:155], v[134:135]
    v_pk_add_f32 v[148:149], v[12:13], v[140:141]
    v_pk_add_f32 v[150:151], v[40:41], v[142:143]
    v_pk_add_f32 v[152:153], v[68:69], v[144:145]
    v_pk_add_f32 v[154:155], v[96:97], v[146:147]
    v_pk_fma_f32 v[128:129], v[148:149], v[148:149], v[128:129]
    v_pk_fma_f32 v[130:131], v[150:151], v[150:151], v[130:131]
    v_pk_fma_f32 v[132:133], v[152:153], v[152:153], v[132:133]
    v_pk_fma_f32 v[134:135], v[154:155], v[154:155], v[134:135]
    v_pk_add_f32 v[148:149], v[14:15], v[140:141]
    v_pk_add_f32 v[150:151], v[42:43], v[142:143]
    v_pk_add_f32 v[152:153], v[70:71], v[144:145]
    v_pk_add_f32 v[154:155], v[98:99], v[146:147]
    v_pk_fma_f32 v[128:129], v[148:149], v[148:149], v[128:129]
    v_pk_fma_f32 v[130:131], v[150:151], v[150:151], v[130:131]
    v_pk_fma_f32 v[132:133], v[152:153], v[152:153], v[132:133]
    v_pk_fma_f32 v[134:135], v[154:155], v[154:155], v[134:135]
    v_pk_add_f32 v[148:149], v[16:17], v[140:141]
    v_pk_add_f32 v[150:151], v[44:45], v[142:143]
    v_pk_add_f32 v[152:153], v[72:73], v[144:145]
    v_pk_add_f32 v[154:155], v[100:101], v[146:147]
    v_pk_fma_f32 v[128:129], v[148:149], v[148:149], v[128:129]
    v_pk_fma_f32 v[130:131], v[150:151], v[150:151], v[130:131]
    v_pk_fma_f32 v[132:133], v[152:153], v[152:153], v[132:133]
    v_pk_fma_f32 v[134:135], v[154:155], v[154:155], v[134:135]
    v_pk_add_f32 v[148:149], v[18:19], v[140:141]
    v_pk_add_f32 v[150:151], v[46:47], v[142:143]
    v_pk_add_f32 v[152:153], v[74:75], v[144:145]
    v_pk_add_f32 v[154:155], v[102:103], v[146:147]
    v_pk_fma_f32 v[128:129], v[148:149], v[148:149], v[128:129]
    v_pk_fma_f32 v[130:131], v[150:151], v[150:151], v[130:131]
    v_pk_fma_f32 v[132:133], v[152:153], v[152:153], v[132:133]
    v_pk_fma_f32 v[134:135], v[154:155], v[154:155], v[134:135]
    v_pk_add_f32 v[148:149], v[20:21], v[140:141]
    v_pk_add_f32 v[150:151], v[48:49], v[142:143]
    v_pk_add_f32 v[152:153], v[76:77], v[144:145]
    v_pk_add_f32 v[154:155], v[104:105], v[146:147]
    v_pk_fma_f32 v[128:129], v[148:149], v[148:149], v[128:129]
    v_pk_fma_f32 v[130:131], v[150:151], v[150:151], v[130:131]
    v_pk_fma_f32 v[132:133], v[152:153], v[152:153], v[132:133]
    v_pk_fma_f32 v[134:135], v[154:155], v[154:155], v[134:135]
    v_pk_add_f32 v[148:149], v[22:23], v[140:141]
    v_pk_add_f32 v[150:151], v[50:51], v[142:143]
    v_pk_add_f32 v[152:153], v[78:79], v[144:145]
    v_pk_add_f32 v[154:155], v[106:107], v[146:147]
    v_pk_fma_f32 v[128:129], v[148:149], v[148:149], v[128:129]
    v_pk_fma_f32 v[130:131], v[150:151], v[150:151], v[130:131]
    v_pk_fma_f32 v[132:133], v[152:153], v[152:153], v[132:133]
    v_pk_fma_f32 v[134:135], v[154:155], v[154:155], v[134:135]
    v_pk_add_f32 v[148:149], v[24:25], v[140:141]
    v_pk_add_f32 v[150:151], v[52:53], v[142:143]
    v_pk_add_f32 v[152:153], v[80:81], v[144:145]
    v_pk_add_f32 v[154:155], v[108:109], v[146:147]
    v_pk_fma_f32 v[128:129], v[148:149], v[148:149], v[128:129]
    v_pk_fma_f32 v[130:131], v[150:151], v[150:151], v[130:131]
    v_pk_fma_f32 v[132:133], v[152:153], v[152:153], v[132:133]
    v_pk_fma_f32 v[134:135], v[154:155], v[154:155], v[134:135]
    v_pk_add_f32 v[148:149], v[26:27], v[140:141]
    v_pk_add_f32 v[150:151], v[54:55], v[142:143]
    v_pk_add_f32 v[152:153], v[82:83], v[144:145]
    v_pk_add_f32 v[154:155], v[110:111], v[146:147]
    v_pk_fma_f32 v[128:129], v[148:149], v[148:149], v[128:129]
    v_pk_fma_f32 v[130:131], v[150:151], v[150:151], v[130:131]
    v_pk_fma_f32 v[132:133], v[152:153], v[152:153], v[132:133]
    v_pk_fma_f32 v[134:135], v[154:155], v[154:155], v[134:135]
    v_add_f32 v156, v128, v129
    v_add_f32 v157, v130, v131
    v_add_f32 v158, v132, v133
    v_add_f32 v159, v134, v135
    s_nop 1
    v_permlane16_swap_b32 v156, v157
    v_permlane16_swap_b32 v158, v159
    v_add_f32 v156, v156, v157
    v_add_f32 v158, v158, v159
    s_nop 1
    v_permlane32_swap_b32 v156, v158
    v_add_f32 v156, v156, v158
    s_add_u32 s12, s4, 0x2800000
    s_addc_u32 s13, s5, 0
    s_mov_b32 s14, 0x80000
    s_mov_b32 s15, 0x00020000
    v_mov_b32 v137, s31
    v_mov_b32 v138, v156
    v_mov_b32 v139, s31
    s_lshl_b32 s6, s22, 8
    s_lshl_b32 s7, s21, 6
    s_add_u32 s6, s6, s7
    s_lshl_b32 s6, s6, 4
    v_add_u32 v160, s6, v245
    s_lshl_b32 s3, s23, 1
    s_add_u32 s3, s3, s24
    s_sub_u32 s3, s3, 2
    s_lshl_b32 s3, s3, 15
    buffer_store_dwordx4 v[136:139], v160, s[12:15], s3 offen sc1
    s_mov_b32 s97, 0x20000
    v_and_b32 v161, 15, v250
    v_lshlrev_b32 v161, 15, v161
    s_add_u32 s6, s6, 1020
stp_95:
    buffer_load_dword v162, v161, s[12:15], s6 offen sc1
    s_sub_u32 s97, s97, 1
    s_cmp_eq_u32 s97, 0
    s_cbranch_scc1 std_96
    s_waitcnt vmcnt(0)
    v_cmp_ne_u32 vcc, s31, v162
    s_cbranch_vccz stp_95f
    s_sleep 4
    s_branch stp_95
stp_95f:
    s_mov_b32 s3, 0
    buffer_load_dwordx4 v[164:167], v160, s[12:15], s3 offen sc1
    s_mov_b32 s3, 32768
    buffer_load_dwordx4 v[168:171], v160, s[12:15], s3 offen sc1
    s_mov_b32 s3, 65536
    buffer_load_dwordx4 v[172:175], v160, s[12:15], s3 offen sc1
    s_mov_b32 s3, 98304
    buffer_load_dwordx4 v[176:179], v160, s[12:15], s3 offen sc1
    s_mov_b32 s3, 131072
    buffer_load_dwordx4 v[180:183], v160, s[12:15], s3 offen sc1
    s_mov_b32 s3, 163840
    buffer_load_dwordx4 v[184:187], v160, s[12:15], s3 offen sc1
    s_mov_b32 s3, 196608
    buffer_load_dwordx4 v[188:191], v160, s[12:15], s3 offen sc1
    s_mov_b32 s3, 229376
    buffer_load_dwordx4 v[192:195], v160, s[12:15], s3 offen sc1
    s_mov_b32 s3, 262144
    buffer_load_dwordx4 v[196:199], v160, s[12:15], s3 offen sc1
    s_mov_b32 s3, 294912
    buffer_load_dwordx4 v[200:203], v160, s[12:15], s3 offen sc1
    s_mov_b32 s3, 327680
    buffer_load_dwordx4 v[204:207], v160, s[12:15], s3 offen sc1
    s_mov_b32 s3, 360448
    buffer_load_dwordx4 v[208:211], v160, s[12:15], s3 offen sc1
    s_mov_b32 s3, 393216
    buffer_load_dwordx4 v[212:215], v160, s[12:15], s3 offen sc1
    s_mov_b32 s3, 425984
    buffer_load_dwordx4 v[216:219], v160, s[12:15], s3 offen sc1
    s_mov_b32 s3, 458752
    buffer_load_dwordx4 v[220:223], v160, s[12:15], s3 offen sc1
    s_mov_b32 s3, 491520
    buffer_load_dwordx4 v[224:227], v160, s[12:15], s3 offen sc1
    s_waitcnt vmcnt(0)
    v_xor_b32 v163, s31, v165
    v_xor_b32 v162, s31, v167
    v_or_b32 v163, v163, v162
    v_xor_b32 v162, s31, v169
    v_or_b32 v163, v163, v162
    v_xor_b32 v162, s31, v171
    v_or_b32 v163, v163, v162
    v_xor_b32 v162, s31, v173
    v_or_b32 v163, v163, v162
    v_xor_b32 v162, s31, v175
    v_or_b32 v163, v163, v162
    v_xor_b32 v162, s31, v177
    v_or_b32 v163, v163, v162
    v_xor_b32 v162, s31, v179
    v_or_b32 v163, v163, v162
    v_xor_b32 v162, s31, v181
    v_or_b32 v163, v163, v162
    v_xor_b32 v162, s31, v183
    v_or_b32 v163, v163, v162
    v_xor_b32 v162, s31, v185
    v_or_b32 v163, v163, v162
    v_xor_b32 v162, s31, v187
    v_or_b32 v163, v163, v162
    v_xor_b32 v162, s31, v189
    v_or_b32 v163, v163, v162
    v_xor_b32 v162, s31, v191
    v_or_b32 v163, v163, v162
    v_xor_b32 v162, s31, v193
    v_or_b32 v163, v163, v162
    v_xor_b32 v162, s31, v195
    v_or_b32 v163, v163, v162
    v_xor_b32 v162, s31, v197
    v_or_b32 v163, v163, v162
    v_xor_b32 v162, s31, v199
    v_or_b32 v163, v163, v162
    v_xor_b32 v162, s31, v201
    v_or_b32 v163, v163, v162
    v_xor_b32 v162, s31, v203
    v_or_b32 v163, v163, v162
    v_xor_b32 v162, s31, v205
    v_or_b32 v163, v163, v162
    v_xor_b32 v162, s31, v207
    v_or_b32 v163, v163, v162
    v_xor_b32 v162, s31, v209
    v_or_b32 v163, v163, v162
    v_xor_b32 v162, s31, v211
    v_or_b32 v163, v163, v162
    v_xor_b32 v162, s31, v213
    v_or_b32 v163, v163, v162
    v_xor_b32 v162, s31, v215
    v_or_b32 v163, v163, v162
    v_xor_b32 v162, s31, v217
    v_or_b32 v163, v163, v162
    v_xor_b32 v162, s31, v219
    v_or_b32 v163, v163, v162
    v_xor_b32 v162, s31, v221
    v_or_b32 v163, v163, v162
    v_xor_b32 v162, s31, v223
    v_or_b32 v163, v163, v162
    v_xor_b32 v162, s31, v225
    v_or_b32 v163, v163, v162
    v_xor_b32 v162, s31, v227
    v_or_b32 v163, v163, v162
    v_cmp_ne_u32 vcc, 0, v163
    s_cbranch_vccnz stp_95
std_96:
    s_waitcnt vmcnt(0)
    v_add_f32 v160, v164, v168
    v_add_f32 v160, v160, v172
    v_add_f32 v160, v160, v176
    v_add_f32 v160, v160, v180
    v_add_f32 v160, v160, v184
    v_add_f32 v160, v160, v188
    v_add_f32 v160, v160, v192
    v_add_f32 v160, v160, v196
    v_add_f32 v160, v160, v200
    v_add_f32 v160, v160, v204
    v_add_f32 v160, v160, v208
    v_add_f32 v160, v160, v212
    v_add_f32 v160, v160, v216
    v_add_f32 v160, v160, v220
    v_add_f32 v160, v160, v224
    v_mul_f32 v160, 0x3a124925, v160
    v_add_f32 v161, v166, v170
    v_add_f32 v161, v161, v174
    v_add_f32 v161, v161, v178
    v_add_f32 v161, v161, v182
    v_add_f32 v161, v161, v186
    v_add_f32 v161, v161, v190
    v_add_f32 v161, v161, v194
    v_add_f32 v161, v161, v198
    v_add_f32 v161, v161, v202
    v_add_f32 v161, v161, v206
    v_add_f32 v161, v161, v210
    v_add_f32 v161, v161, v214
    v_add_f32 v161, v161, v218
    v_add_f32 v161, v161, v222
    v_add_f32 v161, v161, v226
    v_mov_b32 v162, 0x3c124925
    v_mov_b32 v163, 0
    v_fma_f32 v164, v164, v162, -v160
    v_fma_f32 v168, v168, v162, -v160
    v_fma_f32 v172, v172, v162, -v160
    v_fma_f32 v176, v176, v162, -v160
    v_fma_f32 v180, v180, v162, -v160
    v_fma_f32 v184, v184, v162, -v160
    v_fma_f32 v188, v188, v162, -v160
    v_fma_f32 v192, v192, v162, -v160
    v_fma_f32 v196, v196, v162, -v160
    v_fma_f32 v200, v200, v162, -v160
    v_fma_f32 v204, v204, v162, -v160
    v_fma_f32 v208, v208, v162, -v160
    v_fma_f32 v212, v212, v162, -v160
    v_fma_f32 v216, v216, v162, -v160
    v_fma_f32 v220, v220, v162, -v160
    v_fma_f32 v224, v224, v162, -v160
    v_fmac_f32 v163, v164, v164
    v_fmac_f32 v163, v168, v168
    v_fmac_f32 v163, v172, v172
    v_fmac_f32 v163, v176, v176
    v_fmac_f32 v163, v180, v180
    v_fmac_f32 v163, v184, v184
    v_fmac_f32 v163, v188, v188
    v_fmac_f32 v163, v192, v192
    v_fmac_f32 v163, v196, v196
    v_fmac_f32 v163, v200, v200
    v_fmac_f32 v163, v204, v204
    v_fmac_f32 v163, v208, v208
    v_fmac_f32 v163, v212, v212
    v_fmac_f32 v163, v216, v216
    v_fmac_f32 v163, v220, v220
    v_fmac_f32 v163, v224, v224
    v_fmac_f32 v161, 0x42e00000, v163
    v_mul_f32 v161, 0x3a124925, v161
    v_cvt_pk_bf16_f32 v160, v160, v160
    v_and_b32 v160, 0xffff0000, v160
    v_cvt_pk_bf16_f32 v161, v161, v161
    v_and_b32 v161, 0xffff0000, v161
    v_add_f32 v161, 0x3727c5ac, v161
    v_cvt_pk_bf16_f32 v161, v161, v161
    v_and_b32 v161, 0xffff0000, v161
    v_sqrt_f32 v161, v161
    s_nop 0
    v_cvt_pk_bf16_f32 v161, v161, v161
    v_and_b32 v161, 0xffff0000, v161
    v_rcp_f32 v161, v161
    s_nop 0
    v_mul_f32 v160, v160, v161
    v_sub_f32 v160, 0, v160
    v_mov_b32 v128, v161
    v_mov_b32 v132, v161
    s_nop 1
    v_permlane32_swap_b32 v128, v132
    v_mov_b32 v130, v128
    v_mov_b32 v134, v132
    s_nop 1
    v_permlane16_swap_b32 v128, v130
    v_permlane16_swap_b32 v132, v134
    v_mov_b32 v129, v128
    v_mov_b32 v131, v130
    v_mov_b32 v133, v132
    v_mov_b32 v135, v134
    v_mov_b32 v136, v160
    v_mov_b32 v140, v160
    s_nop 1
    v_permlane32_swap_b32 v136, v140
    v_mov_b32 v138, v136
    v_mov_b32 v142, v140
    s_nop 1
    v_permlane16_swap_b32 v136, v138
    v_permlane16_swap_b32 v140, v142
    v_mov_b32 v137, v136
    v_mov_b32 v139, v138
    v_mov_b32 v141, v140
    v_mov_b32 v143, v142
.p2align 3
    v_pk_fma_f32 v[0:1], v[0:1], v[128:129], v[136:137]
    v_pk_fma_f32 v[28:29], v[28:29], v[130:131], v[138:139]
    v_pk_fma_f32 v[56:57], v[56:57], v[132:133], v[140:141]
    v_pk_fma_f32 v[84:85], v[84:85], v[134:135], v[142:143]
    v_pk_fma_f32 v[2:3], v[2:3], v[128:129], v[136:137]
    v_pk_fma_f32 v[30:31], v[30:31], v[130:131], v[138:139]
    v_pk_fma_f32 v[58:59], v[58:59], v[132:133], v[140:141]
    v_pk_fma_f32 v[86:87], v[86:87], v[134:135], v[142:143]
    v_pk_fma_f32 v[4:5], v[4:5], v[128:129], v[136:137]
    v_pk_fma_f32 v[32:33], v[32:33], v[130:131], v[138:139]
    v_pk_fma_f32 v[60:61], v[60:61], v[132:133], v[140:141]
    v_pk_fma_f32 v[88:89], v[88:89], v[134:135], v[142:143]
    v_pk_fma_f32 v[6:7], v[6:7], v[128:129], v[136:137]
    v_pk_fma_f32 v[34:35], v[34:35], v[130:131], v[138:139]
    v_pk_fma_f32 v[62:63], v[62:63], v[132:133], v[140:141]
    v_pk_fma_f32 v[90:91], v[90:91], v[134:135], v[142:143]
    v_pk_fma_f32 v[8:9], v[8:9], v[128:129], v[136:137]
    v_pk_fma_f32 v[36:37], v[36:37], v[130:131], v[138:139]
    v_pk_fma_f32 v[64:65], v[64:65], v[132:133], v[140:141]
    v_pk_fma_f32 v[92:93], v[92:93], v[134:135], v[142:143]
    v_pk_fma_f32 v[10:11], v[10:11], v[128:129], v[136:137]
    v_pk_fma_f32 v[38:39], v[38:39], v[130:131], v[138:139]
    v_pk_fma_f32 v[66:67], v[66:67], v[132:133], v[140:141]
    v_pk_fma_f32 v[94:95], v[94:95], v[134:135], v[142:143]
    v_pk_fma_f32 v[12:13], v[12:13], v[128:129], v[136:137]
    v_pk_fma_f32 v[40:41], v[40:41], v[130:131], v[138:139]
    v_pk_fma_f32 v[68:69], v[68:69], v[132:133], v[140:141]
    v_pk_fma_f32 v[96:97], v[96:97], v[134:135], v[142:143]
    v_pk_fma_f32 v[14:15], v[14:15], v[128:129], v[136:137]
    v_pk_fma_f32 v[42:43], v[42:43], v[130:131], v[138:139]
    v_pk_fma_f32 v[70:71], v[70:71], v[132:133], v[140:141]
    v_pk_fma_f32 v[98:99], v[98:99], v[134:135], v[142:143]
    v_pk_fma_f32 v[16:17], v[16:17], v[128:129], v[136:137]
    v_pk_fma_f32 v[44:45], v[44:45], v[130:131], v[138:139]
    v_pk_fma_f32 v[72:73], v[72:73], v[132:133], v[140:141]
    v_pk_fma_f32 v[100:101], v[100:101], v[134:135], v[142:143]
    v_pk_fma_f32 v[18:19], v[18:19], v[128:129], v[136:137]
    v_pk_fma_f32 v[46:47], v[46:47], v[130:131], v[138:139]
    v_pk_fma_f32 v[74:75], v[74:75], v[132:133], v[140:141]
    v_pk_fma_f32 v[102:103], v[102:103], v[134:135], v[142:143]
    v_pk_fma_f32 v[20:21], v[20:21], v[128:129], v[136:137]
    v_pk_fma_f32 v[48:49], v[48:49], v[130:131], v[138:139]
    v_pk_fma_f32 v[76:77], v[76:77], v[132:133], v[140:141]
    v_pk_fma_f32 v[104:105], v[104:105], v[134:135], v[142:143]
    v_pk_fma_f32 v[22:23], v[22:23], v[128:129], v[136:137]
    v_pk_fma_f32 v[50:51], v[50:51], v[130:131], v[138:139]
    v_pk_fma_f32 v[78:79], v[78:79], v[132:133], v[140:141]
    v_pk_fma_f32 v[106:107], v[106:107], v[134:135], v[142:143]
    v_pk_fma_f32 v[24:25], v[24:25], v[128:129], v[136:137]
    v_pk_fma_f32 v[52:53], v[52:53], v[130:131], v[138:139]
    v_pk_fma_f32 v[80:81], v[80:81], v[132:133], v[140:141]
    v_pk_fma_f32 v[108:109], v[108:109], v[134:135], v[142:143]
    v_pk_fma_f32 v[26:27], v[26:27], v[128:129], v[136:137]
    v_pk_fma_f32 v[54:55], v[54:55], v[130:131], v[138:139]
    v_pk_fma_f32 v[82:83], v[82:83], v[132:133], v[140:141]
    v_pk_fma_f32 v[110:111], v[110:111], v[134:135], v[142:143]
    s_add_u32 s12, s4, 0x2000000
    s_addc_u32 s13, s5, 0
    s_mov_b32 s14, 0x700000
    s_mov_b32 s15, 0x00020000
    s_lshl_b32 s3, s23, 5
    s_lshl_b32 s6, s22, 2
    s_add_u32 s3, s3, s6
    s_add_u32 s3, s3, s21
    s_lshl_b32 s3, s3, 1
    s_and_b32 s6, s24, 1
    s_add_u32 s3, s3, s6
    s_mul_i32 s3, s3, 14336
    v_bfe_u32 v147, v250, 4, 1
    v_lshrrev_b32 v148, 5, v250
    v_lshl_add_u32 v147, v147, 1, v148
    v_lshlrev_b32 v147, 6, v147
    v_xor_b32 v147, v147, v245
    v_add_u32 v147, s3, v147
    s_cmp_eq_u32 s24, 3
    s_cbranch_scc1 h1_92
.p2align 3
    v_cvt_pk_bf16_f32 v148, v0, v1
    v_cvt_pk_bf16_f32 v149, v2, v3
    v_cvt_pk_bf16_f32 v150, v4, v5
    v_cvt_pk_bf16_f32 v151, v6, v7
    v_cvt_pk_bf16_f32 v152, v8, v9
    v_cvt_pk_bf16_f32 v153, v10, v11
    v_cvt_pk_bf16_f32 v154, v12, v13
    v_cvt_pk_bf16_f32 v155, v14, v15
    v_permlane16_swap_b32 v148, v150
    v_permlane16_swap_b32 v149, v151
    buffer_store_dwordx4 v[148:151], v147, s[12:15], 0 offen offset:0 sc1
    v_cvt_pk_bf16_f32 v156, v16, v17
    v_cvt_pk_bf16_f32 v157, v18, v19
    v_cvt_pk_bf16_f32 v158, v20, v21
    v_cvt_pk_bf16_f32 v159, v22, v23
    v_permlane16_swap_b32 v152, v154
    v_permlane16_swap_b32 v153, v155
    buffer_store_dwordx4 v[152:155], v147, s[12:15], 0 offen offset:1024 sc1
    v_cvt_pk_bf16_f32 v160, v28, v29
    v_cvt_pk_bf16_f32 v161, v30, v31
    v_cvt_pk_bf16_f32 v162, v32, v33
    v_cvt_pk_bf16_f32 v163, v34, v35
    v_permlane16_swap_b32 v156, v158
    v_permlane16_swap_b32 v157, v159
    buffer_store_dwordx4 v[156:159], v147, s[12:15], 0 offen offset:2048 sc1
    v_cvt_pk_bf16_f32 v148, v36, v37
    v_cvt_pk_bf16_f32 v149, v38, v39
    v_cvt_pk_bf16_f32 v150, v40, v41
    v_cvt_pk_bf16_f32 v151, v42, v43
    v_permlane16_swap_b32 v160, v162
    v_permlane16_swap_b32 v161, v163
    buffer_store_dwordx4 v[160:163], v147, s[12:15], 0 offen offset:3072 sc1
    v_cvt_pk_bf16_f32 v152, v44, v45
    v_cvt_pk_bf16_f32 v153, v46, v47
    v_cvt_pk_bf16_f32 v154, v48, v49
    v_cvt_pk_bf16_f32 v155, v50, v51
    v_permlane16_swap_b32 v148, v150
    v_permlane16_swap_b32 v149, v151
    buffer_store_dwordx4 v[148:151], v147, s[12:15], s16 offen offset:0 sc1
    v_cvt_pk_bf16_f32 v156, v24, v25
    v_cvt_pk_bf16_f32 v157, v26, v27
    v_cvt_pk_bf16_f32 v158, v52, v53
    v_cvt_pk_bf16_f32 v159, v54, v55
    v_permlane16_swap_b32 v152, v154
    v_permlane16_swap_b32 v153, v155
    buffer_store_dwordx4 v[152:155], v147, s[12:15], s16 offen offset:1024 sc1
    v_cvt_pk_bf16_f32 v160, v56, v57
    v_cvt_pk_bf16_f32 v161, v58, v59
    v_cvt_pk_bf16_f32 v162, v60, v61
    v_cvt_pk_bf16_f32 v163, v62, v63
    v_permlane16_swap_b32 v156, v158
    v_permlane16_swap_b32 v157, v159
    buffer_store_dwordx4 v[156:159], v147, s[12:15], s18 offen offset:0 sc1
    v_cvt_pk_bf16_f32 v148, v64, v65
    v_cvt_pk_bf16_f32 v149, v66, v67
    v_cvt_pk_bf16_f32 v150, v68, v69
    v_cvt_pk_bf16_f32 v151, v70, v71
    v_permlane16_swap_b32 v160, v162
    v_permlane16_swap_b32 v161, v163
    buffer_store_dwordx4 v[160:163], v147, s[12:15], s16 offen offset:2048 sc1
    v_cvt_pk_bf16_f32 v152, v72, v73
    v_cvt_pk_bf16_f32 v153, v74, v75
    v_cvt_pk_bf16_f32 v154, v76, v77
    v_cvt_pk_bf16_f32 v155, v78, v79
    v_permlane16_swap_b32 v148, v150
    v_permlane16_swap_b32 v149, v151
    buffer_store_dwordx4 v[148:151], v147, s[12:15], s16 offen offset:3072 sc1
    v_cvt_pk_bf16_f32 v156, v84, v85
    v_cvt_pk_bf16_f32 v157, v86, v87
    v_cvt_pk_bf16_f32 v158, v88, v89
    v_cvt_pk_bf16_f32 v159, v90, v91
    v_permlane16_swap_b32 v152, v154
    v_permlane16_swap_b32 v153, v155
    buffer_store_dwordx4 v[152:155], v147, s[12:15], s17 offen offset:0 sc1
    v_cvt_pk_bf16_f32 v160, v92, v93
    v_cvt_pk_bf16_f32 v161, v94, v95
    v_cvt_pk_bf16_f32 v162, v96, v97
    v_cvt_pk_bf16_f32 v163, v98, v99
    v_permlane16_swap_b32 v156, v158
    v_permlane16_swap_b32 v157, v159
    buffer_store_dwordx4 v[156:159], v147, s[12:15], s17 offen offset:1024 sc1
    v_cvt_pk_bf16_f32 v148, v100, v101
    v_cvt_pk_bf16_f32 v149, v102, v103
    v_cvt_pk_bf16_f32 v150, v104, v105
    v_cvt_pk_bf16_f32 v151, v106, v107
    v_permlane16_swap_b32 v160, v162
    v_permlane16_swap_b32 v161, v163
    buffer_store_dwordx4 v[160:163], v147, s[12:15], s17 offen offset:2048 sc1
    v_cvt_pk_bf16_f32 v152, v80, v81
    v_cvt_pk_bf16_f32 v153, v82, v83
    v_cvt_pk_bf16_f32 v154, v108, v109
    v_cvt_pk_bf16_f32 v155, v110, v111
    v_permlane16_swap_b32 v148, v150
    v_permlane16_swap_b32 v149, v151
    buffer_store_dwordx4 v[148:151], v147, s[12:15], s17 offen offset:3072 sc1
    v_permlane16_swap_b32 v152, v154
    v_permlane16_swap_b32 v153, v155
    buffer_store_dwordx4 v[152:155], v147, s[12:15], s18 offen offset:1024 sc1
    s_branch eB_93
h1_92:
.p2align 3
    v_cvt_pk_bf16_f32 v148, v4, v5
    v_cvt_pk_bf16_f32 v149, v6, v7
    v_cvt_pk_bf16_f32 v150, v8, v9
    v_cvt_pk_bf16_f32 v151, v10, v11
    v_cvt_pk_bf16_f32 v152, v12, v13
    v_cvt_pk_bf16_f32 v153, v14, v15
    v_cvt_pk_bf16_f32 v154, v16, v17
    v_cvt_pk_bf16_f32 v155, v18, v19
    v_permlane16_swap_b32 v148, v150
    v_permlane16_swap_b32 v149, v151
    buffer_store_dwordx4 v[148:151], v147, s[12:15], 0 offen offset:0 sc1
    v_cvt_pk_bf16_f32 v156, v20, v21
    v_cvt_pk_bf16_f32 v157, v22, v23
    v_cvt_pk_bf16_f32 v158, v24, v25
    v_cvt_pk_bf16_f32 v159, v26, v27
    v_permlane16_swap_b32 v152, v154
    v_permlane16_swap_b32 v153, v155
    buffer_store_dwordx4 v[152:155], v147, s[12:15], 0 offen offset:1024 sc1
    v_cvt_pk_bf16_f32 v160, v32, v33
    v_cvt_pk_bf16_f32 v161, v34, v35
    v_cvt_pk_bf16_f32 v162, v36, v37
    v_cvt_pk_bf16_f32 v163, v38, v39
    v_permlane16_swap_b32 v156, v158
    v_permlane16_swap_b32 v157, v159
    buffer_store_dwordx4 v[156:159], v147, s[12:15], 0 offen offset:2048 sc1
    v_cvt_pk_bf16_f32 v148, v40, v41
    v_cvt_pk_bf16_f32 v149, v42, v43
    v_cvt_pk_bf16_f32 v150, v44, v45
    v_cvt_pk_bf16_f32 v151, v46, v47
    v_permlane16_swap_b32 v160, v162
    v_permlane16_swap_b32 v161, v163
    buffer_store_dwordx4 v[160:163], v147, s[12:15], 0 offen offset:3072 sc1
    v_cvt_pk_bf16_f32 v152, v48, v49
    v_cvt_pk_bf16_f32 v153, v50, v51
    v_cvt_pk_bf16_f32 v154, v52, v53
    v_cvt_pk_bf16_f32 v155, v54, v55
    v_permlane16_swap_b32 v148, v150
    v_permlane16_swap_b32 v149, v151
    buffer_store_dwordx4 v[148:151], v147, s[12:15], s16 offen offset:0 sc1
    v_cvt_pk_bf16_f32 v156, v0, v1
    v_cvt_pk_bf16_f32 v157, v2, v3
    v_cvt_pk_bf16_f32 v158, v28, v29
    v_cvt_pk_bf16_f32 v159, v30, v31
    v_permlane16_swap_b32 v152, v154
    v_permlane16_swap_b32 v153, v155
    buffer_store_dwordx4 v[152:155], v147, s[12:15], s16 offen offset:1024 sc1
    v_cvt_pk_bf16_f32 v160, v60, v61
    v_cvt_pk_bf16_f32 v161, v62, v63
    v_cvt_pk_bf16_f32 v162, v64, v65
    v_cvt_pk_bf16_f32 v163, v66, v67
    v_permlane16_swap_b32 v156, v158
    v_permlane16_swap_b32 v157, v159
    buffer_store_dwordx4 v[156:159], v147, s[12:15], s18 offen offset:0 sc1
    v_cvt_pk_bf16_f32 v148, v68, v69
    v_cvt_pk_bf16_f32 v149, v70, v71
    v_cvt_pk_bf16_f32 v150, v72, v73
    v_cvt_pk_bf16_f32 v151, v74, v75
    v_permlane16_swap_b32 v160, v162
    v_permlane16_swap_b32 v161, v163
    buffer_store_dwordx4 v[160:163], v147, s[12:15], s16 offen offset:2048 sc1
    v_cvt_pk_bf16_f32 v152, v76, v77
    v_cvt_pk_bf16_f32 v153, v78, v79
    v_cvt_pk_bf16_f32 v154, v80, v81
    v_cvt_pk_bf16_f32 v155, v82, v83
    v_permlane16_swap_b32 v148, v150
    v_permlane16_swap_b32 v149, v151
    buffer_store_dwordx4 v[148:151], v147, s[12:15], s16 offen offset:3072 sc1
    v_cvt_pk_bf16_f32 v156, v88, v89
    v_cvt_pk_bf16_f32 v157, v90, v91
    v_cvt_pk_bf16_f32 v158, v92, v93
    v_cvt_pk_bf16_f32 v159, v94, v95
    v_permlane16_swap_b32 v152, v154
    v_permlane16_swap_b32 v153, v155
    buffer_store_dwordx4 v[152:155], v147, s[12:15], s17 offen offset:0 sc1
    v_cvt_pk_bf16_f32 v160, v96, v97
    v_cvt_pk_bf16_f32 v161, v98, v99
    v_cvt_pk_bf16_f32 v162, v100, v101
    v_cvt_pk_bf16_f32 v163, v102, v103
    v_permlane16_swap_b32 v156, v158
    v_permlane16_swap_b32 v157, v159
    buffer_store_dwordx4 v[156:159], v147, s[12:15], s17 offen offset:1024 sc1
    v_cvt_pk_bf16_f32 v148, v104, v105
    v_cvt_pk_bf16_f32 v149, v106, v107
    v_cvt_pk_bf16_f32 v150, v108, v109
    v_cvt_pk_bf16_f32 v151, v110, v111
    v_permlane16_swap_b32 v160, v162
    v_permlane16_swap_b32 v161, v163
    buffer_store_dwordx4 v[160:163], v147, s[12:15], s17 offen offset:2048 sc1
    v_cvt_pk_bf16_f32 v152, v56, v57
    v_cvt_pk_bf16_f32 v153, v58, v59
    v_cvt_pk_bf16_f32 v154, v84, v85
    v_cvt_pk_bf16_f32 v155, v86, v87
    v_permlane16_swap_b32 v148, v150
    v_permlane16_swap_b32 v149, v151
    buffer_store_dwordx4 v[148:151], v147, s[12:15], s17 offen offset:3072 sc1
    v_permlane16_swap_b32 v152, v154
    v_permlane16_swap_b32 v153, v155
    buffer_store_dwordx4 v[152:155], v147, s[12:15], s18 offen offset:1024 sc1
eB_93:
    s_lshl_b32 s43, s23, 12
    s_add_u32 s43, s43, 65536
    s_lshl_b32 s42, s36, 7
    s_add_u32 s42, s42, s43
    s_nop 1
    s_add_u32 s8, s4, 0x2000000
    s_addc_u32 s9, s5, 0
    s_mov_b32 s10, 0x700000
    s_mov_b32 s11, 0x00020000
    s_mov_b32 s12, s58
    s_mov_b32 s13, s59
    s_mov_b32 s14, 0x800000
    s_mov_b32 s15, 0x00020000
    s_and_b32 s39, s36, 1
    s_lshr_b32 s40, s36, 1
    s_lshl_b32 s40, s40, 2
    s_add_u32 s40, s40, s21
    s_lshl_b32 s28, s21, 12
    s_cmp_eq_u32 s21, 3
    s_cmov_b32 s28, 11264
    s_cmp_lt_u32 s21, 2
    s_cselect_b32 s98, -1, 0
    s_mov_b32 s99, s98
    s_mul_i32 s3, s23, 917504
    s_mul_i32 s6, s39, 14336
    s_add_u32 s3, s3, s6
    s_add_u32 s3, s3, s28
    v_add_u32 v208, s3, v245
    s_lshl_b32 s3, s40, 5
    v_lshrrev_b32 v64, 3, v250
    v_add_u32 v64, s3, v64
    v_lshlrev_b32 v64, 12, v64
    v_lshrrev_b32 v65, 4, v250
    v_and_b32 v66, 7, v250
    v_xor_b32 v65, v65, v66
    v_lshl_add_u32 v209, v65, 4, v64
    v_xor_b32 v65, 4, v65
    v_lshl_add_u32 v210, v65, 4, v64
    v_add_u32 v211, 63488, v209
    v_add_u32 v212, 95232, v210
    v_add_u32 v210, 31744, v210
    s_lshl_b32 s30, s21, 12
    s_mov_b32 s26, 0
    s_mov_b32 s27, 0
    v_lshrrev_b32 v64, 5, v250
    v_bfe_u32 v65, v250, 2, 2
    v_bfe_u32 v66, v250, 4, 1
    v_bfe_u32 v67, v250, 1, 1
    v_and_b32 v70, 1, v250
    v_lshl_add_u32 v68, v66, 1, v67
    v_lshl_add_u32 v68, v68, 2, v65
    v_lshlrev_b32 v68, 4, v68
    v_lshl_add_u32 v68, v70, 3, v68
    v_lshl_add_u32 v68, v67, 9, v68
    v_mul_u32_u24 v69, 3072, v64
    v_add_u32 v200, v68, v69
    v_xor_b32 v201, 64, v200
    v_xor_b32 v202, 128, v200
    v_xor_b32 v203, 192, v200
    v_mul_u32_u24 v69, 384, v64
    v_xor_b32 v204, v68, v69
    v_xor_b32 v205, 64, v204
    v_and_b32 v68, 15, v250
    v_lshrrev_b32 v69, 1, v68
    v_lshrrev_b32 v71, 4, v250
    v_xor_b32 v69, v69, v71
    v_lshlrev_b32 v68, 7, v68
    v_lshl_add_u32 v68, v69, 4, v68
    s_add_u32 s3, s30, 106496
    v_add_u32 v206, s3, v68
    v_xor_b32 v207, 64, v206
    v_add_u32 v200, 49152, v200
    v_add_u32 v201, 49152, v201
    v_add_u32 v202, 49152, v202
    v_add_u32 v203, 49152, v203
    v_add_u32 v204, 49152, v204
    v_add_u32 v205, 49152, v205
    v_mov_b32 v0, 0
    v_mov_b32 v1, 0
    v_mov_b32 v2, 0
    v_mov_b32 v3, 0
    v_mov_b32 v4, 0
    v_mov_b32 v5, 0
    v_mov_b32 v6, 0
    v_mov_b32 v7, 0
    v_mov_b32 v8, 0
    v_mov_b32 v9, 0
    v_mov_b32 v10, 0
    v_mov_b32 v11, 0
    v_mov_b32 v12, 0
    v_mov_b32 v13, 0
    v_mov_b32 v14, 0
    v_mov_b32 v15, 0
    v_mov_b32 v16, 0
    v_mov_b32 v17, 0
    v_mov_b32 v18, 0
    v_mov_b32 v19, 0
    v_mov_b32 v20, 0
    v_mov_b32 v21, 0
    v_mov_b32 v22, 0
    v_mov_b32 v23, 0
    v_mov_b32 v24, 0
    v_mov_b32 v25, 0
    v_mov_b32 v26, 0
    v_mov_b32 v27, 0
    v_mov_b32 v28, 0
    v_mov_b32 v29, 0
    v_mov_b32 v30, 0
    v_mov_b32 v31, 0
    v_mov_b32 v32, 0
    v_mov_b32 v33, 0
    v_mov_b32 v34, 0
    v_mov_b32 v35, 0
    v_mov_b32 v36, 0
    v_mov_b32 v37, 0
    v_mov_b32 v38, 0
    v_mov_b32 v39, 0
    v_mov_b32 v40, 0
    v_mov_b32 v41, 0
    v_mov_b32 v42, 0
    v_mov_b32 v43, 0
    v_mov_b32 v44, 0
    v_mov_b32 v45, 0
    v_mov_b32 v46, 0
    v_mov_b32 v47, 0
    v_mov_b32 v48, 0
    v_mov_b32 v49, 0
    v_mov_b32 v50, 0
    v_mov_b32 v51, 0
    v_mov_b32 v52, 0
    v_mov_b32 v53, 0
    v_mov_b32 v54, 0
    v_mov_b32 v55, 0
    s_waitcnt vmcnt(0)
    s_add_u32 s88, s88, 1
    ds_add_u32 v246, v248
    s_cmp_lg_u32 s21, 0
    s_cbranch_scc1 fw_97
    ds_read_b32 v249, v247
    s_waitcnt lgkmcnt(0)
    v_cmp_gt_u32 vcc, s88, v249
    s_cbranch_vccnz spin_98
ok_99:
    v_mov_b32 v242, 0
    v_mov_b32 v243, s31
    s_mov_b64 exec, 1
    buffer_store_dword v243, v242, s[32:35], s42 offen sc1
    s_mov_b64 exec, -1
fw_97:
    s_add_u32 m0, s30, 106496
    s_nop 0
    buffer_load_dwordx4 v209, s[12:15], s27 offen offset:0 lds
    buffer_load_dwordx4 v210, s[12:15], s27 offen offset:1024 lds
    buffer_load_dwordx4 v211, s[12:15], s27 offen offset:2048 lds
    buffer_load_dwordx4 v212, s[12:15], s27 offen offset:3072 lds
    s_add_u32 s27, s27, 128
    s_add_u32 m0, s30, 122880
    s_nop 0
    buffer_load_dwordx4 v209, s[12:15], s27 offen offset:0 lds
    buffer_load_dwordx4 v210, s[12:15], s27 offen offset:1024 lds
    buffer_load_dwordx4 v211, s[12:15], s27 offen offset:2048 lds
    buffer_load_dwordx4 v212, s[12:15], s27 offen offset:3072 lds
    s_add_u32 s27, s27, 128
    s_add_u32 m0, s30, 139264
    s_nop 0
    buffer_load_dwordx4 v209, s[12:15], s27 offen offset:0 lds
    buffer_load_dwordx4 v210, s[12:15], s27 offen offset:1024 lds
    buffer_load_dwordx4 v211, s[12:15], s27 offen offset:2048 lds
    buffer_load_dwordx4 v212, s[12:15], s27 offen offset:3072 lds
    s_add_u32 s27, s27, 128
    s_cmp_lg_u32 s21, 0
    s_cbranch_scc1 fw_100
    v_and_b32 v244, 31, v250
    v_lshlrev_b32 v244, 7, v244
    s_mov_b32 s97, 0x20000
gp_101:
    buffer_load_dword v242, v244, s[32:35], s43 offen sc1
    s_waitcnt vmcnt(0) lgkmcnt(0)
    v_cmp_ne_u32 vcc, s31, v242
    s_cbranch_vccz gpd_102
    s_sleep 4
    s_sub_u32 s97, s97, 1
    s_cmp_lg_u32 s97, 0
    s_cbranch_scc1 gp_101
gpd_102:
fw_100:
    s_add_u32 s88, s88, 1
    ds_add_u32 v246, v248
    ds_read_b32 v249, v247
    s_waitcnt lgkmcnt(0)
    v_cmp_gt_u32 vcc, s88, v249
    s_cbranch_vccnz spin_103
ok_104:
    s_setprio 2
    s_add_u32 m0, s28, 49152
    s_nop 0
    buffer_load_dwordx4 v208, s[8:11], s26 offen offset:0 sc1 lds
    buffer_load_dwordx4 v208, s[8:11], s26 offen offset:1024 sc1 lds
    buffer_load_dwordx4 v208, s[8:11], s26 offen offset:2048 sc1 lds
    s_mov_b64 exec, s[98:99]
    buffer_load_dwordx4 v208, s[8:11], s26 offen offset:3072 sc1 lds
    s_mov_b64 exec, -1
    s_add_u32 s26, s26, 28672
    s_add_u32 m0, s28, 63488
    s_nop 0
    buffer_load_dwordx4 v208, s[8:11], s26 offen offset:0 sc1 lds
    buffer_load_dwordx4 v208, s[8:11], s26 offen offset:1024 sc1 lds
    buffer_load_dwordx4 v208, s[8:11], s26 offen offset:2048 sc1 lds
    s_mov_b64 exec, s[98:99]
    buffer_load_dwordx4 v208, s[8:11], s26 offen offset:3072 sc1 lds
    s_mov_b64 exec, -1
    s_add_u32 s26, s26, 28672
    s_add_u32 m0, s28, 77824
    s_nop 0
    buffer_load_dwordx4 v208, s[8:11], s26 offen offset:0 sc1 lds
    buffer_load_dwordx4 v208, s[8:11], s26 offen offset:1024 sc1 lds
    buffer_load_dwordx4 v208, s[8:11], s26 offen offset:2048 sc1 lds
    s_mov_b64 exec, s[98:99]
    buffer_load_dwordx4 v208, s[8:11], s26 offen offset:3072 sc1 lds
    s_mov_b64 exec, -1
    s_add_u32 s26, s26, 28672
    s_add_u32 m0, s28, 92160
    s_nop 0
    buffer_load_dwordx4 v208, s[8:11], s26 offen offset:0 sc1 lds
    buffer_load_dwordx4 v208, s[8:11], s26 offen offset:1024 sc1 lds
    buffer_load_dwordx4 v208, s[8:11], s26 offen offset:2048 sc1 lds
    s_mov_b64 exec, s[98:99]
    buffer_load_dwordx4 v208, s[8:11], s26 offen offset:3072 sc1 lds
    s_mov_b64 exec, -1
    s_add_u32 s26, s26, 28672
    s_waitcnt vmcnt(12)
    s_add_u32 s88, s88, 1
    ds_add_u32 v246, v248
    ds_read_b32 v249, v247
    s_waitcnt lgkmcnt(0)
    v_cmp_gt_u32 vcc, s88, v249
    s_cbranch_vccnz spin_105
ok_106:
    ds_read_b128 v[56:59], v206 offset:0
    ds_read_b128 v[60:63], v206 offset:2048
    ds_read_b64_tr_b16 v[72:73], v200 offset:0
    ds_read_b64_tr_b16 v[74:75], v201 offset:0
    ds_read_b64_tr_b16 v[76:77], v202 offset:256
    ds_read_b64_tr_b16 v[78:79], v203 offset:256
    ds_read_b64_tr_b16 v[80:81], v200 offset:1024
    ds_read_b64_tr_b16 v[82:83], v201 offset:1024
    ds_read_b64_tr_b16 v[84:85], v202 offset:1280
    ds_read_b64_tr_b16 v[86:87], v203 offset:1280
    ds_read_b64_tr_b16 v[88:89], v200 offset:2048
    ds_read_b64_tr_b16 v[90:91], v201 offset:2048
    ds_read_b64_tr_b16 v[92:93], v202 offset:2304
    ds_read_b64_tr_b16 v[94:95], v203 offset:2304
    ds_read_b64_tr_b16 v[96:97], v204 offset:12288
    ds_read_b64_tr_b16 v[98:99], v205 offset:12288
    ds_read_b128 v[64:67], v207 offset:0
    ds_read_b128 v[68:71], v207 offset:2048
    ds_read_b64_tr_b16 v[100:101], v200 offset:6144
    ds_read_b64_tr_b16 v[102:103], v201 offset:6144
    ds_read_b64_tr_b16 v[104:105], v202 offset:6400
    ds_read_b64_tr_b16 v[106:107], v203 offset:6400
    ds_read_b64_tr_b16 v[108:109], v200 offset:7168
    ds_read_b64_tr_b16 v[110:111], v201 offset:7168
    ds_read_b64_tr_b16 v[112:113], v202 offset:7424
    ds_read_b64_tr_b16 v[114:115], v203 offset:7424
    ds_read_b64_tr_b16 v[116:117], v200 offset:8192
    ds_read_b64_tr_b16 v[118:119], v201 offset:8192
    ds_read_b64_tr_b16 v[120:121], v202 offset:8448
    ds_read_b64_tr_b16 v[122:123], v203 offset:8448
    ds_read_b64_tr_b16 v[124:125], v204 offset:13312
    ds_read_b64_tr_b16 v[126:127], v205 offset:13312
    s_waitcnt vmcnt(8)
    s_add_u32 s88, s88, 1
    ds_add_u32 v246, v248
    ds_read_b32 v249, v247
    s_waitcnt lgkmcnt(0)
    v_cmp_gt_u32 vcc, s88, v249
    s_cbranch_vccnz spin_107
ok_108:
    v_mfma_f32_16x16x32_bf16 v[0:3], v[72:75], v[56:59], v[0:3]
    ds_read_b128 v[128:131], v206 offset:16384
    ds_read_b128 v[132:135], v206 offset:18432
    v_mfma_f32_16x16x32_bf16 v[4:7], v[72:75], v[60:63], v[4:7]
    ds_read_b64_tr_b16 v[144:145], v200 offset:14336
    ds_read_b64_tr_b16 v[146:147], v201 offset:14336
    s_add_u32 m0, s30, 106496
    s_nop 0
    buffer_load_dwordx4 v209, s[12:15], s27 offen offset:0 lds
    v_mfma_f32_16x16x32_bf16 v[8:11], v[76:79], v[56:59], v[8:11]
    ds_read_b64_tr_b16 v[148:149], v202 offset:14592
    ds_read_b64_tr_b16 v[150:151], v203 offset:14592
    v_mfma_f32_16x16x32_bf16 v[12:15], v[76:79], v[60:63], v[12:15]
    ds_read_b64_tr_b16 v[152:153], v200 offset:15360
    ds_read_b64_tr_b16 v[154:155], v201 offset:15360
    v_mfma_f32_16x16x32_bf16 v[16:19], v[80:83], v[56:59], v[16:19]
    ds_read_b64_tr_b16 v[156:157], v202 offset:15616
    ds_read_b64_tr_b16 v[158:159], v203 offset:15616
    buffer_load_dwordx4 v210, s[12:15], s27 offen offset:1024 lds
    v_mfma_f32_16x16x32_bf16 v[20:23], v[80:83], v[60:63], v[20:23]
    ds_read_b64_tr_b16 v[160:161], v200 offset:16384
    ds_read_b64_tr_b16 v[162:163], v201 offset:16384
    v_mfma_f32_16x16x32_bf16 v[24:27], v[84:87], v[56:59], v[24:27]
    ds_read_b64_tr_b16 v[164:165], v202 offset:16640
    ds_read_b64_tr_b16 v[166:167], v203 offset:16640
    v_mfma_f32_16x16x32_bf16 v[28:31], v[84:87], v[60:63], v[28:31]
    ds_read_b64_tr_b16 v[168:169], v204 offset:26624
    ds_read_b64_tr_b16 v[170:171], v205 offset:26624
    buffer_load_dwordx4 v211, s[12:15], s27 offen offset:2048 lds
    v_mfma_f32_16x16x32_bf16 v[32:35], v[88:91], v[56:59], v[32:35]
    ds_read_b128 v[136:139], v207 offset:16384
    ds_read_b128 v[140:143], v207 offset:18432
    v_mfma_f32_16x16x32_bf16 v[36:39], v[88:91], v[60:63], v[36:39]
    ds_read_b64_tr_b16 v[172:173], v200 offset:20480
    ds_read_b64_tr_b16 v[174:175], v201 offset:20480
    v_mfma_f32_16x16x32_bf16 v[40:43], v[92:95], v[56:59], v[40:43]
    ds_read_b64_tr_b16 v[176:177], v202 offset:20736
    ds_read_b64_tr_b16 v[178:179], v203 offset:20736
    buffer_load_dwordx4 v212, s[12:15], s27 offen offset:3072 lds
    s_add_u32 s27, s27, 128
    v_mfma_f32_16x16x32_bf16 v[44:47], v[92:95], v[60:63], v[44:47]
    ds_read_b64_tr_b16 v[180:181], v200 offset:21504
    ds_read_b64_tr_b16 v[182:183], v201 offset:21504
    v_mfma_f32_16x16x32_bf16 v[48:51], v[96:99], v[56:59], v[48:51]
    ds_read_b64_tr_b16 v[184:185], v202 offset:21760
    ds_read_b64_tr_b16 v[186:187], v203 offset:21760
    v_mfma_f32_16x16x32_bf16 v[52:55], v[96:99], v[60:63], v[52:55]
    ds_read_b64_tr_b16 v[188:189], v200 offset:22528
    ds_read_b64_tr_b16 v[190:191], v201 offset:22528
    s_add_u32 m0, s28, 49152
    s_nop 0
    buffer_load_dwordx4 v208, s[8:11], s26 offen offset:0 sc1 lds
    v_mfma_f32_16x16x32_bf16 v[0:3], v[100:103], v[64:67], v[0:3]
    ds_read_b64_tr_b16 v[192:193], v202 offset:22784
    ds_read_b64_tr_b16 v[194:195], v203 offset:22784
    v_mfma_f32_16x16x32_bf16 v[4:7], v[100:103], v[68:71], v[4:7]
    ds_read_b64_tr_b16 v[196:197], v204 offset:27648
    ds_read_b64_tr_b16 v[198:199], v205 offset:27648
    s_waitcnt vmcnt(9)
    s_add_u32 s88, s88, 1
    ds_add_u32 v246, v248
    v_mfma_f32_16x16x32_bf16 v[8:11], v[104:107], v[64:67], v[8:11]
    buffer_load_dwordx4 v208, s[8:11], s26 offen offset:1024 sc1 lds
    v_mfma_f32_16x16x32_bf16 v[12:15], v[104:107], v[68:71], v[12:15]
    v_mfma_f32_16x16x32_bf16 v[16:19], v[108:111], v[64:67], v[16:19]
    v_mfma_f32_16x16x32_bf16 v[20:23], v[108:111], v[68:71], v[20:23]
    buffer_load_dwordx4 v208, s[8:11], s26 offen offset:2048 sc1 lds
    v_mfma_f32_16x16x32_bf16 v[24:27], v[112:115], v[64:67], v[24:27]
    v_mfma_f32_16x16x32_bf16 v[28:31], v[112:115], v[68:71], v[28:31]
    v_mfma_f32_16x16x32_bf16 v[32:35], v[116:119], v[64:67], v[32:35]
    s_mov_b64 exec, s[98:99]
    buffer_load_dwordx4 v208, s[8:11], s26 offen offset:3072 sc1 lds
    s_mov_b64 exec, -1
    s_add_u32 s26, s26, 28672
    v_mfma_f32_16x16x32_bf16 v[36:39], v[116:119], v[68:71], v[36:39]
    ds_read_b32 v249, v247
    v_mfma_f32_16x16x32_bf16 v[40:43], v[120:123], v[64:67], v[40:43]
    v_mfma_f32_16x16x32_bf16 v[44:47], v[120:123], v[68:71], v[44:47]
    v_mfma_f32_16x16x32_bf16 v[48:51], v[124:127], v[64:67], v[48:51]
    v_mfma_f32_16x16x32_bf16 v[52:55], v[124:127], v[68:71], v[52:55]
    s_waitcnt lgkmcnt(0)
    v_cmp_gt_u32 vcc, s88, v249
    s_cbranch_vccnz spin_109
ok_110:
    v_mfma_f32_16x16x32_bf16 v[0:3], v[144:147], v[128:131], v[0:3]
    ds_read_b128 v[56:59], v206 offset:32768
    ds_read_b128 v[60:63], v206 offset:34816
    v_mfma_f32_16x16x32_bf16 v[4:7], v[144:147], v[132:135], v[4:7]
    ds_read_b64_tr_b16 v[72:73], v200 offset:28672
    ds_read_b64_tr_b16 v[74:75], v201 offset:28672
    s_add_u32 m0, s30, 122880
    s_nop 0
    buffer_load_dwordx4 v209, s[12:15], s27 offen offset:0 lds
    v_mfma_f32_16x16x32_bf16 v[8:11], v[148:151], v[128:131], v[8:11]
    ds_read_b64_tr_b16 v[76:77], v202 offset:28928
    ds_read_b64_tr_b16 v[78:79], v203 offset:28928
    v_mfma_f32_16x16x32_bf16 v[12:15], v[148:151], v[132:135], v[12:15]
    ds_read_b64_tr_b16 v[80:81], v200 offset:29696
    ds_read_b64_tr_b16 v[82:83], v201 offset:29696
    v_mfma_f32_16x16x32_bf16 v[16:19], v[152:155], v[128:131], v[16:19]
    ds_read_b64_tr_b16 v[84:85], v202 offset:29952
    ds_read_b64_tr_b16 v[86:87], v203 offset:29952
    buffer_load_dwordx4 v210, s[12:15], s27 offen offset:1024 lds
    v_mfma_f32_16x16x32_bf16 v[20:23], v[152:155], v[132:135], v[20:23]
    ds_read_b64_tr_b16 v[88:89], v200 offset:30720
    ds_read_b64_tr_b16 v[90:91], v201 offset:30720
    v_mfma_f32_16x16x32_bf16 v[24:27], v[156:159], v[128:131], v[24:27]
    ds_read_b64_tr_b16 v[92:93], v202 offset:30976
    ds_read_b64_tr_b16 v[94:95], v203 offset:30976
    v_mfma_f32_16x16x32_bf16 v[28:31], v[156:159], v[132:135], v[28:31]
    ds_read_b64_tr_b16 v[96:97], v204 offset:40960
    ds_read_b64_tr_b16 v[98:99], v205 offset:40960
    buffer_load_dwordx4 v211, s[12:15], s27 offen offset:2048 lds
    v_mfma_f32_16x16x32_bf16 v[32:35], v[160:163], v[128:131], v[32:35]
    ds_read_b128 v[64:67], v207 offset:32768
    ds_read_b128 v[68:71], v207 offset:34816
    v_mfma_f32_16x16x32_bf16 v[36:39], v[160:163], v[132:135], v[36:39]
    ds_read_b64_tr_b16 v[100:101], v200 offset:34816
    ds_read_b64_tr_b16 v[102:103], v201 offset:34816
    v_mfma_f32_16x16x32_bf16 v[40:43], v[164:167], v[128:131], v[40:43]
    ds_read_b64_tr_b16 v[104:105], v202 offset:35072
    ds_read_b64_tr_b16 v[106:107], v203 offset:35072
    buffer_load_dwordx4 v212, s[12:15], s27 offen offset:3072 lds
    s_add_u32 s27, s27, 128
    v_mfma_f32_16x16x32_bf16 v[44:47], v[164:167], v[132:135], v[44:47]
    ds_read_b64_tr_b16 v[108:109], v200 offset:35840
    ds_read_b64_tr_b16 v[110:111], v201 offset:35840
    v_mfma_f32_16x16x32_bf16 v[48:51], v[168:171], v[128:131], v[48:51]
    ds_read_b64_tr_b16 v[112:113], v202 offset:36096
    ds_read_b64_tr_b16 v[114:115], v203 offset:36096
    v_mfma_f32_16x16x32_bf16 v[52:55], v[168:171], v[132:135], v[52:55]
    ds_read_b64_tr_b16 v[116:117], v200 offset:36864
    ds_read_b64_tr_b16 v[118:119], v201 offset:36864
    s_add_u32 m0, s28, 63488
    s_nop 0
    buffer_load_dwordx4 v208, s[8:11], s26 offen offset:0 sc1 lds
    v_mfma_f32_16x16x32_bf16 v[0:3], v[172:175], v[136:139], v[0:3]
    ds_read_b64_tr_b16 v[120:121], v202 offset:37120
    ds_read_b64_tr_b16 v[122:123], v203 offset:37120
    v_mfma_f32_16x16x32_bf16 v[4:7], v[172:175], v[140:143], v[4:7]
    ds_read_b64_tr_b16 v[124:125], v204 offset:41984
    ds_read_b64_tr_b16 v[126:127], v205 offset:41984
    s_waitcnt vmcnt(13)
    s_add_u32 s88, s88, 1
    ds_add_u32 v246, v248
    v_mfma_f32_16x16x32_bf16 v[8:11], v[176:179], v[136:139], v[8:11]
    buffer_load_dwordx4 v208, s[8:11], s26 offen offset:1024 sc1 lds
    v_mfma_f32_16x16x32_bf16 v[12:15], v[176:179], v[140:143], v[12:15]
    v_mfma_f32_16x16x32_bf16 v[16:19], v[180:183], v[136:139], v[16:19]
    v_mfma_f32_16x16x32_bf16 v[20:23], v[180:183], v[140:143], v[20:23]
    buffer_load_dwordx4 v208, s[8:11], s26 offen offset:2048 sc1 lds
    v_mfma_f32_16x16x32_bf16 v[24:27], v[184:187], v[136:139], v[24:27]
    v_mfma_f32_16x16x32_bf16 v[28:31], v[184:187], v[140:143], v[28:31]
    v_mfma_f32_16x16x32_bf16 v[32:35], v[188:191], v[136:139], v[32:35]
    s_mov_b64 exec, s[98:99]
    buffer_load_dwordx4 v208, s[8:11], s26 offen offset:3072 sc1 lds
    s_mov_b64 exec, -1
    s_add_u32 s26, s26, 28672
    v_mfma_f32_16x16x32_bf16 v[36:39], v[188:191], v[140:143], v[36:39]
    ds_read_b32 v249, v247
    v_mfma_f32_16x16x32_bf16 v[40:43], v[192:195], v[136:139], v[40:43]
    v_mfma_f32_16x16x32_bf16 v[44:47], v[192:195], v[140:143], v[44:47]
    v_mfma_f32_16x16x32_bf16 v[48:51], v[196:199], v[136:139], v[48:51]
    v_mfma_f32_16x16x32_bf16 v[52:55], v[196:199], v[140:143], v[52:55]
    s_mov_b32 s29, 2
.p2align 3
sp_111:
    s_waitcnt vmcnt(12)
    s_waitcnt lgkmcnt(0)
    v_cmp_gt_u32 vcc, s88, v249
    s_cbranch_vccnz spin_112
ok_113:
    v_mfma_f32_16x16x32_bf16 v[0:3], v[72:75], v[56:59], v[0:3]
    ds_read_b128 v[128:131], v206 offset:0
    ds_read_b128 v[132:135], v206 offset:2048
    v_mfma_f32_16x16x32_bf16 v[4:7], v[72:75], v[60:63], v[4:7]
    ds_read_b64_tr_b16 v[144:145], v200 offset:43008
    ds_read_b64_tr_b16 v[146:147], v201 offset:43008
    s_add_u32 m0, s30, 139264
    s_nop 0
    buffer_load_dwordx4 v209, s[12:15], s27 offen offset:0 lds
    v_mfma_f32_16x16x32_bf16 v[8:11], v[76:79], v[56:59], v[8:11]
    ds_read_b64_tr_b16 v[148:149], v202 offset:43264
    ds_read_b64_tr_b16 v[150:151], v203 offset:43264
    v_mfma_f32_16x16x32_bf16 v[12:15], v[76:79], v[60:63], v[12:15]
    ds_read_b64_tr_b16 v[152:153], v200 offset:44032
    ds_read_b64_tr_b16 v[154:155], v201 offset:44032
    v_mfma_f32_16x16x32_bf16 v[16:19], v[80:83], v[56:59], v[16:19]
    ds_read_b64_tr_b16 v[156:157], v202 offset:44288
    ds_read_b64_tr_b16 v[158:159], v203 offset:44288
    buffer_load_dwordx4 v210, s[12:15], s27 offen offset:1024 lds
    v_mfma_f32_16x16x32_bf16 v[20:23], v[80:83], v[60:63], v[20:23]
    ds_read_b64_tr_b16 v[160:161], v200 offset:45056
    ds_read_b64_tr_b16 v[162:163], v201 offset:45056
    v_mfma_f32_16x16x32_bf16 v[24:27], v[84:87], v[56:59], v[24:27]
    ds_read_b64_tr_b16 v[164:165], v202 offset:45312
    ds_read_b64_tr_b16 v[166:167], v203 offset:45312
    v_mfma_f32_16x16x32_bf16 v[28:31], v[84:87], v[60:63], v[28:31]
    ds_read_b64_tr_b16 v[168:169], v204 offset:55296
    ds_read_b64_tr_b16 v[170:171], v205 offset:55296
    buffer_load_dwordx4 v211, s[12:15], s27 offen offset:2048 lds
    v_mfma_f32_16x16x32_bf16 v[32:35], v[88:91], v[56:59], v[32:35]
    ds_read_b128 v[136:139], v207 offset:0
    ds_read_b128 v[140:143], v207 offset:2048
    v_mfma_f32_16x16x32_bf16 v[36:39], v[88:91], v[60:63], v[36:39]
    ds_read_b64_tr_b16 v[172:173], v200 offset:49152
    ds_read_b64_tr_b16 v[174:175], v201 offset:49152
    v_mfma_f32_16x16x32_bf16 v[40:43], v[92:95], v[56:59], v[40:43]
    ds_read_b64_tr_b16 v[176:177], v202 offset:49408
    ds_read_b64_tr_b16 v[178:179], v203 offset:49408
    buffer_load_dwordx4 v212, s[12:15], s27 offen offset:3072 lds
    s_add_u32 s27, s27, 128
    v_mfma_f32_16x16x32_bf16 v[44:47], v[92:95], v[60:63], v[44:47]
    ds_read_b64_tr_b16 v[180:181], v200 offset:50176
    ds_read_b64_tr_b16 v[182:183], v201 offset:50176
    v_mfma_f32_16x16x32_bf16 v[48:51], v[96:99], v[56:59], v[48:51]
    ds_read_b64_tr_b16 v[184:185], v202 offset:50432
    ds_read_b64_tr_b16 v[186:187], v203 offset:50432
    v_mfma_f32_16x16x32_bf16 v[52:55], v[96:99], v[60:63], v[52:55]
    ds_read_b64_tr_b16 v[188:189], v200 offset:51200
    ds_read_b64_tr_b16 v[190:191], v201 offset:51200
    s_add_u32 m0, s28, 77824
    s_nop 0
    buffer_load_dwordx4 v208, s[8:11], s26 offen offset:0 sc1 lds
    v_mfma_f32_16x16x32_bf16 v[0:3], v[100:103], v[64:67], v[0:3]
    ds_read_b64_tr_b16 v[192:193], v202 offset:51456
    ds_read_b64_tr_b16 v[194:195], v203 offset:51456
    v_mfma_f32_16x16x32_bf16 v[4:7], v[100:103], v[68:71], v[4:7]
    ds_read_b64_tr_b16 v[196:197], v204 offset:56320
    ds_read_b64_tr_b16 v[198:199], v205 offset:56320
    s_waitcnt vmcnt(13)
    s_add_u32 s88, s88, 1
    ds_add_u32 v246, v248
    v_mfma_f32_16x16x32_bf16 v[8:11], v[104:107], v[64:67], v[8:11]
    buffer_load_dwordx4 v208, s[8:11], s26 offen offset:1024 sc1 lds
    v_mfma_f32_16x16x32_bf16 v[12:15], v[104:107], v[68:71], v[12:15]
    v_mfma_f32_16x16x32_bf16 v[16:19], v[108:111], v[64:67], v[16:19]
    v_mfma_f32_16x16x32_bf16 v[20:23], v[108:111], v[68:71], v[20:23]
    buffer_load_dwordx4 v208, s[8:11], s26 offen offset:2048 sc1 lds
    v_mfma_f32_16x16x32_bf16 v[24:27], v[112:115], v[64:67], v[24:27]
    v_mfma_f32_16x16x32_bf16 v[28:31], v[112:115], v[68:71], v[28:31]
    v_mfma_f32_16x16x32_bf16 v[32:35], v[116:119], v[64:67], v[32:35]
    s_mov_b64 exec, s[98:99]
    buffer_load_dwordx4 v208, s[8:11], s26 offen offset:3072 sc1 lds
    s_mov_b64 exec, -1
    s_add_u32 s26, s26, 28672
    v_mfma_f32_16x16x32_bf16 v[36:39], v[116:119], v[68:71], v[36:39]
    ds_read_b32 v249, v247
    v_mfma_f32_16x16x32_bf16 v[40:43], v[120:123], v[64:67], v[40:43]
    v_mfma_f32_16x16x32_bf16 v[44:47], v[120:123], v[68:71], v[44:47]
    v_mfma_f32_16x16x32_bf16 v[48:51], v[124:127], v[64:67], v[48:51]
    v_mfma_f32_16x16x32_bf16 v[52:55], v[124:127], v[68:71], v[52:55]
    s_waitcnt vmcnt(12)
    s_waitcnt lgkmcnt(0)
    v_cmp_gt_u32 vcc, s88, v249
    s_cbranch_vccnz spin_114
ok_115:
    v_mfma_f32_16x16x32_bf16 v[0:3], v[144:147], v[128:131], v[0:3]
    ds_read_b128 v[56:59], v206 offset:16384
    ds_read_b128 v[60:63], v206 offset:18432
    v_mfma_f32_16x16x32_bf16 v[4:7], v[144:147], v[132:135], v[4:7]
    ds_read_b64_tr_b16 v[72:73], v200 offset:0
    ds_read_b64_tr_b16 v[74:75], v201 offset:0
    s_add_u32 m0, s30, 106496
    s_nop 0
    buffer_load_dwordx4 v209, s[12:15], s27 offen offset:0 lds
    v_mfma_f32_16x16x32_bf16 v[8:11], v[148:151], v[128:131], v[8:11]
    ds_read_b64_tr_b16 v[76:77], v202 offset:256
    ds_read_b64_tr_b16 v[78:79], v203 offset:256
    v_mfma_f32_16x16x32_bf16 v[12:15], v[148:151], v[132:135], v[12:15]
    ds_read_b64_tr_b16 v[80:81], v200 offset:1024
    ds_read_b64_tr_b16 v[82:83], v201 offset:1024
    v_mfma_f32_16x16x32_bf16 v[16:19], v[152:155], v[128:131], v[16:19]
    ds_read_b64_tr_b16 v[84:85], v202 offset:1280
    ds_read_b64_tr_b16 v[86:87], v203 offset:1280
    buffer_load_dwordx4 v210, s[12:15], s27 offen offset:1024 lds
    v_mfma_f32_16x16x32_bf16 v[20:23], v[152:155], v[132:135], v[20:23]
    ds_read_b64_tr_b16 v[88:89], v200 offset:2048
    ds_read_b64_tr_b16 v[90:91], v201 offset:2048
    v_mfma_f32_16x16x32_bf16 v[24:27], v[156:159], v[128:131], v[24:27]
    ds_read_b64_tr_b16 v[92:93], v202 offset:2304
    ds_read_b64_tr_b16 v[94:95], v203 offset:2304
    v_mfma_f32_16x16x32_bf16 v[28:31], v[156:159], v[132:135], v[28:31]
    ds_read_b64_tr_b16 v[96:97], v204 offset:12288
    ds_read_b64_tr_b16 v[98:99], v205 offset:12288
    buffer_load_dwordx4 v211, s[12:15], s27 offen offset:2048 lds
    v_mfma_f32_16x16x32_bf16 v[32:35], v[160:163], v[128:131], v[32:35]
    ds_read_b128 v[64:67], v207 offset:16384
    ds_read_b128 v[68:71], v207 offset:18432
    v_mfma_f32_16x16x32_bf16 v[36:39], v[160:163], v[132:135], v[36:39]
    ds_read_b64_tr_b16 v[100:101], v200 offset:6144
    ds_read_b64_tr_b16 v[102:103], v201 offset:6144
    v_mfma_f32_16x16x32_bf16 v[40:43], v[164:167], v[128:131], v[40:43]
    ds_read_b64_tr_b16 v[104:105], v202 offset:6400
    ds_read_b64_tr_b16 v[106:107], v203 offset:6400
    buffer_load_dwordx4 v212, s[12:15], s27 offen offset:3072 lds
    s_add_u32 s27, s27, 128
    v_mfma_f32_16x16x32_bf16 v[44:47], v[164:167], v[132:135], v[44:47]
    ds_read_b64_tr_b16 v[108:109], v200 offset:7168
    ds_read_b64_tr_b16 v[110:111], v201 offset:7168
    v_mfma_f32_16x16x32_bf16 v[48:51], v[168:171], v[128:131], v[48:51]
    ds_read_b64_tr_b16 v[112:113], v202 offset:7424
    ds_read_b64_tr_b16 v[114:115], v203 offset:7424
    v_mfma_f32_16x16x32_bf16 v[52:55], v[168:171], v[132:135], v[52:55]
    ds_read_b64_tr_b16 v[116:117], v200 offset:8192
    ds_read_b64_tr_b16 v[118:119], v201 offset:8192
    s_add_u32 m0, s28, 92160
    s_nop 0
    buffer_load_dwordx4 v208, s[8:11], s26 offen offset:0 sc1 lds
    v_mfma_f32_16x16x32_bf16 v[0:3], v[172:175], v[136:139], v[0:3]
    ds_read_b64_tr_b16 v[120:121], v202 offset:8448
    ds_read_b64_tr_b16 v[122:123], v203 offset:8448
    v_mfma_f32_16x16x32_bf16 v[4:7], v[172:175], v[140:143], v[4:7]
    ds_read_b64_tr_b16 v[124:125], v204 offset:13312
    ds_read_b64_tr_b16 v[126:127], v205 offset:13312
    s_waitcnt vmcnt(13)
    s_add_u32 s88, s88, 1
    ds_add_u32 v246, v248
    v_mfma_f32_16x16x32_bf16 v[8:11], v[176:179], v[136:139], v[8:11]
    buffer_load_dwordx4 v208, s[8:11], s26 offen offset:1024 sc1 lds
    v_mfma_f32_16x16x32_bf16 v[12:15], v[176:179], v[140:143], v[12:15]
    v_mfma_f32_16x16x32_bf16 v[16:19], v[180:183], v[136:139], v[16:19]
    v_mfma_f32_16x16x32_bf16 v[20:23], v[180:183], v[140:143], v[20:23]
    buffer_load_dwordx4 v208, s[8:11], s26 offen offset:2048 sc1 lds
    v_mfma_f32_16x16x32_bf16 v[24:27], v[184:187], v[136:139], v[24:27]
    v_mfma_f32_16x16x32_bf16 v[28:31], v[184:187], v[140:143], v[28:31]
    v_mfma_f32_16x16x32_bf16 v[32:35], v[188:191], v[136:139], v[32:35]
    s_mov_b64 exec, s[98:99]
    buffer_load_dwordx4 v208, s[8:11], s26 offen offset:3072 sc1 lds
    s_mov_b64 exec, -1
    s_add_u32 s26, s26, 28672
    v_mfma_f32_16x16x32_bf16 v[36:39], v[188:191], v[140:143], v[36:39]
    ds_read_b32 v249, v247
    v_mfma_f32_16x16x32_bf16 v[40:43], v[192:195], v[136:139], v[40:43]
    v_mfma_f32_16x16x32_bf16 v[44:47], v[192:195], v[140:143], v[44:47]
    v_mfma_f32_16x16x32_bf16 v[48:51], v[196:199], v[136:139], v[48:51]
    v_mfma_f32_16x16x32_bf16 v[52:55], v[196:199], v[140:143], v[52:55]
    s_waitcnt vmcnt(12)
    s_waitcnt lgkmcnt(0)
    v_cmp_gt_u32 vcc, s88, v249
    s_cbranch_vccnz spin_116
ok_117:
    v_mfma_f32_16x16x32_bf16 v[0:3], v[72:75], v[56:59], v[0:3]
    ds_read_b128 v[128:131], v206 offset:32768
    ds_read_b128 v[132:135], v206 offset:34816
    v_mfma_f32_16x16x32_bf16 v[4:7], v[72:75], v[60:63], v[4:7]
    ds_read_b64_tr_b16 v[144:145], v200 offset:14336
    ds_read_b64_tr_b16 v[146:147], v201 offset:14336
    s_add_u32 m0, s30, 122880
    s_nop 0
    buffer_load_dwordx4 v209, s[12:15], s27 offen offset:0 lds
    v_mfma_f32_16x16x32_bf16 v[8:11], v[76:79], v[56:59], v[8:11]
    ds_read_b64_tr_b16 v[148:149], v202 offset:14592
    ds_read_b64_tr_b16 v[150:151], v203 offset:14592
    v_mfma_f32_16x16x32_bf16 v[12:15], v[76:79], v[60:63], v[12:15]
    ds_read_b64_tr_b16 v[152:153], v200 offset:15360
    ds_read_b64_tr_b16 v[154:155], v201 offset:15360
    v_mfma_f32_16x16x32_bf16 v[16:19], v[80:83], v[56:59], v[16:19]
    ds_read_b64_tr_b16 v[156:157], v202 offset:15616
    ds_read_b64_tr_b16 v[158:159], v203 offset:15616
    buffer_load_dwordx4 v210, s[12:15], s27 offen offset:1024 lds
    v_mfma_f32_16x16x32_bf16 v[20:23], v[80:83], v[60:63], v[20:23]
    ds_read_b64_tr_b16 v[160:161], v200 offset:16384
    ds_read_b64_tr_b16 v[162:163], v201 offset:16384
    v_mfma_f32_16x16x32_bf16 v[24:27], v[84:87], v[56:59], v[24:27]
    ds_read_b64_tr_b16 v[164:165], v202 offset:16640
    ds_read_b64_tr_b16 v[166:167], v203 offset:16640
    v_mfma_f32_16x16x32_bf16 v[28:31], v[84:87], v[60:63], v[28:31]
    ds_read_b64_tr_b16 v[168:169], v204 offset:26624
    ds_read_b64_tr_b16 v[170:171], v205 offset:26624
    buffer_load_dwordx4 v211, s[12:15], s27 offen offset:2048 lds
    v_mfma_f32_16x16x32_bf16 v[32:35], v[88:91], v[56:59], v[32:35]
    ds_read_b128 v[136:139], v207 offset:32768
    ds_read_b128 v[140:143], v207 offset:34816
    v_mfma_f32_16x16x32_bf16 v[36:39], v[88:91], v[60:63], v[36:39]
    ds_read_b64_tr_b16 v[172:173], v200 offset:20480
    ds_read_b64_tr_b16 v[174:175], v201 offset:20480
    v_mfma_f32_16x16x32_bf16 v[40:43], v[92:95], v[56:59], v[40:43]
    ds_read_b64_tr_b16 v[176:177], v202 offset:20736
    ds_read_b64_tr_b16 v[178:179], v203 offset:20736
    buffer_load_dwordx4 v212, s[12:15], s27 offen offset:3072 lds
    s_add_u32 s27, s27, 128
    v_mfma_f32_16x16x32_bf16 v[44:47], v[92:95], v[60:63], v[44:47]
    ds_read_b64_tr_b16 v[180:181], v200 offset:21504
    ds_read_b64_tr_b16 v[182:183], v201 offset:21504
    v_mfma_f32_16x16x32_bf16 v[48:51], v[96:99], v[56:59], v[48:51]
    ds_read_b64_tr_b16 v[184:185], v202 offset:21760
    ds_read_b64_tr_b16 v[186:187], v203 offset:21760
    v_mfma_f32_16x16x32_bf16 v[52:55], v[96:99], v[60:63], v[52:55]
    ds_read_b64_tr_b16 v[188:189], v200 offset:22528
    ds_read_b64_tr_b16 v[190:191], v201 offset:22528
    s_add_u32 m0, s28, 49152
    s_nop 0
    buffer_load_dwordx4 v208, s[8:11], s26 offen offset:0 sc1 lds
    v_mfma_f32_16x16x32_bf16 v[0:3], v[100:103], v[64:67], v[0:3]
    ds_read_b64_tr_b16 v[192:193], v202 offset:22784
    ds_read_b64_tr_b16 v[194:195], v203 offset:22784
    v_mfma_f32_16x16x32_bf16 v[4:7], v[100:103], v[68:71], v[4:7]
    ds_read_b64_tr_b16 v[196:197], v204 offset:27648
    ds_read_b64_tr_b16 v[198:199], v205 offset:27648
    s_waitcnt vmcnt(13)
    s_add_u32 s88, s88, 1
    ds_add_u32 v246, v248
    v_mfma_f32_16x16x32_bf16 v[8:11], v[104:107], v[64:67], v[8:11]
    buffer_load_dwordx4 v208, s[8:11], s26 offen offset:1024 sc1 lds
    v_mfma_f32_16x16x32_bf16 v[12:15], v[104:107], v[68:71], v[12:15]
    v_mfma_f32_16x16x32_bf16 v[16:19], v[108:111], v[64:67], v[16:19]
    v_mfma_f32_16x16x32_bf16 v[20:23], v[108:111], v[68:71], v[20:23]
    buffer_load_dwordx4 v208, s[8:11], s26 offen offset:2048 sc1 lds
    v_mfma_f32_16x16x32_bf16 v[24:27], v[112:115], v[64:67], v[24:27]
    v_mfma_f32_16x16x32_bf16 v[28:31], v[112:115], v[68:71], v[28:31]
    v_mfma_f32_16x16x32_bf16 v[32:35], v[116:119], v[64:67], v[32:35]
    s_mov_b64 exec, s[98:99]
    buffer_load_dwordx4 v208, s[8:11], s26 offen offset:3072 sc1 lds
    s_mov_b64 exec, -1
    s_add_u32 s26, s26, 28672
    v_mfma_f32_16x16x32_bf16 v[36:39], v[116:119], v[68:71], v[36:39]
    ds_read_b32 v249, v247
    v_mfma_f32_16x16x32_bf16 v[40:43], v[120:123], v[64:67], v[40:43]
    v_mfma_f32_16x16x32_bf16 v[44:47], v[120:123], v[68:71], v[44:47]
    v_mfma_f32_16x16x32_bf16 v[48:51], v[124:127], v[64:67], v[48:51]
    v_mfma_f32_16x16x32_bf16 v[52:55], v[124:127], v[68:71], v[52:55]
    s_waitcnt vmcnt(12)
    s_waitcnt lgkmcnt(0)
    v_cmp_gt_u32 vcc, s88, v249
    s_cbranch_vccnz spin_118
ok_119:
    v_mfma_f32_16x16x32_bf16 v[0:3], v[144:147], v[128:131], v[0:3]
    ds_read_b128 v[56:59], v206 offset:0
    ds_read_b128 v[60:63], v206 offset:2048
    v_mfma_f32_16x16x32_bf16 v[4:7], v[144:147], v[132:135], v[4:7]
    ds_read_b64_tr_b16 v[72:73], v200 offset:28672
    ds_read_b64_tr_b16 v[74:75], v201 offset:28672
    s_add_u32 m0, s30, 139264
    s_nop 0
    buffer_load_dwordx4 v209, s[12:15], s27 offen offset:0 lds
    v_mfma_f32_16x16x32_bf16 v[8:11], v[148:151], v[128:131], v[8:11]
    ds_read_b64_tr_b16 v[76:77], v202 offset:28928
    ds_read_b64_tr_b16 v[78:79], v203 offset:28928
    v_mfma_f32_16x16x32_bf16 v[12:15], v[148:151], v[132:135], v[12:15]
    ds_read_b64_tr_b16 v[80:81], v200 offset:29696
    ds_read_b64_tr_b16 v[82:83], v201 offset:29696
    v_mfma_f32_16x16x32_bf16 v[16:19], v[152:155], v[128:131], v[16:19]
    ds_read_b64_tr_b16 v[84:85], v202 offset:29952
    ds_read_b64_tr_b16 v[86:87], v203 offset:29952
    buffer_load_dwordx4 v210, s[12:15], s27 offen offset:1024 lds
    v_mfma_f32_16x16x32_bf16 v[20:23], v[152:155], v[132:135], v[20:23]
    ds_read_b64_tr_b16 v[88:89], v200 offset:30720
    ds_read_b64_tr_b16 v[90:91], v201 offset:30720
    v_mfma_f32_16x16x32_bf16 v[24:27], v[156:159], v[128:131], v[24:27]
    ds_read_b64_tr_b16 v[92:93], v202 offset:30976
    ds_read_b64_tr_b16 v[94:95], v203 offset:30976
    v_mfma_f32_16x16x32_bf16 v[28:31], v[156:159], v[132:135], v[28:31]
    ds_read_b64_tr_b16 v[96:97], v204 offset:40960
    ds_read_b64_tr_b16 v[98:99], v205 offset:40960
    buffer_load_dwordx4 v211, s[12:15], s27 offen offset:2048 lds
    v_mfma_f32_16x16x32_bf16 v[32:35], v[160:163], v[128:131], v[32:35]
    ds_read_b128 v[64:67], v207 offset:0
    ds_read_b128 v[68:71], v207 offset:2048
    v_mfma_f32_16x16x32_bf16 v[36:39], v[160:163], v[132:135], v[36:39]
    ds_read_b64_tr_b16 v[100:101], v200 offset:34816
    ds_read_b64_tr_b16 v[102:103], v201 offset:34816
    v_mfma_f32_16x16x32_bf16 v[40:43], v[164:167], v[128:131], v[40:43]
    ds_read_b64_tr_b16 v[104:105], v202 offset:35072
    ds_read_b64_tr_b16 v[106:107], v203 offset:35072
    buffer_load_dwordx4 v212, s[12:15], s27 offen offset:3072 lds
    s_add_u32 s27, s27, 128
    v_mfma_f32_16x16x32_bf16 v[44:47], v[164:167], v[132:135], v[44:47]
    ds_read_b64_tr_b16 v[108:109], v200 offset:35840
    ds_read_b64_tr_b16 v[110:111], v201 offset:35840
    v_mfma_f32_16x16x32_bf16 v[48:51], v[168:171], v[128:131], v[48:51]
    ds_read_b64_tr_b16 v[112:113], v202 offset:36096
    ds_read_b64_tr_b16 v[114:115], v203 offset:36096
    v_mfma_f32_16x16x32_bf16 v[52:55], v[168:171], v[132:135], v[52:55]
    ds_read_b64_tr_b16 v[116:117], v200 offset:36864
    ds_read_b64_tr_b16 v[118:119], v201 offset:36864
    s_add_u32 m0, s28, 63488
    s_nop 0
    buffer_load_dwordx4 v208, s[8:11], s26 offen offset:0 sc1 lds
    v_mfma_f32_16x16x32_bf16 v[0:3], v[172:175], v[136:139], v[0:3]
    ds_read_b64_tr_b16 v[120:121], v202 offset:37120
    ds_read_b64_tr_b16 v[122:123], v203 offset:37120
    v_mfma_f32_16x16x32_bf16 v[4:7], v[172:175], v[140:143], v[4:7]
    ds_read_b64_tr_b16 v[124:125], v204 offset:41984
    ds_read_b64_tr_b16 v[126:127], v205 offset:41984
    s_waitcnt vmcnt(13)
    s_add_u32 s88, s88, 1
    ds_add_u32 v246, v248
    v_mfma_f32_16x16x32_bf16 v[8:11], v[176:179], v[136:139], v[8:11]
    buffer_load_dwordx4 v208, s[8:11], s26 offen offset:1024 sc1 lds
    v_mfma_f32_16x16x32_bf16 v[12:15], v[176:179], v[140:143], v[12:15]
    v_mfma_f32_16x16x32_bf16 v[16:19], v[180:183], v[136:139], v[16:19]
    v_mfma_f32_16x16x32_bf16 v[20:23], v[180:183], v[140:143], v[20:23]
    buffer_load_dwordx4 v208, s[8:11], s26 offen offset:2048 sc1 lds
    v_mfma_f32_16x16x32_bf16 v[24:27], v[184:187], v[136:139], v[24:27]
    v_mfma_f32_16x16x32_bf16 v[28:31], v[184:187], v[140:143], v[28:31]
    v_mfma_f32_16x16x32_bf16 v[32:35], v[188:191], v[136:139], v[32:35]
    s_mov_b64 exec, s[98:99]
    buffer_load_dwordx4 v208, s[8:11], s26 offen offset:3072 sc1 lds
    s_mov_b64 exec, -1
    s_add_u32 s26, s26, 28672
    v_mfma_f32_16x16x32_bf16 v[36:39], v[188:191], v[140:143], v[36:39]
    ds_read_b32 v249, v247
    v_mfma_f32_16x16x32_bf16 v[40:43], v[192:195], v[136:139], v[40:43]
    v_mfma_f32_16x16x32_bf16 v[44:47], v[192:195], v[140:143], v[44:47]
    v_mfma_f32_16x16x32_bf16 v[48:51], v[196:199], v[136:139], v[48:51]
    v_mfma_f32_16x16x32_bf16 v[52:55], v[196:199], v[140:143], v[52:55]
    s_waitcnt vmcnt(12)
    s_waitcnt lgkmcnt(0)
    v_cmp_gt_u32 vcc, s88, v249
    s_cbranch_vccnz spin_120
ok_121:
    v_mfma_f32_16x16x32_bf16 v[0:3], v[72:75], v[56:59], v[0:3]
    ds_read_b128 v[128:131], v206 offset:16384
    ds_read_b128 v[132:135], v206 offset:18432
    v_mfma_f32_16x16x32_bf16 v[4:7], v[72:75], v[60:63], v[4:7]
    ds_read_b64_tr_b16 v[144:145], v200 offset:43008
    ds_read_b64_tr_b16 v[146:147], v201 offset:43008
    s_add_u32 m0, s30, 106496
    s_nop 0
    buffer_load_dwordx4 v209, s[12:15], s27 offen offset:0 lds
    v_mfma_f32_16x16x32_bf16 v[8:11], v[76:79], v[56:59], v[8:11]
    ds_read_b64_tr_b16 v[148:149], v202 offset:43264
    ds_read_b64_tr_b16 v[150:151], v203 offset:43264
    v_mfma_f32_16x16x32_bf16 v[12:15], v[76:79], v[60:63], v[12:15]
    ds_read_b64_tr_b16 v[152:153], v200 offset:44032
    ds_read_b64_tr_b16 v[154:155], v201 offset:44032
    v_mfma_f32_16x16x32_bf16 v[16:19], v[80:83], v[56:59], v[16:19]
    ds_read_b64_tr_b16 v[156:157], v202 offset:44288
    ds_read_b64_tr_b16 v[158:159], v203 offset:44288
    buffer_load_dwordx4 v210, s[12:15], s27 offen offset:1024 lds
    v_mfma_f32_16x16x32_bf16 v[20:23], v[80:83], v[60:63], v[20:23]
    ds_read_b64_tr_b16 v[160:161], v200 offset:45056
    ds_read_b64_tr_b16 v[162:163], v201 offset:45056
    v_mfma_f32_16x16x32_bf16 v[24:27], v[84:87], v[56:59], v[24:27]
    ds_read_b64_tr_b16 v[164:165], v202 offset:45312
    ds_read_b64_tr_b16 v[166:167], v203 offset:45312
    v_mfma_f32_16x16x32_bf16 v[28:31], v[84:87], v[60:63], v[28:31]
    ds_read_b64_tr_b16 v[168:169], v204 offset:55296
    ds_read_b64_tr_b16 v[170:171], v205 offset:55296
    buffer_load_dwordx4 v211, s[12:15], s27 offen offset:2048 lds
    v_mfma_f32_16x16x32_bf16 v[32:35], v[88:91], v[56:59], v[32:35]
    ds_read_b128 v[136:139], v207 offset:16384
    ds_read_b128 v[140:143], v207 offset:18432
    v_mfma_f32_16x16x32_bf16 v[36:39], v[88:91], v[60:63], v[36:39]
    ds_read_b64_tr_b16 v[172:173], v200 offset:49152
    ds_read_b64_tr_b16 v[174:175], v201 offset:49152
    v_mfma_f32_16x16x32_bf16 v[40:43], v[92:95], v[56:59], v[40:43]
    ds_read_b64_tr_b16 v[176:177], v202 offset:49408
    ds_read_b64_tr_b16 v[178:179], v203 offset:49408
    buffer_load_dwordx4 v212, s[12:15], s27 offen offset:3072 lds
    s_add_u32 s27, s27, 128
    v_mfma_f32_16x16x32_bf16 v[44:47], v[92:95], v[60:63], v[44:47]
    ds_read_b64_tr_b16 v[180:181], v200 offset:50176
    ds_read_b64_tr_b16 v[182:183], v201 offset:50176
    v_mfma_f32_16x16x32_bf16 v[48:51], v[96:99], v[56:59], v[48:51]
    ds_read_b64_tr_b16 v[184:185], v202 offset:50432
    ds_read_b64_tr_b16 v[186:187], v203 offset:50432
    v_mfma_f32_16x16x32_bf16 v[52:55], v[96:99], v[60:63], v[52:55]
    ds_read_b64_tr_b16 v[188:189], v200 offset:51200
    ds_read_b64_tr_b16 v[190:191], v201 offset:51200
    s_add_u32 m0, s28, 77824
    s_nop 0
    buffer_load_dwordx4 v208, s[8:11], s26 offen offset:0 sc1 lds
    v_mfma_f32_16x16x32_bf16 v[0:3], v[100:103], v[64:67], v[0:3]
    ds_read_b64_tr_b16 v[192:193], v202 offset:51456
    ds_read_b64_tr_b16 v[194:195], v203 offset:51456
    v_mfma_f32_16x16x32_bf16 v[4:7], v[100:103], v[68:71], v[4:7]
    ds_read_b64_tr_b16 v[196:197], v204 offset:56320
    ds_read_b64_tr_b16 v[198:199], v205 offset:56320
    s_waitcnt vmcnt(13)
    s_add_u32 s88, s88, 1
    ds_add_u32 v246, v248
    v_mfma_f32_16x16x32_bf16 v[8:11], v[104:107], v[64:67], v[8:11]
    buffer_load_dwordx4 v208, s[8:11], s26 offen offset:1024 sc1 lds
    v_mfma_f32_16x16x32_bf16 v[12:15], v[104:107], v[68:71], v[12:15]
    v_mfma_f32_16x16x32_bf16 v[16:19], v[108:111], v[64:67], v[16:19]
    v_mfma_f32_16x16x32_bf16 v[20:23], v[108:111], v[68:71], v[20:23]
    buffer_load_dwordx4 v208, s[8:11], s26 offen offset:2048 sc1 lds
    v_mfma_f32_16x16x32_bf16 v[24:27], v[112:115], v[64:67], v[24:27]
    v_mfma_f32_16x16x32_bf16 v[28:31], v[112:115], v[68:71], v[28:31]
    v_mfma_f32_16x16x32_bf16 v[32:35], v[116:119], v[64:67], v[32:35]
    s_mov_b64 exec, s[98:99]
    buffer_load_dwordx4 v208, s[8:11], s26 offen offset:3072 sc1 lds
    s_mov_b64 exec, -1
    s_add_u32 s26, s26, 28672
    v_mfma_f32_16x16x32_bf16 v[36:39], v[116:119], v[68:71], v[36:39]
    ds_read_b32 v249, v247
    v_mfma_f32_16x16x32_bf16 v[40:43], v[120:123], v[64:67], v[40:43]
    v_mfma_f32_16x16x32_bf16 v[44:47], v[120:123], v[68:71], v[44:47]
    v_mfma_f32_16x16x32_bf16 v[48:51], v[124:127], v[64:67], v[48:51]
    v_mfma_f32_16x16x32_bf16 v[52:55], v[124:127], v[68:71], v[52:55]
    s_waitcnt vmcnt(12)
    s_waitcnt lgkmcnt(0)
    v_cmp_gt_u32 vcc, s88, v249
    s_cbranch_vccnz spin_122
ok_123:
    v_mfma_f32_16x16x32_bf16 v[0:3], v[144:147], v[128:131], v[0:3]
    ds_read_b128 v[56:59], v206 offset:32768
    ds_read_b128 v[60:63], v206 offset:34816
    v_mfma_f32_16x16x32_bf16 v[4:7], v[144:147], v[132:135], v[4:7]
    ds_read_b64_tr_b16 v[72:73], v200 offset:0
    ds_read_b64_tr_b16 v[74:75], v201 offset:0
    s_add_u32 m0, s30, 122880
    s_nop 0
    buffer_load_dwordx4 v209, s[12:15], s27 offen offset:0 lds
    v_mfma_f32_16x16x32_bf16 v[8:11], v[148:151], v[128:131], v[8:11]
    ds_read_b64_tr_b16 v[76:77], v202 offset:256
    ds_read_b64_tr_b16 v[78:79], v203 offset:256
    v_mfma_f32_16x16x32_bf16 v[12:15], v[148:151], v[132:135], v[12:15]
    ds_read_b64_tr_b16 v[80:81], v200 offset:1024
    ds_read_b64_tr_b16 v[82:83], v201 offset:1024
    v_mfma_f32_16x16x32_bf16 v[16:19], v[152:155], v[128:131], v[16:19]
    ds_read_b64_tr_b16 v[84:85], v202 offset:1280
    ds_read_b64_tr_b16 v[86:87], v203 offset:1280
    buffer_load_dwordx4 v210, s[12:15], s27 offen offset:1024 lds
    v_mfma_f32_16x16x32_bf16 v[20:23], v[152:155], v[132:135], v[20:23]
    ds_read_b64_tr_b16 v[88:89], v200 offset:2048
    ds_read_b64_tr_b16 v[90:91], v201 offset:2048
    v_mfma_f32_16x16x32_bf16 v[24:27], v[156:159], v[128:131], v[24:27]
    ds_read_b64_tr_b16 v[92:93], v202 offset:2304
    ds_read_b64_tr_b16 v[94:95], v203 offset:2304
    v_mfma_f32_16x16x32_bf16 v[28:31], v[156:159], v[132:135], v[28:31]
    ds_read_b64_tr_b16 v[96:97], v204 offset:12288
    ds_read_b64_tr_b16 v[98:99], v205 offset:12288
    buffer_load_dwordx4 v211, s[12:15], s27 offen offset:2048 lds
    v_mfma_f32_16x16x32_bf16 v[32:35], v[160:163], v[128:131], v[32:35]
    ds_read_b128 v[64:67], v207 offset:32768
    ds_read_b128 v[68:71], v207 offset:34816
    v_mfma_f32_16x16x32_bf16 v[36:39], v[160:163], v[132:135], v[36:39]
    ds_read_b64_tr_b16 v[100:101], v200 offset:6144
    ds_read_b64_tr_b16 v[102:103], v201 offset:6144
    v_mfma_f32_16x16x32_bf16 v[40:43], v[164:167], v[128:131], v[40:43]
    ds_read_b64_tr_b16 v[104:105], v202 offset:6400
    ds_read_b64_tr_b16 v[106:107], v203 offset:6400
    buffer_load_dwordx4 v212, s[12:15], s27 offen offset:3072 lds
    s_add_u32 s27, s27, 128
    v_mfma_f32_16x16x32_bf16 v[44:47], v[164:167], v[132:135], v[44:47]
    ds_read_b64_tr_b16 v[108:109], v200 offset:7168
    ds_read_b64_tr_b16 v[110:111], v201 offset:7168
    v_mfma_f32_16x16x32_bf16 v[48:51], v[168:171], v[128:131], v[48:51]
    ds_read_b64_tr_b16 v[112:113], v202 offset:7424
    ds_read_b64_tr_b16 v[114:115], v203 offset:7424
    v_mfma_f32_16x16x32_bf16 v[52:55], v[168:171], v[132:135], v[52:55]
    ds_read_b64_tr_b16 v[116:117], v200 offset:8192
    ds_read_b64_tr_b16 v[118:119], v201 offset:8192
    s_add_u32 m0, s28, 92160
    s_nop 0
    buffer_load_dwordx4 v208, s[8:11], s26 offen offset:0 sc1 lds
    v_mfma_f32_16x16x32_bf16 v[0:3], v[172:175], v[136:139], v[0:3]
    ds_read_b64_tr_b16 v[120:121], v202 offset:8448
    ds_read_b64_tr_b16 v[122:123], v203 offset:8448
    v_mfma_f32_16x16x32_bf16 v[4:7], v[172:175], v[140:143], v[4:7]
    ds_read_b64_tr_b16 v[124:125], v204 offset:13312
    ds_read_b64_tr_b16 v[126:127], v205 offset:13312
    s_waitcnt vmcnt(13)
    s_add_u32 s88, s88, 1
    ds_add_u32 v246, v248
    v_mfma_f32_16x16x32_bf16 v[8:11], v[176:179], v[136:139], v[8:11]
    buffer_load_dwordx4 v208, s[8:11], s26 offen offset:1024 sc1 lds
    v_mfma_f32_16x16x32_bf16 v[12:15], v[176:179], v[140:143], v[12:15]
    v_mfma_f32_16x16x32_bf16 v[16:19], v[180:183], v[136:139], v[16:19]
    v_mfma_f32_16x16x32_bf16 v[20:23], v[180:183], v[140:143], v[20:23]
    buffer_load_dwordx4 v208, s[8:11], s26 offen offset:2048 sc1 lds
    v_mfma_f32_16x16x32_bf16 v[24:27], v[184:187], v[136:139], v[24:27]
    v_mfma_f32_16x16x32_bf16 v[28:31], v[184:187], v[140:143], v[28:31]
    v_mfma_f32_16x16x32_bf16 v[32:35], v[188:191], v[136:139], v[32:35]
    s_mov_b64 exec, s[98:99]
    buffer_load_dwordx4 v208, s[8:11], s26 offen offset:3072 sc1 lds
    s_mov_b64 exec, -1
    s_add_u32 s26, s26, 28672
    v_mfma_f32_16x16x32_bf16 v[36:39], v[188:191], v[140:143], v[36:39]
    ds_read_b32 v249, v247
    v_mfma_f32_16x16x32_bf16 v[40:43], v[192:195], v[136:139], v[40:43]
    v_mfma_f32_16x16x32_bf16 v[44:47], v[192:195], v[140:143], v[44:47]
    v_mfma_f32_16x16x32_bf16 v[48:51], v[196:199], v[136:139], v[48:51]
    v_mfma_f32_16x16x32_bf16 v[52:55], v[196:199], v[140:143], v[52:55]
    s_waitcnt vmcnt(12)
    s_waitcnt lgkmcnt(0)
    v_cmp_gt_u32 vcc, s88, v249
    s_cbranch_vccnz spin_124
ok_125:
    v_mfma_f32_16x16x32_bf16 v[0:3], v[72:75], v[56:59], v[0:3]
    ds_read_b128 v[128:131], v206 offset:0
    ds_read_b128 v[132:135], v206 offset:2048
    v_mfma_f32_16x16x32_bf16 v[4:7], v[72:75], v[60:63], v[4:7]
    ds_read_b64_tr_b16 v[144:145], v200 offset:14336
    ds_read_b64_tr_b16 v[146:147], v201 offset:14336
    s_add_u32 m0, s30, 139264
    s_nop 0
    buffer_load_dwordx4 v209, s[12:15], s27 offen offset:0 lds
    v_mfma_f32_16x16x32_bf16 v[8:11], v[76:79], v[56:59], v[8:11]
    ds_read_b64_tr_b16 v[148:149], v202 offset:14592
    ds_read_b64_tr_b16 v[150:151], v203 offset:14592
    v_mfma_f32_16x16x32_bf16 v[12:15], v[76:79], v[60:63], v[12:15]
    ds_read_b64_tr_b16 v[152:153], v200 offset:15360
    ds_read_b64_tr_b16 v[154:155], v201 offset:15360
    v_mfma_f32_16x16x32_bf16 v[16:19], v[80:83], v[56:59], v[16:19]
    ds_read_b64_tr_b16 v[156:157], v202 offset:15616
    ds_read_b64_tr_b16 v[158:159], v203 offset:15616
    buffer_load_dwordx4 v210, s[12:15], s27 offen offset:1024 lds
    v_mfma_f32_16x16x32_bf16 v[20:23], v[80:83], v[60:63], v[20:23]
    ds_read_b64_tr_b16 v[160:161], v200 offset:16384
    ds_read_b64_tr_b16 v[162:163], v201 offset:16384
    v_mfma_f32_16x16x32_bf16 v[24:27], v[84:87], v[56:59], v[24:27]
    ds_read_b64_tr_b16 v[164:165], v202 offset:16640
    ds_read_b64_tr_b16 v[166:167], v203 offset:16640
    v_mfma_f32_16x16x32_bf16 v[28:31], v[84:87], v[60:63], v[28:31]
    ds_read_b64_tr_b16 v[168:169], v204 offset:26624
    ds_read_b64_tr_b16 v[170:171], v205 offset:26624
    buffer_load_dwordx4 v211, s[12:15], s27 offen offset:2048 lds
    v_mfma_f32_16x16x32_bf16 v[32:35], v[88:91], v[56:59], v[32:35]
    ds_read_b128 v[136:139], v207 offset:0
    ds_read_b128 v[140:143], v207 offset:2048
    v_mfma_f32_16x16x32_bf16 v[36:39], v[88:91], v[60:63], v[36:39]
    ds_read_b64_tr_b16 v[172:173], v200 offset:20480
    ds_read_b64_tr_b16 v[174:175], v201 offset:20480
    v_mfma_f32_16x16x32_bf16 v[40:43], v[92:95], v[56:59], v[40:43]
    ds_read_b64_tr_b16 v[176:177], v202 offset:20736
    ds_read_b64_tr_b16 v[178:179], v203 offset:20736
    buffer_load_dwordx4 v212, s[12:15], s27 offen offset:3072 lds
    s_add_u32 s27, s27, 128
    v_mfma_f32_16x16x32_bf16 v[44:47], v[92:95], v[60:63], v[44:47]
    ds_read_b64_tr_b16 v[180:181], v200 offset:21504
    ds_read_b64_tr_b16 v[182:183], v201 offset:21504
    v_mfma_f32_16x16x32_bf16 v[48:51], v[96:99], v[56:59], v[48:51]
    ds_read_b64_tr_b16 v[184:185], v202 offset:21760
    ds_read_b64_tr_b16 v[186:187], v203 offset:21760
    v_mfma_f32_16x16x32_bf16 v[52:55], v[96:99], v[60:63], v[52:55]
    ds_read_b64_tr_b16 v[188:189], v200 offset:22528
    ds_read_b64_tr_b16 v[190:191], v201 offset:22528
    s_add_u32 m0, s28, 49152
    s_nop 0
    buffer_load_dwordx4 v208, s[8:11], s26 offen offset:0 sc1 lds
    v_mfma_f32_16x16x32_bf16 v[0:3], v[100:103], v[64:67], v[0:3]
    ds_read_b64_tr_b16 v[192:193], v202 offset:22784
    ds_read_b64_tr_b16 v[194:195], v203 offset:22784
    v_mfma_f32_16x16x32_bf16 v[4:7], v[100:103], v[68:71], v[4:7]
    ds_read_b64_tr_b16 v[196:197], v204 offset:27648
    ds_read_b64_tr_b16 v[198:199], v205 offset:27648
    s_waitcnt vmcnt(13)
    s_add_u32 s88, s88, 1
    ds_add_u32 v246, v248
    v_mfma_f32_16x16x32_bf16 v[8:11], v[104:107], v[64:67], v[8:11]
    buffer_load_dwordx4 v208, s[8:11], s26 offen offset:1024 sc1 lds
    v_mfma_f32_16x16x32_bf16 v[12:15], v[104:107], v[68:71], v[12:15]
    v_mfma_f32_16x16x32_bf16 v[16:19], v[108:111], v[64:67], v[16:19]
    v_mfma_f32_16x16x32_bf16 v[20:23], v[108:111], v[68:71], v[20:23]
    buffer_load_dwordx4 v208, s[8:11], s26 offen offset:2048 sc1 lds
    v_mfma_f32_16x16x32_bf16 v[24:27], v[112:115], v[64:67], v[24:27]
    v_mfma_f32_16x16x32_bf16 v[28:31], v[112:115], v[68:71], v[28:31]
    v_mfma_f32_16x16x32_bf16 v[32:35], v[116:119], v[64:67], v[32:35]
    s_mov_b64 exec, s[98:99]
    buffer_load_dwordx4 v208, s[8:11], s26 offen offset:3072 sc1 lds
    s_mov_b64 exec, -1
    s_add_u32 s26, s26, 28672
    v_mfma_f32_16x16x32_bf16 v[36:39], v[116:119], v[68:71], v[36:39]
    ds_read_b32 v249, v247
    v_mfma_f32_16x16x32_bf16 v[40:43], v[120:123], v[64:67], v[40:43]
    v_mfma_f32_16x16x32_bf16 v[44:47], v[120:123], v[68:71], v[44:47]
    v_mfma_f32_16x16x32_bf16 v[48:51], v[124:127], v[64:67], v[48:51]
    v_mfma_f32_16x16x32_bf16 v[52:55], v[124:127], v[68:71], v[52:55]
    s_waitcnt vmcnt(12)
    s_waitcnt lgkmcnt(0)
    v_cmp_gt_u32 vcc, s88, v249
    s_cbranch_vccnz spin_126
ok_127:
    v_mfma_f32_16x16x32_bf16 v[0:3], v[144:147], v[128:131], v[0:3]
    ds_read_b128 v[56:59], v206 offset:16384
    ds_read_b128 v[60:63], v206 offset:18432
    v_mfma_f32_16x16x32_bf16 v[4:7], v[144:147], v[132:135], v[4:7]
    ds_read_b64_tr_b16 v[72:73], v200 offset:28672
    ds_read_b64_tr_b16 v[74:75], v201 offset:28672
    s_add_u32 m0, s30, 106496
    s_nop 0
    buffer_load_dwordx4 v209, s[12:15], s27 offen offset:0 lds
    v_mfma_f32_16x16x32_bf16 v[8:11], v[148:151], v[128:131], v[8:11]
    ds_read_b64_tr_b16 v[76:77], v202 offset:28928
    ds_read_b64_tr_b16 v[78:79], v203 offset:28928
    v_mfma_f32_16x16x32_bf16 v[12:15], v[148:151], v[132:135], v[12:15]
    ds_read_b64_tr_b16 v[80:81], v200 offset:29696
    ds_read_b64_tr_b16 v[82:83], v201 offset:29696
    v_mfma_f32_16x16x32_bf16 v[16:19], v[152:155], v[128:131], v[16:19]
    ds_read_b64_tr_b16 v[84:85], v202 offset:29952
    ds_read_b64_tr_b16 v[86:87], v203 offset:29952
    buffer_load_dwordx4 v210, s[12:15], s27 offen offset:1024 lds
    v_mfma_f32_16x16x32_bf16 v[20:23], v[152:155], v[132:135], v[20:23]
    ds_read_b64_tr_b16 v[88:89], v200 offset:30720
    ds_read_b64_tr_b16 v[90:91], v201 offset:30720
    v_mfma_f32_16x16x32_bf16 v[24:27], v[156:159], v[128:131], v[24:27]
    ds_read_b64_tr_b16 v[92:93], v202 offset:30976
    ds_read_b64_tr_b16 v[94:95], v203 offset:30976
    v_mfma_f32_16x16x32_bf16 v[28:31], v[156:159], v[132:135], v[28:31]
    ds_read_b64_tr_b16 v[96:97], v204 offset:40960
    ds_read_b64_tr_b16 v[98:99], v205 offset:40960
    buffer_load_dwordx4 v211, s[12:15], s27 offen offset:2048 lds
    v_mfma_f32_16x16x32_bf16 v[32:35], v[160:163], v[128:131], v[32:35]
    ds_read_b128 v[64:67], v207 offset:16384
    ds_read_b128 v[68:71], v207 offset:18432
    v_mfma_f32_16x16x32_bf16 v[36:39], v[160:163], v[132:135], v[36:39]
    ds_read_b64_tr_b16 v[100:101], v200 offset:34816
    ds_read_b64_tr_b16 v[102:103], v201 offset:34816
    v_mfma_f32_16x16x32_bf16 v[40:43], v[164:167], v[128:131], v[40:43]
    ds_read_b64_tr_b16 v[104:105], v202 offset:35072
    ds_read_b64_tr_b16 v[106:107], v203 offset:35072
    buffer_load_dwordx4 v212, s[12:15], s27 offen offset:3072 lds
    s_add_u32 s27, s27, 128
    v_mfma_f32_16x16x32_bf16 v[44:47], v[164:167], v[132:135], v[44:47]
    ds_read_b64_tr_b16 v[108:109], v200 offset:35840
    ds_read_b64_tr_b16 v[110:111], v201 offset:35840
    v_mfma_f32_16x16x32_bf16 v[48:51], v[168:171], v[128:131], v[48:51]
    ds_read_b64_tr_b16 v[112:113], v202 offset:36096
    ds_read_b64_tr_b16 v[114:115], v203 offset:36096
    v_mfma_f32_16x16x32_bf16 v[52:55], v[168:171], v[132:135], v[52:55]
    ds_read_b64_tr_b16 v[116:117], v200 offset:36864
    ds_read_b64_tr_b16 v[118:119], v201 offset:36864
    s_add_u32 m0, s28, 63488
    s_nop 0
    buffer_load_dwordx4 v208, s[8:11], s26 offen offset:0 sc1 lds
    v_mfma_f32_16x16x32_bf16 v[0:3], v[172:175], v[136:139], v[0:3]
    ds_read_b64_tr_b16 v[120:121], v202 offset:37120
    ds_read_b64_tr_b16 v[122:123], v203 offset:37120
    v_mfma_f32_16x16x32_bf16 v[4:7], v[172:175], v[140:143], v[4:7]
    ds_read_b64_tr_b16 v[124:125], v204 offset:41984
    ds_read_b64_tr_b16 v[126:127], v205 offset:41984
    s_waitcnt vmcnt(13)
    s_add_u32 s88, s88, 1
    ds_add_u32 v246, v248
    v_mfma_f32_16x16x32_bf16 v[8:11], v[176:179], v[136:139], v[8:11]
    buffer_load_dwordx4 v208, s[8:11], s26 offen offset:1024 sc1 lds
    v_mfma_f32_16x16x32_bf16 v[12:15], v[176:179], v[140:143], v[12:15]
    v_mfma_f32_16x16x32_bf16 v[16:19], v[180:183], v[136:139], v[16:19]
    v_mfma_f32_16x16x32_bf16 v[20:23], v[180:183], v[140:143], v[20:23]
    buffer_load_dwordx4 v208, s[8:11], s26 offen offset:2048 sc1 lds
    v_mfma_f32_16x16x32_bf16 v[24:27], v[184:187], v[136:139], v[24:27]
    v_mfma_f32_16x16x32_bf16 v[28:31], v[184:187], v[140:143], v[28:31]
    v_mfma_f32_16x16x32_bf16 v[32:35], v[188:191], v[136:139], v[32:35]
    s_mov_b64 exec, s[98:99]
    buffer_load_dwordx4 v208, s[8:11], s26 offen offset:3072 sc1 lds
    s_mov_b64 exec, -1
    s_add_u32 s26, s26, 28672
    v_mfma_f32_16x16x32_bf16 v[36:39], v[188:191], v[140:143], v[36:39]
    ds_read_b32 v249, v247
    v_mfma_f32_16x16x32_bf16 v[40:43], v[192:195], v[136:139], v[40:43]
    v_mfma_f32_16x16x32_bf16 v[44:47], v[192:195], v[140:143], v[44:47]
    v_mfma_f32_16x16x32_bf16 v[48:51], v[196:199], v[136:139], v[48:51]
    v_mfma_f32_16x16x32_bf16 v[52:55], v[196:199], v[140:143], v[52:55]
    s_waitcnt vmcnt(12)
    s_waitcnt lgkmcnt(0)
    v_cmp_gt_u32 vcc, s88, v249
    s_cbranch_vccnz spin_128
ok_129:
    v_mfma_f32_16x16x32_bf16 v[0:3], v[72:75], v[56:59], v[0:3]
    ds_read_b128 v[128:131], v206 offset:32768
    ds_read_b128 v[132:135], v206 offset:34816
    v_mfma_f32_16x16x32_bf16 v[4:7], v[72:75], v[60:63], v[4:7]
    ds_read_b64_tr_b16 v[144:145], v200 offset:43008
    ds_read_b64_tr_b16 v[146:147], v201 offset:43008
    s_add_u32 m0, s30, 122880
    s_nop 0
    buffer_load_dwordx4 v209, s[12:15], s27 offen offset:0 lds
    v_mfma_f32_16x16x32_bf16 v[8:11], v[76:79], v[56:59], v[8:11]
    ds_read_b64_tr_b16 v[148:149], v202 offset:43264
    ds_read_b64_tr_b16 v[150:151], v203 offset:43264
    v_mfma_f32_16x16x32_bf16 v[12:15], v[76:79], v[60:63], v[12:15]
    ds_read_b64_tr_b16 v[152:153], v200 offset:44032
    ds_read_b64_tr_b16 v[154:155], v201 offset:44032
    v_mfma_f32_16x16x32_bf16 v[16:19], v[80:83], v[56:59], v[16:19]
    ds_read_b64_tr_b16 v[156:157], v202 offset:44288
    ds_read_b64_tr_b16 v[158:159], v203 offset:44288
    buffer_load_dwordx4 v210, s[12:15], s27 offen offset:1024 lds
    v_mfma_f32_16x16x32_bf16 v[20:23], v[80:83], v[60:63], v[20:23]
    ds_read_b64_tr_b16 v[160:161], v200 offset:45056
    ds_read_b64_tr_b16 v[162:163], v201 offset:45056
    v_mfma_f32_16x16x32_bf16 v[24:27], v[84:87], v[56:59], v[24:27]
    ds_read_b64_tr_b16 v[164:165], v202 offset:45312
    ds_read_b64_tr_b16 v[166:167], v203 offset:45312
    v_mfma_f32_16x16x32_bf16 v[28:31], v[84:87], v[60:63], v[28:31]
    ds_read_b64_tr_b16 v[168:169], v204 offset:55296
    ds_read_b64_tr_b16 v[170:171], v205 offset:55296
    buffer_load_dwordx4 v211, s[12:15], s27 offen offset:2048 lds
    v_mfma_f32_16x16x32_bf16 v[32:35], v[88:91], v[56:59], v[32:35]
    ds_read_b128 v[136:139], v207 offset:32768
    ds_read_b128 v[140:143], v207 offset:34816
    v_mfma_f32_16x16x32_bf16 v[36:39], v[88:91], v[60:63], v[36:39]
    ds_read_b64_tr_b16 v[172:173], v200 offset:49152
    ds_read_b64_tr_b16 v[174:175], v201 offset:49152
    v_mfma_f32_16x16x32_bf16 v[40:43], v[92:95], v[56:59], v[40:43]
    ds_read_b64_tr_b16 v[176:177], v202 offset:49408
    ds_read_b64_tr_b16 v[178:179], v203 offset:49408
    buffer_load_dwordx4 v212, s[12:15], s27 offen offset:3072 lds
    s_add_u32 s27, s27, 128
    v_mfma_f32_16x16x32_bf16 v[44:47], v[92:95], v[60:63], v[44:47]
    ds_read_b64_tr_b16 v[180:181], v200 offset:50176
    ds_read_b64_tr_b16 v[182:183], v201 offset:50176
    v_mfma_f32_16x16x32_bf16 v[48:51], v[96:99], v[56:59], v[48:51]
    ds_read_b64_tr_b16 v[184:185], v202 offset:50432
    ds_read_b64_tr_b16 v[186:187], v203 offset:50432
    v_mfma_f32_16x16x32_bf16 v[52:55], v[96:99], v[60:63], v[52:55]
    ds_read_b64_tr_b16 v[188:189], v200 offset:51200
    ds_read_b64_tr_b16 v[190:191], v201 offset:51200
    s_add_u32 m0, s28, 77824
    s_nop 0
    buffer_load_dwordx4 v208, s[8:11], s26 offen offset:0 sc1 lds
    v_mfma_f32_16x16x32_bf16 v[0:3], v[100:103], v[64:67], v[0:3]
    ds_read_b64_tr_b16 v[192:193], v202 offset:51456
    ds_read_b64_tr_b16 v[194:195], v203 offset:51456
    v_mfma_f32_16x16x32_bf16 v[4:7], v[100:103], v[68:71], v[4:7]
    ds_read_b64_tr_b16 v[196:197], v204 offset:56320
    ds_read_b64_tr_b16 v[198:199], v205 offset:56320
    s_waitcnt vmcnt(13)
    s_add_u32 s88, s88, 1
    ds_add_u32 v246, v248
    v_mfma_f32_16x16x32_bf16 v[8:11], v[104:107], v[64:67], v[8:11]
    buffer_load_dwordx4 v208, s[8:11], s26 offen offset:1024 sc1 lds
    v_mfma_f32_16x16x32_bf16 v[12:15], v[104:107], v[68:71], v[12:15]
    v_mfma_f32_16x16x32_bf16 v[16:19], v[108:111], v[64:67], v[16:19]
    v_mfma_f32_16x16x32_bf16 v[20:23], v[108:111], v[68:71], v[20:23]
    buffer_load_dwordx4 v208, s[8:11], s26 offen offset:2048 sc1 lds
    v_mfma_f32_16x16x32_bf16 v[24:27], v[112:115], v[64:67], v[24:27]
    v_mfma_f32_16x16x32_bf16 v[28:31], v[112:115], v[68:71], v[28:31]
    v_mfma_f32_16x16x32_bf16 v[32:35], v[116:119], v[64:67], v[32:35]
    s_mov_b64 exec, s[98:99]
    buffer_load_dwordx4 v208, s[8:11], s26 offen offset:3072 sc1 lds
    s_mov_b64 exec, -1
    s_add_u32 s26, s26, 28672
    v_mfma_f32_16x16x32_bf16 v[36:39], v[116:119], v[68:71], v[36:39]
    ds_read_b32 v249, v247
    v_mfma_f32_16x16x32_bf16 v[40:43], v[120:123], v[64:67], v[40:43]
    v_mfma_f32_16x16x32_bf16 v[44:47], v[120:123], v[68:71], v[44:47]
    v_mfma_f32_16x16x32_bf16 v[48:51], v[124:127], v[64:67], v[48:51]
    v_mfma_f32_16x16x32_bf16 v[52:55], v[124:127], v[68:71], v[52:55]
    s_waitcnt vmcnt(12)
    s_waitcnt lgkmcnt(0)
    v_cmp_gt_u32 vcc, s88, v249
    s_cbranch_vccnz spin_130
ok_131:
    v_mfma_f32_16x16x32_bf16 v[0:3], v[144:147], v[128:131], v[0:3]
    ds_read_b128 v[56:59], v206 offset:0
    ds_read_b128 v[60:63], v206 offset:2048
    v_mfma_f32_16x16x32_bf16 v[4:7], v[144:147], v[132:135], v[4:7]
    ds_read_b64_tr_b16 v[72:73], v200 offset:0
    ds_read_b64_tr_b16 v[74:75], v201 offset:0
    s_add_u32 m0, s30, 139264
    s_nop 0
    buffer_load_dwordx4 v209, s[12:15], s27 offen offset:0 lds
    v_mfma_f32_16x16x32_bf16 v[8:11], v[148:151], v[128:131], v[8:11]
    ds_read_b64_tr_b16 v[76:77], v202 offset:256
    ds_read_b64_tr_b16 v[78:79], v203 offset:256
    v_mfma_f32_16x16x32_bf16 v[12:15], v[148:151], v[132:135], v[12:15]
    ds_read_b64_tr_b16 v[80:81], v200 offset:1024
    ds_read_b64_tr_b16 v[82:83], v201 offset:1024
    v_mfma_f32_16x16x32_bf16 v[16:19], v[152:155], v[128:131], v[16:19]
    ds_read_b64_tr_b16 v[84:85], v202 offset:1280
    ds_read_b64_tr_b16 v[86:87], v203 offset:1280
    buffer_load_dwordx4 v210, s[12:15], s27 offen offset:1024 lds
    v_mfma_f32_16x16x32_bf16 v[20:23], v[152:155], v[132:135], v[20:23]
    ds_read_b64_tr_b16 v[88:89], v200 offset:2048
    ds_read_b64_tr_b16 v[90:91], v201 offset:2048
    v_mfma_f32_16x16x32_bf16 v[24:27], v[156:159], v[128:131], v[24:27]
    ds_read_b64_tr_b16 v[92:93], v202 offset:2304
    ds_read_b64_tr_b16 v[94:95], v203 offset:2304
    v_mfma_f32_16x16x32_bf16 v[28:31], v[156:159], v[132:135], v[28:31]
    ds_read_b64_tr_b16 v[96:97], v204 offset:12288
    ds_read_b64_tr_b16 v[98:99], v205 offset:12288
    buffer_load_dwordx4 v211, s[12:15], s27 offen offset:2048 lds
    v_mfma_f32_16x16x32_bf16 v[32:35], v[160:163], v[128:131], v[32:35]
    ds_read_b128 v[64:67], v207 offset:0
    ds_read_b128 v[68:71], v207 offset:2048
    v_mfma_f32_16x16x32_bf16 v[36:39], v[160:163], v[132:135], v[36:39]
    ds_read_b64_tr_b16 v[100:101], v200 offset:6144
    ds_read_b64_tr_b16 v[102:103], v201 offset:6144
    v_mfma_f32_16x16x32_bf16 v[40:43], v[164:167], v[128:131], v[40:43]
    ds_read_b64_tr_b16 v[104:105], v202 offset:6400
    ds_read_b64_tr_b16 v[106:107], v203 offset:6400
    buffer_load_dwordx4 v212, s[12:15], s27 offen offset:3072 lds
    s_add_u32 s27, s27, 128
    v_mfma_f32_16x16x32_bf16 v[44:47], v[164:167], v[132:135], v[44:47]
    ds_read_b64_tr_b16 v[108:109], v200 offset:7168
    ds_read_b64_tr_b16 v[110:111], v201 offset:7168
    v_mfma_f32_16x16x32_bf16 v[48:51], v[168:171], v[128:131], v[48:51]
    ds_read_b64_tr_b16 v[112:113], v202 offset:7424
    ds_read_b64_tr_b16 v[114:115], v203 offset:7424
    v_mfma_f32_16x16x32_bf16 v[52:55], v[168:171], v[132:135], v[52:55]
    ds_read_b64_tr_b16 v[116:117], v200 offset:8192
    ds_read_b64_tr_b16 v[118:119], v201 offset:8192
    s_add_u32 m0, s28, 92160
    s_nop 0
    buffer_load_dwordx4 v208, s[8:11], s26 offen offset:0 sc1 lds
    v_mfma_f32_16x16x32_bf16 v[0:3], v[172:175], v[136:139], v[0:3]
    ds_read_b64_tr_b16 v[120:121], v202 offset:8448
    ds_read_b64_tr_b16 v[122:123], v203 offset:8448
    v_mfma_f32_16x16x32_bf16 v[4:7], v[172:175], v[140:143], v[4:7]
    ds_read_b64_tr_b16 v[124:125], v204 offset:13312
    ds_read_b64_tr_b16 v[126:127], v205 offset:13312
    s_waitcnt vmcnt(13)
    s_add_u32 s88, s88, 1
    ds_add_u32 v246, v248
    v_mfma_f32_16x16x32_bf16 v[8:11], v[176:179], v[136:139], v[8:11]
    buffer_load_dwordx4 v208, s[8:11], s26 offen offset:1024 sc1 lds
    v_mfma_f32_16x16x32_bf16 v[12:15], v[176:179], v[140:143], v[12:15]
    v_mfma_f32_16x16x32_bf16 v[16:19], v[180:183], v[136:139], v[16:19]
    v_mfma_f32_16x16x32_bf16 v[20:23], v[180:183], v[140:143], v[20:23]
    buffer_load_dwordx4 v208, s[8:11], s26 offen offset:2048 sc1 lds
    v_mfma_f32_16x16x32_bf16 v[24:27], v[184:187], v[136:139], v[24:27]
    v_mfma_f32_16x16x32_bf16 v[28:31], v[184:187], v[140:143], v[28:31]
    v_mfma_f32_16x16x32_bf16 v[32:35], v[188:191], v[136:139], v[32:35]
    s_mov_b64 exec, s[98:99]
    buffer_load_dwordx4 v208, s[8:11], s26 offen offset:3072 sc1 lds
    s_mov_b64 exec, -1
    s_add_u32 s26, s26, 28672
    v_mfma_f32_16x16x32_bf16 v[36:39], v[188:191], v[140:143], v[36:39]
    ds_read_b32 v249, v247
    v_mfma_f32_16x16x32_bf16 v[40:43], v[192:195], v[136:139], v[40:43]
    v_mfma_f32_16x16x32_bf16 v[44:47], v[192:195], v[140:143], v[44:47]
    v_mfma_f32_16x16x32_bf16 v[48:51], v[196:199], v[136:139], v[48:51]
    v_mfma_f32_16x16x32_bf16 v[52:55], v[196:199], v[140:143], v[52:55]
    s_waitcnt vmcnt(12)
    s_waitcnt lgkmcnt(0)
    v_cmp_gt_u32 vcc, s88, v249
    s_cbranch_vccnz spin_132
ok_133:
    v_mfma_f32_16x16x32_bf16 v[0:3], v[72:75], v[56:59], v[0:3]
    ds_read_b128 v[128:131], v206 offset:16384
    ds_read_b128 v[132:135], v206 offset:18432
    v_mfma_f32_16x16x32_bf16 v[4:7], v[72:75], v[60:63], v[4:7]
    ds_read_b64_tr_b16 v[144:145], v200 offset:14336
    ds_read_b64_tr_b16 v[146:147], v201 offset:14336
    s_add_u32 m0, s30, 106496
    s_nop 0
    buffer_load_dwordx4 v209, s[12:15], s27 offen offset:0 lds
    v_mfma_f32_16x16x32_bf16 v[8:11], v[76:79], v[56:59], v[8:11]
    ds_read_b64_tr_b16 v[148:149], v202 offset:14592
    ds_read_b64_tr_b16 v[150:151], v203 offset:14592
    v_mfma_f32_16x16x32_bf16 v[12:15], v[76:79], v[60:63], v[12:15]
    ds_read_b64_tr_b16 v[152:153], v200 offset:15360
    ds_read_b64_tr_b16 v[154:155], v201 offset:15360
    v_mfma_f32_16x16x32_bf16 v[16:19], v[80:83], v[56:59], v[16:19]
    ds_read_b64_tr_b16 v[156:157], v202 offset:15616
    ds_read_b64_tr_b16 v[158:159], v203 offset:15616
    buffer_load_dwordx4 v210, s[12:15], s27 offen offset:1024 lds
    v_mfma_f32_16x16x32_bf16 v[20:23], v[80:83], v[60:63], v[20:23]
    ds_read_b64_tr_b16 v[160:161], v200 offset:16384
    ds_read_b64_tr_b16 v[162:163], v201 offset:16384
    v_mfma_f32_16x16x32_bf16 v[24:27], v[84:87], v[56:59], v[24:27]
    ds_read_b64_tr_b16 v[164:165], v202 offset:16640
    ds_read_b64_tr_b16 v[166:167], v203 offset:16640
    v_mfma_f32_16x16x32_bf16 v[28:31], v[84:87], v[60:63], v[28:31]
    ds_read_b64_tr_b16 v[168:169], v204 offset:26624
    ds_read_b64_tr_b16 v[170:171], v205 offset:26624
    buffer_load_dwordx4 v211, s[12:15], s27 offen offset:2048 lds
    v_mfma_f32_16x16x32_bf16 v[32:35], v[88:91], v[56:59], v[32:35]
    ds_read_b128 v[136:139], v207 offset:16384
    ds_read_b128 v[140:143], v207 offset:18432
    v_mfma_f32_16x16x32_bf16 v[36:39], v[88:91], v[60:63], v[36:39]
    ds_read_b64_tr_b16 v[172:173], v200 offset:20480
    ds_read_b64_tr_b16 v[174:175], v201 offset:20480
    v_mfma_f32_16x16x32_bf16 v[40:43], v[92:95], v[56:59], v[40:43]
    ds_read_b64_tr_b16 v[176:177], v202 offset:20736
    ds_read_b64_tr_b16 v[178:179], v203 offset:20736
    buffer_load_dwordx4 v212, s[12:15], s27 offen offset:3072 lds
    s_add_u32 s27, s27, 128
    v_mfma_f32_16x16x32_bf16 v[44:47], v[92:95], v[60:63], v[44:47]
    ds_read_b64_tr_b16 v[180:181], v200 offset:21504
    ds_read_b64_tr_b16 v[182:183], v201 offset:21504
    v_mfma_f32_16x16x32_bf16 v[48:51], v[96:99], v[56:59], v[48:51]
    ds_read_b64_tr_b16 v[184:185], v202 offset:21760
    ds_read_b64_tr_b16 v[186:187], v203 offset:21760
    v_mfma_f32_16x16x32_bf16 v[52:55], v[96:99], v[60:63], v[52:55]
    ds_read_b64_tr_b16 v[188:189], v200 offset:22528
    ds_read_b64_tr_b16 v[190:191], v201 offset:22528
    s_add_u32 m0, s28, 49152
    s_nop 0
    buffer_load_dwordx4 v208, s[8:11], s26 offen offset:0 sc1 lds
    v_mfma_f32_16x16x32_bf16 v[0:3], v[100:103], v[64:67], v[0:3]
    ds_read_b64_tr_b16 v[192:193], v202 offset:22784
    ds_read_b64_tr_b16 v[194:195], v203 offset:22784
    v_mfma_f32_16x16x32_bf16 v[4:7], v[100:103], v[68:71], v[4:7]
    ds_read_b64_tr_b16 v[196:197], v204 offset:27648
    ds_read_b64_tr_b16 v[198:199], v205 offset:27648
    s_waitcnt vmcnt(13)
    s_add_u32 s88, s88, 1
    ds_add_u32 v246, v248
    v_mfma_f32_16x16x32_bf16 v[8:11], v[104:107], v[64:67], v[8:11]
    buffer_load_dwordx4 v208, s[8:11], s26 offen offset:1024 sc1 lds
    v_mfma_f32_16x16x32_bf16 v[12:15], v[104:107], v[68:71], v[12:15]
    v_mfma_f32_16x16x32_bf16 v[16:19], v[108:111], v[64:67], v[16:19]
    v_mfma_f32_16x16x32_bf16 v[20:23], v[108:111], v[68:71], v[20:23]
    buffer_load_dwordx4 v208, s[8:11], s26 offen offset:2048 sc1 lds
    v_mfma_f32_16x16x32_bf16 v[24:27], v[112:115], v[64:67], v[24:27]
    v_mfma_f32_16x16x32_bf16 v[28:31], v[112:115], v[68:71], v[28:31]
    v_mfma_f32_16x16x32_bf16 v[32:35], v[116:119], v[64:67], v[32:35]
    s_mov_b64 exec, s[98:99]
    buffer_load_dwordx4 v208, s[8:11], s26 offen offset:3072 sc1 lds
    s_mov_b64 exec, -1
    s_add_u32 s26, s26, 28672
    v_mfma_f32_16x16x32_bf16 v[36:39], v[116:119], v[68:71], v[36:39]
    ds_read_b32 v249, v247
    v_mfma_f32_16x16x32_bf16 v[40:43], v[120:123], v[64:67], v[40:43]
    v_mfma_f32_16x16x32_bf16 v[44:47], v[120:123], v[68:71], v[44:47]
    v_mfma_f32_16x16x32_bf16 v[48:51], v[124:127], v[64:67], v[48:51]
    v_mfma_f32_16x16x32_bf16 v[52:55], v[124:127], v[68:71], v[52:55]
    s_waitcnt vmcnt(12)
    s_waitcnt lgkmcnt(0)
    v_cmp_gt_u32 vcc, s88, v249
    s_cbranch_vccnz spin_134
ok_135:
    v_mfma_f32_16x16x32_bf16 v[0:3], v[144:147], v[128:131], v[0:3]
    ds_read_b128 v[56:59], v206 offset:32768
    ds_read_b128 v[60:63], v206 offset:34816
    v_mfma_f32_16x16x32_bf16 v[4:7], v[144:147], v[132:135], v[4:7]
    ds_read_b64_tr_b16 v[72:73], v200 offset:28672
    ds_read_b64_tr_b16 v[74:75], v201 offset:28672
    s_add_u32 m0, s30, 122880
    s_nop 0
    buffer_load_dwordx4 v209, s[12:15], s27 offen offset:0 lds
    v_mfma_f32_16x16x32_bf16 v[8:11], v[148:151], v[128:131], v[8:11]
    ds_read_b64_tr_b16 v[76:77], v202 offset:28928
    ds_read_b64_tr_b16 v[78:79], v203 offset:28928
    v_mfma_f32_16x16x32_bf16 v[12:15], v[148:151], v[132:135], v[12:15]
    ds_read_b64_tr_b16 v[80:81], v200 offset:29696
    ds_read_b64_tr_b16 v[82:83], v201 offset:29696
    v_mfma_f32_16x16x32_bf16 v[16:19], v[152:155], v[128:131], v[16:19]
    ds_read_b64_tr_b16 v[84:85], v202 offset:29952
    ds_read_b64_tr_b16 v[86:87], v203 offset:29952
    buffer_load_dwordx4 v210, s[12:15], s27 offen offset:1024 lds
    v_mfma_f32_16x16x32_bf16 v[20:23], v[152:155], v[132:135], v[20:23]
    ds_read_b64_tr_b16 v[88:89], v200 offset:30720
    ds_read_b64_tr_b16 v[90:91], v201 offset:30720
    v_mfma_f32_16x16x32_bf16 v[24:27], v[156:159], v[128:131], v[24:27]
    ds_read_b64_tr_b16 v[92:93], v202 offset:30976
    ds_read_b64_tr_b16 v[94:95], v203 offset:30976
    v_mfma_f32_16x16x32_bf16 v[28:31], v[156:159], v[132:135], v[28:31]
    ds_read_b64_tr_b16 v[96:97], v204 offset:40960
    ds_read_b64_tr_b16 v[98:99], v205 offset:40960
    buffer_load_dwordx4 v211, s[12:15], s27 offen offset:2048 lds
    v_mfma_f32_16x16x32_bf16 v[32:35], v[160:163], v[128:131], v[32:35]
    ds_read_b128 v[64:67], v207 offset:32768
    ds_read_b128 v[68:71], v207 offset:34816
    v_mfma_f32_16x16x32_bf16 v[36:39], v[160:163], v[132:135], v[36:39]
    ds_read_b64_tr_b16 v[100:101], v200 offset:34816
    ds_read_b64_tr_b16 v[102:103], v201 offset:34816
    v_mfma_f32_16x16x32_bf16 v[40:43], v[164:167], v[128:131], v[40:43]
    ds_read_b64_tr_b16 v[104:105], v202 offset:35072
    ds_read_b64_tr_b16 v[106:107], v203 offset:35072
    buffer_load_dwordx4 v212, s[12:15], s27 offen offset:3072 lds
    s_add_u32 s27, s27, 128
    v_mfma_f32_16x16x32_bf16 v[44:47], v[164:167], v[132:135], v[44:47]
    ds_read_b64_tr_b16 v[108:109], v200 offset:35840
    ds_read_b64_tr_b16 v[110:111], v201 offset:35840
    v_mfma_f32_16x16x32_bf16 v[48:51], v[168:171], v[128:131], v[48:51]
    ds_read_b64_tr_b16 v[112:113], v202 offset:36096
    ds_read_b64_tr_b16 v[114:115], v203 offset:36096
    v_mfma_f32_16x16x32_bf16 v[52:55], v[168:171], v[132:135], v[52:55]
    ds_read_b64_tr_b16 v[116:117], v200 offset:36864
    ds_read_b64_tr_b16 v[118:119], v201 offset:36864
    s_add_u32 m0, s28, 63488
    s_nop 0
    buffer_load_dwordx4 v208, s[8:11], s26 offen offset:0 sc1 lds
    v_mfma_f32_16x16x32_bf16 v[0:3], v[172:175], v[136:139], v[0:3]
    ds_read_b64_tr_b16 v[120:121], v202 offset:37120
    ds_read_b64_tr_b16 v[122:123], v203 offset:37120
    v_mfma_f32_16x16x32_bf16 v[4:7], v[172:175], v[140:143], v[4:7]
    ds_read_b64_tr_b16 v[124:125], v204 offset:41984
    ds_read_b64_tr_b16 v[126:127], v205 offset:41984
    s_waitcnt vmcnt(13)
    s_add_u32 s88, s88, 1
    ds_add_u32 v246, v248
    v_mfma_f32_16x16x32_bf16 v[8:11], v[176:179], v[136:139], v[8:11]
    buffer_load_dwordx4 v208, s[8:11], s26 offen offset:1024 sc1 lds
    v_mfma_f32_16x16x32_bf16 v[12:15], v[176:179], v[140:143], v[12:15]
    v_mfma_f32_16x16x32_bf16 v[16:19], v[180:183], v[136:139], v[16:19]
    v_mfma_f32_16x16x32_bf16 v[20:23], v[180:183], v[140:143], v[20:23]
    buffer_load_dwordx4 v208, s[8:11], s26 offen offset:2048 sc1 lds
    v_mfma_f32_16x16x32_bf16 v[24:27], v[184:187], v[136:139], v[24:27]
    v_mfma_f32_16x16x32_bf16 v[28:31], v[184:187], v[140:143], v[28:31]
    v_mfma_f32_16x16x32_bf16 v[32:35], v[188:191], v[136:139], v[32:35]
    s_mov_b64 exec, s[98:99]
    buffer_load_dwordx4 v208, s[8:11], s26 offen offset:3072 sc1 lds
    s_mov_b64 exec, -1
    s_add_u32 s26, s26, 28672
    v_mfma_f32_16x16x32_bf16 v[36:39], v[188:191], v[140:143], v[36:39]
    ds_read_b32 v249, v247
    v_mfma_f32_16x16x32_bf16 v[40:43], v[192:195], v[136:139], v[40:43]
    v_mfma_f32_16x16x32_bf16 v[44:47], v[192:195], v[140:143], v[44:47]
    v_mfma_f32_16x16x32_bf16 v[48:51], v[196:199], v[136:139], v[48:51]
    v_mfma_f32_16x16x32_bf16 v[52:55], v[196:199], v[140:143], v[52:55]
    s_sub_u32 s29, s29, 1
    s_cmp_lg_u32 s29, 0
    s_cbranch_scc1 sp_111
    s_waitcnt vmcnt(12)
    s_waitcnt lgkmcnt(0)
    v_cmp_gt_u32 vcc, s88, v249
    s_cbranch_vccnz spin_136
ok_137:
    v_mfma_f32_16x16x32_bf16 v[0:3], v[72:75], v[56:59], v[0:3]
    ds_read_b128 v[128:131], v206 offset:0
    ds_read_b128 v[132:135], v206 offset:2048
    v_mfma_f32_16x16x32_bf16 v[4:7], v[72:75], v[60:63], v[4:7]
    ds_read_b64_tr_b16 v[144:145], v200 offset:43008
    ds_read_b64_tr_b16 v[146:147], v201 offset:43008
    s_add_u32 m0, s30, 139264
    s_nop 0
    buffer_load_dwordx4 v209, s[12:15], s27 offen offset:0 lds
    v_mfma_f32_16x16x32_bf16 v[8:11], v[76:79], v[56:59], v[8:11]
    ds_read_b64_tr_b16 v[148:149], v202 offset:43264
    ds_read_b64_tr_b16 v[150:151], v203 offset:43264
    v_mfma_f32_16x16x32_bf16 v[12:15], v[76:79], v[60:63], v[12:15]
    ds_read_b64_tr_b16 v[152:153], v200 offset:44032
    ds_read_b64_tr_b16 v[154:155], v201 offset:44032
    v_mfma_f32_16x16x32_bf16 v[16:19], v[80:83], v[56:59], v[16:19]
    ds_read_b64_tr_b16 v[156:157], v202 offset:44288
    ds_read_b64_tr_b16 v[158:159], v203 offset:44288
    buffer_load_dwordx4 v210, s[12:15], s27 offen offset:1024 lds
    v_mfma_f32_16x16x32_bf16 v[20:23], v[80:83], v[60:63], v[20:23]
    ds_read_b64_tr_b16 v[160:161], v200 offset:45056
    ds_read_b64_tr_b16 v[162:163], v201 offset:45056
    v_mfma_f32_16x16x32_bf16 v[24:27], v[84:87], v[56:59], v[24:27]
    ds_read_b64_tr_b16 v[164:165], v202 offset:45312
    ds_read_b64_tr_b16 v[166:167], v203 offset:45312
    v_mfma_f32_16x16x32_bf16 v[28:31], v[84:87], v[60:63], v[28:31]
    ds_read_b64_tr_b16 v[168:169], v204 offset:55296
    ds_read_b64_tr_b16 v[170:171], v205 offset:55296
    buffer_load_dwordx4 v211, s[12:15], s27 offen offset:2048 lds
    v_mfma_f32_16x16x32_bf16 v[32:35], v[88:91], v[56:59], v[32:35]
    ds_read_b128 v[136:139], v207 offset:0
    ds_read_b128 v[140:143], v207 offset:2048
    v_mfma_f32_16x16x32_bf16 v[36:39], v[88:91], v[60:63], v[36:39]
    ds_read_b64_tr_b16 v[172:173], v200 offset:49152
    ds_read_b64_tr_b16 v[174:175], v201 offset:49152
    v_mfma_f32_16x16x32_bf16 v[40:43], v[92:95], v[56:59], v[40:43]
    ds_read_b64_tr_b16 v[176:177], v202 offset:49408
    ds_read_b64_tr_b16 v[178:179], v203 offset:49408
    buffer_load_dwordx4 v212, s[12:15], s27 offen offset:3072 lds
    s_add_u32 s27, s27, 128
    v_mfma_f32_16x16x32_bf16 v[44:47], v[92:95], v[60:63], v[44:47]
    ds_read_b64_tr_b16 v[180:181], v200 offset:50176
    ds_read_b64_tr_b16 v[182:183], v201 offset:50176
    v_mfma_f32_16x16x32_bf16 v[48:51], v[96:99], v[56:59], v[48:51]
    ds_read_b64_tr_b16 v[184:185], v202 offset:50432
    ds_read_b64_tr_b16 v[186:187], v203 offset:50432
    v_mfma_f32_16x16x32_bf16 v[52:55], v[96:99], v[60:63], v[52:55]
    ds_read_b64_tr_b16 v[188:189], v200 offset:51200
    ds_read_b64_tr_b16 v[190:191], v201 offset:51200
    s_add_u32 m0, s28, 77824
    s_nop 0
    buffer_load_dwordx4 v208, s[8:11], s26 offen offset:0 sc1 lds
    v_mfma_f32_16x16x32_bf16 v[0:3], v[100:103], v[64:67], v[0:3]
    ds_read_b64_tr_b16 v[192:193], v202 offset:51456
    ds_read_b64_tr_b16 v[194:195], v203 offset:51456
    v_mfma_f32_16x16x32_bf16 v[4:7], v[100:103], v[68:71], v[4:7]
    ds_read_b64_tr_b16 v[196:197], v204 offset:56320
    ds_read_b64_tr_b16 v[198:199], v205 offset:56320
    s_waitcnt vmcnt(13)
    s_add_u32 s88, s88, 1
    ds_add_u32 v246, v248
    v_mfma_f32_16x16x32_bf16 v[8:11], v[104:107], v[64:67], v[8:11]
    buffer_load_dwordx4 v208, s[8:11], s26 offen offset:1024 sc1 lds
    v_mfma_f32_16x16x32_bf16 v[12:15], v[104:107], v[68:71], v[12:15]
    v_mfma_f32_16x16x32_bf16 v[16:19], v[108:111], v[64:67], v[16:19]
    v_mfma_f32_16x16x32_bf16 v[20:23], v[108:111], v[68:71], v[20:23]
    buffer_load_dwordx4 v208, s[8:11], s26 offen offset:2048 sc1 lds
    v_mfma_f32_16x16x32_bf16 v[24:27], v[112:115], v[64:67], v[24:27]
    v_mfma_f32_16x16x32_bf16 v[28:31], v[112:115], v[68:71], v[28:31]
    v_mfma_f32_16x16x32_bf16 v[32:35], v[116:119], v[64:67], v[32:35]
    s_mov_b64 exec, s[98:99]
    buffer_load_dwordx4 v208, s[8:11], s26 offen offset:3072 sc1 lds
    s_mov_b64 exec, -1
    s_add_u32 s26, s26, 28672
    v_mfma_f32_16x16x32_bf16 v[36:39], v[116:119], v[68:71], v[36:39]
    ds_read_b32 v249, v247
    v_mfma_f32_16x16x32_bf16 v[40:43], v[120:123], v[64:67], v[40:43]
    v_mfma_f32_16x16x32_bf16 v[44:47], v[120:123], v[68:71], v[44:47]
    v_mfma_f32_16x16x32_bf16 v[48:51], v[124:127], v[64:67], v[48:51]
    v_mfma_f32_16x16x32_bf16 v[52:55], v[124:127], v[68:71], v[52:55]
    s_waitcnt vmcnt(12)
    s_waitcnt lgkmcnt(0)
    v_cmp_gt_u32 vcc, s88, v249
    s_cbranch_vccnz spin_138
ok_139:
    v_mfma_f32_16x16x32_bf16 v[0:3], v[144:147], v[128:131], v[0:3]
    ds_read_b128 v[56:59], v206 offset:16384
    ds_read_b128 v[60:63], v206 offset:18432
    v_mfma_f32_16x16x32_bf16 v[4:7], v[144:147], v[132:135], v[4:7]
    ds_read_b64_tr_b16 v[72:73], v200 offset:0
    ds_read_b64_tr_b16 v[74:75], v201 offset:0
    s_add_u32 m0, s30, 106496
    s_nop 0
    buffer_load_dwordx4 v209, s[12:15], s27 offen offset:0 lds
    v_mfma_f32_16x16x32_bf16 v[8:11], v[148:151], v[128:131], v[8:11]
    ds_read_b64_tr_b16 v[76:77], v202 offset:256
    ds_read_b64_tr_b16 v[78:79], v203 offset:256
    v_mfma_f32_16x16x32_bf16 v[12:15], v[148:151], v[132:135], v[12:15]
    ds_read_b64_tr_b16 v[80:81], v200 offset:1024
    ds_read_b64_tr_b16 v[82:83], v201 offset:1024
    v_mfma_f32_16x16x32_bf16 v[16:19], v[152:155], v[128:131], v[16:19]
    ds_read_b64_tr_b16 v[84:85], v202 offset:1280
    ds_read_b64_tr_b16 v[86:87], v203 offset:1280
    buffer_load_dwordx4 v210, s[12:15], s27 offen offset:1024 lds
    v_mfma_f32_16x16x32_bf16 v[20:23], v[152:155], v[132:135], v[20:23]
    ds_read_b64_tr_b16 v[88:89], v200 offset:2048
    ds_read_b64_tr_b16 v[90:91], v201 offset:2048
    v_mfma_f32_16x16x32_bf16 v[24:27], v[156:159], v[128:131], v[24:27]
    ds_read_b64_tr_b16 v[92:93], v202 offset:2304
    ds_read_b64_tr_b16 v[94:95], v203 offset:2304
    v_mfma_f32_16x16x32_bf16 v[28:31], v[156:159], v[132:135], v[28:31]
    ds_read_b64_tr_b16 v[96:97], v204 offset:12288
    ds_read_b64_tr_b16 v[98:99], v205 offset:12288
    buffer_load_dwordx4 v211, s[12:15], s27 offen offset:2048 lds
    v_mfma_f32_16x16x32_bf16 v[32:35], v[160:163], v[128:131], v[32:35]
    ds_read_b128 v[64:67], v207 offset:16384
    ds_read_b128 v[68:71], v207 offset:18432
    v_mfma_f32_16x16x32_bf16 v[36:39], v[160:163], v[132:135], v[36:39]
    ds_read_b64_tr_b16 v[100:101], v200 offset:6144
    ds_read_b64_tr_b16 v[102:103], v201 offset:6144
    v_mfma_f32_16x16x32_bf16 v[40:43], v[164:167], v[128:131], v[40:43]
    ds_read_b64_tr_b16 v[104:105], v202 offset:6400
    ds_read_b64_tr_b16 v[106:107], v203 offset:6400
    buffer_load_dwordx4 v212, s[12:15], s27 offen offset:3072 lds
    s_add_u32 s27, s27, 128
    v_mfma_f32_16x16x32_bf16 v[44:47], v[164:167], v[132:135], v[44:47]
    ds_read_b64_tr_b16 v[108:109], v200 offset:7168
    ds_read_b64_tr_b16 v[110:111], v201 offset:7168
    v_mfma_f32_16x16x32_bf16 v[48:51], v[168:171], v[128:131], v[48:51]
    ds_read_b64_tr_b16 v[112:113], v202 offset:7424
    ds_read_b64_tr_b16 v[114:115], v203 offset:7424
    v_mfma_f32_16x16x32_bf16 v[52:55], v[168:171], v[132:135], v[52:55]
    ds_read_b64_tr_b16 v[116:117], v200 offset:8192
    ds_read_b64_tr_b16 v[118:119], v201 offset:8192
    s_add_u32 m0, s28, 92160
    s_nop 0
    buffer_load_dwordx4 v208, s[8:11], s26 offen offset:0 sc1 lds
    v_mfma_f32_16x16x32_bf16 v[0:3], v[172:175], v[136:139], v[0:3]
    ds_read_b64_tr_b16 v[120:121], v202 offset:8448
    ds_read_b64_tr_b16 v[122:123], v203 offset:8448
    v_mfma_f32_16x16x32_bf16 v[4:7], v[172:175], v[140:143], v[4:7]
    ds_read_b64_tr_b16 v[124:125], v204 offset:13312
    ds_read_b64_tr_b16 v[126:127], v205 offset:13312
    s_waitcnt vmcnt(13)
    s_add_u32 s88, s88, 1
    ds_add_u32 v246, v248
    v_mfma_f32_16x16x32_bf16 v[8:11], v[176:179], v[136:139], v[8:11]
    buffer_load_dwordx4 v208, s[8:11], s26 offen offset:1024 sc1 lds
    v_mfma_f32_16x16x32_bf16 v[12:15], v[176:179], v[140:143], v[12:15]
    v_mfma_f32_16x16x32_bf16 v[16:19], v[180:183], v[136:139], v[16:19]
    v_mfma_f32_16x16x32_bf16 v[20:23], v[180:183], v[140:143], v[20:23]
    buffer_load_dwordx4 v208, s[8:11], s26 offen offset:2048 sc1 lds
    v_mfma_f32_16x16x32_bf16 v[24:27], v[184:187], v[136:139], v[24:27]
    v_mfma_f32_16x16x32_bf16 v[28:31], v[184:187], v[140:143], v[28:31]
    v_mfma_f32_16x16x32_bf16 v[32:35], v[188:191], v[136:139], v[32:35]
    s_mov_b64 exec, s[98:99]
    buffer_load_dwordx4 v208, s[8:11], s26 offen offset:3072 sc1 lds
    s_mov_b64 exec, -1
    s_add_u32 s26, s26, 28672
    v_mfma_f32_16x16x32_bf16 v[36:39], v[188:191], v[140:143], v[36:39]
    ds_read_b32 v249, v247
    v_mfma_f32_16x16x32_bf16 v[40:43], v[192:195], v[136:139], v[40:43]
    v_mfma_f32_16x16x32_bf16 v[44:47], v[192:195], v[140:143], v[44:47]
    v_mfma_f32_16x16x32_bf16 v[48:51], v[196:199], v[136:139], v[48:51]
    v_mfma_f32_16x16x32_bf16 v[52:55], v[196:199], v[140:143], v[52:55]
    s_waitcnt vmcnt(12)
    s_waitcnt lgkmcnt(0)
    v_cmp_gt_u32 vcc, s88, v249
    s_cbranch_vccnz spin_140
ok_141:
    v_mfma_f32_16x16x32_bf16 v[0:3], v[72:75], v[56:59], v[0:3]
    ds_read_b128 v[128:131], v206 offset:32768
    ds_read_b128 v[132:135], v206 offset:34816
    v_mfma_f32_16x16x32_bf16 v[4:7], v[72:75], v[60:63], v[4:7]
    ds_read_b64_tr_b16 v[144:145], v200 offset:14336
    ds_read_b64_tr_b16 v[146:147], v201 offset:14336
    s_add_u32 m0, s30, 122880
    s_nop 0
    buffer_load_dwordx4 v209, s[12:15], s27 offen offset:0 lds
    v_mfma_f32_16x16x32_bf16 v[8:11], v[76:79], v[56:59], v[8:11]
    ds_read_b64_tr_b16 v[148:149], v202 offset:14592
    ds_read_b64_tr_b16 v[150:151], v203 offset:14592
    v_mfma_f32_16x16x32_bf16 v[12:15], v[76:79], v[60:63], v[12:15]
    ds_read_b64_tr_b16 v[152:153], v200 offset:15360
    ds_read_b64_tr_b16 v[154:155], v201 offset:15360
    v_mfma_f32_16x16x32_bf16 v[16:19], v[80:83], v[56:59], v[16:19]
    ds_read_b64_tr_b16 v[156:157], v202 offset:15616
    ds_read_b64_tr_b16 v[158:159], v203 offset:15616
    buffer_load_dwordx4 v210, s[12:15], s27 offen offset:1024 lds
    v_mfma_f32_16x16x32_bf16 v[20:23], v[80:83], v[60:63], v[20:23]
    ds_read_b64_tr_b16 v[160:161], v200 offset:16384
    ds_read_b64_tr_b16 v[162:163], v201 offset:16384
    v_mfma_f32_16x16x32_bf16 v[24:27], v[84:87], v[56:59], v[24:27]
    ds_read_b64_tr_b16 v[164:165], v202 offset:16640
    ds_read_b64_tr_b16 v[166:167], v203 offset:16640
    v_mfma_f32_16x16x32_bf16 v[28:31], v[84:87], v[60:63], v[28:31]
    ds_read_b64_tr_b16 v[168:169], v204 offset:26624
    ds_read_b64_tr_b16 v[170:171], v205 offset:26624
    buffer_load_dwordx4 v211, s[12:15], s27 offen offset:2048 lds
    v_mfma_f32_16x16x32_bf16 v[32:35], v[88:91], v[56:59], v[32:35]
    ds_read_b128 v[136:139], v207 offset:32768
    ds_read_b128 v[140:143], v207 offset:34816
    v_mfma_f32_16x16x32_bf16 v[36:39], v[88:91], v[60:63], v[36:39]
    ds_read_b64_tr_b16 v[172:173], v200 offset:20480
    ds_read_b64_tr_b16 v[174:175], v201 offset:20480
    v_mfma_f32_16x16x32_bf16 v[40:43], v[92:95], v[56:59], v[40:43]
    ds_read_b64_tr_b16 v[176:177], v202 offset:20736
    ds_read_b64_tr_b16 v[178:179], v203 offset:20736
    buffer_load_dwordx4 v212, s[12:15], s27 offen offset:3072 lds
    s_add_u32 s27, s27, 128
    v_mfma_f32_16x16x32_bf16 v[44:47], v[92:95], v[60:63], v[44:47]
    ds_read_b64_tr_b16 v[180:181], v200 offset:21504
    ds_read_b64_tr_b16 v[182:183], v201 offset:21504
    v_mfma_f32_16x16x32_bf16 v[48:51], v[96:99], v[56:59], v[48:51]
    ds_read_b64_tr_b16 v[184:185], v202 offset:21760
    ds_read_b64_tr_b16 v[186:187], v203 offset:21760
    v_mfma_f32_16x16x32_bf16 v[52:55], v[96:99], v[60:63], v[52:55]
    ds_read_b64_tr_b16 v[188:189], v200 offset:22528
    ds_read_b64_tr_b16 v[190:191], v201 offset:22528
    v_mfma_f32_16x16x32_bf16 v[0:3], v[100:103], v[64:67], v[0:3]
    ds_read_b64_tr_b16 v[192:193], v202 offset:22784
    ds_read_b64_tr_b16 v[194:195], v203 offset:22784
    v_mfma_f32_16x16x32_bf16 v[4:7], v[100:103], v[68:71], v[4:7]
    ds_read_b64_tr_b16 v[196:197], v204 offset:27648
    ds_read_b64_tr_b16 v[198:199], v205 offset:27648
    s_waitcnt vmcnt(12)
    s_add_u32 s88, s88, 1
    ds_add_u32 v246, v248
    v_mfma_f32_16x16x32_bf16 v[8:11], v[104:107], v[64:67], v[8:11]
    v_mfma_f32_16x16x32_bf16 v[12:15], v[104:107], v[68:71], v[12:15]
    v_mfma_f32_16x16x32_bf16 v[16:19], v[108:111], v[64:67], v[16:19]
    v_mfma_f32_16x16x32_bf16 v[20:23], v[108:111], v[68:71], v[20:23]
    v_mfma_f32_16x16x32_bf16 v[24:27], v[112:115], v[64:67], v[24:27]
    v_mfma_f32_16x16x32_bf16 v[28:31], v[112:115], v[68:71], v[28:31]
    v_mfma_f32_16x16x32_bf16 v[32:35], v[116:119], v[64:67], v[32:35]
    v_mfma_f32_16x16x32_bf16 v[36:39], v[116:119], v[68:71], v[36:39]
    ds_read_b32 v249, v247
    v_mfma_f32_16x16x32_bf16 v[40:43], v[120:123], v[64:67], v[40:43]
    v_mfma_f32_16x16x32_bf16 v[44:47], v[120:123], v[68:71], v[44:47]
    v_mfma_f32_16x16x32_bf16 v[48:51], v[124:127], v[64:67], v[48:51]
    v_mfma_f32_16x16x32_bf16 v[52:55], v[124:127], v[68:71], v[52:55]
    s_waitcnt vmcnt(8)
    s_waitcnt lgkmcnt(0)
    v_cmp_gt_u32 vcc, s88, v249
    s_cbranch_vccnz spin_142
ok_143:
    v_mfma_f32_16x16x32_bf16 v[0:3], v[144:147], v[128:131], v[0:3]
    ds_read_b128 v[56:59], v206 offset:0
    ds_read_b128 v[60:63], v206 offset:2048
    v_mfma_f32_16x16x32_bf16 v[4:7], v[144:147], v[132:135], v[4:7]
    ds_read_b64_tr_b16 v[72:73], v200 offset:28672
    ds_read_b64_tr_b16 v[74:75], v201 offset:28672
    v_mfma_f32_16x16x32_bf16 v[8:11], v[148:151], v[128:131], v[8:11]
    ds_read_b64_tr_b16 v[76:77], v202 offset:28928
    ds_read_b64_tr_b16 v[78:79], v203 offset:28928
    v_mfma_f32_16x16x32_bf16 v[12:15], v[148:151], v[132:135], v[12:15]
    ds_read_b64_tr_b16 v[80:81], v200 offset:29696
    ds_read_b64_tr_b16 v[82:83], v201 offset:29696
    v_mfma_f32_16x16x32_bf16 v[16:19], v[152:155], v[128:131], v[16:19]
    ds_read_b64_tr_b16 v[84:85], v202 offset:29952
    ds_read_b64_tr_b16 v[86:87], v203 offset:29952
    v_mfma_f32_16x16x32_bf16 v[20:23], v[152:155], v[132:135], v[20:23]
    ds_read_b64_tr_b16 v[88:89], v200 offset:30720
    ds_read_b64_tr_b16 v[90:91], v201 offset:30720
    v_mfma_f32_16x16x32_bf16 v[24:27], v[156:159], v[128:131], v[24:27]
    ds_read_b64_tr_b16 v[92:93], v202 offset:30976
    ds_read_b64_tr_b16 v[94:95], v203 offset:30976
    v_mfma_f32_16x16x32_bf16 v[28:31], v[156:159], v[132:135], v[28:31]
    ds_read_b64_tr_b16 v[96:97], v204 offset:40960
    ds_read_b64_tr_b16 v[98:99], v205 offset:40960
    v_mfma_f32_16x16x32_bf16 v[32:35], v[160:163], v[128:131], v[32:35]
    ds_read_b128 v[64:67], v207 offset:0
    ds_read_b128 v[68:71], v207 offset:2048
    v_mfma_f32_16x16x32_bf16 v[36:39], v[160:163], v[132:135], v[36:39]
    ds_read_b64_tr_b16 v[100:101], v200 offset:34816
    ds_read_b64_tr_b16 v[102:103], v201 offset:34816
    v_mfma_f32_16x16x32_bf16 v[40:43], v[164:167], v[128:131], v[40:43]
    ds_read_b64_tr_b16 v[104:105], v202 offset:35072
    ds_read_b64_tr_b16 v[106:107], v203 offset:35072
    v_mfma_f32_16x16x32_bf16 v[44:47], v[164:167], v[132:135], v[44:47]
    ds_read_b64_tr_b16 v[108:109], v200 offset:35840
    ds_read_b64_tr_b16 v[110:111], v201 offset:35840
    v_mfma_f32_16x16x32_bf16 v[48:51], v[168:171], v[128:131], v[48:51]
    ds_read_b64_tr_b16 v[112:113], v202 offset:36096
    ds_read_b64_tr_b16 v[114:115], v203 offset:36096
    v_mfma_f32_16x16x32_bf16 v[52:55], v[168:171], v[132:135], v[52:55]
    ds_read_b64_tr_b16 v[116:117], v200 offset:36864
    ds_read_b64_tr_b16 v[118:119], v201 offset:36864
    v_mfma_f32_16x16x32_bf16 v[0:3], v[172:175], v[136:139], v[0:3]
    ds_read_b64_tr_b16 v[120:121], v202 offset:37120
    ds_read_b64_tr_b16 v[122:123], v203 offset:37120
    v_mfma_f32_16x16x32_bf16 v[4:7], v[172:175], v[140:143], v[4:7]
    ds_read_b64_tr_b16 v[124:125], v204 offset:41984
    ds_read_b64_tr_b16 v[126:127], v205 offset:41984
    s_waitcnt vmcnt(4)
    s_add_u32 s88, s88, 1
    ds_add_u32 v246, v248
    s_add_u32 s16, s4, 0x1000000
    s_addc_u32 s17, s5, 0
    s_mov_b32 s18, 0x700000
    s_mov_b32 s19, 0x00020000
    s_lshl_b32 s3, s23, 6
    s_add_u32 s3, s3, s40
    s_mul_i32 s3, s3, 14336
    s_mul_i32 s6, s39, 7168
    s_add_u32 s6, s6, s3
    s_add_u32 s7, s6, 4096
    s_mul_i32 s41, s21, 7168
    s_add_u32 m0, s41, 49152
    v_and_b32 v216, 15, v250
    buffer_load_dwordx4 v245, s[16:19], s6 offen offset:0 sc1 lds
    buffer_load_dwordx4 v245, s[16:19], s6 offen offset:1024 sc1 lds
    buffer_load_dwordx4 v245, s[16:19], s6 offen offset:2048 sc1 lds
    buffer_load_dwordx4 v245, s[16:19], s6 offen offset:3072 sc1 lds
    s_add_u32 m0, m0, 4096
    s_nop 0
    buffer_load_dwordx4 v245, s[16:19], s7 offen offset:0 sc1 lds
    buffer_load_dwordx4 v245, s[16:19], s7 offen offset:1024 sc1 lds
    buffer_load_dwordx4 v245, s[16:19], s7 offen offset:2048 sc1 lds
    s_mov_b32 s16, s60
    s_mov_b32 s17, s61
    s_mov_b32 s18, 0x1000
    s_mov_b32 s19, 0x00020000
    s_lshl_b32 s3, s40, 6
    v_lshlrev_b32 v216, 1, v216
    buffer_load_ushort v218, v216, s[16:19], s3 offen offset:32
    buffer_load_ushort v216, v216, s[16:19], s3 offen
    v_mfma_f32_16x16x32_bf16 v[8:11], v[176:179], v[136:139], v[8:11]
    v_mfma_f32_16x16x32_bf16 v[12:15], v[176:179], v[140:143], v[12:15]
    v_mfma_f32_16x16x32_bf16 v[16:19], v[180:183], v[136:139], v[16:19]
    v_mfma_f32_16x16x32_bf16 v[20:23], v[180:183], v[140:143], v[20:23]
    v_mfma_f32_16x16x32_bf16 v[24:27], v[184:187], v[136:139], v[24:27]
    v_mfma_f32_16x16x32_bf16 v[28:31], v[184:187], v[140:143], v[28:31]
    v_mfma_f32_16x16x32_bf16 v[32:35], v[188:191], v[136:139], v[32:35]
    v_mfma_f32_16x16x32_bf16 v[36:39], v[188:191], v[140:143], v[36:39]
    ds_read_b32 v249, v247
    v_mfma_f32_16x16x32_bf16 v[40:43], v[192:195], v[136:139], v[40:43]
    v_mfma_f32_16x16x32_bf16 v[44:47], v[192:195], v[140:143], v[44:47]
    v_mfma_f32_16x16x32_bf16 v[48:51], v[196:199], v[136:139], v[48:51]
    v_mfma_f32_16x16x32_bf16 v[52:55], v[196:199], v[140:143], v[52:55]
    s_waitcnt vmcnt(9)
    s_waitcnt lgkmcnt(0)
    v_cmp_gt_u32 vcc, s88, v249
    s_cbranch_vccnz spin_144
ok_145:
    v_mfma_f32_16x16x32_bf16 v[0:3], v[72:75], v[56:59], v[0:3]
    ds_read_b128 v[128:131], v206 offset:16384
    ds_read_b128 v[132:135], v206 offset:18432
    v_mfma_f32_16x16x32_bf16 v[4:7], v[72:75], v[60:63], v[4:7]
    ds_read_b64_tr_b16 v[144:145], v200 offset:43008
    ds_read_b64_tr_b16 v[146:147], v201 offset:43008
    v_mfma_f32_16x16x32_bf16 v[8:11], v[76:79], v[56:59], v[8:11]
    ds_read_b64_tr_b16 v[148:149], v202 offset:43264
    ds_read_b64_tr_b16 v[150:151], v203 offset:43264
    v_mfma_f32_16x16x32_bf16 v[12:15], v[76:79], v[60:63], v[12:15]
    ds_read_b64_tr_b16 v[152:153], v200 offset:44032
    ds_read_b64_tr_b16 v[154:155], v201 offset:44032
    v_mfma_f32_16x16x32_bf16 v[16:19], v[80:83], v[56:59], v[16:19]
    ds_read_b64_tr_b16 v[156:157], v202 offset:44288
    ds_read_b64_tr_b16 v[158:159], v203 offset:44288
    v_mfma_f32_16x16x32_bf16 v[20:23], v[80:83], v[60:63], v[20:23]
    ds_read_b64_tr_b16 v[160:161], v200 offset:45056
    ds_read_b64_tr_b16 v[162:163], v201 offset:45056
    v_mfma_f32_16x16x32_bf16 v[24:27], v[84:87], v[56:59], v[24:27]
    ds_read_b64_tr_b16 v[164:165], v202 offset:45312
    ds_read_b64_tr_b16 v[166:167], v203 offset:45312
    v_mfma_f32_16x16x32_bf16 v[28:31], v[84:87], v[60:63], v[28:31]
    ds_read_b64_tr_b16 v[168:169], v204 offset:55296
    ds_read_b64_tr_b16 v[170:171], v205 offset:55296
    v_mfma_f32_16x16x32_bf16 v[32:35], v[88:91], v[56:59], v[32:35]
    ds_read_b128 v[136:139], v207 offset:16384
    ds_read_b128 v[140:143], v207 offset:18432
    v_mfma_f32_16x16x32_bf16 v[36:39], v[88:91], v[60:63], v[36:39]
    ds_read_b64_tr_b16 v[172:173], v200 offset:49152
    ds_read_b64_tr_b16 v[174:175], v201 offset:49152
    v_mfma_f32_16x16x32_bf16 v[40:43], v[92:95], v[56:59], v[40:43]
    ds_read_b64_tr_b16 v[176:177], v202 offset:49408
    ds_read_b64_tr_b16 v[178:179], v203 offset:49408
    v_mfma_f32_16x16x32_bf16 v[44:47], v[92:95], v[60:63], v[44:47]
    ds_read_b64_tr_b16 v[180:181], v200 offset:50176
    ds_read_b64_tr_b16 v[182:183], v201 offset:50176
    v_mfma_f32_16x16x32_bf16 v[48:51], v[96:99], v[56:59], v[48:51]
    ds_read_b64_tr_b16 v[184:185], v202 offset:50432
    ds_read_b64_tr_b16 v[186:187], v203 offset:50432
    v_mfma_f32_16x16x32_bf16 v[52:55], v[96:99], v[60:63], v[52:55]
    ds_read_b64_tr_b16 v[188:189], v200 offset:51200
    ds_read_b64_tr_b16 v[190:191], v201 offset:51200
    v_mfma_f32_16x16x32_bf16 v[0:3], v[100:103], v[64:67], v[0:3]
    ds_read_b64_tr_b16 v[192:193], v202 offset:51456
    ds_read_b64_tr_b16 v[194:195], v203 offset:51456
    v_mfma_f32_16x16x32_bf16 v[4:7], v[100:103], v[68:71], v[4:7]
    ds_read_b64_tr_b16 v[196:197], v204 offset:56320
    ds_read_b64_tr_b16 v[198:199], v205 offset:56320
    v_mfma_f32_16x16x32_bf16 v[8:11], v[104:107], v[64:67], v[8:11]
    v_mfma_f32_16x16x32_bf16 v[12:15], v[104:107], v[68:71], v[12:15]
    v_mfma_f32_16x16x32_bf16 v[16:19], v[108:111], v[64:67], v[16:19]
    v_mfma_f32_16x16x32_bf16 v[20:23], v[108:111], v[68:71], v[20:23]
    v_mfma_f32_16x16x32_bf16 v[24:27], v[112:115], v[64:67], v[24:27]
    v_mfma_f32_16x16x32_bf16 v[28:31], v[112:115], v[68:71], v[28:31]
    v_mfma_f32_16x16x32_bf16 v[32:35], v[116:119], v[64:67], v[32:35]
    v_mfma_f32_16x16x32_bf16 v[36:39], v[116:119], v[68:71], v[36:39]
    v_mfma_f32_16x16x32_bf16 v[40:43], v[120:123], v[64:67], v[40:43]
    v_mfma_f32_16x16x32_bf16 v[44:47], v[120:123], v[68:71], v[44:47]
    v_mfma_f32_16x16x32_bf16 v[48:51], v[124:127], v[64:67], v[48:51]
    v_mfma_f32_16x16x32_bf16 v[52:55], v[124:127], v[68:71], v[52:55]
    s_add_u32 s6, s41, 49152
    v_add_u32 v220, s6, v245
    s_waitcnt vmcnt(0)
    ds_read_b128 v[56:59], v220 offset:0
    ds_read_b128 v[60:63], v220 offset:1024
    ds_read_b128 v[64:67], v220 offset:2048
    ds_read_b128 v[68:71], v220 offset:3072
    ds_read_b128 v[72:75], v220 offset:4096
    ds_read_b128 v[76:79], v220 offset:5120
    ds_read_b128 v[80:83], v220 offset:6144
    s_waitcnt lgkmcnt(0)
    v_mfma_f32_16x16x32_bf16 v[0:3], v[144:147], v[128:131], v[0:3]
    v_mfma_f32_16x16x32_bf16 v[4:7], v[144:147], v[132:135], v[4:7]
    v_mfma_f32_16x16x32_bf16 v[8:11], v[148:151], v[128:131], v[8:11]
    v_mfma_f32_16x16x32_bf16 v[12:15], v[148:151], v[132:135], v[12:15]
    v_mfma_f32_16x16x32_bf16 v[16:19], v[152:155], v[128:131], v[16:19]
    v_mfma_f32_16x16x32_bf16 v[20:23], v[152:155], v[132:135], v[20:23]
    v_mfma_f32_16x16x32_bf16 v[24:27], v[156:159], v[128:131], v[24:27]
    v_mfma_f32_16x16x32_bf16 v[28:31], v[156:159], v[132:135], v[28:31]
    v_mfma_f32_16x16x32_bf16 v[32:35], v[160:163], v[128:131], v[32:35]
    v_mfma_f32_16x16x32_bf16 v[36:39], v[160:163], v[132:135], v[36:39]
    v_mfma_f32_16x16x32_bf16 v[40:43], v[164:167], v[128:131], v[40:43]
    v_mfma_f32_16x16x32_bf16 v[44:47], v[164:167], v[132:135], v[44:47]
    v_mfma_f32_16x16x32_bf16 v[48:51], v[168:171], v[128:131], v[48:51]
    v_mfma_f32_16x16x32_bf16 v[52:55], v[168:171], v[132:135], v[52:55]
    v_mfma_f32_16x16x32_bf16 v[0:3], v[172:175], v[136:139], v[0:3]
    v_mfma_f32_16x16x32_bf16 v[4:7], v[172:175], v[140:143], v[4:7]
    v_mfma_f32_16x16x32_bf16 v[8:11], v[176:179], v[136:139], v[8:11]
    v_mfma_f32_16x16x32_bf16 v[12:15], v[176:179], v[140:143], v[12:15]
    v_mfma_f32_16x16x32_bf16 v[16:19], v[180:183], v[136:139], v[16:19]
    v_mfma_f32_16x16x32_bf16 v[20:23], v[180:183], v[140:143], v[20:23]
    v_mfma_f32_16x16x32_bf16 v[24:27], v[184:187], v[136:139], v[24:27]
    v_mfma_f32_16x16x32_bf16 v[28:31], v[184:187], v[140:143], v[28:31]
    v_mfma_f32_16x16x32_bf16 v[32:35], v[188:191], v[136:139], v[32:35]
    v_mfma_f32_16x16x32_bf16 v[36:39], v[188:191], v[140:143], v[36:39]
    v_mfma_f32_16x16x32_bf16 v[40:43], v[192:195], v[136:139], v[40:43]
    v_mfma_f32_16x16x32_bf16 v[44:47], v[192:195], v[140:143], v[44:47]
    v_mfma_f32_16x16x32_bf16 v[48:51], v[196:199], v[136:139], v[48:51]
    v_mfma_f32_16x16x32_bf16 v[52:55], v[196:199], v[140:143], v[52:55]
    s_setprio 2
    s_add_u32 s16, s4, 0x3000000
    s_addc_u32 s17, s5, 0
    s_mov_b32 s18, 0x700000
    s_mov_b32 s19, 0x00020000
    s_mul_i32 s3, s40, 56
    s_mul_i32 s6, s23, 7
    s_add_u32 s3, s3, s6
    s_lshl_b32 s3, s3, 11
    s_lshl_b32 s6, s39, 13
    s_add_u32 s6, s6, s3
    s_add_u32 s7, s6, 4096
    s_lshl_b32 s41, s39, 3
    s_add_u32 s3, s3, s41
    s_add_u32 s3, s3, 6144
    v_lshlrev_b32 v216, 16, v216
    v_lshlrev_b32 v218, 16, v218
    v_mov_b32 v217, v216
    v_mov_b32 v219, v218
.p2align 3
    v_lshlrev_b32 v88, 16, v56
    v_and_b32 v89, s89, v56
    v_lshlrev_b32 v90, 16, v57
    v_and_b32 v91, s89, v57
    v_lshlrev_b32 v92, 16, v58
    v_and_b32 v93, s89, v58
    v_lshlrev_b32 v94, 16, v59
    v_and_b32 v95, s89, v59
    v_add_f32 v0, v0, v216
    v_add_f32 v1, v1, v217
    v_add_f32 v2, v2, v216
    v_add_f32 v3, v3, v217
    v_add_f32 v8, v8, v216
    v_add_f32 v9, v9, v217
    v_add_f32 v10, v10, v216
    v_add_f32 v11, v11, v217
    v_mul_f32 v0, v0, v88
    v_mul_f32 v1, v1, v89
    v_mul_f32 v2, v2, v90
    v_mul_f32 v3, v3, v91
    v_mul_f32 v8, v8, v92
    v_mul_f32 v9, v9, v93
    v_mul_f32 v10, v10, v94
    v_mul_f32 v11, v11, v95
    v_cvt_pk_bf16_f32 v104, v0, v1
    v_cvt_pk_bf16_f32 v105, v2, v3
    v_cvt_pk_bf16_f32 v106, v8, v9
    v_cvt_pk_bf16_f32 v107, v10, v11
    buffer_store_dwordx4 v[104:107], v245, s[16:19], s6 offen offset:0 sc1
    v_lshlrev_b32 v96, 16, v60
    v_and_b32 v97, s89, v60
    v_lshlrev_b32 v98, 16, v61
    v_and_b32 v99, s89, v61
    v_lshlrev_b32 v100, 16, v62
    v_and_b32 v101, s89, v62
    v_lshlrev_b32 v102, 16, v63
    v_and_b32 v103, s89, v63
    v_add_f32 v4, v4, v218
    v_add_f32 v5, v5, v219
    v_add_f32 v6, v6, v218
    v_add_f32 v7, v7, v219
    v_add_f32 v12, v12, v218
    v_add_f32 v13, v13, v219
    v_add_f32 v14, v14, v218
    v_add_f32 v15, v15, v219
    v_mul_f32 v4, v4, v96
    v_mul_f32 v5, v5, v97
    v_mul_f32 v6, v6, v98
    v_mul_f32 v7, v7, v99
    v_mul_f32 v12, v12, v100
    v_mul_f32 v13, v13, v101
    v_mul_f32 v14, v14, v102
    v_mul_f32 v15, v15, v103
    v_cvt_pk_bf16_f32 v108, v4, v5
    v_cvt_pk_bf16_f32 v109, v6, v7
    v_cvt_pk_bf16_f32 v110, v12, v13
    v_cvt_pk_bf16_f32 v111, v14, v15
    buffer_store_dwordx4 v[108:111], v245, s[16:19], s6 offen offset:1024 sc1
    v_lshlrev_b32 v88, 16, v64
    v_and_b32 v89, s89, v64
    v_lshlrev_b32 v90, 16, v65
    v_and_b32 v91, s89, v65
    v_lshlrev_b32 v92, 16, v66
    v_and_b32 v93, s89, v66
    v_lshlrev_b32 v94, 16, v67
    v_and_b32 v95, s89, v67
    v_add_f32 v16, v16, v216
    v_add_f32 v17, v17, v217
    v_add_f32 v18, v18, v216
    v_add_f32 v19, v19, v217
    v_add_f32 v24, v24, v216
    v_add_f32 v25, v25, v217
    v_add_f32 v26, v26, v216
    v_add_f32 v27, v27, v217
    v_mul_f32 v16, v16, v88
    v_mul_f32 v17, v17, v89
    v_mul_f32 v18, v18, v90
    v_mul_f32 v19, v19, v91
    v_mul_f32 v24, v24, v92
    v_mul_f32 v25, v25, v93
    v_mul_f32 v26, v26, v94
    v_mul_f32 v27, v27, v95
    v_cvt_pk_bf16_f32 v112, v16, v17
    v_cvt_pk_bf16_f32 v113, v18, v19
    v_cvt_pk_bf16_f32 v114, v24, v25
    v_cvt_pk_bf16_f32 v115, v26, v27
    buffer_store_dwordx4 v[112:115], v245, s[16:19], s6 offen offset:2048 sc1
    v_lshlrev_b32 v96, 16, v68
    v_and_b32 v97, s89, v68
    v_lshlrev_b32 v98, 16, v69
    v_and_b32 v99, s89, v69
    v_lshlrev_b32 v100, 16, v70
    v_and_b32 v101, s89, v70
    v_lshlrev_b32 v102, 16, v71
    v_and_b32 v103, s89, v71
    v_add_f32 v20, v20, v218
    v_add_f32 v21, v21, v219
    v_add_f32 v22, v22, v218
    v_add_f32 v23, v23, v219
    v_add_f32 v28, v28, v218
    v_add_f32 v29, v29, v219
    v_add_f32 v30, v30, v218
    v_add_f32 v31, v31, v219
    v_mul_f32 v20, v20, v96
    v_mul_f32 v21, v21, v97
    v_mul_f32 v22, v22, v98
    v_mul_f32 v23, v23, v99
    v_mul_f32 v28, v28, v100
    v_mul_f32 v29, v29, v101
    v_mul_f32 v30, v30, v102
    v_mul_f32 v31, v31, v103
    v_cvt_pk_bf16_f32 v116, v20, v21
    v_cvt_pk_bf16_f32 v117, v22, v23
    v_cvt_pk_bf16_f32 v118, v28, v29
    v_cvt_pk_bf16_f32 v119, v30, v31
    buffer_store_dwordx4 v[116:119], v245, s[16:19], s6 offen offset:3072 sc1
    v_lshlrev_b32 v88, 16, v72
    v_and_b32 v89, s89, v72
    v_lshlrev_b32 v90, 16, v73
    v_and_b32 v91, s89, v73
    v_lshlrev_b32 v92, 16, v74
    v_and_b32 v93, s89, v74
    v_lshlrev_b32 v94, 16, v75
    v_and_b32 v95, s89, v75
    v_add_f32 v32, v32, v216
    v_add_f32 v33, v33, v217
    v_add_f32 v34, v34, v216
    v_add_f32 v35, v35, v217
    v_add_f32 v40, v40, v216
    v_add_f32 v41, v41, v217
    v_add_f32 v42, v42, v216
    v_add_f32 v43, v43, v217
    v_mul_f32 v32, v32, v88
    v_mul_f32 v33, v33, v89
    v_mul_f32 v34, v34, v90
    v_mul_f32 v35, v35, v91
    v_mul_f32 v40, v40, v92
    v_mul_f32 v41, v41, v93
    v_mul_f32 v42, v42, v94
    v_mul_f32 v43, v43, v95
    v_cvt_pk_bf16_f32 v120, v32, v33
    v_cvt_pk_bf16_f32 v121, v34, v35
    v_cvt_pk_bf16_f32 v122, v40, v41
    v_cvt_pk_bf16_f32 v123, v42, v43
    buffer_store_dwordx4 v[120:123], v245, s[16:19], s7 offen offset:0 sc1
    v_lshlrev_b32 v96, 16, v76
    v_and_b32 v97, s89, v76
    v_lshlrev_b32 v98, 16, v77
    v_and_b32 v99, s89, v77
    v_lshlrev_b32 v100, 16, v78
    v_and_b32 v101, s89, v78
    v_lshlrev_b32 v102, 16, v79
    v_and_b32 v103, s89, v79
    v_add_f32 v36, v36, v218
    v_add_f32 v37, v37, v219
    v_add_f32 v38, v38, v218
    v_add_f32 v39, v39, v219
    v_add_f32 v44, v44, v218
    v_add_f32 v45, v45, v219
    v_add_f32 v46, v46, v218
    v_add_f32 v47, v47, v219
    v_mul_f32 v36, v36, v96
    v_mul_f32 v37, v37, v97
    v_mul_f32 v38, v38, v98
    v_mul_f32 v39, v39, v99
    v_mul_f32 v44, v44, v100
    v_mul_f32 v45, v45, v101
    v_mul_f32 v46, v46, v102
    v_mul_f32 v47, v47, v103
    v_cvt_pk_bf16_f32 v124, v36, v37
    v_cvt_pk_bf16_f32 v125, v38, v39
    v_cvt_pk_bf16_f32 v126, v44, v45
    v_cvt_pk_bf16_f32 v127, v46, v47
    buffer_store_dwordx4 v[124:127], v245, s[16:19], s7 offen offset:1024 sc1
    v_lshlrev_b32 v88, 16, v80
    v_and_b32 v89, s89, v80
    v_lshlrev_b32 v90, 16, v81
    v_and_b32 v91, s89, v81
    v_lshlrev_b32 v92, 16, v82
    v_and_b32 v93, s89, v82
    v_lshlrev_b32 v94, 16, v83
    v_and_b32 v95, s89, v83
    v_add_f32 v48, v48, v216
    v_add_f32 v49, v49, v217
    v_add_f32 v50, v50, v216
    v_add_f32 v51, v51, v217
    v_add_f32 v52, v52, v218
    v_add_f32 v53, v53, v219
    v_add_f32 v54, v54, v218
    v_add_f32 v55, v55, v219
    v_mul_f32 v48, v48, v88
    v_mul_f32 v49, v49, v89
    v_mul_f32 v50, v50, v90
    v_mul_f32 v51, v51, v91
    v_mul_f32 v52, v52, v92
    v_mul_f32 v53, v53, v93
    v_mul_f32 v54, v54, v94
    v_mul_f32 v55, v55, v95
    v_cvt_pk_bf16_f32 v128, v48, v49
    v_cvt_pk_bf16_f32 v129, v50, v51
    v_cvt_pk_bf16_f32 v130, v52, v53
    v_cvt_pk_bf16_f32 v131, v54, v55
    buffer_store_dwordx2 v[128:129], v245, s[16:19], s3 offen sc1
    buffer_store_dwordx2 v[130:131], v245, s[16:19], s3 offen offset:1024 sc1
    s_lshr_b32 s42, s36, 1
    s_lshl_b32 s42, s42, 3
    s_add_u32 s42, s42, s23
    s_lshl_b32 s42, s42, 1
    s_add_u32 s42, s42, s39
    s_lshl_b32 s42, s42, 7
    s_add_u32 s42, s42, 98304
    s_lshl_b32 s43, s100, 11
    s_add_u32 s43, s43, 98304
    s_nop 1
    s_add_u32 s8, s4, 0x3000000
    s_addc_u32 s9, s5, 0
    s_mov_b32 s10, 0x700000
    s_mov_b32 s11, 0x00020000
    s_mov_b32 s12, s62
    s_mov_b32 s13, s63
    s_mov_b32 s14, 0x380000
    s_mov_b32 s15, 0x00020000
    s_lshl_b32 s3, s100, 2
    s_add_u32 s3, s3, s21
    s_mul_i32 s3, s3, 114688
    v_add_u32 v228, s3, v245
    v_lshrrev_b32 v97, 3, v250
    s_lshl_b32 s3, s21, 4
    v_add_u32 v97, s3, v97
    v_lshlrev_b32 v97, 11, v97
    v_lshrrev_b32 v98, 4, v250
    v_lshlrev_b32 v98, 1, v98
    v_and_b32 v99, 7, v250
    v_xor_b32 v98, v98, v99
    v_lshl_add_u32 v97, v98, 4, v97
    s_lshl_b32 s3, s101, 7
    v_add_u32 v229, s3, v97
    v_add_u32 v230, 15360, v229
    s_lshl_b32 s30, s21, 11
    s_mov_b32 s26, 0
    s_mov_b32 s27, 0
    v_bfe_u32 v97, v250, 4, 1
    v_lshrrev_b32 v98, 5, v250
    v_bfe_u32 v99, v250, 2, 2
    v_lshlrev_b32 v100, 2, v97
    v_lshl_add_u32 v100, v98, 3, v100
    v_add_u32 v100, v100, v99
    v_lshlrev_b32 v100, 7, v100
    v_lshrrev_b32 v99, 1, v99
    v_lshl_add_u32 v99, v97, 1, v99
    v_lshl_add_u32 v100, v99, 5, v100
    v_and_b32 v98, 3, v250
    v_lshl_add_u32 v100, v98, 3, v100
    v_add_u32 v224, 65536, v100
    v_xor_b32 v225, 32, v224
    v_xor_b32 v226, 64, v224
    v_xor_b32 v227, 96, v224
    v_mov_b32 v0, 0
    v_mov_b32 v1, 0
    v_mov_b32 v2, 0
    v_mov_b32 v3, 0
    v_mov_b32 v4, 0
    v_mov_b32 v5, 0
    v_mov_b32 v6, 0
    v_mov_b32 v7, 0
    v_mov_b32 v8, 0
    v_mov_b32 v9, 0
    v_mov_b32 v10, 0
    v_mov_b32 v11, 0
    v_mov_b32 v12, 0
    v_mov_b32 v13, 0
    v_mov_b32 v14, 0
    v_mov_b32 v15, 0
    v_mov_b32 v16, 0
    v_mov_b32 v17, 0
    v_mov_b32 v18, 0
    v_mov_b32 v19, 0
    v_mov_b32 v20, 0
    v_mov_b32 v21, 0
    v_mov_b32 v22, 0
    v_mov_b32 v23, 0
    v_mov_b32 v24, 0
    v_mov_b32 v25, 0
    v_mov_b32 v26, 0
    v_mov_b32 v27, 0
    v_mov_b32 v28, 0
    v_mov_b32 v29, 0
    v_mov_b32 v30, 0
    v_mov_b32 v31, 0
    s_waitcnt vmcnt(0)
    s_add_u32 s88, s88, 1
    ds_add_u32 v246, v248
    ds_read_b32 v249, v247
    s_waitcnt lgkmcnt(0)
    v_cmp_gt_u32 vcc, s88, v249
    s_cbranch_vccnz spin_147
ok_148:
    s_cmp_lg_u32 s21, 0
    s_cbranch_scc1 fw_146
    v_mov_b32 v242, 0
    v_mov_b32 v243, s31
    s_mov_b64 exec, 1
    buffer_store_dword v243, v242, s[32:35], s42 offen sc1
    s_mov_b64 exec, -1
fw_146:
    s_mov_b32 s16, s48
    s_mov_b32 s17, s49
    s_mov_b32 s18, 0x400000
    s_mov_b32 s19, 0x00020000
    s_lshl_b32 s3, s100, 2
    s_add_u32 s3, s3, s21
    s_lshl_b32 s3, s3, 5
    v_and_b32 v231, 15, v250
    v_add_u32 v231, s3, v231
    v_lshlrev_b32 v231, 11, v231
    v_lshrrev_b32 v232, 5, v250
    v_lshl_add_u32 v231, v232, 4, v231
    v_bfe_u32 v232, v250, 4, 1
    v_lshl_add_u32 v231, v232, 5, v231
    s_lshl_b32 s3, s101, 7
    s_add_u32 s3, s3, 64
    v_add_u32 v231, s3, v231
    s_mov_b32 s41, 32768
    buffer_load_dwordx4 v[232:235], v231, s[16:19], 0 offen
    buffer_load_dwordx4 v[236:239], v231, s[16:19], s41 offen
    s_add_u32 m0, s30, 65536
    s_nop 0
    buffer_load_dwordx4 v229, s[12:15], s27 offen lds
    buffer_load_dwordx4 v230, s[12:15], s27 offen offset:1024 lds
    s_add_u32 s27, s27, 131072
    s_add_u32 m0, s30, 73728
    s_nop 0
    buffer_load_dwordx4 v229, s[12:15], s27 offen lds
    buffer_load_dwordx4 v230, s[12:15], s27 offen offset:1024 lds
    s_add_u32 s27, s27, 131072
    s_add_u32 m0, s30, 81920
    s_nop 0
    buffer_load_dwordx4 v229, s[12:15], s27 offen lds
    buffer_load_dwordx4 v230, s[12:15], s27 offen offset:1024 lds
    s_add_u32 s27, s27, 131072
    s_add_u32 m0, s30, 90112
    s_nop 0
    buffer_load_dwordx4 v229, s[12:15], s27 offen lds
    buffer_load_dwordx4 v230, s[12:15], s27 offen offset:1024 lds
    s_add_u32 s27, s27, 131072
    s_add_u32 m0, s30, 98304
    s_nop 0
    buffer_load_dwordx4 v229, s[12:15], s27 offen lds
    buffer_load_dwordx4 v230, s[12:15], s27 offen offset:1024 lds
    s_add_u32 s27, s27, 131072
    s_cmp_lg_u32 s21, 0
    s_cbranch_scc1 fw_149
    v_and_b32 v244, 15, v250
    v_lshlrev_b32 v244, 7, v244
    s_mov_b32 s97, 0x20000
gp_150:
    buffer_load_dword v242, v244, s[32:35], s43 offen sc1
    s_waitcnt vmcnt(0) lgkmcnt(0)
    v_cmp_ne_u32 vcc, s31, v242
    s_cbranch_vccz gpd_151
    s_sleep 4
    s_sub_u32 s97, s97, 1
    s_cmp_lg_u32 s97, 0
    s_cbranch_scc1 gp_150
gpd_151:
fw_149:
    s_add_u32 s88, s88, 1
    ds_add_u32 v246, v248
    ds_read_b32 v249, v247
    s_waitcnt lgkmcnt(0)
    v_cmp_gt_u32 vcc, s88, v249
    s_cbranch_vccnz spin_152
ok_153:
    s_setprio 0
    buffer_load_dwordx4 v[96:99], v228, s[8:11], s26 offen offset:0 sc1
    buffer_load_dwordx4 v[100:103], v228, s[8:11], s26 offen offset:1024 sc1
    buffer_load_dwordx4 v[104:107], v228, s[8:11], s26 offen offset:2048 sc1
    buffer_load_dwordx4 v[108:111], v228, s[8:11], s26 offen offset:3072 sc1
    s_add_u32 s26, s26, 4096
    buffer_load_dwordx4 v[112:115], v228, s[8:11], s26 offen offset:0 sc1
    buffer_load_dwordx4 v[116:119], v228, s[8:11], s26 offen offset:1024 sc1
    buffer_load_dwordx4 v[120:123], v228, s[8:11], s26 offen offset:2048 sc1
    buffer_load_dwordx4 v[124:127], v228, s[8:11], s26 offen offset:3072 sc1
    s_add_u32 s26, s26, 4096
    buffer_load_dwordx4 v[128:131], v228, s[8:11], s26 offen offset:0 sc1
    buffer_load_dwordx4 v[132:135], v228, s[8:11], s26 offen offset:1024 sc1
    buffer_load_dwordx4 v[136:139], v228, s[8:11], s26 offen offset:2048 sc1
    buffer_load_dwordx4 v[140:143], v228, s[8:11], s26 offen offset:3072 sc1
    s_add_u32 s26, s26, 4096
    s_waitcnt vmcnt(12)
    s_add_u32 s88, s88, 1
    ds_add_u32 v246, v248
    ds_read_b32 v249, v247
    s_waitcnt lgkmcnt(0)
    v_cmp_gt_u32 vcc, s88, v249
    s_cbranch_vccnz spin_154
ok_155:
    ds_read_b64_tr_b16 v[32:33], v224 offset:0
    ds_read_b64_tr_b16 v[34:35], v224 offset:2048
    ds_read_b64_tr_b16 v[36:37], v225 offset:0
    ds_read_b64_tr_b16 v[38:39], v225 offset:2048
    ds_read_b64_tr_b16 v[40:41], v226 offset:0
    ds_read_b64_tr_b16 v[42:43], v226 offset:2048
    ds_read_b64_tr_b16 v[44:45], v227 offset:0
    ds_read_b64_tr_b16 v[46:47], v227 offset:2048
    ds_read_b64_tr_b16 v[48:49], v224 offset:4096
    ds_read_b64_tr_b16 v[50:51], v224 offset:6144
    ds_read_b64_tr_b16 v[52:53], v225 offset:4096
    ds_read_b64_tr_b16 v[54:55], v225 offset:6144
    ds_read_b64_tr_b16 v[56:57], v226 offset:4096
    ds_read_b64_tr_b16 v[58:59], v226 offset:6144
    ds_read_b64_tr_b16 v[60:61], v227 offset:4096
    ds_read_b64_tr_b16 v[62:63], v227 offset:6144
    s_add_u32 s88, s88, 1
    ds_add_u32 v246, v248
    ds_read_b32 v249, v247
    s_waitcnt vmcnt(8)
    s_waitcnt lgkmcnt(0)
    v_cmp_gt_u32 vcc, s88, v249
    s_cbranch_vccnz spin_156
ok_157:
    s_add_u32 s88, s88, 1
    ds_add_u32 v246, v248
    v_mfma_f32_16x16x32_bf16 v[0:3], v[32:35], v[96:99], v[0:3]
    ds_read_b64_tr_b16 v[64:65], v224 offset:8192
    ds_read_b64_tr_b16 v[66:67], v224 offset:10240
    v_mfma_f32_16x16x32_bf16 v[4:7], v[32:35], v[100:103], v[4:7]
    ds_read_b64_tr_b16 v[68:69], v225 offset:8192
    s_add_u32 m0, s30, 106496
    s_nop 0
    buffer_load_dwordx4 v229, s[12:15], s27 offen lds
    v_mfma_f32_16x16x32_bf16 v[8:11], v[36:39], v[96:99], v[8:11]
    ds_read_b64_tr_b16 v[70:71], v225 offset:10240
    ds_read_b64_tr_b16 v[72:73], v226 offset:8192
    v_mfma_f32_16x16x32_bf16 v[12:15], v[36:39], v[100:103], v[12:15]
    ds_read_b64_tr_b16 v[74:75], v226 offset:10240
    buffer_load_dwordx4 v230, s[12:15], s27 offen offset:1024 lds
    s_add_u32 s27, s27, 131072
    v_mfma_f32_16x16x32_bf16 v[16:19], v[40:43], v[96:99], v[16:19]
    ds_read_b64_tr_b16 v[76:77], v227 offset:8192
    ds_read_b64_tr_b16 v[78:79], v227 offset:10240
    v_mfma_f32_16x16x32_bf16 v[20:23], v[40:43], v[100:103], v[20:23]
    ds_read_b64_tr_b16 v[80:81], v224 offset:12288
    v_mfma_f32_16x16x32_bf16 v[24:27], v[44:47], v[96:99], v[24:27]
    buffer_load_dwordx4 v[144:147], v228, s[8:11], s26 offen offset:0 sc1
    ds_read_b64_tr_b16 v[82:83], v224 offset:14336
    v_mfma_f32_16x16x32_bf16 v[28:31], v[44:47], v[100:103], v[28:31]
    ds_read_b64_tr_b16 v[84:85], v225 offset:12288
    ds_read_b64_tr_b16 v[86:87], v225 offset:14336
    v_mfma_f32_16x16x32_bf16 v[0:3], v[48:51], v[104:107], v[0:3]
    buffer_load_dwordx4 v[148:151], v228, s[8:11], s26 offen offset:1024 sc1
    ds_read_b64_tr_b16 v[88:89], v226 offset:12288
    v_mfma_f32_16x16x32_bf16 v[4:7], v[48:51], v[108:111], v[4:7]
    ds_read_b64_tr_b16 v[90:91], v226 offset:14336
    ds_read_b64_tr_b16 v[92:93], v227 offset:12288
    v_mfma_f32_16x16x32_bf16 v[8:11], v[52:55], v[104:107], v[8:11]
    buffer_load_dwordx4 v[152:155], v228, s[8:11], s26 offen offset:2048 sc1
    ds_read_b64_tr_b16 v[94:95], v227 offset:14336
    v_mfma_f32_16x16x32_bf16 v[12:15], v[52:55], v[108:111], v[12:15]
    buffer_load_dwordx4 v[156:159], v228, s[8:11], s26 offen offset:3072 sc1
    s_add_u32 s26, s26, 4096
    v_mfma_f32_16x16x32_bf16 v[16:19], v[56:59], v[104:107], v[16:19]
    v_mfma_f32_16x16x32_bf16 v[20:23], v[56:59], v[108:111], v[20:23]
    ds_read_b32 v249, v247
    v_mfma_f32_16x16x32_bf16 v[24:27], v[60:63], v[104:107], v[24:27]
    v_mfma_f32_16x16x32_bf16 v[28:31], v[60:63], v[108:111], v[28:31]
    s_waitcnt vmcnt(10)
    s_waitcnt lgkmcnt(0)
    v_cmp_gt_u32 vcc, s88, v249
    s_cbranch_vccnz spin_158
ok_159:
    s_add_u32 s88, s88, 1
    ds_add_u32 v246, v248
    v_mfma_f32_16x16x32_bf16 v[0:3], v[64:67], v[112:115], v[0:3]
    ds_read_b64_tr_b16 v[32:33], v224 offset:16384
    ds_read_b64_tr_b16 v[34:35], v224 offset:18432
    v_mfma_f32_16x16x32_bf16 v[4:7], v[64:67], v[116:119], v[4:7]
    ds_read_b64_tr_b16 v[36:37], v225 offset:16384
    s_add_u32 m0, s30, 114688
    s_nop 0
    buffer_load_dwordx4 v229, s[12:15], s27 offen lds
    v_mfma_f32_16x16x32_bf16 v[8:11], v[68:71], v[112:115], v[8:11]
    ds_read_b64_tr_b16 v[38:39], v225 offset:18432
    ds_read_b64_tr_b16 v[40:41], v226 offset:16384
    v_mfma_f32_16x16x32_bf16 v[12:15], v[68:71], v[116:119], v[12:15]
    ds_read_b64_tr_b16 v[42:43], v226 offset:18432
    buffer_load_dwordx4 v230, s[12:15], s27 offen offset:1024 lds
    s_add_u32 s27, s27, 131072
    v_mfma_f32_16x16x32_bf16 v[16:19], v[72:75], v[112:115], v[16:19]
    ds_read_b64_tr_b16 v[44:45], v227 offset:16384
    ds_read_b64_tr_b16 v[46:47], v227 offset:18432
    v_mfma_f32_16x16x32_bf16 v[20:23], v[72:75], v[116:119], v[20:23]
    ds_read_b64_tr_b16 v[48:49], v224 offset:20480
    v_mfma_f32_16x16x32_bf16 v[24:27], v[76:79], v[112:115], v[24:27]
    buffer_load_dwordx4 v[160:163], v228, s[8:11], s26 offen offset:0 sc1
    ds_read_b64_tr_b16 v[50:51], v224 offset:22528
    v_mfma_f32_16x16x32_bf16 v[28:31], v[76:79], v[116:119], v[28:31]
    ds_read_b64_tr_b16 v[52:53], v225 offset:20480
    ds_read_b64_tr_b16 v[54:55], v225 offset:22528
    v_mfma_f32_16x16x32_bf16 v[0:3], v[80:83], v[120:123], v[0:3]
    buffer_load_dwordx4 v[164:167], v228, s[8:11], s26 offen offset:1024 sc1
    ds_read_b64_tr_b16 v[56:57], v226 offset:20480
    v_mfma_f32_16x16x32_bf16 v[4:7], v[80:83], v[124:127], v[4:7]
    ds_read_b64_tr_b16 v[58:59], v226 offset:22528
    ds_read_b64_tr_b16 v[60:61], v227 offset:20480
    v_mfma_f32_16x16x32_bf16 v[8:11], v[84:87], v[120:123], v[8:11]
    buffer_load_dwordx4 v[168:171], v228, s[8:11], s26 offen offset:2048 sc1
    ds_read_b64_tr_b16 v[62:63], v227 offset:22528
    v_mfma_f32_16x16x32_bf16 v[12:15], v[84:87], v[124:127], v[12:15]
    buffer_load_dwordx4 v[172:175], v228, s[8:11], s26 offen offset:3072 sc1
    s_add_u32 s26, s26, 4096
    v_mfma_f32_16x16x32_bf16 v[16:19], v[88:91], v[120:123], v[16:19]
    v_mfma_f32_16x16x32_bf16 v[20:23], v[88:91], v[124:127], v[20:23]
    ds_read_b32 v249, v247
    v_mfma_f32_16x16x32_bf16 v[24:27], v[92:95], v[120:123], v[24:27]
    v_mfma_f32_16x16x32_bf16 v[28:31], v[92:95], v[124:127], v[28:31]
    s_waitcnt vmcnt(12)
    s_waitcnt lgkmcnt(0)
    v_cmp_gt_u32 vcc, s88, v249
    s_cbranch_vccnz spin_160
ok_161:
    s_add_u32 s88, s88, 1
    ds_add_u32 v246, v248
    v_mfma_f32_16x16x32_bf16 v[0:3], v[32:35], v[128:131], v[0:3]
    ds_read_b64_tr_b16 v[64:65], v224 offset:24576
    ds_read_b64_tr_b16 v[66:67], v224 offset:26624
    v_mfma_f32_16x16x32_bf16 v[4:7], v[32:35], v[132:135], v[4:7]
    ds_read_b64_tr_b16 v[68:69], v225 offset:24576
    s_add_u32 m0, s30, 122880
    s_nop 0
    buffer_load_dwordx4 v229, s[12:15], s27 offen lds
    v_mfma_f32_16x16x32_bf16 v[8:11], v[36:39], v[128:131], v[8:11]
    ds_read_b64_tr_b16 v[70:71], v225 offset:26624
    ds_read_b64_tr_b16 v[72:73], v226 offset:24576
    v_mfma_f32_16x16x32_bf16 v[12:15], v[36:39], v[132:135], v[12:15]
    ds_read_b64_tr_b16 v[74:75], v226 offset:26624
    buffer_load_dwordx4 v230, s[12:15], s27 offen offset:1024 lds
    s_add_u32 s27, s27, 131072
    v_mfma_f32_16x16x32_bf16 v[16:19], v[40:43], v[128:131], v[16:19]
    ds_read_b64_tr_b16 v[76:77], v227 offset:24576
    ds_read_b64_tr_b16 v[78:79], v227 offset:26624
    v_mfma_f32_16x16x32_bf16 v[20:23], v[40:43], v[132:135], v[20:23]
    ds_read_b64_tr_b16 v[80:81], v224 offset:28672
    v_mfma_f32_16x16x32_bf16 v[24:27], v[44:47], v[128:131], v[24:27]
    buffer_load_dwordx4 v[176:179], v228, s[8:11], s26 offen offset:0 sc1
    ds_read_b64_tr_b16 v[82:83], v224 offset:30720
    v_mfma_f32_16x16x32_bf16 v[28:31], v[44:47], v[132:135], v[28:31]
    ds_read_b64_tr_b16 v[84:85], v225 offset:28672
    ds_read_b64_tr_b16 v[86:87], v225 offset:30720
    v_mfma_f32_16x16x32_bf16 v[0:3], v[48:51], v[136:139], v[0:3]
    buffer_load_dwordx4 v[180:183], v228, s[8:11], s26 offen offset:1024 sc1
    ds_read_b64_tr_b16 v[88:89], v226 offset:28672
    v_mfma_f32_16x16x32_bf16 v[4:7], v[48:51], v[140:143], v[4:7]
    ds_read_b64_tr_b16 v[90:91], v226 offset:30720
    ds_read_b64_tr_b16 v[92:93], v227 offset:28672
    v_mfma_f32_16x16x32_bf16 v[8:11], v[52:55], v[136:139], v[8:11]
    buffer_load_dwordx4 v[184:187], v228, s[8:11], s26 offen offset:2048 sc1
    ds_read_b64_tr_b16 v[94:95], v227 offset:30720
    v_mfma_f32_16x16x32_bf16 v[12:15], v[52:55], v[140:143], v[12:15]
    buffer_load_dwordx4 v[188:191], v228, s[8:11], s26 offen offset:3072 sc1
    s_add_u32 s26, s26, 4096
    v_mfma_f32_16x16x32_bf16 v[16:19], v[56:59], v[136:139], v[16:19]
    v_mfma_f32_16x16x32_bf16 v[20:23], v[56:59], v[140:143], v[20:23]
    ds_read_b32 v249, v247
    v_mfma_f32_16x16x32_bf16 v[24:27], v[60:63], v[136:139], v[24:27]
    v_mfma_f32_16x16x32_bf16 v[28:31], v[60:63], v[140:143], v[28:31]
    s_waitcnt vmcnt(12)
    s_waitcnt lgkmcnt(0)
    v_cmp_gt_u32 vcc, s88, v249
    s_cbranch_vccnz spin_162
ok_163:
    s_add_u32 s88, s88, 1
    ds_add_u32 v246, v248
    v_mfma_f32_16x16x32_bf16 v[0:3], v[64:67], v[144:147], v[0:3]
    ds_read_b64_tr_b16 v[32:33], v224 offset:32768
    ds_read_b64_tr_b16 v[34:35], v224 offset:34816
    v_mfma_f32_16x16x32_bf16 v[4:7], v[64:67], v[148:151], v[4:7]
    ds_read_b64_tr_b16 v[36:37], v225 offset:32768
    s_add_u32 m0, s30, 65536
    s_nop 0
    buffer_load_dwordx4 v229, s[12:15], s27 offen lds
    v_mfma_f32_16x16x32_bf16 v[8:11], v[68:71], v[144:147], v[8:11]
    ds_read_b64_tr_b16 v[38:39], v225 offset:34816
    ds_read_b64_tr_b16 v[40:41], v226 offset:32768
    v_mfma_f32_16x16x32_bf16 v[12:15], v[68:71], v[148:151], v[12:15]
    ds_read_b64_tr_b16 v[42:43], v226 offset:34816
    buffer_load_dwordx4 v230, s[12:15], s27 offen offset:1024 lds
    s_add_u32 s27, s27, 131072
    v_mfma_f32_16x16x32_bf16 v[16:19], v[72:75], v[144:147], v[16:19]
    ds_read_b64_tr_b16 v[44:45], v227 offset:32768
    ds_read_b64_tr_b16 v[46:47], v227 offset:34816
    v_mfma_f32_16x16x32_bf16 v[20:23], v[72:75], v[148:151], v[20:23]
    ds_read_b64_tr_b16 v[48:49], v224 offset:36864
    v_mfma_f32_16x16x32_bf16 v[24:27], v[76:79], v[144:147], v[24:27]
    buffer_load_dwordx4 v[192:195], v228, s[8:11], s26 offen offset:0 sc1
    ds_read_b64_tr_b16 v[50:51], v224 offset:38912
    v_mfma_f32_16x16x32_bf16 v[28:31], v[76:79], v[148:151], v[28:31]
    ds_read_b64_tr_b16 v[52:53], v225 offset:36864
    ds_read_b64_tr_b16 v[54:55], v225 offset:38912
    v_mfma_f32_16x16x32_bf16 v[0:3], v[80:83], v[152:155], v[0:3]
    buffer_load_dwordx4 v[196:199], v228, s[8:11], s26 offen offset:1024 sc1
    ds_read_b64_tr_b16 v[56:57], v226 offset:36864
    v_mfma_f32_16x16x32_bf16 v[4:7], v[80:83], v[156:159], v[4:7]
    ds_read_b64_tr_b16 v[58:59], v226 offset:38912
    ds_read_b64_tr_b16 v[60:61], v227 offset:36864
    v_mfma_f32_16x16x32_bf16 v[8:11], v[84:87], v[152:155], v[8:11]
    buffer_load_dwordx4 v[200:203], v228, s[8:11], s26 offen offset:2048 sc1
    ds_read_b64_tr_b16 v[62:63], v227 offset:38912
    v_mfma_f32_16x16x32_bf16 v[12:15], v[84:87], v[156:159], v[12:15]
    buffer_load_dwordx4 v[204:207], v228, s[8:11], s26 offen offset:3072 sc1
    s_add_u32 s26, s26, 4096
    v_mfma_f32_16x16x32_bf16 v[16:19], v[88:91], v[152:155], v[16:19]
    v_mfma_f32_16x16x32_bf16 v[20:23], v[88:91], v[156:159], v[20:23]
    ds_read_b32 v249, v247
    v_mfma_f32_16x16x32_bf16 v[24:27], v[92:95], v[152:155], v[24:27]
    v_mfma_f32_16x16x32_bf16 v[28:31], v[92:95], v[156:159], v[28:31]
    s_waitcnt vmcnt(12)
    s_waitcnt lgkmcnt(0)
    v_cmp_gt_u32 vcc, s88, v249
    s_cbranch_vccnz spin_164
ok_165:
    s_add_u32 s88, s88, 1
    ds_add_u32 v246, v248
    v_mfma_f32_16x16x32_bf16 v[0:3], v[32:35], v[160:163], v[0:3]
    ds_read_b64_tr_b16 v[64:65], v224 offset:40960
    ds_read_b64_tr_b16 v[66:67], v224 offset:43008
    v_mfma_f32_16x16x32_bf16 v[4:7], v[32:35], v[164:167], v[4:7]
    ds_read_b64_tr_b16 v[68:69], v225 offset:40960
    s_add_u32 m0, s30, 73728
    s_nop 0
    buffer_load_dwordx4 v229, s[12:15], s27 offen lds
    v_mfma_f32_16x16x32_bf16 v[8:11], v[36:39], v[160:163], v[8:11]
    ds_read_b64_tr_b16 v[70:71], v225 offset:43008
    ds_read_b64_tr_b16 v[72:73], v226 offset:40960
    v_mfma_f32_16x16x32_bf16 v[12:15], v[36:39], v[164:167], v[12:15]
    ds_read_b64_tr_b16 v[74:75], v226 offset:43008
    buffer_load_dwordx4 v230, s[12:15], s27 offen offset:1024 lds
    s_add_u32 s27, s27, 131072
    v_mfma_f32_16x16x32_bf16 v[16:19], v[40:43], v[160:163], v[16:19]
    ds_read_b64_tr_b16 v[76:77], v227 offset:40960
    ds_read_b64_tr_b16 v[78:79], v227 offset:43008
    v_mfma_f32_16x16x32_bf16 v[20:23], v[40:43], v[164:167], v[20:23]
    ds_read_b64_tr_b16 v[80:81], v224 offset:45056
    v_mfma_f32_16x16x32_bf16 v[24:27], v[44:47], v[160:163], v[24:27]
    buffer_load_dwordx4 v[208:211], v228, s[8:11], s26 offen offset:0 sc1
    ds_read_b64_tr_b16 v[82:83], v224 offset:47104
    v_mfma_f32_16x16x32_bf16 v[28:31], v[44:47], v[164:167], v[28:31]
    ds_read_b64_tr_b16 v[84:85], v225 offset:45056
    ds_read_b64_tr_b16 v[86:87], v225 offset:47104
    v_mfma_f32_16x16x32_bf16 v[0:3], v[48:51], v[168:171], v[0:3]
    buffer_load_dwordx4 v[212:215], v228, s[8:11], s26 offen offset:1024 sc1
    ds_read_b64_tr_b16 v[88:89], v226 offset:45056
    v_mfma_f32_16x16x32_bf16 v[4:7], v[48:51], v[172:175], v[4:7]
    ds_read_b64_tr_b16 v[90:91], v226 offset:47104
    ds_read_b64_tr_b16 v[92:93], v227 offset:45056
    v_mfma_f32_16x16x32_bf16 v[8:11], v[52:55], v[168:171], v[8:11]
    buffer_load_dwordx4 v[216:219], v228, s[8:11], s26 offen offset:2048 sc1
    ds_read_b64_tr_b16 v[94:95], v227 offset:47104
    v_mfma_f32_16x16x32_bf16 v[12:15], v[52:55], v[172:175], v[12:15]
    buffer_load_dwordx4 v[220:223], v228, s[8:11], s26 offen offset:3072 sc1
    s_add_u32 s26, s26, 4096
    v_mfma_f32_16x16x32_bf16 v[16:19], v[56:59], v[168:171], v[16:19]
    v_mfma_f32_16x16x32_bf16 v[20:23], v[56:59], v[172:175], v[20:23]
    ds_read_b32 v249, v247
    v_mfma_f32_16x16x32_bf16 v[24:27], v[60:63], v[168:171], v[24:27]
    v_mfma_f32_16x16x32_bf16 v[28:31], v[60:63], v[172:175], v[28:31]
    s_mov_b32 s29, 2
.p2align 3
    s_nop 0
finB_166:
    s_waitcnt vmcnt(12)
    s_waitcnt lgkmcnt(0)
    v_cmp_gt_u32 vcc, s88, v249
    s_cbranch_vccnz spin_167
ok_168:
    s_add_u32 s88, s88, 1
    ds_add_u32 v246, v248
    v_mfma_f32_16x16x32_bf16 v[0:3], v[64:67], v[176:179], v[0:3]
    ds_read_b64_tr_b16 v[32:33], v224 offset:49152
    ds_read_b64_tr_b16 v[34:35], v224 offset:51200
    v_mfma_f32_16x16x32_bf16 v[4:7], v[64:67], v[180:183], v[4:7]
    ds_read_b64_tr_b16 v[36:37], v225 offset:49152
    s_add_u32 m0, s30, 81920
    s_nop 0
    buffer_load_dwordx4 v229, s[12:15], s27 offen lds
    v_mfma_f32_16x16x32_bf16 v[8:11], v[68:71], v[176:179], v[8:11]
    ds_read_b64_tr_b16 v[38:39], v225 offset:51200
    ds_read_b64_tr_b16 v[40:41], v226 offset:49152
    v_mfma_f32_16x16x32_bf16 v[12:15], v[68:71], v[180:183], v[12:15]
    ds_read_b64_tr_b16 v[42:43], v226 offset:51200
    buffer_load_dwordx4 v230, s[12:15], s27 offen offset:1024 lds
    s_add_u32 s27, s27, 131072
    v_mfma_f32_16x16x32_bf16 v[16:19], v[72:75], v[176:179], v[16:19]
    ds_read_b64_tr_b16 v[44:45], v227 offset:49152
    ds_read_b64_tr_b16 v[46:47], v227 offset:51200
    v_mfma_f32_16x16x32_bf16 v[20:23], v[72:75], v[180:183], v[20:23]
    ds_read_b64_tr_b16 v[48:49], v224 offset:53248
    v_mfma_f32_16x16x32_bf16 v[24:27], v[76:79], v[176:179], v[24:27]
    buffer_load_dwordx4 v[96:99], v228, s[8:11], s26 offen offset:0 sc1
    ds_read_b64_tr_b16 v[50:51], v224 offset:55296
    v_mfma_f32_16x16x32_bf16 v[28:31], v[76:79], v[180:183], v[28:31]
    ds_read_b64_tr_b16 v[52:53], v225 offset:53248
    ds_read_b64_tr_b16 v[54:55], v225 offset:55296
    v_mfma_f32_16x16x32_bf16 v[0:3], v[80:83], v[184:187], v[0:3]
    buffer_load_dwordx4 v[100:103], v228, s[8:11], s26 offen offset:1024 sc1
    ds_read_b64_tr_b16 v[56:57], v226 offset:53248
    v_mfma_f32_16x16x32_bf16 v[4:7], v[80:83], v[188:191], v[4:7]
    ds_read_b64_tr_b16 v[58:59], v226 offset:55296
    ds_read_b64_tr_b16 v[60:61], v227 offset:53248
    v_mfma_f32_16x16x32_bf16 v[8:11], v[84:87], v[184:187], v[8:11]
    buffer_load_dwordx4 v[104:107], v228, s[8:11], s26 offen offset:2048 sc1
    ds_read_b64_tr_b16 v[62:63], v227 offset:55296
    v_mfma_f32_16x16x32_bf16 v[12:15], v[84:87], v[188:191], v[12:15]
    buffer_load_dwordx4 v[108:111], v228, s[8:11], s26 offen offset:3072 sc1
    s_add_u32 s26, s26, 4096
    v_mfma_f32_16x16x32_bf16 v[16:19], v[88:91], v[184:187], v[16:19]
    v_mfma_f32_16x16x32_bf16 v[20:23], v[88:91], v[188:191], v[20:23]
    ds_read_b32 v249, v247
    v_mfma_f32_16x16x32_bf16 v[24:27], v[92:95], v[184:187], v[24:27]
    v_mfma_f32_16x16x32_bf16 v[28:31], v[92:95], v[188:191], v[28:31]
    s_waitcnt vmcnt(12)
    s_waitcnt lgkmcnt(0)
    v_cmp_gt_u32 vcc, s88, v249
    s_cbranch_vccnz spin_169
ok_170:
    s_add_u32 s88, s88, 1
    ds_add_u32 v246, v248
    v_mfma_f32_16x16x32_bf16 v[0:3], v[32:35], v[192:195], v[0:3]
    ds_read_b64_tr_b16 v[64:65], v224 offset:57344
    ds_read_b64_tr_b16 v[66:67], v224 offset:59392
    v_mfma_f32_16x16x32_bf16 v[4:7], v[32:35], v[196:199], v[4:7]
    ds_read_b64_tr_b16 v[68:69], v225 offset:57344
    s_add_u32 m0, s30, 90112
    s_nop 0
    buffer_load_dwordx4 v229, s[12:15], s27 offen lds
    v_mfma_f32_16x16x32_bf16 v[8:11], v[36:39], v[192:195], v[8:11]
    ds_read_b64_tr_b16 v[70:71], v225 offset:59392
    ds_read_b64_tr_b16 v[72:73], v226 offset:57344
    v_mfma_f32_16x16x32_bf16 v[12:15], v[36:39], v[196:199], v[12:15]
    ds_read_b64_tr_b16 v[74:75], v226 offset:59392
    buffer_load_dwordx4 v230, s[12:15], s27 offen offset:1024 lds
    s_add_u32 s27, s27, 131072
    v_mfma_f32_16x16x32_bf16 v[16:19], v[40:43], v[192:195], v[16:19]
    ds_read_b64_tr_b16 v[76:77], v227 offset:57344
    ds_read_b64_tr_b16 v[78:79], v227 offset:59392
    v_mfma_f32_16x16x32_bf16 v[20:23], v[40:43], v[196:199], v[20:23]
    ds_read_b64_tr_b16 v[80:81], v224 offset:61440
    v_mfma_f32_16x16x32_bf16 v[24:27], v[44:47], v[192:195], v[24:27]
    buffer_load_dwordx4 v[112:115], v228, s[8:11], s26 offen offset:0 sc1
    ds_read_b64_tr_b16 v[82:83], v224 offset:63488
    v_mfma_f32_16x16x32_bf16 v[28:31], v[44:47], v[196:199], v[28:31]
    ds_read_b64_tr_b16 v[84:85], v225 offset:61440
    ds_read_b64_tr_b16 v[86:87], v225 offset:63488
    v_mfma_f32_16x16x32_bf16 v[0:3], v[48:51], v[200:203], v[0:3]
    buffer_load_dwordx4 v[116:119], v228, s[8:11], s26 offen offset:1024 sc1
    ds_read_b64_tr_b16 v[88:89], v226 offset:61440
    v_mfma_f32_16x16x32_bf16 v[4:7], v[48:51], v[204:207], v[4:7]
    ds_read_b64_tr_b16 v[90:91], v226 offset:63488
    ds_read_b64_tr_b16 v[92:93], v227 offset:61440
    v_mfma_f32_16x16x32_bf16 v[8:11], v[52:55], v[200:203], v[8:11]
    buffer_load_dwordx4 v[120:123], v228, s[8:11], s26 offen offset:2048 sc1
    ds_read_b64_tr_b16 v[94:95], v227 offset:63488
    v_mfma_f32_16x16x32_bf16 v[12:15], v[52:55], v[204:207], v[12:15]
    buffer_load_dwordx4 v[124:127], v228, s[8:11], s26 offen offset:3072 sc1
    s_add_u32 s26, s26, 4096
    v_mfma_f32_16x16x32_bf16 v[16:19], v[56:59], v[200:203], v[16:19]
    v_mfma_f32_16x16x32_bf16 v[20:23], v[56:59], v[204:207], v[20:23]
    ds_read_b32 v249, v247
    v_mfma_f32_16x16x32_bf16 v[24:27], v[60:63], v[200:203], v[24:27]
    v_mfma_f32_16x16x32_bf16 v[28:31], v[60:63], v[204:207], v[28:31]
    s_waitcnt vmcnt(12)
    s_waitcnt lgkmcnt(0)
    v_cmp_gt_u32 vcc, s88, v249
    s_cbranch_vccnz spin_171
ok_172:
    s_add_u32 s88, s88, 1
    ds_add_u32 v246, v248
    v_mfma_f32_16x16x32_bf16 v[0:3], v[64:67], v[208:211], v[0:3]
    ds_read_b64_tr_b16 v[32:33], v224 offset:0
    ds_read_b64_tr_b16 v[34:35], v224 offset:2048
    v_mfma_f32_16x16x32_bf16 v[4:7], v[64:67], v[212:215], v[4:7]
    ds_read_b64_tr_b16 v[36:37], v225 offset:0
    s_add_u32 m0, s30, 98304
    s_nop 0
    buffer_load_dwordx4 v229, s[12:15], s27 offen lds
    v_mfma_f32_16x16x32_bf16 v[8:11], v[68:71], v[208:211], v[8:11]
    ds_read_b64_tr_b16 v[38:39], v225 offset:2048
    ds_read_b64_tr_b16 v[40:41], v226 offset:0
    v_mfma_f32_16x16x32_bf16 v[12:15], v[68:71], v[212:215], v[12:15]
    ds_read_b64_tr_b16 v[42:43], v226 offset:2048
    buffer_load_dwordx4 v230, s[12:15], s27 offen offset:1024 lds
    s_add_u32 s27, s27, 131072
    v_mfma_f32_16x16x32_bf16 v[16:19], v[72:75], v[208:211], v[16:19]
    ds_read_b64_tr_b16 v[44:45], v227 offset:0
    ds_read_b64_tr_b16 v[46:47], v227 offset:2048
    v_mfma_f32_16x16x32_bf16 v[20:23], v[72:75], v[212:215], v[20:23]
    ds_read_b64_tr_b16 v[48:49], v224 offset:4096
    v_mfma_f32_16x16x32_bf16 v[24:27], v[76:79], v[208:211], v[24:27]
    buffer_load_dwordx4 v[128:131], v228, s[8:11], s26 offen offset:0 sc1
    ds_read_b64_tr_b16 v[50:51], v224 offset:6144
    v_mfma_f32_16x16x32_bf16 v[28:31], v[76:79], v[212:215], v[28:31]
    ds_read_b64_tr_b16 v[52:53], v225 offset:4096
    ds_read_b64_tr_b16 v[54:55], v225 offset:6144
    v_mfma_f32_16x16x32_bf16 v[0:3], v[80:83], v[216:219], v[0:3]
    buffer_load_dwordx4 v[132:135], v228, s[8:11], s26 offen offset:1024 sc1
    ds_read_b64_tr_b16 v[56:57], v226 offset:4096
    v_mfma_f32_16x16x32_bf16 v[4:7], v[80:83], v[220:223], v[4:7]
    ds_read_b64_tr_b16 v[58:59], v226 offset:6144
    ds_read_b64_tr_b16 v[60:61], v227 offset:4096
    v_mfma_f32_16x16x32_bf16 v[8:11], v[84:87], v[216:219], v[8:11]
    buffer_load_dwordx4 v[136:139], v228, s[8:11], s26 offen offset:2048 sc1
    ds_read_b64_tr_b16 v[62:63], v227 offset:6144
    v_mfma_f32_16x16x32_bf16 v[12:15], v[84:87], v[220:223], v[12:15]
    buffer_load_dwordx4 v[140:143], v228, s[8:11], s26 offen offset:3072 sc1
    s_add_u32 s26, s26, 4096
    v_mfma_f32_16x16x32_bf16 v[16:19], v[88:91], v[216:219], v[16:19]
    v_mfma_f32_16x16x32_bf16 v[20:23], v[88:91], v[220:223], v[20:23]
    ds_read_b32 v249, v247
    v_mfma_f32_16x16x32_bf16 v[24:27], v[92:95], v[216:219], v[24:27]
    v_mfma_f32_16x16x32_bf16 v[28:31], v[92:95], v[220:223], v[28:31]
    s_waitcnt vmcnt(12)
    s_waitcnt lgkmcnt(0)
    v_cmp_gt_u32 vcc, s88, v249
    s_cbranch_vccnz spin_173
ok_174:
    s_add_u32 s88, s88, 1
    ds_add_u32 v246, v248
    v_mfma_f32_16x16x32_bf16 v[0:3], v[32:35], v[96:99], v[0:3]
    ds_read_b64_tr_b16 v[64:65], v224 offset:8192
    ds_read_b64_tr_b16 v[66:67], v224 offset:10240
    v_mfma_f32_16x16x32_bf16 v[4:7], v[32:35], v[100:103], v[4:7]
    ds_read_b64_tr_b16 v[68:69], v225 offset:8192
    s_add_u32 m0, s30, 106496
    s_nop 0
    buffer_load_dwordx4 v229, s[12:15], s27 offen lds
    v_mfma_f32_16x16x32_bf16 v[8:11], v[36:39], v[96:99], v[8:11]
    ds_read_b64_tr_b16 v[70:71], v225 offset:10240
    ds_read_b64_tr_b16 v[72:73], v226 offset:8192
    v_mfma_f32_16x16x32_bf16 v[12:15], v[36:39], v[100:103], v[12:15]
    ds_read_b64_tr_b16 v[74:75], v226 offset:10240
    buffer_load_dwordx4 v230, s[12:15], s27 offen offset:1024 lds
    s_add_u32 s27, s27, 131072
    v_mfma_f32_16x16x32_bf16 v[16:19], v[40:43], v[96:99], v[16:19]
    ds_read_b64_tr_b16 v[76:77], v227 offset:8192
    ds_read_b64_tr_b16 v[78:79], v227 offset:10240
    v_mfma_f32_16x16x32_bf16 v[20:23], v[40:43], v[100:103], v[20:23]
    ds_read_b64_tr_b16 v[80:81], v224 offset:12288
    v_mfma_f32_16x16x32_bf16 v[24:27], v[44:47], v[96:99], v[24:27]
    buffer_load_dwordx4 v[144:147], v228, s[8:11], s26 offen offset:0 sc1
    ds_read_b64_tr_b16 v[82:83], v224 offset:14336
    v_mfma_f32_16x16x32_bf16 v[28:31], v[44:47], v[100:103], v[28:31]
    ds_read_b64_tr_b16 v[84:85], v225 offset:12288
    ds_read_b64_tr_b16 v[86:87], v225 offset:14336
    v_mfma_f32_16x16x32_bf16 v[0:3], v[48:51], v[104:107], v[0:3]
    buffer_load_dwordx4 v[148:151], v228, s[8:11], s26 offen offset:1024 sc1
    ds_read_b64_tr_b16 v[88:89], v226 offset:12288
    v_mfma_f32_16x16x32_bf16 v[4:7], v[48:51], v[108:111], v[4:7]
    ds_read_b64_tr_b16 v[90:91], v226 offset:14336
    ds_read_b64_tr_b16 v[92:93], v227 offset:12288
    v_mfma_f32_16x16x32_bf16 v[8:11], v[52:55], v[104:107], v[8:11]
    buffer_load_dwordx4 v[152:155], v228, s[8:11], s26 offen offset:2048 sc1
    ds_read_b64_tr_b16 v[94:95], v227 offset:14336
    v_mfma_f32_16x16x32_bf16 v[12:15], v[52:55], v[108:111], v[12:15]
    buffer_load_dwordx4 v[156:159], v228, s[8:11], s26 offen offset:3072 sc1
    s_add_u32 s26, s26, 4096
    v_mfma_f32_16x16x32_bf16 v[16:19], v[56:59], v[104:107], v[16:19]
    v_mfma_f32_16x16x32_bf16 v[20:23], v[56:59], v[108:111], v[20:23]
    ds_read_b32 v249, v247
    v_mfma_f32_16x16x32_bf16 v[24:27], v[60:63], v[104:107], v[24:27]
    v_mfma_f32_16x16x32_bf16 v[28:31], v[60:63], v[108:111], v[28:31]
    s_waitcnt vmcnt(12)
    s_waitcnt lgkmcnt(0)
    v_cmp_gt_u32 vcc, s88, v249
    s_cbranch_vccnz spin_175
ok_176:
    s_add_u32 s88, s88, 1
    ds_add_u32 v246, v248
    v_mfma_f32_16x16x32_bf16 v[0:3], v[64:67], v[112:115], v[0:3]
    ds_read_b64_tr_b16 v[32:33], v224 offset:16384
    ds_read_b64_tr_b16 v[34:35], v224 offset:18432
    v_mfma_f32_16x16x32_bf16 v[4:7], v[64:67], v[116:119], v[4:7]
    ds_read_b64_tr_b16 v[36:37], v225 offset:16384
    s_add_u32 m0, s30, 114688
    s_nop 0
    buffer_load_dwordx4 v229, s[12:15], s27 offen lds
    v_mfma_f32_16x16x32_bf16 v[8:11], v[68:71], v[112:115], v[8:11]
    ds_read_b64_tr_b16 v[38:39], v225 offset:18432
    ds_read_b64_tr_b16 v[40:41], v226 offset:16384
    v_mfma_f32_16x16x32_bf16 v[12:15], v[68:71], v[116:119], v[12:15]
    ds_read_b64_tr_b16 v[42:43], v226 offset:18432
    buffer_load_dwordx4 v230, s[12:15], s27 offen offset:1024 lds
    s_add_u32 s27, s27, 131072
    v_mfma_f32_16x16x32_bf16 v[16:19], v[72:75], v[112:115], v[16:19]
    ds_read_b64_tr_b16 v[44:45], v227 offset:16384
    ds_read_b64_tr_b16 v[46:47], v227 offset:18432
    v_mfma_f32_16x16x32_bf16 v[20:23], v[72:75], v[116:119], v[20:23]
    ds_read_b64_tr_b16 v[48:49], v224 offset:20480
    v_mfma_f32_16x16x32_bf16 v[24:27], v[76:79], v[112:115], v[24:27]
    buffer_load_dwordx4 v[160:163], v228, s[8:11], s26 offen offset:0 sc1
    ds_read_b64_tr_b16 v[50:51], v224 offset:22528
    v_mfma_f32_16x16x32_bf16 v[28:31], v[76:79], v[116:119], v[28:31]
    ds_read_b64_tr_b16 v[52:53], v225 offset:20480
    ds_read_b64_tr_b16 v[54:55], v225 offset:22528
    v_mfma_f32_16x16x32_bf16 v[0:3], v[80:83], v[120:123], v[0:3]
    buffer_load_dwordx4 v[164:167], v228, s[8:11], s26 offen offset:1024 sc1
    ds_read_b64_tr_b16 v[56:57], v226 offset:20480
    v_mfma_f32_16x16x32_bf16 v[4:7], v[80:83], v[124:127], v[4:7]
    ds_read_b64_tr_b16 v[58:59], v226 offset:22528
    ds_read_b64_tr_b16 v[60:61], v227 offset:20480
    v_mfma_f32_16x16x32_bf16 v[8:11], v[84:87], v[120:123], v[8:11]
    buffer_load_dwordx4 v[168:171], v228, s[8:11], s26 offen offset:2048 sc1
    ds_read_b64_tr_b16 v[62:63], v227 offset:22528
    v_mfma_f32_16x16x32_bf16 v[12:15], v[84:87], v[124:127], v[12:15]
    buffer_load_dwordx4 v[172:175], v228, s[8:11], s26 offen offset:3072 sc1
    s_add_u32 s26, s26, 4096
    v_mfma_f32_16x16x32_bf16 v[16:19], v[88:91], v[120:123], v[16:19]
    v_mfma_f32_16x16x32_bf16 v[20:23], v[88:91], v[124:127], v[20:23]
    ds_read_b32 v249, v247
    v_mfma_f32_16x16x32_bf16 v[24:27], v[92:95], v[120:123], v[24:27]
    v_mfma_f32_16x16x32_bf16 v[28:31], v[92:95], v[124:127], v[28:31]
    s_waitcnt vmcnt(12)
    s_waitcnt lgkmcnt(0)
    v_cmp_gt_u32 vcc, s88, v249
    s_cbranch_vccnz spin_177
ok_178:
    s_add_u32 s88, s88, 1
    ds_add_u32 v246, v248
    v_mfma_f32_16x16x32_bf16 v[0:3], v[32:35], v[128:131], v[0:3]
    ds_read_b64_tr_b16 v[64:65], v224 offset:24576
    ds_read_b64_tr_b16 v[66:67], v224 offset:26624
    v_mfma_f32_16x16x32_bf16 v[4:7], v[32:35], v[132:135], v[4:7]
    ds_read_b64_tr_b16 v[68:69], v225 offset:24576
    s_add_u32 m0, s30, 122880
    s_nop 0
    buffer_load_dwordx4 v229, s[12:15], s27 offen lds
    v_mfma_f32_16x16x32_bf16 v[8:11], v[36:39], v[128:131], v[8:11]
    ds_read_b64_tr_b16 v[70:71], v225 offset:26624
    ds_read_b64_tr_b16 v[72:73], v226 offset:24576
    v_mfma_f32_16x16x32_bf16 v[12:15], v[36:39], v[132:135], v[12:15]
    ds_read_b64_tr_b16 v[74:75], v226 offset:26624
    buffer_load_dwordx4 v230, s[12:15], s27 offen offset:1024 lds
    s_add_u32 s27, s27, 131072
    v_mfma_f32_16x16x32_bf16 v[16:19], v[40:43], v[128:131], v[16:19]
    ds_read_b64_tr_b16 v[76:77], v227 offset:24576
    ds_read_b64_tr_b16 v[78:79], v227 offset:26624
    v_mfma_f32_16x16x32_bf16 v[20:23], v[40:43], v[132:135], v[20:23]
    ds_read_b64_tr_b16 v[80:81], v224 offset:28672
    v_mfma_f32_16x16x32_bf16 v[24:27], v[44:47], v[128:131], v[24:27]
    buffer_load_dwordx4 v[176:179], v228, s[8:11], s26 offen offset:0 sc1
    ds_read_b64_tr_b16 v[82:83], v224 offset:30720
    v_mfma_f32_16x16x32_bf16 v[28:31], v[44:47], v[132:135], v[28:31]
    ds_read_b64_tr_b16 v[84:85], v225 offset:28672
    ds_read_b64_tr_b16 v[86:87], v225 offset:30720
    v_mfma_f32_16x16x32_bf16 v[0:3], v[48:51], v[136:139], v[0:3]
    buffer_load_dwordx4 v[180:183], v228, s[8:11], s26 offen offset:1024 sc1
    ds_read_b64_tr_b16 v[88:89], v226 offset:28672
    v_mfma_f32_16x16x32_bf16 v[4:7], v[48:51], v[140:143], v[4:7]
    ds_read_b64_tr_b16 v[90:91], v226 offset:30720
    ds_read_b64_tr_b16 v[92:93], v227 offset:28672
    v_mfma_f32_16x16x32_bf16 v[8:11], v[52:55], v[136:139], v[8:11]
    buffer_load_dwordx4 v[184:187], v228, s[8:11], s26 offen offset:2048 sc1
    ds_read_b64_tr_b16 v[94:95], v227 offset:30720
    v_mfma_f32_16x16x32_bf16 v[12:15], v[52:55], v[140:143], v[12:15]
    buffer_load_dwordx4 v[188:191], v228, s[8:11], s26 offen offset:3072 sc1
    s_add_u32 s26, s26, 4096
    v_mfma_f32_16x16x32_bf16 v[16:19], v[56:59], v[136:139], v[16:19]
    v_mfma_f32_16x16x32_bf16 v[20:23], v[56:59], v[140:143], v[20:23]
    ds_read_b32 v249, v247
    v_mfma_f32_16x16x32_bf16 v[24:27], v[60:63], v[136:139], v[24:27]
    v_mfma_f32_16x16x32_bf16 v[28:31], v[60:63], v[140:143], v[28:31]
    s_waitcnt vmcnt(12)
    s_waitcnt lgkmcnt(0)
    v_cmp_gt_u32 vcc, s88, v249
    s_cbranch_vccnz spin_179
ok_180:
    s_add_u32 s88, s88, 1
    ds_add_u32 v246, v248
    v_mfma_f32_16x16x32_bf16 v[0:3], v[64:67], v[144:147], v[0:3]
    ds_read_b64_tr_b16 v[32:33], v224 offset:32768
    ds_read_b64_tr_b16 v[34:35], v224 offset:34816
    v_mfma_f32_16x16x32_bf16 v[4:7], v[64:67], v[148:151], v[4:7]
    ds_read_b64_tr_b16 v[36:37], v225 offset:32768
    s_add_u32 m0, s30, 65536
    s_nop 0
    buffer_load_dwordx4 v229, s[12:15], s27 offen lds
    v_mfma_f32_16x16x32_bf16 v[8:11], v[68:71], v[144:147], v[8:11]
    ds_read_b64_tr_b16 v[38:39], v225 offset:34816
    ds_read_b64_tr_b16 v[40:41], v226 offset:32768
    v_mfma_f32_16x16x32_bf16 v[12:15], v[68:71], v[148:151], v[12:15]
    ds_read_b64_tr_b16 v[42:43], v226 offset:34816
    buffer_load_dwordx4 v230, s[12:15], s27 offen offset:1024 lds
    s_add_u32 s27, s27, 131072
    v_mfma_f32_16x16x32_bf16 v[16:19], v[72:75], v[144:147], v[16:19]
    ds_read_b64_tr_b16 v[44:45], v227 offset:32768
    ds_read_b64_tr_b16 v[46:47], v227 offset:34816
    v_mfma_f32_16x16x32_bf16 v[20:23], v[72:75], v[148:151], v[20:23]
    ds_read_b64_tr_b16 v[48:49], v224 offset:36864
    v_mfma_f32_16x16x32_bf16 v[24:27], v[76:79], v[144:147], v[24:27]
    buffer_load_dwordx4 v[192:195], v228, s[8:11], s26 offen offset:0 sc1
    ds_read_b64_tr_b16 v[50:51], v224 offset:38912
    v_mfma_f32_16x16x32_bf16 v[28:31], v[76:79], v[148:151], v[28:31]
    ds_read_b64_tr_b16 v[52:53], v225 offset:36864
    ds_read_b64_tr_b16 v[54:55], v225 offset:38912
    v_mfma_f32_16x16x32_bf16 v[0:3], v[80:83], v[152:155], v[0:3]
    buffer_load_dwordx4 v[196:199], v228, s[8:11], s26 offen offset:1024 sc1
    ds_read_b64_tr_b16 v[56:57], v226 offset:36864
    v_mfma_f32_16x16x32_bf16 v[4:7], v[80:83], v[156:159], v[4:7]
    ds_read_b64_tr_b16 v[58:59], v226 offset:38912
    ds_read_b64_tr_b16 v[60:61], v227 offset:36864
    v_mfma_f32_16x16x32_bf16 v[8:11], v[84:87], v[152:155], v[8:11]
    buffer_load_dwordx4 v[200:203], v228, s[8:11], s26 offen offset:2048 sc1
    ds_read_b64_tr_b16 v[62:63], v227 offset:38912
    v_mfma_f32_16x16x32_bf16 v[12:15], v[84:87], v[156:159], v[12:15]
    buffer_load_dwordx4 v[204:207], v228, s[8:11], s26 offen offset:3072 sc1
    s_add_u32 s26, s26, 4096
    v_mfma_f32_16x16x32_bf16 v[16:19], v[88:91], v[152:155], v[16:19]
    v_mfma_f32_16x16x32_bf16 v[20:23], v[88:91], v[156:159], v[20:23]
    ds_read_b32 v249, v247
    v_mfma_f32_16x16x32_bf16 v[24:27], v[92:95], v[152:155], v[24:27]
    v_mfma_f32_16x16x32_bf16 v[28:31], v[92:95], v[156:159], v[28:31]
    s_waitcnt vmcnt(12)
    s_waitcnt lgkmcnt(0)
    v_cmp_gt_u32 vcc, s88, v249
    s_cbranch_vccnz spin_181
ok_182:
    s_add_u32 s88, s88, 1
    ds_add_u32 v246, v248
    v_mfma_f32_16x16x32_bf16 v[0:3], v[32:35], v[160:163], v[0:3]
    ds_read_b64_tr_b16 v[64:65], v224 offset:40960
    ds_read_b64_tr_b16 v[66:67], v224 offset:43008
    v_mfma_f32_16x16x32_bf16 v[4:7], v[32:35], v[164:167], v[4:7]
    ds_read_b64_tr_b16 v[68:69], v225 offset:40960
    s_add_u32 m0, s30, 73728
    s_nop 0
    buffer_load_dwordx4 v229, s[12:15], s27 offen lds
    v_mfma_f32_16x16x32_bf16 v[8:11], v[36:39], v[160:163], v[8:11]
    ds_read_b64_tr_b16 v[70:71], v225 offset:43008
    ds_read_b64_tr_b16 v[72:73], v226 offset:40960
    v_mfma_f32_16x16x32_bf16 v[12:15], v[36:39], v[164:167], v[12:15]
    ds_read_b64_tr_b16 v[74:75], v226 offset:43008
    buffer_load_dwordx4 v230, s[12:15], s27 offen offset:1024 lds
    s_add_u32 s27, s27, 131072
    v_mfma_f32_16x16x32_bf16 v[16:19], v[40:43], v[160:163], v[16:19]
    ds_read_b64_tr_b16 v[76:77], v227 offset:40960
    ds_read_b64_tr_b16 v[78:79], v227 offset:43008
    v_mfma_f32_16x16x32_bf16 v[20:23], v[40:43], v[164:167], v[20:23]
    ds_read_b64_tr_b16 v[80:81], v224 offset:45056
    v_mfma_f32_16x16x32_bf16 v[24:27], v[44:47], v[160:163], v[24:27]
    buffer_load_dwordx4 v[208:211], v228, s[8:11], s26 offen offset:0 sc1
    ds_read_b64_tr_b16 v[82:83], v224 offset:47104
    v_mfma_f32_16x16x32_bf16 v[28:31], v[44:47], v[164:167], v[28:31]
    ds_read_b64_tr_b16 v[84:85], v225 offset:45056
    ds_read_b64_tr_b16 v[86:87], v225 offset:47104
    v_mfma_f32_16x16x32_bf16 v[0:3], v[48:51], v[168:171], v[0:3]
    buffer_load_dwordx4 v[212:215], v228, s[8:11], s26 offen offset:1024 sc1
    ds_read_b64_tr_b16 v[88:89], v226 offset:45056
    v_mfma_f32_16x16x32_bf16 v[4:7], v[48:51], v[172:175], v[4:7]
    ds_read_b64_tr_b16 v[90:91], v226 offset:47104
    ds_read_b64_tr_b16 v[92:93], v227 offset:45056
    v_mfma_f32_16x16x32_bf16 v[8:11], v[52:55], v[168:171], v[8:11]
    buffer_load_dwordx4 v[216:219], v228, s[8:11], s26 offen offset:2048 sc1
    ds_read_b64_tr_b16 v[94:95], v227 offset:47104
    v_mfma_f32_16x16x32_bf16 v[12:15], v[52:55], v[172:175], v[12:15]
    buffer_load_dwordx4 v[220:223], v228, s[8:11], s26 offen offset:3072 sc1
    s_add_u32 s26, s26, 4096
    v_mfma_f32_16x16x32_bf16 v[16:19], v[56:59], v[168:171], v[16:19]
    v_mfma_f32_16x16x32_bf16 v[20:23], v[56:59], v[172:175], v[20:23]
    ds_read_b32 v249, v247
    v_mfma_f32_16x16x32_bf16 v[24:27], v[60:63], v[168:171], v[24:27]
    v_mfma_f32_16x16x32_bf16 v[28:31], v[60:63], v[172:175], v[28:31]
    s_sub_u32 s29, s29, 1
    s_cmp_lg_u32 s29, 0
    s_cbranch_scc1 finB_166
    s_waitcnt vmcnt(12)
    s_waitcnt lgkmcnt(0)
    v_cmp_gt_u32 vcc, s88, v249
    s_cbranch_vccnz spin_183
ok_184:
    s_add_u32 s88, s88, 1
    ds_add_u32 v246, v248
    v_mfma_f32_16x16x32_bf16 v[0:3], v[64:67], v[176:179], v[0:3]
    ds_read_b64_tr_b16 v[32:33], v224 offset:49152
    ds_read_b64_tr_b16 v[34:35], v224 offset:51200
    v_mfma_f32_16x16x32_bf16 v[4:7], v[64:67], v[180:183], v[4:7]
    ds_read_b64_tr_b16 v[36:37], v225 offset:49152
    s_add_u32 m0, s30, 81920
    s_nop 0
    buffer_load_dwordx4 v229, s[12:15], s27 offen lds
    v_mfma_f32_16x16x32_bf16 v[8:11], v[68:71], v[176:179], v[8:11]
    ds_read_b64_tr_b16 v[38:39], v225 offset:51200
    ds_read_b64_tr_b16 v[40:41], v226 offset:49152
    v_mfma_f32_16x16x32_bf16 v[12:15], v[68:71], v[180:183], v[12:15]
    ds_read_b64_tr_b16 v[42:43], v226 offset:51200
    buffer_load_dwordx4 v230, s[12:15], s27 offen offset:1024 lds
    s_add_u32 s27, s27, 131072
    v_mfma_f32_16x16x32_bf16 v[16:19], v[72:75], v[176:179], v[16:19]
    ds_read_b64_tr_b16 v[44:45], v227 offset:49152
    ds_read_b64_tr_b16 v[46:47], v227 offset:51200
    v_mfma_f32_16x16x32_bf16 v[20:23], v[72:75], v[180:183], v[20:23]
    ds_read_b64_tr_b16 v[48:49], v224 offset:53248
    v_mfma_f32_16x16x32_bf16 v[24:27], v[76:79], v[176:179], v[24:27]
    buffer_load_dwordx4 v[96:99], v228, s[8:11], s26 offen offset:0 sc1
    ds_read_b64_tr_b16 v[50:51], v224 offset:55296
    v_mfma_f32_16x16x32_bf16 v[28:31], v[76:79], v[180:183], v[28:31]
    ds_read_b64_tr_b16 v[52:53], v225 offset:53248
    ds_read_b64_tr_b16 v[54:55], v225 offset:55296
    v_mfma_f32_16x16x32_bf16 v[0:3], v[80:83], v[184:187], v[0:3]
    buffer_load_dwordx4 v[100:103], v228, s[8:11], s26 offen offset:1024 sc1
    ds_read_b64_tr_b16 v[56:57], v226 offset:53248
    v_mfma_f32_16x16x32_bf16 v[4:7], v[80:83], v[188:191], v[4:7]
    ds_read_b64_tr_b16 v[58:59], v226 offset:55296
    ds_read_b64_tr_b16 v[60:61], v227 offset:53248
    v_mfma_f32_16x16x32_bf16 v[8:11], v[84:87], v[184:187], v[8:11]
    buffer_load_dwordx4 v[104:107], v228, s[8:11], s26 offen offset:2048 sc1
    ds_read_b64_tr_b16 v[62:63], v227 offset:55296
    v_mfma_f32_16x16x32_bf16 v[12:15], v[84:87], v[188:191], v[12:15]
    buffer_load_dwordx4 v[108:111], v228, s[8:11], s26 offen offset:3072 sc1
    s_add_u32 s26, s26, 4096
    v_mfma_f32_16x16x32_bf16 v[16:19], v[88:91], v[184:187], v[16:19]
    v_mfma_f32_16x16x32_bf16 v[20:23], v[88:91], v[188:191], v[20:23]
    ds_read_b32 v249, v247
    v_mfma_f32_16x16x32_bf16 v[24:27], v[92:95], v[184:187], v[24:27]
    v_mfma_f32_16x16x32_bf16 v[28:31], v[92:95], v[188:191], v[28:31]
    s_waitcnt vmcnt(12)
    s_waitcnt lgkmcnt(0)
    v_cmp_gt_u32 vcc, s88, v249
    s_cbranch_vccnz spin_185
ok_186:
    s_add_u32 s88, s88, 1
    ds_add_u32 v246, v248
    v_mfma_f32_16x16x32_bf16 v[0:3], v[32:35], v[192:195], v[0:3]
    ds_read_b64_tr_b16 v[64:65], v224 offset:57344
    ds_read_b64_tr_b16 v[66:67], v224 offset:59392
    v_mfma_f32_16x16x32_bf16 v[4:7], v[32:35], v[196:199], v[4:7]
    ds_read_b64_tr_b16 v[68:69], v225 offset:57344
    s_add_u32 m0, s30, 90112
    s_nop 0
    buffer_load_dwordx4 v229, s[12:15], s27 offen lds
    v_mfma_f32_16x16x32_bf16 v[8:11], v[36:39], v[192:195], v[8:11]
    ds_read_b64_tr_b16 v[70:71], v225 offset:59392
    ds_read_b64_tr_b16 v[72:73], v226 offset:57344
    v_mfma_f32_16x16x32_bf16 v[12:15], v[36:39], v[196:199], v[12:15]
    ds_read_b64_tr_b16 v[74:75], v226 offset:59392
    buffer_load_dwordx4 v230, s[12:15], s27 offen offset:1024 lds
    s_add_u32 s27, s27, 131072
    v_mfma_f32_16x16x32_bf16 v[16:19], v[40:43], v[192:195], v[16:19]
    ds_read_b64_tr_b16 v[76:77], v227 offset:57344
    ds_read_b64_tr_b16 v[78:79], v227 offset:59392
    v_mfma_f32_16x16x32_bf16 v[20:23], v[40:43], v[196:199], v[20:23]
    ds_read_b64_tr_b16 v[80:81], v224 offset:61440
    v_mfma_f32_16x16x32_bf16 v[24:27], v[44:47], v[192:195], v[24:27]
    buffer_load_dwordx4 v[112:115], v228, s[8:11], s26 offen offset:0 sc1
    ds_read_b64_tr_b16 v[82:83], v224 offset:63488
    v_mfma_f32_16x16x32_bf16 v[28:31], v[44:47], v[196:199], v[28:31]
    ds_read_b64_tr_b16 v[84:85], v225 offset:61440
    ds_read_b64_tr_b16 v[86:87], v225 offset:63488
    v_mfma_f32_16x16x32_bf16 v[0:3], v[48:51], v[200:203], v[0:3]
    buffer_load_dwordx4 v[116:119], v228, s[8:11], s26 offen offset:1024 sc1
    ds_read_b64_tr_b16 v[88:89], v226 offset:61440
    v_mfma_f32_16x16x32_bf16 v[4:7], v[48:51], v[204:207], v[4:7]
    ds_read_b64_tr_b16 v[90:91], v226 offset:63488
    ds_read_b64_tr_b16 v[92:93], v227 offset:61440
    v_mfma_f32_16x16x32_bf16 v[8:11], v[52:55], v[200:203], v[8:11]
    buffer_load_dwordx4 v[120:123], v228, s[8:11], s26 offen offset:2048 sc1
    ds_read_b64_tr_b16 v[94:95], v227 offset:63488
    v_mfma_f32_16x16x32_bf16 v[12:15], v[52:55], v[204:207], v[12:15]
    buffer_load_dwordx4 v[124:127], v228, s[8:11], s26 offen offset:3072 sc1
    s_add_u32 s26, s26, 4096
    v_mfma_f32_16x16x32_bf16 v[16:19], v[56:59], v[200:203], v[16:19]
    v_mfma_f32_16x16x32_bf16 v[20:23], v[56:59], v[204:207], v[20:23]
    ds_read_b32 v249, v247
    v_mfma_f32_16x16x32_bf16 v[24:27], v[60:63], v[200:203], v[24:27]
    v_mfma_f32_16x16x32_bf16 v[28:31], v[60:63], v[204:207], v[28:31]
    s_waitcnt vmcnt(12)
    s_waitcnt lgkmcnt(0)
    v_cmp_gt_u32 vcc, s88, v249
    s_cbranch_vccnz spin_187
ok_188:
    s_add_u32 s88, s88, 1
    ds_add_u32 v246, v248
    v_mfma_f32_16x16x32_bf16 v[0:3], v[64:67], v[208:211], v[0:3]
    ds_read_b64_tr_b16 v[32:33], v224 offset:0
    ds_read_b64_tr_b16 v[34:35], v224 offset:2048
    v_mfma_f32_16x16x32_bf16 v[4:7], v[64:67], v[212:215], v[4:7]
    ds_read_b64_tr_b16 v[36:37], v225 offset:0
    buffer_load_dwordx4 v[128:131], v228, s[8:11], s26 offen offset:0 sc1
    v_mfma_f32_16x16x32_bf16 v[8:11], v[68:71], v[208:211], v[8:11]
    ds_read_b64_tr_b16 v[38:39], v225 offset:2048
    v_mfma_f32_16x16x32_bf16 v[12:15], v[68:71], v[212:215], v[12:15]
    ds_read_b64_tr_b16 v[40:41], v226 offset:0
    ds_read_b64_tr_b16 v[42:43], v226 offset:2048
    v_mfma_f32_16x16x32_bf16 v[16:19], v[72:75], v[208:211], v[16:19]
    buffer_load_dwordx4 v[132:135], v228, s[8:11], s26 offen offset:1024 sc1
    ds_read_b64_tr_b16 v[44:45], v227 offset:0
    v_mfma_f32_16x16x32_bf16 v[20:23], v[72:75], v[212:215], v[20:23]
    ds_read_b64_tr_b16 v[46:47], v227 offset:2048
    v_mfma_f32_16x16x32_bf16 v[24:27], v[76:79], v[208:211], v[24:27]
    ds_read_b64_tr_b16 v[48:49], v224 offset:4096
    buffer_load_dwordx4 v[136:139], v228, s[8:11], s26 offen offset:2048 sc1
    v_mfma_f32_16x16x32_bf16 v[28:31], v[76:79], v[212:215], v[28:31]
    ds_read_b64_tr_b16 v[50:51], v224 offset:6144
    ds_read_b64_tr_b16 v[52:53], v225 offset:4096
    v_mfma_f32_16x16x32_bf16 v[0:3], v[80:83], v[216:219], v[0:3]
    ds_read_b64_tr_b16 v[54:55], v225 offset:6144
    v_mfma_f32_16x16x32_bf16 v[4:7], v[80:83], v[220:223], v[4:7]
    buffer_load_dwordx4 v[140:143], v228, s[8:11], s26 offen offset:3072 sc1
    s_add_u32 s26, s26, 4096
    ds_read_b64_tr_b16 v[56:57], v226 offset:4096
    v_mfma_f32_16x16x32_bf16 v[8:11], v[84:87], v[216:219], v[8:11]
    ds_read_b64_tr_b16 v[58:59], v226 offset:6144
    ds_read_b64_tr_b16 v[60:61], v227 offset:4096
    v_mfma_f32_16x16x32_bf16 v[12:15], v[84:87], v[220:223], v[12:15]
    ds_read_b64_tr_b16 v[62:63], v227 offset:6144
    v_mfma_f32_16x16x32_bf16 v[16:19], v[88:91], v[216:219], v[16:19]
    v_mfma_f32_16x16x32_bf16 v[20:23], v[88:91], v[220:223], v[20:23]
    ds_read_b32 v249, v247
    v_mfma_f32_16x16x32_bf16 v[24:27], v[92:95], v[216:219], v[24:27]
    v_mfma_f32_16x16x32_bf16 v[28:31], v[92:95], v[220:223], v[28:31]
    s_waitcnt vmcnt(10)
    s_waitcnt lgkmcnt(0)
    v_cmp_gt_u32 vcc, s88, v249
    s_cbranch_vccnz spin_189
ok_190:
    s_add_u32 s88, s88, 1
    ds_add_u32 v246, v248
    v_mfma_f32_16x16x32_bf16 v[0:3], v[32:35], v[96:99], v[0:3]
    ds_read_b64_tr_b16 v[64:65], v224 offset:8192
    ds_read_b64_tr_b16 v[66:67], v224 offset:10240
    v_mfma_f32_16x16x32_bf16 v[4:7], v[32:35], v[100:103], v[4:7]
    ds_read_b64_tr_b16 v[68:69], v225 offset:8192
    buffer_load_dwordx4 v[144:147], v228, s[8:11], s26 offen offset:0 sc1
    v_mfma_f32_16x16x32_bf16 v[8:11], v[36:39], v[96:99], v[8:11]
    ds_read_b64_tr_b16 v[70:71], v225 offset:10240
    v_mfma_f32_16x16x32_bf16 v[12:15], v[36:39], v[100:103], v[12:15]
    ds_read_b64_tr_b16 v[72:73], v226 offset:8192
    ds_read_b64_tr_b16 v[74:75], v226 offset:10240
    v_mfma_f32_16x16x32_bf16 v[16:19], v[40:43], v[96:99], v[16:19]
    buffer_load_dwordx4 v[148:151], v228, s[8:11], s26 offen offset:1024 sc1
    ds_read_b64_tr_b16 v[76:77], v227 offset:8192
    v_mfma_f32_16x16x32_bf16 v[20:23], v[40:43], v[100:103], v[20:23]
    ds_read_b64_tr_b16 v[78:79], v227 offset:10240
    v_mfma_f32_16x16x32_bf16 v[24:27], v[44:47], v[96:99], v[24:27]
    ds_read_b64_tr_b16 v[80:81], v224 offset:12288
    buffer_load_dwordx4 v[152:155], v228, s[8:11], s26 offen offset:2048 sc1
    v_mfma_f32_16x16x32_bf16 v[28:31], v[44:47], v[100:103], v[28:31]
    ds_read_b64_tr_b16 v[82:83], v224 offset:14336
    ds_read_b64_tr_b16 v[84:85], v225 offset:12288
    v_mfma_f32_16x16x32_bf16 v[0:3], v[48:51], v[104:107], v[0:3]
    ds_read_b64_tr_b16 v[86:87], v225 offset:14336
    v_mfma_f32_16x16x32_bf16 v[4:7], v[48:51], v[108:111], v[4:7]
    buffer_load_dwordx4 v[156:159], v228, s[8:11], s26 offen offset:3072 sc1
    s_add_u32 s26, s26, 4096
    ds_read_b64_tr_b16 v[88:89], v226 offset:12288
    v_mfma_f32_16x16x32_bf16 v[8:11], v[52:55], v[104:107], v[8:11]
    ds_read_b64_tr_b16 v[90:91], v226 offset:14336
    ds_read_b64_tr_b16 v[92:93], v227 offset:12288
    v_mfma_f32_16x16x32_bf16 v[12:15], v[52:55], v[108:111], v[12:15]
    ds_read_b64_tr_b16 v[94:95], v227 offset:14336
    v_mfma_f32_16x16x32_bf16 v[16:19], v[56:59], v[104:107], v[16:19]
    v_mfma_f32_16x16x32_bf16 v[20:23], v[56:59], v[108:111], v[20:23]
    ds_read_b32 v249, v247
    v_mfma_f32_16x16x32_bf16 v[24:27], v[60:63], v[104:107], v[24:27]
    v_mfma_f32_16x16x32_bf16 v[28:31], v[60:63], v[108:111], v[28:31]
    s_waitcnt vmcnt(8)
    s_waitcnt lgkmcnt(0)
    v_cmp_gt_u32 vcc, s88, v249
    s_cbranch_vccnz spin_191
ok_192:
    s_add_u32 s88, s88, 1
    ds_add_u32 v246, v248
    v_mfma_f32_16x16x32_bf16 v[0:3], v[64:67], v[112:115], v[0:3]
    ds_read_b64_tr_b16 v[32:33], v224 offset:16384
    ds_read_b64_tr_b16 v[34:35], v224 offset:18432
    v_mfma_f32_16x16x32_bf16 v[4:7], v[64:67], v[116:119], v[4:7]
    ds_read_b64_tr_b16 v[36:37], v225 offset:16384
    v_mfma_f32_16x16x32_bf16 v[8:11], v[68:71], v[112:115], v[8:11]
    ds_read_b64_tr_b16 v[38:39], v225 offset:18432
    v_mfma_f32_16x16x32_bf16 v[12:15], v[68:71], v[116:119], v[12:15]
    ds_read_b64_tr_b16 v[40:41], v226 offset:16384
    ds_read_b64_tr_b16 v[42:43], v226 offset:18432
    v_mfma_f32_16x16x32_bf16 v[16:19], v[72:75], v[112:115], v[16:19]
    ds_read_b64_tr_b16 v[44:45], v227 offset:16384
    v_mfma_f32_16x16x32_bf16 v[20:23], v[72:75], v[116:119], v[20:23]
    ds_read_b64_tr_b16 v[46:47], v227 offset:18432
    v_mfma_f32_16x16x32_bf16 v[24:27], v[76:79], v[112:115], v[24:27]
    ds_read_b64_tr_b16 v[48:49], v224 offset:20480
    ds_read_b64_tr_b16 v[50:51], v224 offset:22528
    v_mfma_f32_16x16x32_bf16 v[28:31], v[76:79], v[116:119], v[28:31]
    ds_read_b64_tr_b16 v[52:53], v225 offset:20480
    v_mfma_f32_16x16x32_bf16 v[0:3], v[80:83], v[120:123], v[0:3]
    ds_read_b64_tr_b16 v[54:55], v225 offset:22528
    v_mfma_f32_16x16x32_bf16 v[4:7], v[80:83], v[124:127], v[4:7]
    ds_read_b64_tr_b16 v[56:57], v226 offset:20480
    ds_read_b64_tr_b16 v[58:59], v226 offset:22528
    v_mfma_f32_16x16x32_bf16 v[8:11], v[84:87], v[120:123], v[8:11]
    ds_read_b64_tr_b16 v[60:61], v227 offset:20480
    v_mfma_f32_16x16x32_bf16 v[12:15], v[84:87], v[124:127], v[12:15]
    ds_read_b64_tr_b16 v[62:63], v227 offset:22528
    v_mfma_f32_16x16x32_bf16 v[16:19], v[88:91], v[120:123], v[16:19]
    v_mfma_f32_16x16x32_bf16 v[20:23], v[88:91], v[124:127], v[20:23]
    ds_read_b32 v249, v247
    v_mfma_f32_16x16x32_bf16 v[24:27], v[92:95], v[120:123], v[24:27]
    v_mfma_f32_16x16x32_bf16 v[28:31], v[92:95], v[124:127], v[28:31]
    s_waitcnt vmcnt(4)
    s_waitcnt lgkmcnt(0)
    v_cmp_gt_u32 vcc, s88, v249
    s_cbranch_vccnz spin_193
ok_194:
    s_add_u32 s88, s88, 1
    ds_add_u32 v246, v248
    v_mfma_f32_16x16x32_bf16 v[0:3], v[32:35], v[128:131], v[0:3]
    ds_read_b64_tr_b16 v[64:65], v224 offset:24576
    ds_read_b64_tr_b16 v[66:67], v224 offset:26624
    v_mfma_f32_16x16x32_bf16 v[4:7], v[32:35], v[132:135], v[4:7]
    ds_read_b64_tr_b16 v[68:69], v225 offset:24576
    v_mfma_f32_16x16x32_bf16 v[8:11], v[36:39], v[128:131], v[8:11]
    ds_read_b64_tr_b16 v[70:71], v225 offset:26624
    v_mfma_f32_16x16x32_bf16 v[12:15], v[36:39], v[132:135], v[12:15]
    ds_read_b64_tr_b16 v[72:73], v226 offset:24576
    ds_read_b64_tr_b16 v[74:75], v226 offset:26624
    v_mfma_f32_16x16x32_bf16 v[16:19], v[40:43], v[128:131], v[16:19]
    ds_read_b64_tr_b16 v[76:77], v227 offset:24576
    v_mfma_f32_16x16x32_bf16 v[20:23], v[40:43], v[132:135], v[20:23]
    ds_read_b64_tr_b16 v[78:79], v227 offset:26624
    v_mfma_f32_16x16x32_bf16 v[24:27], v[44:47], v[128:131], v[24:27]
    ds_read_b64_tr_b16 v[80:81], v224 offset:28672
    ds_read_b64_tr_b16 v[82:83], v224 offset:30720
    v_mfma_f32_16x16x32_bf16 v[28:31], v[44:47], v[132:135], v[28:31]
    ds_read_b64_tr_b16 v[84:85], v225 offset:28672
    v_mfma_f32_16x16x32_bf16 v[0:3], v[48:51], v[136:139], v[0:3]
    ds_read_b64_tr_b16 v[86:87], v225 offset:30720
    v_mfma_f32_16x16x32_bf16 v[4:7], v[48:51], v[140:143], v[4:7]
    ds_read_b64_tr_b16 v[88:89], v226 offset:28672
    ds_read_b64_tr_b16 v[90:91], v226 offset:30720
    v_mfma_f32_16x16x32_bf16 v[8:11], v[52:55], v[136:139], v[8:11]
    ds_read_b64_tr_b16 v[92:93], v227 offset:28672
    v_mfma_f32_16x16x32_bf16 v[12:15], v[52:55], v[140:143], v[12:15]
    ds_read_b64_tr_b16 v[94:95], v227 offset:30720
    v_mfma_f32_16x16x32_bf16 v[16:19], v[56:59], v[136:139], v[16:19]
    v_mfma_f32_16x16x32_bf16 v[20:23], v[56:59], v[140:143], v[20:23]
    ds_read_b32 v249, v247
    v_mfma_f32_16x16x32_bf16 v[24:27], v[60:63], v[136:139], v[24:27]
    v_mfma_f32_16x16x32_bf16 v[28:31], v[60:63], v[140:143], v[28:31]
    s_waitcnt vmcnt(0) lgkmcnt(0)
    v_mfma_f32_16x16x32_bf16 v[0:3], v[64:67], v[144:147], v[0:3]
    v_mfma_f32_16x16x32_bf16 v[4:7], v[64:67], v[148:151], v[4:7]
    v_mfma_f32_16x16x32_bf16 v[8:11], v[68:71], v[144:147], v[8:11]
    v_mfma_f32_16x16x32_bf16 v[12:15], v[68:71], v[148:151], v[12:15]
    v_mfma_f32_16x16x32_bf16 v[16:19], v[72:75], v[144:147], v[16:19]
    v_mfma_f32_16x16x32_bf16 v[20:23], v[72:75], v[148:151], v[20:23]
    v_mfma_f32_16x16x32_bf16 v[24:27], v[76:79], v[144:147], v[24:27]
    v_mfma_f32_16x16x32_bf16 v[28:31], v[76:79], v[148:151], v[28:31]
    v_mfma_f32_16x16x32_bf16 v[0:3], v[80:83], v[152:155], v[0:3]
    v_mfma_f32_16x16x32_bf16 v[4:7], v[80:83], v[156:159], v[4:7]
    v_mfma_f32_16x16x32_bf16 v[8:11], v[84:87], v[152:155], v[8:11]
    v_mfma_f32_16x16x32_bf16 v[12:15], v[84:87], v[156:159], v[12:15]
    v_mfma_f32_16x16x32_bf16 v[16:19], v[88:91], v[152:155], v[16:19]
    v_mfma_f32_16x16x32_bf16 v[20:23], v[88:91], v[156:159], v[20:23]
    v_mfma_f32_16x16x32_bf16 v[24:27], v[92:95], v[152:155], v[24:27]
    v_mfma_f32_16x16x32_bf16 v[28:31], v[92:95], v[156:159], v[28:31]
    v_mov_b32 v241, 161796
    v_mov_b32 v243, s31
    ds_write_b32 v241, v243
    s_mov_b32 s12, s44
    s_mov_b32 s13, s45
    s_mov_b32 s14, 0x400000
    s_mov_b32 s15, 0x00020000
    s_lshl_b32 s3, s21, 12
    v_add_u32 v103, s3, v245
    v_add_u32 v102, 131072, v103
    v_add_u32 v103, 16384, v103
    v_permlane16_swap_b32 v232, v234
    v_permlane16_swap_b32 v233, v235
    v_permlane16_swap_b32 v236, v238
    v_permlane16_swap_b32 v237, v239
    v_mov_b32 v96, 0xbfb8aa3b
    v_mov_b32 v97, 0xbfb8aa3b
    v_mov_b32 v98, 1.0
    v_mov_b32 v99, 1.0
.p2align 3
    v_pk_mul_f32 v[64:65], v[0:1], v[96:97]
    v_pk_mul_f32 v[66:67], v[2:3], v[96:97]
    v_pk_mul_f32 v[68:69], v[4:5], v[96:97]
    v_pk_mul_f32 v[70:71], v[6:7], v[96:97]
    v_pk_mul_f32 v[72:73], v[8:9], v[96:97]
    v_pk_mul_f32 v[74:75], v[10:11], v[96:97]
    v_pk_mul_f32 v[76:77], v[12:13], v[96:97]
    v_pk_mul_f32 v[78:79], v[14:15], v[96:97]
    v_exp_f32 v64, v64
    v_exp_f32 v65, v65
    v_exp_f32 v66, v66
    v_exp_f32 v67, v67
    v_exp_f32 v68, v68
    v_exp_f32 v69, v69
    v_exp_f32 v70, v70
    v_exp_f32 v71, v71
    v_exp_f32 v72, v72
    v_exp_f32 v73, v73
    v_exp_f32 v74, v74
    v_exp_f32 v75, v75
    v_exp_f32 v76, v76
    v_exp_f32 v77, v77
    v_exp_f32 v78, v78
    v_exp_f32 v79, v79
    v_pk_add_f32 v[64:65], v[64:65], v[98:99]
    v_pk_add_f32 v[66:67], v[66:67], v[98:99]
    v_pk_add_f32 v[68:69], v[68:69], v[98:99]
    v_pk_add_f32 v[70:71], v[70:71], v[98:99]
    v_pk_add_f32 v[72:73], v[72:73], v[98:99]
    v_pk_add_f32 v[74:75], v[74:75], v[98:99]
    v_pk_add_f32 v[76:77], v[76:77], v[98:99]
    v_pk_add_f32 v[78:79], v[78:79], v[98:99]
    v_rcp_f32 v64, v64
    v_rcp_f32 v65, v65
    v_rcp_f32 v66, v66
    v_rcp_f32 v67, v67
    v_rcp_f32 v68, v68
    v_rcp_f32 v69, v69
    v_rcp_f32 v70, v70
    v_rcp_f32 v71, v71
    v_rcp_f32 v72, v72
    v_rcp_f32 v73, v73
    v_rcp_f32 v74, v74
    v_rcp_f32 v75, v75
    v_rcp_f32 v76, v76
    v_rcp_f32 v77, v77
    v_rcp_f32 v78, v78
    v_rcp_f32 v79, v79
    v_pk_mul_f32 v[0:1], v[0:1], v[64:65]
    v_pk_mul_f32 v[2:3], v[2:3], v[66:67]
    v_pk_mul_f32 v[4:5], v[4:5], v[68:69]
    v_pk_mul_f32 v[6:7], v[6:7], v[70:71]
    v_pk_mul_f32 v[8:9], v[8:9], v[72:73]
    v_pk_mul_f32 v[10:11], v[10:11], v[74:75]
    v_pk_mul_f32 v[12:13], v[12:13], v[76:77]
    v_pk_mul_f32 v[14:15], v[14:15], v[78:79]
    ds_write_b128 v102, v[0:3] offset:0
    ds_write_b128 v102, v[4:7] offset:1024
    ds_write_b128 v102, v[8:11] offset:2048
    ds_write_b128 v102, v[12:15] offset:3072
.p2align 3
    v_pk_mul_f32 v[64:65], v[16:17], v[96:97]
    v_pk_mul_f32 v[66:67], v[18:19], v[96:97]
    v_pk_mul_f32 v[68:69], v[20:21], v[96:97]
    v_pk_mul_f32 v[70:71], v[22:23], v[96:97]
    v_pk_mul_f32 v[72:73], v[24:25], v[96:97]
    v_pk_mul_f32 v[74:75], v[26:27], v[96:97]
    v_pk_mul_f32 v[76:77], v[28:29], v[96:97]
    v_pk_mul_f32 v[78:79], v[30:31], v[96:97]
    v_exp_f32 v64, v64
    v_exp_f32 v65, v65
    v_exp_f32 v66, v66
    v_exp_f32 v67, v67
    v_exp_f32 v68, v68
    v_exp_f32 v69, v69
    v_exp_f32 v70, v70
    v_exp_f32 v71, v71
    v_exp_f32 v72, v72
    v_exp_f32 v73, v73
    v_exp_f32 v74, v74
    v_exp_f32 v75, v75
    v_exp_f32 v76, v76
    v_exp_f32 v77, v77
    v_exp_f32 v78, v78
    v_exp_f32 v79, v79
    v_pk_add_f32 v[64:65], v[64:65], v[98:99]
    v_pk_add_f32 v[66:67], v[66:67], v[98:99]
    v_pk_add_f32 v[68:69], v[68:69], v[98:99]
    v_pk_add_f32 v[70:71], v[70:71], v[98:99]
    v_pk_add_f32 v[72:73], v[72:73], v[98:99]
    v_pk_add_f32 v[74:75], v[74:75], v[98:99]
    v_pk_add_f32 v[76:77], v[76:77], v[98:99]
    v_pk_add_f32 v[78:79], v[78:79], v[98:99]
    v_rcp_f32 v64, v64
    v_rcp_f32 v65, v65
    v_rcp_f32 v66, v66
    v_rcp_f32 v67, v67
    v_rcp_f32 v68, v68
    v_rcp_f32 v69, v69
    v_rcp_f32 v70, v70
    v_rcp_f32 v71, v71
    v_rcp_f32 v72, v72
    v_rcp_f32 v73, v73
    v_rcp_f32 v74, v74
    v_rcp_f32 v75, v75
    v_rcp_f32 v76, v76
    v_rcp_f32 v77, v77
    v_rcp_f32 v78, v78
    v_rcp_f32 v79, v79
    v_pk_mul_f32 v[16:17], v[16:17], v[64:65]
    v_pk_mul_f32 v[18:19], v[18:19], v[66:67]
    v_pk_mul_f32 v[20:21], v[20:21], v[68:69]
    v_pk_mul_f32 v[22:23], v[22:23], v[70:71]
    v_pk_mul_f32 v[24:25], v[24:25], v[72:73]
    v_pk_mul_f32 v[26:27], v[26:27], v[74:75]
    v_pk_mul_f32 v[28:29], v[28:29], v[76:77]
    v_pk_mul_f32 v[30:31], v[30:31], v[78:79]
    v_lshlrev_b32 v64, 16, v232
    v_and_b32 v65, s89, v232
    v_lshlrev_b32 v66, 16, v233
    v_and_b32 v67, s89, v233
    v_lshlrev_b32 v68, 16, v236
    v_and_b32 v69, s89, v236
    v_lshlrev_b32 v70, 16, v237
    v_and_b32 v71, s89, v237
    v_lshlrev_b32 v72, 16, v234
    v_and_b32 v73, s89, v234
    v_lshlrev_b32 v74, 16, v235
    v_and_b32 v75, s89, v235
    v_lshlrev_b32 v76, 16, v238
    v_and_b32 v77, s89, v238
    v_lshlrev_b32 v78, 16, v239
    v_and_b32 v79, s89, v239
    s_waitcnt lgkmcnt(0)
    s_barrier
    ds_read_b128 v[32:35], v103 offset:0
    ds_read_b128 v[36:39], v103 offset:1024
    ds_read_b128 v[40:43], v103 offset:2048
    ds_read_b128 v[44:47], v103 offset:3072
    s_waitcnt lgkmcnt(0)
    v_pk_fma_f32 v[64:65], v[16:17], v[32:33], v[64:65]
    v_pk_fma_f32 v[66:67], v[18:19], v[34:35], v[66:67]
    v_pk_fma_f32 v[68:69], v[20:21], v[36:37], v[68:69]
    v_pk_fma_f32 v[70:71], v[22:23], v[38:39], v[70:71]
    v_pk_fma_f32 v[72:73], v[24:25], v[40:41], v[72:73]
    v_pk_fma_f32 v[74:75], v[26:27], v[42:43], v[74:75]
    v_pk_fma_f32 v[76:77], v[28:29], v[44:45], v[76:77]
    v_pk_fma_f32 v[78:79], v[30:31], v[46:47], v[78:79]
    v_cvt_pk_bf16_f32 v232, v64, v65
    v_cvt_pk_bf16_f32 v233, v66, v67
    v_cvt_pk_bf16_f32 v236, v68, v69
    v_cvt_pk_bf16_f32 v237, v70, v71
    v_cvt_pk_bf16_f32 v234, v72, v73
    v_cvt_pk_bf16_f32 v235, v74, v75
    v_cvt_pk_bf16_f32 v238, v76, v77
    v_cvt_pk_bf16_f32 v239, v78, v79
    s_nop 1
    v_permlane16_swap_b32 v232, v234
    v_permlane16_swap_b32 v233, v235
    buffer_store_dwordx4 v[232:235], v231, s[12:15], 0 offen
    v_permlane16_swap_b32 v236, v238
    v_permlane16_swap_b32 v237, v239
    buffer_store_dwordx4 v[236:239], v231, s[12:15], s41 offen
L_end:
    s_endpgm
nn_2:
    s_mov_b32 s97, 0x20000
nn_2b:
    s_sleep 4
    buffer_load_dword v243, v242, s[16:19], 0 offen sc1
    s_waitcnt vmcnt(0)
    s_memrealtime s[6:7]
    v_readfirstlane_b32 s31, v243
    s_waitcnt lgkmcnt(0)
    s_sub_u32 s3, s6, s31
    s_add_u32 s3, s3, 16
    s_cmp_lt_u32 s3, 4000
    s_cbranch_scc1 nnd_3
    s_sub_u32 s97, s97, 1
    s_cmp_eq_u32 s97, 0
    s_cbranch_scc1 nnd_3
    s_cmp_gt_u32 s97, 0x1fe00
    s_cbranch_scc1 nn_2b
    s_cmp_eq_u32 s31, 0
    s_cbranch_scc1 nn_2b
    s_branch nnd_3
cs_5:
    v_smfmac_f32_16x16x64_bf16 v[192:195], v[204:207], v[112:119], v208
    v_smfmac_f32_16x16x64_bf16 v[196:199], v[204:207], v[120:127], v208
    v_smfmac_f32_16x16x64_bf16 v[200:203], v[204:207], v[128:135], v208
    s_branch cs_5r
cs_6:
    v_smfmac_f32_16x16x64_bf16 v[192:195], v[204:207], v[152:159], v208
    v_smfmac_f32_16x16x64_bf16 v[196:199], v[204:207], v[160:167], v208
    v_smfmac_f32_16x16x64_bf16 v[200:203], v[204:207], v[168:175], v208
    s_bitcmp1_b32 s41, 0
    s_cbranch_scc0 cs_6r
    s_nop 7
    v_add_f32 v192, v192, v193
    v_add_f32 v194, v194, v195
    v_add_f32 v196, v196, v197
    v_add_f32 v198, v198, v199
    v_add_f32 v200, v200, v201
    v_add_f32 v202, v202, v203
    s_lshl_b32 s3, s25, 3
    s_add_u32 s3, s3, s22
    s_lshl_b32 s3, s3, 11
    v_mov_b32 v193, s31
    v_mov_b32 v195, s31
    v_mov_b32 v197, s31
    v_mov_b32 v199, s31
    v_mov_b32 v201, s31
    v_mov_b32 v203, s31
    s_mov_b64 exec, 0xffff
    buffer_store_dwordx4 v[192:195], v245, s[12:15], s3 offen offset:0 sc1
    buffer_store_dwordx4 v[196:199], v245, s[12:15], s3 offen offset:256 sc1
    buffer_store_dwordx4 v[200:203], v245, s[12:15], s3 offen offset:512 sc1
    s_mov_b64 exec, -1
    s_nop 0
    v_mov_b32 v192, 0
    v_mov_b32 v193, 0
    v_mov_b32 v194, 0
    v_mov_b32 v195, 0
    v_mov_b32 v196, 0
    v_mov_b32 v197, 0
    v_mov_b32 v198, 0
    v_mov_b32 v199, 0
    v_mov_b32 v200, 0
    v_mov_b32 v201, 0
    v_mov_b32 v202, 0
    v_mov_b32 v203, 0
    s_branch cs_6r
rs_17:
    s_mov_b32 s97, 0x20000
rs_17b:
    s_sleep 2
    buffer_load_dwordx4 v[186:189], v245, s[16:19], s39 offen sc1
    s_sub_u32 s97, s97, 1
    s_cmp_eq_u32 s97, 0
    s_cbranch_scc1 rs_17t
    s_waitcnt vmcnt(0)
    v_cmp_ne_u32 vcc, s31, v187
    v_cmp_ne_u32 s[40:41], s31, v189
    s_nop 0
    s_or_b64 vcc, vcc, s[40:41]
    s_cbranch_vccnz rs_17b
rs_17t:
    s_waitcnt vmcnt(0)
    s_branch rs_17r
spin_19:
    s_mov_b32 s97, 0x400000
spin_19b:
    ds_read_b32 v249, v247
    s_sub_u32 s97, s97, 1
    s_cmp_eq_u32 s97, 0
    s_cbranch_scc1 ok_20
    s_waitcnt lgkmcnt(0)
    v_cmp_gt_u32 vcc, s88, v249
    s_cbranch_vccnz spin_19b
    s_branch ok_20
kp_22:
    s_cmp_lg_u32 s21, 0
    s_cbranch_scc1 kp_22r
    v_and_b32 v244, 7, v250
    v_lshlrev_b32 v244, 7, v244
    s_mov_b32 s97, 0x20000
gp_7023:
    buffer_load_dword v242, v244, s[32:35], s43 offen sc1
    s_waitcnt vmcnt(0) lgkmcnt(0)
    v_cmp_ne_u32 vcc, s31, v242
    s_cbranch_vccz gpd_7024
    s_sleep 4
    s_sub_u32 s97, s97, 1
    s_cmp_lg_u32 s97, 0
    s_cbranch_scc1 gp_7023
gpd_7024:
    s_branch kp_22r
spin_23:
    s_mov_b32 s97, 0x400000
spin_23b:
    ds_read_b32 v249, v247
    s_sub_u32 s97, s97, 1
    s_cmp_eq_u32 s97, 0
    s_cbranch_scc1 ok_24
    s_waitcnt lgkmcnt(0)
    v_cmp_gt_u32 vcc, s88, v249
    s_cbranch_vccnz spin_23b
    s_branch ok_24
spin_25:
    s_mov_b32 s97, 0x400000
spin_25b:
    ds_read_b32 v249, v247
    s_sub_u32 s97, s97, 1
    s_cmp_eq_u32 s97, 0
    s_cbranch_scc1 ok_26
    s_waitcnt lgkmcnt(0)
    v_cmp_gt_u32 vcc, s88, v249
    s_cbranch_vccnz spin_25b
    s_branch ok_26
spin_27:
    s_mov_b32 s97, 0x400000
spin_27b:
    ds_read_b32 v249, v247
    s_sub_u32 s97, s97, 1
    s_cmp_eq_u32 s97, 0
    s_cbranch_scc1 ok_28
    s_waitcnt lgkmcnt(0)
    v_cmp_gt_u32 vcc, s88, v249
    s_cbranch_vccnz spin_27b
    s_branch ok_28
slow_30:
    v_mov_b32 v0, 0
    v_mov_b32 v1, 0
    v_mov_b32 v2, 0
    v_mov_b32 v3, 0
    v_mov_b32 v4, 0
    v_mov_b32 v5, 0
    v_mov_b32 v6, 0
    v_mov_b32 v7, 0
    v_mov_b32 v8, 0
    v_mov_b32 v9, 0
    v_mov_b32 v10, 0
    v_mov_b32 v11, 0
    v_mov_b32 v12, 0
    v_mov_b32 v13, 0
    v_mov_b32 v14, 0
    v_mov_b32 v15, 0
    v_mov_b32 v16, 0
    v_mov_b32 v17, 0
    v_mov_b32 v18, 0
    v_mov_b32 v19, 0
    v_mov_b32 v20, 0
    v_mov_b32 v21, 0
    v_mov_b32 v22, 0
    v_mov_b32 v23, 0
    v_mov_b32 v24, 0
    v_mov_b32 v25, 0
    v_mov_b32 v26, 0
    v_mov_b32 v27, 0
    v_mov_b32 v28, 0
    v_mov_b32 v29, 0
    v_mov_b32 v30, 0
    v_mov_b32 v31, 0
    v_mov_b32 v148, 0
    v_mov_b32 v152, 0xff61b1e6
    v_mov_b32 v149, 0
    v_mov_b32 v153, 0xff61b1e6
    v_mov_b32 v150, 0
    v_mov_b32 v154, 0xff61b1e6
    v_mov_b32 v151, 0
    v_mov_b32 v155, 0xff61b1e6
    s_lshl_b32 s26, s25, 17
    s_add_u32 s27, s26, 4194304
    s_mov_b32 s29, 64
sl_9001:
    buffer_load_dwordx4 v[112:115], v245, s[8:11], s26 offen sc1
    buffer_load_dwordx4 v[116:119], v245, s[8:11], s26 offen offset:1024 sc1
    buffer_load_dwordx4 v[120:123], v245, s[8:11], s27 offen sc1
    buffer_load_dwordx4 v[124:127], v245, s[8:11], s27 offen offset:1024 sc1
    s_add_u32 s26, s26, 2048
    s_add_u32 s27, s27, 2048
    s_waitcnt vmcnt(0)
    v_mfma_f32_16x16x32_bf16 v[32:35], v[112:115], v[96:99], 0
    v_mfma_f32_16x16x32_bf16 v[36:39], v[116:119], v[96:99], 0
    v_mfma_f32_16x16x32_bf16 v[40:43], v[112:115], v[100:103], 0
    v_mfma_f32_16x16x32_bf16 v[44:47], v[116:119], v[100:103], 0
    s_nop 7
    v_max3_f32 v158, v32, v33, v152
    v_max3_f32 v158, v34, v35, v158
    v_max3_f32 v158, v36, v37, v158
    v_max3_f32 v158, v38, v39, v158
    v_max3_f32 v159, v40, v41, v153
    v_max3_f32 v159, v42, v43, v159
    v_max3_f32 v159, v44, v45, v159
    v_max3_f32 v159, v46, v47, v159
    v_mov_b32 v160, v158
    v_mov_b32 v161, v159
    s_nop 1
    v_permlane16_swap_b32 v158, v160
    v_permlane16_swap_b32 v159, v161
    v_max_f32 v158, v158, v160
    v_max_f32 v159, v159, v161
    v_mov_b32 v160, v158
    v_mov_b32 v161, v159
    s_nop 1
    v_permlane32_swap_b32 v158, v160
    v_permlane32_swap_b32 v159, v161
    v_max_f32 v158, v158, v160
    v_max_f32 v159, v159, v161
    v_sub_f32 v156, v152, v158
    v_exp_f32 v156, v156
    v_mov_b32 v152, v158
    v_sub_f32 v157, v153, v159
    v_exp_f32 v157, v157
    v_mov_b32 v153, v159
    v_sub_f32 v32, v32, v158
    v_sub_f32 v33, v33, v158
    v_sub_f32 v34, v34, v158
    v_sub_f32 v35, v35, v158
    v_sub_f32 v36, v36, v158
    v_sub_f32 v37, v37, v158
    v_sub_f32 v38, v38, v158
    v_sub_f32 v39, v39, v158
    v_sub_f32 v40, v40, v159
    v_sub_f32 v41, v41, v159
    v_sub_f32 v42, v42, v159
    v_sub_f32 v43, v43, v159
    v_sub_f32 v44, v44, v159
    v_sub_f32 v45, v45, v159
    v_sub_f32 v46, v46, v159
    v_sub_f32 v47, v47, v159
    v_exp_f32 v32, v32
    v_exp_f32 v33, v33
    v_exp_f32 v34, v34
    v_exp_f32 v35, v35
    v_exp_f32 v36, v36
    v_exp_f32 v37, v37
    v_exp_f32 v38, v38
    v_exp_f32 v39, v39
    v_exp_f32 v40, v40
    v_exp_f32 v41, v41
    v_exp_f32 v42, v42
    v_exp_f32 v43, v43
    v_exp_f32 v44, v44
    v_exp_f32 v45, v45
    v_exp_f32 v46, v46
    v_exp_f32 v47, v47
    v_mul_f32 v148, v148, v156
    v_mul_f32 v149, v149, v157
    v_mul_f32 v0, v0, v156
    v_mul_f32 v1, v1, v156
    v_mul_f32 v2, v2, v156
    v_mul_f32 v3, v3, v156
    v_mul_f32 v4, v4, v156
    v_mul_f32 v5, v5, v156
    v_mul_f32 v6, v6, v156
    v_mul_f32 v7, v7, v156
    v_mul_f32 v8, v8, v157
    v_mul_f32 v9, v9, v157
    v_mul_f32 v10, v10, v157
    v_mul_f32 v11, v11, v157
    v_mul_f32 v12, v12, v157
    v_mul_f32 v13, v13, v157
    v_mul_f32 v14, v14, v157
    v_mul_f32 v15, v15, v157
    v_add_f32 v148, v148, v32
    v_add_f32 v148, v148, v33
    v_add_f32 v148, v148, v34
    v_add_f32 v148, v148, v35
    v_add_f32 v148, v148, v36
    v_add_f32 v148, v148, v37
    v_add_f32 v148, v148, v38
    v_add_f32 v148, v148, v39
    v_add_f32 v149, v149, v40
    v_add_f32 v149, v149, v41
    v_add_f32 v149, v149, v42
    v_add_f32 v149, v149, v43
    v_add_f32 v149, v149, v44
    v_add_f32 v149, v149, v45
    v_add_f32 v149, v149, v46
    v_add_f32 v149, v149, v47
    v_cvt_pk_bf16_f32 v64, v32, v33
    v_cvt_pk_bf16_f32 v65, v34, v35
    v_cvt_pk_bf16_f32 v66, v36, v37
    v_cvt_pk_bf16_f32 v67, v38, v39
    v_cvt_pk_bf16_f32 v68, v40, v41
    v_cvt_pk_bf16_f32 v69, v42, v43
    v_cvt_pk_bf16_f32 v70, v44, v45
    v_cvt_pk_bf16_f32 v71, v46, v47
    s_nop 1
    v_mfma_f32_16x16x32_bf16 v[0:3], v[120:123], v[64:67], v[0:3]
    v_mfma_f32_16x16x32_bf16 v[4:7], v[124:127], v[64:67], v[4:7]
    v_mfma_f32_16x16x32_bf16 v[8:11], v[120:123], v[68:71], v[8:11]
    v_mfma_f32_16x16x32_bf16 v[12:15], v[124:127], v[68:71], v[12:15]
    v_mfma_f32_16x16x32_bf16 v[32:35], v[112:115], v[104:107], 0
    v_mfma_f32_16x16x32_bf16 v[36:39], v[116:119], v[104:107], 0
    v_mfma_f32_16x16x32_bf16 v[40:43], v[112:115], v[108:111], 0
    v_mfma_f32_16x16x32_bf16 v[44:47], v[116:119], v[108:111], 0
    s_nop 7
    v_max3_f32 v158, v32, v33, v154
    v_max3_f32 v158, v34, v35, v158
    v_max3_f32 v158, v36, v37, v158
    v_max3_f32 v158, v38, v39, v158
    v_max3_f32 v159, v40, v41, v155
    v_max3_f32 v159, v42, v43, v159
    v_max3_f32 v159, v44, v45, v159
    v_max3_f32 v159, v46, v47, v159
    v_mov_b32 v160, v158
    v_mov_b32 v161, v159
    s_nop 1
    v_permlane16_swap_b32 v158, v160
    v_permlane16_swap_b32 v159, v161
    v_max_f32 v158, v158, v160
    v_max_f32 v159, v159, v161
    v_mov_b32 v160, v158
    v_mov_b32 v161, v159
    s_nop 1
    v_permlane32_swap_b32 v158, v160
    v_permlane32_swap_b32 v159, v161
    v_max_f32 v158, v158, v160
    v_max_f32 v159, v159, v161
    v_sub_f32 v156, v154, v158
    v_exp_f32 v156, v156
    v_mov_b32 v154, v158
    v_sub_f32 v157, v155, v159
    v_exp_f32 v157, v157
    v_mov_b32 v155, v159
    v_sub_f32 v32, v32, v158
    v_sub_f32 v33, v33, v158
    v_sub_f32 v34, v34, v158
    v_sub_f32 v35, v35, v158
    v_sub_f32 v36, v36, v158
    v_sub_f32 v37, v37, v158
    v_sub_f32 v38, v38, v158
    v_sub_f32 v39, v39, v158
    v_sub_f32 v40, v40, v159
    v_sub_f32 v41, v41, v159
    v_sub_f32 v42, v42, v159
    v_sub_f32 v43, v43, v159
    v_sub_f32 v44, v44, v159
    v_sub_f32 v45, v45, v159
    v_sub_f32 v46, v46, v159
    v_sub_f32 v47, v47, v159
    v_exp_f32 v32, v32
    v_exp_f32 v33, v33
    v_exp_f32 v34, v34
    v_exp_f32 v35, v35
    v_exp_f32 v36, v36
    v_exp_f32 v37, v37
    v_exp_f32 v38, v38
    v_exp_f32 v39, v39
    v_exp_f32 v40, v40
    v_exp_f32 v41, v41
    v_exp_f32 v42, v42
    v_exp_f32 v43, v43
    v_exp_f32 v44, v44
    v_exp_f32 v45, v45
    v_exp_f32 v46, v46
    v_exp_f32 v47, v47
    v_mul_f32 v150, v150, v156
    v_mul_f32 v151, v151, v157
    v_mul_f32 v16, v16, v156
    v_mul_f32 v17, v17, v156
    v_mul_f32 v18, v18, v156
    v_mul_f32 v19, v19, v156
    v_mul_f32 v20, v20, v156
    v_mul_f32 v21, v21, v156
    v_mul_f32 v22, v22, v156
    v_mul_f32 v23, v23, v156
    v_mul_f32 v24, v24, v157
    v_mul_f32 v25, v25, v157
    v_mul_f32 v26, v26, v157
    v_mul_f32 v27, v27, v157
    v_mul_f32 v28, v28, v157
    v_mul_f32 v29, v29, v157
    v_mul_f32 v30, v30, v157
    v_mul_f32 v31, v31, v157
    v_add_f32 v150, v150, v32
    v_add_f32 v150, v150, v33
    v_add_f32 v150, v150, v34
    v_add_f32 v150, v150, v35
    v_add_f32 v150, v150, v36
    v_add_f32 v150, v150, v37
    v_add_f32 v150, v150, v38
    v_add_f32 v150, v150, v39
    v_add_f32 v151, v151, v40
    v_add_f32 v151, v151, v41
    v_add_f32 v151, v151, v42
    v_add_f32 v151, v151, v43
    v_add_f32 v151, v151, v44
    v_add_f32 v151, v151, v45
    v_add_f32 v151, v151, v46
    v_add_f32 v151, v151, v47
    v_cvt_pk_bf16_f32 v64, v32, v33
    v_cvt_pk_bf16_f32 v65, v34, v35
    v_cvt_pk_bf16_f32 v66, v36, v37
    v_cvt_pk_bf16_f32 v67, v38, v39
    v_cvt_pk_bf16_f32 v68, v40, v41
    v_cvt_pk_bf16_f32 v69, v42, v43
    v_cvt_pk_bf16_f32 v70, v44, v45
    v_cvt_pk_bf16_f32 v71, v46, v47
    s_nop 1
    v_mfma_f32_16x16x32_bf16 v[16:19], v[120:123], v[64:67], v[16:19]
    v_mfma_f32_16x16x32_bf16 v[20:23], v[124:127], v[64:67], v[20:23]
    v_mfma_f32_16x16x32_bf16 v[24:27], v[120:123], v[68:71], v[24:27]
    v_mfma_f32_16x16x32_bf16 v[28:31], v[124:127], v[68:71], v[28:31]
    s_sub_u32 s29, s29, 1
    s_cmp_lg_u32 s29, 0
    s_nop 3
    s_cbranch_scc1 sl_9001
    s_nop 3
    v_mov_b32 v152, v148
    v_mov_b32 v153, v149
    v_mov_b32 v154, v150
    v_mov_b32 v155, v151
    s_nop 1
    v_permlane16_swap_b32 v148, v152
    v_permlane16_swap_b32 v149, v153
    v_permlane16_swap_b32 v150, v154
    v_permlane16_swap_b32 v151, v155
    v_add_f32 v148, v148, v152
    v_add_f32 v149, v149, v153
    v_add_f32 v150, v150, v154
    v_add_f32 v151, v151, v155
    v_mov_b32 v152, v148
    v_mov_b32 v153, v149
    v_mov_b32 v154, v150
    v_mov_b32 v155, v151
    s_nop 1
    v_permlane32_swap_b32 v148, v152
    v_permlane32_swap_b32 v149, v153
    v_permlane32_swap_b32 v150, v154
    v_permlane32_swap_b32 v151, v155
    v_add_f32 v148, v148, v152
    v_add_f32 v149, v149, v153
    v_add_f32 v150, v150, v154
    v_add_f32 v151, v151, v155
    s_branch fin_31
spin_33:
    s_mov_b32 s97, 0x400000
spin_33b:
    ds_read_b32 v249, v247
    s_sub_u32 s97, s97, 1
    s_cmp_eq_u32 s97, 0
    s_cbranch_scc1 ok_34
    s_waitcnt lgkmcnt(0)
    v_cmp_gt_u32 vcc, s88, v249
    s_cbranch_vccnz spin_33b
    s_branch ok_34
spin_36:
    s_mov_b32 s97, 0x400000
spin_36b:
    s_sleep 2
    ds_read_b32 v249, v244
    s_sub_u32 s97, s97, 1
    s_cmp_eq_u32 s97, 0
    s_cbranch_scc1 ok_37
    s_waitcnt lgkmcnt(0)
    v_cmp_gt_u32 vcc, 35, v249
    s_cbranch_vccnz spin_36b
    s_branch ok_37
spin_40:
    s_mov_b32 s97, 0x400000
spin_40b:
    s_sleep 2
    ds_read_b32 v249, v247
    s_sub_u32 s97, s97, 1
    s_cmp_eq_u32 s97, 0
    s_cbranch_scc1 ok_41
    s_waitcnt lgkmcnt(0)
    v_cmp_gt_u32 vcc, s88, v249
    s_cbranch_vccnz spin_40b
    s_branch ok_41
spin_42:
    s_mov_b32 s97, 0x400000
spin_42b:
    ds_read_b32 v249, v247
    s_sub_u32 s97, s97, 1
    s_cmp_eq_u32 s97, 0
    s_cbranch_scc1 ok_43
    s_waitcnt lgkmcnt(0)
    v_cmp_gt_u32 vcc, s88, v249
    s_cbranch_vccnz spin_42b
    s_branch ok_43
spin_44:
    s_mov_b32 s97, 0x400000
spin_44b:
    ds_read_b32 v249, v247
    s_sub_u32 s97, s97, 1
    s_cmp_eq_u32 s97, 0
    s_cbranch_scc1 ok_45
    s_waitcnt lgkmcnt(0)
    v_cmp_gt_u32 vcc, s88, v249
    s_cbranch_vccnz spin_44b
    s_branch ok_45
spin_46:
    s_mov_b32 s97, 0x400000
spin_46b:
    ds_read_b32 v249, v247
    s_sub_u32 s97, s97, 1
    s_cmp_eq_u32 s97, 0
    s_cbranch_scc1 ok_47
    s_waitcnt lgkmcnt(0)
    v_cmp_gt_u32 vcc, s88, v249
    s_cbranch_vccnz spin_46b
    s_branch ok_47
spin_48:
    s_mov_b32 s97, 0x400000
spin_48b:
    ds_read_b32 v249, v247
    s_sub_u32 s97, s97, 1
    s_cmp_eq_u32 s97, 0
    s_cbranch_scc1 ok_49
    s_waitcnt lgkmcnt(0)
    v_cmp_gt_u32 vcc, s88, v249
    s_cbranch_vccnz spin_48b
    s_branch ok_49
spin_50:
    s_mov_b32 s97, 0x400000
spin_50b:
    ds_read_b32 v249, v247
    s_sub_u32 s97, s97, 1
    s_cmp_eq_u32 s97, 0
    s_cbranch_scc1 ok_51
    s_waitcnt lgkmcnt(0)
    v_cmp_gt_u32 vcc, s88, v249
    s_cbranch_vccnz spin_50b
    s_branch ok_51
spin_52:
    s_mov_b32 s97, 0x400000
spin_52b:
    ds_read_b32 v249, v247
    s_sub_u32 s97, s97, 1
    s_cmp_eq_u32 s97, 0
    s_cbranch_scc1 ok_53
    s_waitcnt lgkmcnt(0)
    v_cmp_gt_u32 vcc, s88, v249
    s_cbranch_vccnz spin_52b
    s_branch ok_53
spin_54:
    s_mov_b32 s97, 0x400000
spin_54b:
    ds_read_b32 v249, v247
    s_sub_u32 s97, s97, 1
    s_cmp_eq_u32 s97, 0
    s_cbranch_scc1 ok_55
    s_waitcnt lgkmcnt(0)
    v_cmp_gt_u32 vcc, s88, v249
    s_cbranch_vccnz spin_54b
    s_branch ok_55
spin_56:
    s_mov_b32 s97, 0x400000
spin_56b:
    ds_read_b32 v249, v247
    s_sub_u32 s97, s97, 1
    s_cmp_eq_u32 s97, 0
    s_cbranch_scc1 ok_57
    s_waitcnt lgkmcnt(0)
    v_cmp_gt_u32 vcc, s88, v249
    s_cbranch_vccnz spin_56b
    s_branch ok_57
spin_58:
    s_mov_b32 s97, 0x400000
spin_58b:
    ds_read_b32 v249, v247
    s_sub_u32 s97, s97, 1
    s_cmp_eq_u32 s97, 0
    s_cbranch_scc1 ok_59
    s_waitcnt lgkmcnt(0)
    v_cmp_gt_u32 vcc, s88, v249
    s_cbranch_vccnz spin_58b
    s_branch ok_59
spin_60:
    s_mov_b32 s97, 0x400000
spin_60b:
    ds_read_b32 v249, v247
    s_sub_u32 s97, s97, 1
    s_cmp_eq_u32 s97, 0
    s_cbranch_scc1 ok_61
    s_waitcnt lgkmcnt(0)
    v_cmp_gt_u32 vcc, s88, v249
    s_cbranch_vccnz spin_60b
    s_branch ok_61
spin_62:
    s_mov_b32 s97, 0x400000
spin_62b:
    ds_read_b32 v249, v247
    s_sub_u32 s97, s97, 1
    s_cmp_eq_u32 s97, 0
    s_cbranch_scc1 ok_63
    s_waitcnt lgkmcnt(0)
    v_cmp_gt_u32 vcc, s88, v249
    s_cbranch_vccnz spin_62b
    s_branch ok_63
spin_64:
    s_mov_b32 s97, 0x400000
spin_64b:
    ds_read_b32 v249, v247
    s_sub_u32 s97, s97, 1
    s_cmp_eq_u32 s97, 0
    s_cbranch_scc1 ok_65
    s_waitcnt lgkmcnt(0)
    v_cmp_gt_u32 vcc, s88, v249
    s_cbranch_vccnz spin_64b
    s_branch ok_65
spin_66:
    s_mov_b32 s97, 0x400000
spin_66b:
    ds_read_b32 v249, v247
    s_sub_u32 s97, s97, 1
    s_cmp_eq_u32 s97, 0
    s_cbranch_scc1 ok_67
    s_waitcnt lgkmcnt(0)
    v_cmp_gt_u32 vcc, s88, v249
    s_cbranch_vccnz spin_66b
    s_branch ok_67
spin_68:
    s_mov_b32 s97, 0x400000
spin_68b:
    ds_read_b32 v249, v247
    s_sub_u32 s97, s97, 1
    s_cmp_eq_u32 s97, 0
    s_cbranch_scc1 ok_69
    s_waitcnt lgkmcnt(0)
    v_cmp_gt_u32 vcc, s88, v249
    s_cbranch_vccnz spin_68b
    s_branch ok_69
spin_70:
    s_mov_b32 s97, 0x400000
spin_70b:
    ds_read_b32 v249, v247
    s_sub_u32 s97, s97, 1
    s_cmp_eq_u32 s97, 0
    s_cbranch_scc1 ok_71
    s_waitcnt lgkmcnt(0)
    v_cmp_gt_u32 vcc, s88, v249
    s_cbranch_vccnz spin_70b
    s_branch ok_71
spin_72:
    s_mov_b32 s97, 0x400000
spin_72b:
    ds_read_b32 v249, v247
    s_sub_u32 s97, s97, 1
    s_cmp_eq_u32 s97, 0
    s_cbranch_scc1 ok_73
    s_waitcnt lgkmcnt(0)
    v_cmp_gt_u32 vcc, s88, v249
    s_cbranch_vccnz spin_72b
    s_branch ok_73
mw_77:
    buffer_load_dword v211, v210, s[16:19], s30 offen
    s_add_u32 s30, s30, 8192
    s_add_u32 s43, s43, 3
    s_branch mw_77r
w2_78:
    buffer_load_dword v213, v214, s[8:11], 0 offen
    buffer_load_dword v213, v215, s[8:11], 0 offen
    buffer_load_dword v213, v237, s[8:11], 0 offen
    s_branch w2_78r
cs_80:
    v_smfmac_f32_16x16x64_bf16 v[216:219], v[232:235], v[128:135], v236
    v_smfmac_f32_16x16x64_bf16 v[220:223], v[232:235], v[136:143], v236
    v_smfmac_f32_16x16x64_bf16 v[224:227], v[232:235], v[144:151], v236
    v_mfma_f32_16x16x32_bf16 v[228:231], v[232:235], v[152:155], v[228:231]
    s_branch cs_80r
cs_81:
    v_smfmac_f32_16x16x64_bf16 v[216:219], v[232:235], v[172:179], v236
    v_smfmac_f32_16x16x64_bf16 v[220:223], v[232:235], v[180:187], v236
    v_smfmac_f32_16x16x64_bf16 v[224:227], v[232:235], v[188:195], v236
    v_mfma_f32_16x16x32_bf16 v[228:231], v[232:235], v[196:199], v[228:231]
    s_bitcmp1_b32 s41, 0
    s_cbranch_scc0 cs_81r
    s_nop 7
    v_add_f32 v216, v216, v217
    v_add_f32 v218, v218, v219
    v_add_f32 v220, v220, v221
    v_add_f32 v222, v222, v223
    v_add_f32 v224, v224, v225
    v_add_f32 v226, v226, v227
    v_add_f32 v228, v228, v230
    s_lshl_b32 s3, s25, 3
    s_add_u32 s3, s3, s22
    s_lshl_b32 s3, s3, 11
    v_mov_b32 v217, s31
    v_mov_b32 v219, s31
    v_mov_b32 v221, s31
    v_mov_b32 v223, s31
    v_mov_b32 v225, s31
    v_mov_b32 v227, s31
    v_mov_b32 v229, s31
    v_mov_b32 v231, s31
    s_mov_b64 exec, 0xffff
    buffer_store_dwordx4 v[216:219], v245, s[12:15], s3 offen offset:1024 sc1
    buffer_store_dwordx4 v[220:223], v245, s[12:15], s3 offen offset:1280 sc1
    buffer_store_dwordx4 v[224:227], v245, s[12:15], s3 offen offset:1536 sc1
    buffer_store_dwordx4 v[228:231], v245, s[12:15], s3 offen offset:1792 sc1
    s_mov_b64 exec, -1
    s_nop 0
    v_mov_b32 v216, 0
    v_mov_b32 v217, 0
    v_mov_b32 v218, 0
    v_mov_b32 v219, 0
    v_mov_b32 v220, 0
    v_mov_b32 v221, 0
    v_mov_b32 v222, 0
    v_mov_b32 v223, 0
    v_mov_b32 v224, 0
    v_mov_b32 v225, 0
    v_mov_b32 v226, 0
    v_mov_b32 v227, 0
    v_mov_b32 v228, 0
    v_mov_b32 v229, 0
    v_mov_b32 v230, 0
    v_mov_b32 v231, 0
    s_branch cs_81r
rs_90:
    s_mov_b32 s97, 0x20000
rs_90b:
    s_sleep 2
    buffer_load_dwordx4 v[212:215], v245, s[16:19], s39 offen sc1
    s_sub_u32 s97, s97, 1
    s_cmp_eq_u32 s97, 0
    s_cbranch_scc1 rs_90t
    s_waitcnt vmcnt(0)
    v_cmp_ne_u32 vcc, s31, v213
    v_cmp_ne_u32 s[40:41], s31, v215
    s_nop 0
    s_or_b64 vcc, vcc, s[40:41]
    s_cbranch_vccnz rs_90b
rs_90t:
    s_waitcnt vmcnt(0)
    s_branch rs_90r
z2_91x:
    s_add_u32 s12, s4, 0x1000000
    s_addc_u32 s13, s5, 0
    s_mov_b32 s14, 0x700000
    s_mov_b32 s15, 0x00020000
    s_lshl_b32 s3, s23, 6
    s_lshl_b32 s6, s22, 3
    s_add_u32 s3, s3, s6
    s_lshl_b32 s6, s21, 1
    s_add_u32 s3, s3, s6
    s_lshl_b32 s3, s3, 1
    s_add_u32 s3, s3, s24
    s_mul_i32 s3, s3, 7168
    v_add_u32 v130, s3, v245
    v_add_u32 v131, 14336, v130
    s_cmp_eq_u32 s24, 1
    s_cbranch_scc1 z1h_94
    v_cvt_pk_bf16_f32 v136, v0, v1
    v_cvt_pk_bf16_f32 v137, v2, v3
    v_cvt_pk_bf16_f32 v138, v4, v5
    v_cvt_pk_bf16_f32 v139, v6, v7
    buffer_store_dwordx4 v[136:139], v130, s[12:15], 0 offen offset:0 sc1
    v_cvt_pk_bf16_f32 v140, v28, v29
    v_cvt_pk_bf16_f32 v141, v30, v31
    v_cvt_pk_bf16_f32 v142, v32, v33
    v_cvt_pk_bf16_f32 v143, v34, v35
    buffer_store_dwordx4 v[140:143], v130, s[12:15], 0 offen offset:1024 sc1
    v_cvt_pk_bf16_f32 v144, v8, v9
    v_cvt_pk_bf16_f32 v145, v10, v11
    v_cvt_pk_bf16_f32 v146, v12, v13
    v_cvt_pk_bf16_f32 v147, v14, v15
    buffer_store_dwordx4 v[144:147], v130, s[12:15], 0 offen offset:2048 sc1
    v_cvt_pk_bf16_f32 v148, v36, v37
    v_cvt_pk_bf16_f32 v149, v38, v39
    v_cvt_pk_bf16_f32 v150, v40, v41
    v_cvt_pk_bf16_f32 v151, v42, v43
    buffer_store_dwordx4 v[148:151], v130, s[12:15], 0 offen offset:3072 sc1
    v_cvt_pk_bf16_f32 v136, v16, v17
    v_cvt_pk_bf16_f32 v137, v18, v19
    v_cvt_pk_bf16_f32 v138, v20, v21
    v_cvt_pk_bf16_f32 v139, v22, v23
    buffer_store_dwordx4 v[136:139], v130, s[12:15], s16 offen offset:0 sc1
    v_cvt_pk_bf16_f32 v140, v44, v45
    v_cvt_pk_bf16_f32 v141, v46, v47
    v_cvt_pk_bf16_f32 v142, v48, v49
    v_cvt_pk_bf16_f32 v143, v50, v51
    buffer_store_dwordx4 v[140:143], v130, s[12:15], s16 offen offset:1024 sc1
    v_cvt_pk_bf16_f32 v144, v24, v25
    v_cvt_pk_bf16_f32 v145, v26, v27
    v_cvt_pk_bf16_f32 v146, v52, v53
    v_cvt_pk_bf16_f32 v147, v54, v55
    buffer_store_dwordx4 v[144:147], v130, s[12:15], s16 offen offset:2048 sc1
    v_cvt_pk_bf16_f32 v148, v56, v57
    v_cvt_pk_bf16_f32 v149, v58, v59
    v_cvt_pk_bf16_f32 v150, v60, v61
    v_cvt_pk_bf16_f32 v151, v62, v63
    buffer_store_dwordx4 v[148:151], v131, s[12:15], 0 offen offset:0 sc1
    v_cvt_pk_bf16_f32 v136, v84, v85
    v_cvt_pk_bf16_f32 v137, v86, v87
    v_cvt_pk_bf16_f32 v138, v88, v89
    v_cvt_pk_bf16_f32 v139, v90, v91
    buffer_store_dwordx4 v[136:139], v131, s[12:15], 0 offen offset:1024 sc1
    v_cvt_pk_bf16_f32 v140, v64, v65
    v_cvt_pk_bf16_f32 v141, v66, v67
    v_cvt_pk_bf16_f32 v142, v68, v69
    v_cvt_pk_bf16_f32 v143, v70, v71
    buffer_store_dwordx4 v[140:143], v131, s[12:15], 0 offen offset:2048 sc1
    v_cvt_pk_bf16_f32 v144, v92, v93
    v_cvt_pk_bf16_f32 v145, v94, v95
    v_cvt_pk_bf16_f32 v146, v96, v97
    v_cvt_pk_bf16_f32 v147, v98, v99
    buffer_store_dwordx4 v[144:147], v131, s[12:15], 0 offen offset:3072 sc1
    v_cvt_pk_bf16_f32 v148, v72, v73
    v_cvt_pk_bf16_f32 v149, v74, v75
    v_cvt_pk_bf16_f32 v150, v76, v77
    v_cvt_pk_bf16_f32 v151, v78, v79
    buffer_store_dwordx4 v[148:151], v131, s[12:15], s16 offen offset:0 sc1
    v_cvt_pk_bf16_f32 v136, v100, v101
    v_cvt_pk_bf16_f32 v137, v102, v103
    v_cvt_pk_bf16_f32 v138, v104, v105
    v_cvt_pk_bf16_f32 v139, v106, v107
    buffer_store_dwordx4 v[136:139], v131, s[12:15], s16 offen offset:1024 sc1
    v_cvt_pk_bf16_f32 v140, v80, v81
    v_cvt_pk_bf16_f32 v141, v82, v83
    v_cvt_pk_bf16_f32 v142, v108, v109
    v_cvt_pk_bf16_f32 v143, v110, v111
    buffer_store_dwordx4 v[140:143], v131, s[12:15], s16 offen offset:2048 sc1
    s_branch eB_93
z1h_94:
    v_cvt_pk_bf16_f32 v136, v4, v5
    v_cvt_pk_bf16_f32 v137, v6, v7
    v_cvt_pk_bf16_f32 v138, v8, v9
    v_cvt_pk_bf16_f32 v139, v10, v11
    buffer_store_dwordx4 v[136:139], v130, s[12:15], 0 offen offset:0 sc1
    v_cvt_pk_bf16_f32 v140, v32, v33
    v_cvt_pk_bf16_f32 v141, v34, v35
    v_cvt_pk_bf16_f32 v142, v36, v37
    v_cvt_pk_bf16_f32 v143, v38, v39
    buffer_store_dwordx4 v[140:143], v130, s[12:15], 0 offen offset:1024 sc1
    v_cvt_pk_bf16_f32 v144, v12, v13
    v_cvt_pk_bf16_f32 v145, v14, v15
    v_cvt_pk_bf16_f32 v146, v16, v17
    v_cvt_pk_bf16_f32 v147, v18, v19
    buffer_store_dwordx4 v[144:147], v130, s[12:15], 0 offen offset:2048 sc1
    v_cvt_pk_bf16_f32 v148, v40, v41
    v_cvt_pk_bf16_f32 v149, v42, v43
    v_cvt_pk_bf16_f32 v150, v44, v45
    v_cvt_pk_bf16_f32 v151, v46, v47
    buffer_store_dwordx4 v[148:151], v130, s[12:15], 0 offen offset:3072 sc1
    v_cvt_pk_bf16_f32 v136, v20, v21
    v_cvt_pk_bf16_f32 v137, v22, v23
    v_cvt_pk_bf16_f32 v138, v24, v25
    v_cvt_pk_bf16_f32 v139, v26, v27
    buffer_store_dwordx4 v[136:139], v130, s[12:15], s16 offen offset:0 sc1
    v_cvt_pk_bf16_f32 v140, v48, v49
    v_cvt_pk_bf16_f32 v141, v50, v51
    v_cvt_pk_bf16_f32 v142, v52, v53
    v_cvt_pk_bf16_f32 v143, v54, v55
    buffer_store_dwordx4 v[140:143], v130, s[12:15], s16 offen offset:1024 sc1
    v_cvt_pk_bf16_f32 v144, v0, v1
    v_cvt_pk_bf16_f32 v145, v2, v3
    v_cvt_pk_bf16_f32 v146, v28, v29
    v_cvt_pk_bf16_f32 v147, v30, v31
    buffer_store_dwordx4 v[144:147], v130, s[12:15], s16 offen offset:2048 sc1
    v_cvt_pk_bf16_f32 v148, v60, v61
    v_cvt_pk_bf16_f32 v149, v62, v63
    v_cvt_pk_bf16_f32 v150, v64, v65
    v_cvt_pk_bf16_f32 v151, v66, v67
    buffer_store_dwordx4 v[148:151], v131, s[12:15], 0 offen offset:0 sc1
    v_cvt_pk_bf16_f32 v136, v88, v89
    v_cvt_pk_bf16_f32 v137, v90, v91
    v_cvt_pk_bf16_f32 v138, v92, v93
    v_cvt_pk_bf16_f32 v139, v94, v95
    buffer_store_dwordx4 v[136:139], v131, s[12:15], 0 offen offset:1024 sc1
    v_cvt_pk_bf16_f32 v140, v68, v69
    v_cvt_pk_bf16_f32 v141, v70, v71
    v_cvt_pk_bf16_f32 v142, v72, v73
    v_cvt_pk_bf16_f32 v143, v74, v75
    buffer_store_dwordx4 v[140:143], v131, s[12:15], 0 offen offset:2048 sc1
    v_cvt_pk_bf16_f32 v144, v96, v97
    v_cvt_pk_bf16_f32 v145, v98, v99
    v_cvt_pk_bf16_f32 v146, v100, v101
    v_cvt_pk_bf16_f32 v147, v102, v103
    buffer_store_dwordx4 v[144:147], v131, s[12:15], 0 offen offset:3072 sc1
    v_cvt_pk_bf16_f32 v148, v76, v77
    v_cvt_pk_bf16_f32 v149, v78, v79
    v_cvt_pk_bf16_f32 v150, v80, v81
    v_cvt_pk_bf16_f32 v151, v82, v83
    buffer_store_dwordx4 v[148:151], v131, s[12:15], s16 offen offset:0 sc1
    v_cvt_pk_bf16_f32 v136, v104, v105
    v_cvt_pk_bf16_f32 v137, v106, v107
    v_cvt_pk_bf16_f32 v138, v108, v109
    v_cvt_pk_bf16_f32 v139, v110, v111
    buffer_store_dwordx4 v[136:139], v131, s[12:15], s16 offen offset:1024 sc1
    v_cvt_pk_bf16_f32 v140, v56, v57
    v_cvt_pk_bf16_f32 v141, v58, v59
    v_cvt_pk_bf16_f32 v142, v84, v85
    v_cvt_pk_bf16_f32 v143, v86, v87
    buffer_store_dwordx4 v[140:143], v131, s[12:15], s16 offen offset:2048 sc1
    s_branch eB_93
spin_98:
    s_mov_b32 s97, 0x400000
spin_98b:
    ds_read_b32 v249, v247
    s_sub_u32 s97, s97, 1
    s_cmp_eq_u32 s97, 0
    s_cbranch_scc1 ok_99
    s_waitcnt lgkmcnt(0)
    v_cmp_gt_u32 vcc, s88, v249
    s_cbranch_vccnz spin_98b
    s_branch ok_99
spin_103:
    s_mov_b32 s97, 0x400000
spin_103b:
    s_sleep 2
    ds_read_b32 v249, v247
    s_sub_u32 s97, s97, 1
    s_cmp_eq_u32 s97, 0
    s_cbranch_scc1 ok_104
    s_waitcnt lgkmcnt(0)
    v_cmp_gt_u32 vcc, s88, v249
    s_cbranch_vccnz spin_103b
    s_branch ok_104
spin_105:
    s_mov_b32 s97, 0x400000
spin_105b:
    ds_read_b32 v249, v247
    s_sub_u32 s97, s97, 1
    s_cmp_eq_u32 s97, 0
    s_cbranch_scc1 ok_106
    s_waitcnt lgkmcnt(0)
    v_cmp_gt_u32 vcc, s88, v249
    s_cbranch_vccnz spin_105b
    s_branch ok_106
spin_107:
    s_mov_b32 s97, 0x400000
spin_107b:
    ds_read_b32 v249, v247
    s_sub_u32 s97, s97, 1
    s_cmp_eq_u32 s97, 0
    s_cbranch_scc1 ok_108
    s_waitcnt lgkmcnt(0)
    v_cmp_gt_u32 vcc, s88, v249
    s_cbranch_vccnz spin_107b
    s_branch ok_108
spin_109:
    s_mov_b32 s97, 0x400000
spin_109b:
    ds_read_b32 v249, v247
    s_sub_u32 s97, s97, 1
    s_cmp_eq_u32 s97, 0
    s_cbranch_scc1 ok_110
    s_waitcnt lgkmcnt(0)
    v_cmp_gt_u32 vcc, s88, v249
    s_cbranch_vccnz spin_109b
    s_branch ok_110
spin_112:
    s_mov_b32 s97, 0x400000
spin_112b:
    ds_read_b32 v249, v247
    s_sub_u32 s97, s97, 1
    s_cmp_eq_u32 s97, 0
    s_cbranch_scc1 ok_113
    s_waitcnt lgkmcnt(0)
    v_cmp_gt_u32 vcc, s88, v249
    s_cbranch_vccnz spin_112b
    s_branch ok_113
spin_114:
    s_mov_b32 s97, 0x400000
spin_114b:
    ds_read_b32 v249, v247
    s_sub_u32 s97, s97, 1
    s_cmp_eq_u32 s97, 0
    s_cbranch_scc1 ok_115
    s_waitcnt lgkmcnt(0)
    v_cmp_gt_u32 vcc, s88, v249
    s_cbranch_vccnz spin_114b
    s_branch ok_115
spin_116:
    s_mov_b32 s97, 0x400000
spin_116b:
    ds_read_b32 v249, v247
    s_sub_u32 s97, s97, 1
    s_cmp_eq_u32 s97, 0
    s_cbranch_scc1 ok_117
    s_waitcnt lgkmcnt(0)
    v_cmp_gt_u32 vcc, s88, v249
    s_cbranch_vccnz spin_116b
    s_branch ok_117
spin_118:
    s_mov_b32 s97, 0x400000
spin_118b:
    ds_read_b32 v249, v247
    s_sub_u32 s97, s97, 1
    s_cmp_eq_u32 s97, 0
    s_cbranch_scc1 ok_119
    s_waitcnt lgkmcnt(0)
    v_cmp_gt_u32 vcc, s88, v249
    s_cbranch_vccnz spin_118b
    s_branch ok_119
spin_120:
    s_mov_b32 s97, 0x400000
spin_120b:
    ds_read_b32 v249, v247
    s_sub_u32 s97, s97, 1
    s_cmp_eq_u32 s97, 0
    s_cbranch_scc1 ok_121
    s_waitcnt lgkmcnt(0)
    v_cmp_gt_u32 vcc, s88, v249
    s_cbranch_vccnz spin_120b
    s_branch ok_121
spin_122:
    s_mov_b32 s97, 0x400000
spin_122b:
    ds_read_b32 v249, v247
    s_sub_u32 s97, s97, 1
    s_cmp_eq_u32 s97, 0
    s_cbranch_scc1 ok_123
    s_waitcnt lgkmcnt(0)
    v_cmp_gt_u32 vcc, s88, v249
    s_cbranch_vccnz spin_122b
    s_branch ok_123
spin_124:
    s_mov_b32 s97, 0x400000
spin_124b:
    ds_read_b32 v249, v247
    s_sub_u32 s97, s97, 1
    s_cmp_eq_u32 s97, 0
    s_cbranch_scc1 ok_125
    s_waitcnt lgkmcnt(0)
    v_cmp_gt_u32 vcc, s88, v249
    s_cbranch_vccnz spin_124b
    s_branch ok_125
spin_126:
    s_mov_b32 s97, 0x400000
spin_126b:
    ds_read_b32 v249, v247
    s_sub_u32 s97, s97, 1
    s_cmp_eq_u32 s97, 0
    s_cbranch_scc1 ok_127
    s_waitcnt lgkmcnt(0)
    v_cmp_gt_u32 vcc, s88, v249
    s_cbranch_vccnz spin_126b
    s_branch ok_127
spin_128:
    s_mov_b32 s97, 0x400000
spin_128b:
    ds_read_b32 v249, v247
    s_sub_u32 s97, s97, 1
    s_cmp_eq_u32 s97, 0
    s_cbranch_scc1 ok_129
    s_waitcnt lgkmcnt(0)
    v_cmp_gt_u32 vcc, s88, v249
    s_cbranch_vccnz spin_128b
    s_branch ok_129
spin_130:
    s_mov_b32 s97, 0x400000
spin_130b:
    ds_read_b32 v249, v247
    s_sub_u32 s97, s97, 1
    s_cmp_eq_u32 s97, 0
    s_cbranch_scc1 ok_131
    s_waitcnt lgkmcnt(0)
    v_cmp_gt_u32 vcc, s88, v249
    s_cbranch_vccnz spin_130b
    s_branch ok_131
spin_132:
    s_mov_b32 s97, 0x400000
spin_132b:
    ds_read_b32 v249, v247
    s_sub_u32 s97, s97, 1
    s_cmp_eq_u32 s97, 0
    s_cbranch_scc1 ok_133
    s_waitcnt lgkmcnt(0)
    v_cmp_gt_u32 vcc, s88, v249
    s_cbranch_vccnz spin_132b
    s_branch ok_133
spin_134:
    s_mov_b32 s97, 0x400000
spin_134b:
    ds_read_b32 v249, v247
    s_sub_u32 s97, s97, 1
    s_cmp_eq_u32 s97, 0
    s_cbranch_scc1 ok_135
    s_waitcnt lgkmcnt(0)
    v_cmp_gt_u32 vcc, s88, v249
    s_cbranch_vccnz spin_134b
    s_branch ok_135
spin_136:
    s_mov_b32 s97, 0x400000
spin_136b:
    ds_read_b32 v249, v247
    s_sub_u32 s97, s97, 1
    s_cmp_eq_u32 s97, 0
    s_cbranch_scc1 ok_137
    s_waitcnt lgkmcnt(0)
    v_cmp_gt_u32 vcc, s88, v249
    s_cbranch_vccnz spin_136b
    s_branch ok_137
spin_138:
    s_mov_b32 s97, 0x400000
spin_138b:
    ds_read_b32 v249, v247
    s_sub_u32 s97, s97, 1
    s_cmp_eq_u32 s97, 0
    s_cbranch_scc1 ok_139
    s_waitcnt lgkmcnt(0)
    v_cmp_gt_u32 vcc, s88, v249
    s_cbranch_vccnz spin_138b
    s_branch ok_139
spin_140:
    s_mov_b32 s97, 0x400000
spin_140b:
    ds_read_b32 v249, v247
    s_sub_u32 s97, s97, 1
    s_cmp_eq_u32 s97, 0
    s_cbranch_scc1 ok_141
    s_waitcnt lgkmcnt(0)
    v_cmp_gt_u32 vcc, s88, v249
    s_cbranch_vccnz spin_140b
    s_branch ok_141
spin_142:
    s_mov_b32 s97, 0x400000
spin_142b:
    ds_read_b32 v249, v247
    s_sub_u32 s97, s97, 1
    s_cmp_eq_u32 s97, 0
    s_cbranch_scc1 ok_143
    s_waitcnt lgkmcnt(0)
    v_cmp_gt_u32 vcc, s88, v249
    s_cbranch_vccnz spin_142b
    s_branch ok_143
spin_144:
    s_mov_b32 s97, 0x400000
spin_144b:
    ds_read_b32 v249, v247
    s_sub_u32 s97, s97, 1
    s_cmp_eq_u32 s97, 0
    s_cbranch_scc1 ok_145
    s_waitcnt lgkmcnt(0)
    v_cmp_gt_u32 vcc, s88, v249
    s_cbranch_vccnz spin_144b
    s_branch ok_145
spin_147:
    s_mov_b32 s97, 0x400000
spin_147b:
    ds_read_b32 v249, v247
    s_sub_u32 s97, s97, 1
    s_cmp_eq_u32 s97, 0
    s_cbranch_scc1 ok_148
    s_waitcnt lgkmcnt(0)
    v_cmp_gt_u32 vcc, s88, v249
    s_cbranch_vccnz spin_147b
    s_branch ok_148
spin_152:
    s_mov_b32 s97, 0x400000
spin_152b:
    s_sleep 2
    ds_read_b32 v249, v247
    s_sub_u32 s97, s97, 1
    s_cmp_eq_u32 s97, 0
    s_cbranch_scc1 ok_153
    s_waitcnt lgkmcnt(0)
    v_cmp_gt_u32 vcc, s88, v249
    s_cbranch_vccnz spin_152b
    s_branch ok_153
spin_154:
    s_mov_b32 s97, 0x400000
spin_154b:
    ds_read_b32 v249, v247
    s_sub_u32 s97, s97, 1
    s_cmp_eq_u32 s97, 0
    s_cbranch_scc1 ok_155
    s_waitcnt lgkmcnt(0)
    v_cmp_gt_u32 vcc, s88, v249
    s_cbranch_vccnz spin_154b
    s_branch ok_155
spin_156:
    s_mov_b32 s97, 0x400000
spin_156b:
    ds_read_b32 v249, v247
    s_sub_u32 s97, s97, 1
    s_cmp_eq_u32 s97, 0
    s_cbranch_scc1 ok_157
    s_waitcnt lgkmcnt(0)
    v_cmp_gt_u32 vcc, s88, v249
    s_cbranch_vccnz spin_156b
    s_branch ok_157
spin_158:
    s_mov_b32 s97, 0x400000
spin_158b:
    ds_read_b32 v249, v247
    s_sub_u32 s97, s97, 1
    s_cmp_eq_u32 s97, 0
    s_cbranch_scc1 ok_159
    s_waitcnt lgkmcnt(0)
    v_cmp_gt_u32 vcc, s88, v249
    s_cbranch_vccnz spin_158b
    s_branch ok_159
spin_160:
    s_mov_b32 s97, 0x400000
spin_160b:
    ds_read_b32 v249, v247
    s_sub_u32 s97, s97, 1
    s_cmp_eq_u32 s97, 0
    s_cbranch_scc1 ok_161
    s_waitcnt lgkmcnt(0)
    v_cmp_gt_u32 vcc, s88, v249
    s_cbranch_vccnz spin_160b
    s_branch ok_161
spin_162:
    s_mov_b32 s97, 0x400000
spin_162b:
    ds_read_b32 v249, v247
    s_sub_u32 s97, s97, 1
    s_cmp_eq_u32 s97, 0
    s_cbranch_scc1 ok_163
    s_waitcnt lgkmcnt(0)
    v_cmp_gt_u32 vcc, s88, v249
    s_cbranch_vccnz spin_162b
    s_branch ok_163
spin_164:
    s_mov_b32 s97, 0x400000
spin_164b:
    ds_read_b32 v249, v247
    s_sub_u32 s97, s97, 1
    s_cmp_eq_u32 s97, 0
    s_cbranch_scc1 ok_165
    s_waitcnt lgkmcnt(0)
    v_cmp_gt_u32 vcc, s88, v249
    s_cbranch_vccnz spin_164b
    s_branch ok_165
spin_167:
    s_mov_b32 s97, 0x400000
spin_167b:
    ds_read_b32 v249, v247
    s_sub_u32 s97, s97, 1
    s_cmp_eq_u32 s97, 0
    s_cbranch_scc1 ok_168
    s_waitcnt lgkmcnt(0)
    v_cmp_gt_u32 vcc, s88, v249
    s_cbranch_vccnz spin_167b
    s_branch ok_168
spin_169:
    s_mov_b32 s97, 0x400000
spin_169b:
    ds_read_b32 v249, v247
    s_sub_u32 s97, s97, 1
    s_cmp_eq_u32 s97, 0
    s_cbranch_scc1 ok_170
    s_waitcnt lgkmcnt(0)
    v_cmp_gt_u32 vcc, s88, v249
    s_cbranch_vccnz spin_169b
    s_branch ok_170
spin_171:
    s_mov_b32 s97, 0x400000
spin_171b:
    ds_read_b32 v249, v247
    s_sub_u32 s97, s97, 1
    s_cmp_eq_u32 s97, 0
    s_cbranch_scc1 ok_172
    s_waitcnt lgkmcnt(0)
    v_cmp_gt_u32 vcc, s88, v249
    s_cbranch_vccnz spin_171b
    s_branch ok_172
spin_173:
    s_mov_b32 s97, 0x400000
spin_173b:
    ds_read_b32 v249, v247
    s_sub_u32 s97, s97, 1
    s_cmp_eq_u32 s97, 0
    s_cbranch_scc1 ok_174
    s_waitcnt lgkmcnt(0)
    v_cmp_gt_u32 vcc, s88, v249
    s_cbranch_vccnz spin_173b
    s_branch ok_174
spin_175:
    s_mov_b32 s97, 0x400000
spin_175b:
    ds_read_b32 v249, v247
    s_sub_u32 s97, s97, 1
    s_cmp_eq_u32 s97, 0
    s_cbranch_scc1 ok_176
    s_waitcnt lgkmcnt(0)
    v_cmp_gt_u32 vcc, s88, v249
    s_cbranch_vccnz spin_175b
    s_branch ok_176
spin_177:
    s_mov_b32 s97, 0x400000
spin_177b:
    ds_read_b32 v249, v247
    s_sub_u32 s97, s97, 1
    s_cmp_eq_u32 s97, 0
    s_cbranch_scc1 ok_178
    s_waitcnt lgkmcnt(0)
    v_cmp_gt_u32 vcc, s88, v249
    s_cbranch_vccnz spin_177b
    s_branch ok_178
spin_179:
    s_mov_b32 s97, 0x400000
spin_179b:
    ds_read_b32 v249, v247
    s_sub_u32 s97, s97, 1
    s_cmp_eq_u32 s97, 0
    s_cbranch_scc1 ok_180
    s_waitcnt lgkmcnt(0)
    v_cmp_gt_u32 vcc, s88, v249
    s_cbranch_vccnz spin_179b
    s_branch ok_180
spin_181:
    s_mov_b32 s97, 0x400000
spin_181b:
    ds_read_b32 v249, v247
    s_sub_u32 s97, s97, 1
    s_cmp_eq_u32 s97, 0
    s_cbranch_scc1 ok_182
    s_waitcnt lgkmcnt(0)
    v_cmp_gt_u32 vcc, s88, v249
    s_cbranch_vccnz spin_181b
    s_branch ok_182
spin_183:
    s_mov_b32 s97, 0x400000
spin_183b:
    ds_read_b32 v249, v247
    s_sub_u32 s97, s97, 1
    s_cmp_eq_u32 s97, 0
    s_cbranch_scc1 ok_184
    s_waitcnt lgkmcnt(0)
    v_cmp_gt_u32 vcc, s88, v249
    s_cbranch_vccnz spin_183b
    s_branch ok_184
spin_185:
    s_mov_b32 s97, 0x400000
spin_185b:
    ds_read_b32 v249, v247
    s_sub_u32 s97, s97, 1
    s_cmp_eq_u32 s97, 0
    s_cbranch_scc1 ok_186
    s_waitcnt lgkmcnt(0)
    v_cmp_gt_u32 vcc, s88, v249
    s_cbranch_vccnz spin_185b
    s_branch ok_186
spin_187:
    s_mov_b32 s97, 0x400000
spin_187b:
    ds_read_b32 v249, v247
    s_sub_u32 s97, s97, 1
    s_cmp_eq_u32 s97, 0
    s_cbranch_scc1 ok_188
    s_waitcnt lgkmcnt(0)
    v_cmp_gt_u32 vcc, s88, v249
    s_cbranch_vccnz spin_187b
    s_branch ok_188
spin_189:
    s_mov_b32 s97, 0x400000
spin_189b:
    ds_read_b32 v249, v247
    s_sub_u32 s97, s97, 1
    s_cmp_eq_u32 s97, 0
    s_cbranch_scc1 ok_190
    s_waitcnt lgkmcnt(0)
    v_cmp_gt_u32 vcc, s88, v249
    s_cbranch_vccnz spin_189b
    s_branch ok_190
spin_191:
    s_mov_b32 s97, 0x400000
spin_191b:
    ds_read_b32 v249, v247
    s_sub_u32 s97, s97, 1
    s_cmp_eq_u32 s97, 0
    s_cbranch_scc1 ok_192
    s_waitcnt lgkmcnt(0)
    v_cmp_gt_u32 vcc, s88, v249
    s_cbranch_vccnz spin_191b
    s_branch ok_192
spin_193:
    s_mov_b32 s97, 0x400000
spin_193b:
    ds_read_b32 v249, v247
    s_sub_u32 s97, s97, 1
    s_cmp_eq_u32 s97, 0
    s_cbranch_scc1 ok_194
    s_waitcnt lgkmcnt(0)
    v_cmp_gt_u32 vcc, s88, v249
    s_cbranch_vccnz spin_193b
    s_branch ok_194
L_codeend:
.section .rodata,"a"
.p2align 6
.amdhsa_kernel recurrent_scan__mha_block__mixer_gmlp__prompt_kernel
  .amdhsa_next_free_vgpr 256
  .amdhsa_next_free_sgpr 102
  .amdhsa_accum_offset 256
  .amdhsa_group_segment_fixed_size 0
  .amdhsa_kernarg_size 88
  .amdhsa_user_sgpr_count 2
  .amdhsa_user_sgpr_kernarg_segment_ptr 1
  .amdhsa_system_sgpr_workgroup_id_x 1
  .amdhsa_float_denorm_mode_32 3
.end_amdhsa_kernel
.text
```
